```python
import torch

def _softmax(x, axis=-1):
    return torch.softmax(x, dim=axis)

def _gelu(x):
    return torch.nn.functional.gelu(x, approximate='tanh')

def _silu(x):
    return torch.nn.functional.silu(x)

def _sigmoid(x):
    return torch.sigmoid(x)

def _layernorm(x, axis=-1, eps=1e-05):
    m = x.mean(dim=axis, keepdim=True)
    v = x.var(dim=axis, keepdim=True, unbiased=False)
    return (x - m) / torch.sqrt(v + eps)

def _scatter_add(tgt, idx, src, axis=0):
    return tgt.clone().index_add_(axis, idx, src)

def _segment_sum(src, seg, n):
    out = torch.zeros((n,) + src.shape[1:], dtype=src.dtype)
    return out.index_add_(0, seg, src)

def _pad(x, pw):
    flat = tuple((v for pair in reversed(pw) for v in pair))
    return torch.nn.functional.pad(x, flat)
kernel_name = 'concat_heads__memory_aug_recurrent_mem_tr__memory_aug_recurrent_mem_tr__prompt'

def setup_inputs():

    _w = lambda a: (lambda t: t.to(torch.bfloat16) if t.is_floating_point() else t)(torch.as_tensor(a))

    def _A_setup():
        B, S, Dm = (1, 2048, 640)
        H, Dh = (32, 192)
        M, seg = (8, 32)
        seg = min(seg, S)
        S = S // seg * seg
        return {'x': _w((lambda *s: torch.randn(*s, dtype=torch.bfloat16) * 0.05)(B, S, Dm)), 'mem0': _w((lambda *s: torch.randn(*s, dtype=torch.bfloat16) * 0.4)(B, M, Dm)), 'Wq': _w((lambda *s: torch.randn(*s, dtype=torch.bfloat16) * 6.4)(Dm, H, Dh) * Dm ** (-0.5)), 'Wk': _w((lambda *s: torch.randn(*s, dtype=torch.bfloat16) * 6.4)(Dm, H, Dh) * Dm ** (-0.5)), 'Wv': _w((lambda *s: torch.randn(*s, dtype=torch.bfloat16) * 0.4)(Dm, H, Dh) * Dm ** (-0.5)), 'Wo': _w((lambda *s: torch.randn(*s, dtype=torch.bfloat16) * 0.4)(H, Dh, Dm) * (H * Dh) ** (-0.5)), 'seg_len': seg}
    _A_in = _A_setup()

    def _B_setup():
        B, S, Dm = (1, 2048, 640)
        H, Dh = (32, 192)
        M, seg = (8, 32)
        seg = min(seg, S)
        S = S // seg * seg
        return {'x': _w((lambda *s: torch.randn(*s, dtype=torch.bfloat16) * 0.05)(B, S, Dm)), 'mem0': _w((lambda *s: torch.randn(*s, dtype=torch.bfloat16) * 0.4)(B, M, Dm)), 'Wq': _w((lambda *s: torch.randn(*s, dtype=torch.bfloat16) * 6.4)(Dm, H, Dh) * Dm ** (-0.5)), 'Wk': _w((lambda *s: torch.randn(*s, dtype=torch.bfloat16) * 6.4)(Dm, H, Dh) * Dm ** (-0.5)), 'Wv': _w((lambda *s: torch.randn(*s, dtype=torch.bfloat16) * 0.4)(Dm, H, Dh) * Dm ** (-0.5)), 'Wo': _w((lambda *s: torch.randn(*s, dtype=torch.bfloat16) * 0.4)(H, Dh, Dm) * (H * Dh) ** (-0.5)), 'seg_len': seg}
    _B_in = _B_setup()
    return {'A_x': _A_in['x'], 'A_mem0': _A_in['mem0'], 'A_Wq': _A_in['Wq'], 'A_Wk': _A_in['Wk'], 'A_Wv': _A_in['Wv'], 'A_Wo': _A_in['Wo'], 'A_seg_len': _A_in['seg_len'], 'B_x': _B_in['x'], 'B_mem0': _B_in['mem0'], 'B_Wq': _B_in['Wq'], 'B_Wk': _B_in['Wk'], 'B_Wv': _B_in['Wv'], 'B_Wo': _B_in['Wo'], 'B_seg_len': _B_in['seg_len']}

def reference(A_x, A_mem0, A_Wq, A_Wk, A_Wv, A_Wo, A_seg_len, B_x, B_mem0, B_Wq, B_Wk, B_Wv, B_Wo, B_seg_len):

    def _A_ref(x, mem0, Wq, Wk, Wv, Wo, seg_len):
        B, S, Dm = x.shape
        H, Dh = (Wq.shape[1], Wq.shape[2])
        M = mem0.shape[1]
        scale = Dh ** (-0.5)
        n_seg = S // seg_len
        L = M + seg_len
        idx = torch.arange(L)
        mask = (idx[:, None] < M) | (idx[:, None] >= idx[None, :])
        mem = mem0
        outs = []
        for s in range(n_seg):
            xs = x[:, s * seg_len:(s + 1) * seg_len, :].clone()
            h = torch.concatenate([mem, xs], axis=1)
            q = torch.einsum('btd,dhe->bhte', h, Wq)
            k = torch.einsum('btd,dhe->bhte', h, Wk)
            v = torch.einsum('btd,dhe->bhte', h, Wv)
            scores = torch.einsum('bhqe,bhke->bhqk', q, k) * scale
            scores = torch.where(mask[None, None], scores, -1000000000.0)
            p = _softmax(scores, axis=-1)
            o = torch.einsum('bhqk,bhke->bhqe', p, v)
            o = torch.einsum('bhte,hed->btd', o, Wo)
            mem = o[:, :M, :].clone()
            outs.append(o[:, M:, :])
        return torch.concatenate(outs, axis=1)

    def _B_ref(x, mem0, Wq, Wk, Wv, Wo, seg_len):
        B, S, Dm = x.shape
        H, Dh = (Wq.shape[1], Wq.shape[2])
        M = mem0.shape[1]
        scale = Dh ** (-0.5)
        n_seg = S // seg_len
        L = M + seg_len
        idx = torch.arange(L)
        mask = (idx[:, None] < M) | (idx[:, None] >= idx[None, :])
        mem = mem0
        outs = []
        for s in range(n_seg):
            xs = x[:, s * seg_len:(s + 1) * seg_len, :].clone()
            h = torch.concatenate([mem, xs], axis=1)
            q = torch.einsum('btd,dhe->bhte', h, Wq)
            k = torch.einsum('btd,dhe->bhte', h, Wk)
            v = torch.einsum('btd,dhe->bhte', h, Wv)
            scores = torch.einsum('bhqe,bhke->bhqk', q, k) * scale
            scores = torch.where(mask[None, None], scores, -1000000000.0)
            p = _softmax(scores, axis=-1)
            o = torch.einsum('bhqk,bhke->bhqe', p, v)
            o = torch.einsum('bhte,hed->btd', o, Wo)
            mem = o[:, :M, :].clone()
            outs.append(o[:, M:, :])
        return torch.concatenate(outs, axis=1)
    a = _A_ref(A_x, A_mem0, A_Wq, A_Wk, A_Wv, A_Wo, A_seg_len)
    b = _B_ref(B_x, B_mem0, B_Wq, B_Wk, B_Wv, B_Wo, B_seg_len)
    return torch.concatenate([a, b], axis=-1)
```

```asm
; @launch kernel=main_kernel grid=(256,1,1) block=(256,1,1) lds=163840
.amdgcn_target "amdgcn-amd-amdhsa--gfx950"
.text
.globl main_kernel
.p2align 8
.type main_kernel,@function
main_kernel:
    s_cmp_ge_u32 s2, 256
    s_cbranch_scc1 G_end
    s_load_dwordx2 s[54:55], s[0:1], 120
    s_getreg_b32 s52, hwreg(HW_REG_XCC_ID)
    s_and_b32 s52, s52, 7
    v_lshrrev_b32 v1, 6, v0
    s_nop 1
    v_readfirstlane_b32 s25, v1
    s_mov_b32 s34, 3000000
    s_waitcnt lgkmcnt(0)
    s_mov_b32 s4, s54
    s_and_b32 s5, s55, 0xffff
    s_mov_b32 s6, 256
    s_mov_b32 s7, 0x20000
    s_cmp_lg_u32 s25, 0
    s_cbranch_scc1 M_na
    v_mov_b32 v2, 1
    v_mov_b32 v3, s52
    v_lshlrev_b32 v3, 2, v3
    s_mov_b64 exec, 1
    buffer_atomic_add v2, v3, s[4:7], 0 offen sc0
    s_waitcnt vmcnt(0)
    v_mov_b32 v3, 0
    ds_write_b32 v3, v2
    s_waitcnt lgkmcnt(0)
    s_mov_b64 exec, -1
M_na:
    s_barrier
    v_mov_b32 v3, 0
    ds_read_b32 v2, v3
    s_waitcnt lgkmcnt(0)
    v_readfirstlane_b32 s53, v2
    s_barrier
    s_lshl_b32 s3, s52, 5
    s_add_u32 s3, s3, s53
    s_mov_b32 s36, 1
    s_cmp_lt_u32 s53, 32
    s_cbranch_scc1 M_role
M_ov:
    v_mbcnt_lo_u32_b32 v2, -1, 0
    v_and_b32 v2, 7, v2
    v_lshlrev_b32 v2, 2, v2
    buffer_load_dword v3, v2, s[4:7], 0 offen sc1
    s_waitcnt vmcnt(0)
    v_readlane_b32 s60, v3, 0
    v_readlane_b32 s61, v3, 1
    v_readlane_b32 s62, v3, 2
    v_readlane_b32 s63, v3, 3
    v_readlane_b32 s64, v3, 4
    v_readlane_b32 s65, v3, 5
    v_readlane_b32 s66, v3, 6
    v_readlane_b32 s67, v3, 7
    s_mov_b32 s68, 0
    s_nop 1
    s_add_u32 s68, s68, s60
    s_add_u32 s68, s68, s61
    s_add_u32 s68, s68, s62
    s_add_u32 s68, s68, s63
    s_add_u32 s68, s68, s64
    s_add_u32 s68, s68, s65
    s_add_u32 s68, s68, s66
    s_add_u32 s68, s68, s67
    s_sub_u32 s34, s34, 1
    s_cbranch_scc1 G_end
    s_cmp_eq_u32 s68, 256
    s_cbranch_scc1 M_ov2
    s_sleep 8
    s_branch M_ov
M_ov2:
    s_sub_u32 s53, s53, 32
    s_sub_u32 s30, s60, 32
    s_max_i32 s30, s30, 0
    s_cmp_gt_u32 s52, 0
    s_cselect_b32 s30, s30, 0
    s_add_u32 s53, s53, s30
    s_sub_u32 s30, s61, 32
    s_max_i32 s30, s30, 0
    s_cmp_gt_u32 s52, 1
    s_cselect_b32 s30, s30, 0
    s_add_u32 s53, s53, s30
    s_sub_u32 s30, s62, 32
    s_max_i32 s30, s30, 0
    s_cmp_gt_u32 s52, 2
    s_cselect_b32 s30, s30, 0
    s_add_u32 s53, s53, s30
    s_sub_u32 s30, s63, 32
    s_max_i32 s30, s30, 0
    s_cmp_gt_u32 s52, 3
    s_cselect_b32 s30, s30, 0
    s_add_u32 s53, s53, s30
    s_sub_u32 s30, s64, 32
    s_max_i32 s30, s30, 0
    s_cmp_gt_u32 s52, 4
    s_cselect_b32 s30, s30, 0
    s_add_u32 s53, s53, s30
    s_sub_u32 s30, s65, 32
    s_max_i32 s30, s30, 0
    s_cmp_gt_u32 s52, 5
    s_cselect_b32 s30, s30, 0
    s_add_u32 s53, s53, s30
    s_sub_u32 s30, s66, 32
    s_max_i32 s30, s30, 0
    s_cmp_gt_u32 s52, 6
    s_cselect_b32 s30, s30, 0
    s_add_u32 s53, s53, s30
    s_sub_u32 s30, s67, 32
    s_max_i32 s30, s30, 0
    s_cmp_gt_u32 s52, 7
    s_cselect_b32 s30, s30, 0
    s_add_u32 s53, s53, s30
    s_mov_b32 s3, -1
    s_cmp_lg_u32 s3, -1
    s_cbranch_scc1 M_o_1
    s_sub_u32 s30, 32, s60
    s_max_i32 s30, s30, 0
    s_add_u32 s31, s60, s53
    s_add_u32 s31, s31, 0
    s_cmp_lt_u32 s53, s30
    s_cselect_b32 s3, s31, -1
    s_cselect_b32 s30, 0, s30
    s_sub_u32 s53, s53, s30
M_o_1:
    s_cmp_lg_u32 s3, -1
    s_cbranch_scc1 M_o_2
    s_sub_u32 s30, 32, s61
    s_max_i32 s30, s30, 0
    s_add_u32 s31, s61, s53
    s_add_u32 s31, s31, 32
    s_cmp_lt_u32 s53, s30
    s_cselect_b32 s3, s31, -1
    s_cselect_b32 s30, 0, s30
    s_sub_u32 s53, s53, s30
M_o_2:
    s_cmp_lg_u32 s3, -1
    s_cbranch_scc1 M_o_3
    s_sub_u32 s30, 32, s62
    s_max_i32 s30, s30, 0
    s_add_u32 s31, s62, s53
    s_add_u32 s31, s31, 64
    s_cmp_lt_u32 s53, s30
    s_cselect_b32 s3, s31, -1
    s_cselect_b32 s30, 0, s30
    s_sub_u32 s53, s53, s30
M_o_3:
    s_cmp_lg_u32 s3, -1
    s_cbranch_scc1 M_o_4
    s_sub_u32 s30, 32, s63
    s_max_i32 s30, s30, 0
    s_add_u32 s31, s63, s53
    s_add_u32 s31, s31, 96
    s_cmp_lt_u32 s53, s30
    s_cselect_b32 s3, s31, -1
    s_cselect_b32 s30, 0, s30
    s_sub_u32 s53, s53, s30
M_o_4:
    s_cmp_lg_u32 s3, -1
    s_cbranch_scc1 M_o_5
    s_sub_u32 s30, 32, s64
    s_max_i32 s30, s30, 0
    s_add_u32 s31, s64, s53
    s_add_u32 s31, s31, 128
    s_cmp_lt_u32 s53, s30
    s_cselect_b32 s3, s31, -1
    s_cselect_b32 s30, 0, s30
    s_sub_u32 s53, s53, s30
M_o_5:
    s_cmp_lg_u32 s3, -1
    s_cbranch_scc1 M_o_6
    s_sub_u32 s30, 32, s65
    s_max_i32 s30, s30, 0
    s_add_u32 s31, s65, s53
    s_add_u32 s31, s31, 160
    s_cmp_lt_u32 s53, s30
    s_cselect_b32 s3, s31, -1
    s_cselect_b32 s30, 0, s30
    s_sub_u32 s53, s53, s30
M_o_6:
    s_cmp_lg_u32 s3, -1
    s_cbranch_scc1 M_o_7
    s_sub_u32 s30, 32, s66
    s_max_i32 s30, s30, 0
    s_add_u32 s31, s66, s53
    s_add_u32 s31, s31, 192
    s_cmp_lt_u32 s53, s30
    s_cselect_b32 s3, s31, -1
    s_cselect_b32 s30, 0, s30
    s_sub_u32 s53, s53, s30
M_o_7:
    s_cmp_lg_u32 s3, -1
    s_cbranch_scc1 M_o_8
    s_sub_u32 s30, 32, s67
    s_max_i32 s30, s30, 0
    s_add_u32 s31, s67, s53
    s_add_u32 s31, s31, 224
    s_cmp_lt_u32 s53, s30
    s_cselect_b32 s3, s31, -1
    s_cselect_b32 s30, 0, s30
    s_sub_u32 s53, s53, s30
M_o_8:
    s_mov_b32 s36, 0
    s_cmp_ge_u32 s3, 256
    s_cbranch_scc1 G_end
M_role:
    s_bfe_u32 s20, s3, 0x10006
    s_bfe_u32 s21, s3, 0x10005
    s_and_b32 s22, s3, 31
    s_load_dwordx16 s[48:63], s[0:1], 0
    s_load_dwordx16 s[64:79], s[0:1], 64
    s_load_dwordx2 s[46:47], s[0:1], 128
    v_lshrrev_b32 v1, 6, v0
    s_nop 1
    v_readfirstlane_b32 s25, v1
    s_waitcnt lgkmcnt(0)
    s_cmp_eq_u32 s20, 0
    s_cselect_b64 s[42:43], s[48:49], s[62:63]
    s_cselect_b64 s[88:89], s[50:51], s[64:65]
    s_cselect_b64 s[80:81], s[52:53], s[66:67]
    s_cselect_b64 s[82:83], s[54:55], s[68:69]
    s_cselect_b64 s[84:85], s[56:57], s[70:71]
    s_cselect_b64 s[86:87], s[58:59], s[72:73]
    s_mov_b32 s8, s46
    s_and_b32 s9, s47, 0xffff
    s_mov_b32 s10, 268435456
    s_mov_b32 s11, 0x20000
    s_mov_b32 s4, s78
    s_and_b32 s5, s79, 0xffff
    s_mov_b32 s6, 256
    s_mov_b32 s7, 0x20000
    v_lshlrev_b32 v1, 4, v0
    s_mov_b32 s30, s3
M_clr:
    s_cmp_ge_u32 s30, 301
    s_cbranch_scc1 M_clr2
    s_cmp_ge_u32 s30, 131
    s_cselect_b32 s31, -1, 0
    v_mov_b32 v4, s31
    v_mov_b32 v5, s31
    v_mov_b32 v6, s31
    v_mov_b32 v7, s31
    s_lshl_b32 s31, s30, 14
    s_add_u32 s31, s31, 180355072
    buffer_store_dwordx4 v[4:7], v1, s[8:11], s31 offen sc1
    s_add_u32 s31, s31, 4096
    buffer_store_dwordx4 v[4:7], v1, s[8:11], s31 offen sc1
    s_add_u32 s31, s31, 4096
    buffer_store_dwordx4 v[4:7], v1, s[8:11], s31 offen sc1
    s_add_u32 s31, s31, 4096
    buffer_store_dwordx4 v[4:7], v1, s[8:11], s31 offen sc1
    s_add_u32 s31, s31, 4096
    s_add_u32 s30, s30, 256
    s_branch M_clr
M_clr2:
    s_cmp_ge_u32 s3, 128
    s_cbranch_scc1 M_gemm
    s_lshl_b32 s23, s21, 5
    s_add_u32 s23, s23, s22
    s_lshr_b32 s24, s23, 1
    s_and_b32 s26, s22, 1
    s_and_b32 s51, s25, 1
    v_and_b32 v1, 63, v0
    v_mov_b32 v5, v0
    v_lshlrev_b32 v2, 4, v1
    v_mov_b32 v22, 0
    v_mov_b32 v26, 2147483632
    v_cmp_eq_u32 vcc, 0, v1
    s_nop 1
    v_cndmask_b32 v22, v26, v22, vcc
    v_lshlrev_b32 v13, 3, v1
    v_and_b32 v24, 15, v1
    v_lshrrev_b32 v25, 4, v1
    s_mul_i32 s30, s51, 5120
    s_add_u32 s31, s30, 122880
    v_add_u32 v3, s31, v2
    s_sub_u32 s31, 128000, s30
    v_add_u32 v4, s31, v2
    s_mov_b32 s8, s46
    s_and_b32 s9, s47, 0xffff
    s_mov_b32 s10, 268435456
    s_mov_b32 s11, 0x20000
    s_mul_i32 s34, s24, 384
    s_mul_i32 s30, s26, 192
    s_add_u32 s34, s34, s30
    s_mul_i32 s30, s25, 80
    s_add_u32 s30, s30, 0
    v_add_u32 v190, 0, v1
    v_mul_u32_u24 v191, 5462, v190
    v_lshrrev_b32 v191, 16, v191
    v_mul_u32_u24 v192, 12, v191
    v_sub_u32 v190, v190, v192
    v_add_u32 v191, s30, v191
    v_bfe_u32 v192, v191, 5, 1
    v_bfe_u32 v193, v191, 2, 1
    v_lshl_add_u32 v192, v192, 1, v193
    v_and_b32 v193, 3, v191
    v_lshl_add_u32 v152, v193, 2, v192
    v_lshl_add_u32 v192, v192, 2, v193
    v_lshrrev_b32 v193, 6, v191
    v_cmp_eq_u32 vcc, 4, v193
    s_nop 1
    v_cndmask_b32 v152, v152, v192, vcc
    v_lshl_add_u32 v152, v193, 6, v152
    v_bfe_u32 v193, v191, 3, 2
    v_lshl_add_u32 v152, v193, 4, v152
    v_mul_u32_u24 v152, 12288, v152
    v_lshl_add_u32 v152, v190, 4, v152
    v_add_u32 v190, 64, v1
    v_mul_u32_u24 v191, 5462, v190
    v_lshrrev_b32 v191, 16, v191
    v_mul_u32_u24 v192, 12, v191
    v_sub_u32 v190, v190, v192
    v_add_u32 v191, s30, v191
    v_bfe_u32 v192, v191, 5, 1
    v_bfe_u32 v193, v191, 2, 1
    v_lshl_add_u32 v192, v192, 1, v193
    v_and_b32 v193, 3, v191
    v_lshl_add_u32 v153, v193, 2, v192
    v_lshl_add_u32 v192, v192, 2, v193
    v_lshrrev_b32 v193, 6, v191
    v_cmp_eq_u32 vcc, 4, v193
    s_nop 1
    v_cndmask_b32 v153, v153, v192, vcc
    v_lshl_add_u32 v153, v193, 6, v153
    v_bfe_u32 v193, v191, 3, 2
    v_lshl_add_u32 v153, v193, 4, v153
    v_mul_u32_u24 v153, 12288, v153
    v_lshl_add_u32 v153, v190, 4, v153
    v_add_u32 v190, 128, v1
    v_mul_u32_u24 v191, 5462, v190
    v_lshrrev_b32 v191, 16, v191
    v_mul_u32_u24 v192, 12, v191
    v_sub_u32 v190, v190, v192
    v_add_u32 v191, s30, v191
    v_bfe_u32 v192, v191, 5, 1
    v_bfe_u32 v193, v191, 2, 1
    v_lshl_add_u32 v192, v192, 1, v193
    v_and_b32 v193, 3, v191
    v_lshl_add_u32 v154, v193, 2, v192
    v_lshl_add_u32 v192, v192, 2, v193
    v_lshrrev_b32 v193, 6, v191
    v_cmp_eq_u32 vcc, 4, v193
    s_nop 1
    v_cndmask_b32 v154, v154, v192, vcc
    v_lshl_add_u32 v154, v193, 6, v154
    v_bfe_u32 v193, v191, 3, 2
    v_lshl_add_u32 v154, v193, 4, v154
    v_mul_u32_u24 v154, 12288, v154
    v_lshl_add_u32 v154, v190, 4, v154
    v_add_u32 v190, 192, v1
    v_mul_u32_u24 v191, 5462, v190
    v_lshrrev_b32 v191, 16, v191
    v_mul_u32_u24 v192, 12, v191
    v_sub_u32 v190, v190, v192
    v_add_u32 v191, s30, v191
    v_bfe_u32 v192, v191, 5, 1
    v_bfe_u32 v193, v191, 2, 1
    v_lshl_add_u32 v192, v192, 1, v193
    v_and_b32 v193, 3, v191
    v_lshl_add_u32 v155, v193, 2, v192
    v_lshl_add_u32 v192, v192, 2, v193
    v_lshrrev_b32 v193, 6, v191
    v_cmp_eq_u32 vcc, 4, v193
    s_nop 1
    v_cndmask_b32 v155, v155, v192, vcc
    v_lshl_add_u32 v155, v193, 6, v155
    v_bfe_u32 v193, v191, 3, 2
    v_lshl_add_u32 v155, v193, 4, v155
    v_mul_u32_u24 v155, 12288, v155
    v_lshl_add_u32 v155, v190, 4, v155
    v_add_u32 v190, 256, v1
    v_mul_u32_u24 v191, 5462, v190
    v_lshrrev_b32 v191, 16, v191
    v_mul_u32_u24 v192, 12, v191
    v_sub_u32 v190, v190, v192
    v_add_u32 v191, s30, v191
    v_bfe_u32 v192, v191, 5, 1
    v_bfe_u32 v193, v191, 2, 1
    v_lshl_add_u32 v192, v192, 1, v193
    v_and_b32 v193, 3, v191
    v_lshl_add_u32 v156, v193, 2, v192
    v_lshl_add_u32 v192, v192, 2, v193
    v_lshrrev_b32 v193, 6, v191
    v_cmp_eq_u32 vcc, 4, v193
    s_nop 1
    v_cndmask_b32 v156, v156, v192, vcc
    v_lshl_add_u32 v156, v193, 6, v156
    v_bfe_u32 v193, v191, 3, 2
    v_lshl_add_u32 v156, v193, 4, v156
    v_mul_u32_u24 v156, 12288, v156
    v_lshl_add_u32 v156, v190, 4, v156
    v_add_u32 v190, 320, v1
    v_mul_u32_u24 v191, 5462, v190
    v_lshrrev_b32 v191, 16, v191
    v_mul_u32_u24 v192, 12, v191
    v_sub_u32 v190, v190, v192
    v_add_u32 v191, s30, v191
    v_bfe_u32 v192, v191, 5, 1
    v_bfe_u32 v193, v191, 2, 1
    v_lshl_add_u32 v192, v192, 1, v193
    v_and_b32 v193, 3, v191
    v_lshl_add_u32 v157, v193, 2, v192
    v_lshl_add_u32 v192, v192, 2, v193
    v_lshrrev_b32 v193, 6, v191
    v_cmp_eq_u32 vcc, 4, v193
    s_nop 1
    v_cndmask_b32 v157, v157, v192, vcc
    v_lshl_add_u32 v157, v193, 6, v157
    v_bfe_u32 v193, v191, 3, 2
    v_lshl_add_u32 v157, v193, 4, v157
    v_mul_u32_u24 v157, 12288, v157
    v_lshl_add_u32 v157, v190, 4, v157
    v_add_u32 v190, 384, v1
    v_mul_u32_u24 v191, 5462, v190
    v_lshrrev_b32 v191, 16, v191
    v_mul_u32_u24 v192, 12, v191
    v_sub_u32 v190, v190, v192
    v_add_u32 v191, s30, v191
    v_bfe_u32 v192, v191, 5, 1
    v_bfe_u32 v193, v191, 2, 1
    v_lshl_add_u32 v192, v192, 1, v193
    v_and_b32 v193, 3, v191
    v_lshl_add_u32 v158, v193, 2, v192
    v_lshl_add_u32 v192, v192, 2, v193
    v_lshrrev_b32 v193, 6, v191
    v_cmp_eq_u32 vcc, 4, v193
    s_nop 1
    v_cndmask_b32 v158, v158, v192, vcc
    v_lshl_add_u32 v158, v193, 6, v158
    v_bfe_u32 v193, v191, 3, 2
    v_lshl_add_u32 v158, v193, 4, v158
    v_mul_u32_u24 v158, 12288, v158
    v_lshl_add_u32 v158, v190, 4, v158
    v_add_u32 v190, 448, v1
    v_mul_u32_u24 v191, 5462, v190
    v_lshrrev_b32 v191, 16, v191
    v_mul_u32_u24 v192, 12, v191
    v_sub_u32 v190, v190, v192
    v_add_u32 v191, s30, v191
    v_bfe_u32 v192, v191, 5, 1
    v_bfe_u32 v193, v191, 2, 1
    v_lshl_add_u32 v192, v192, 1, v193
    v_and_b32 v193, 3, v191
    v_lshl_add_u32 v159, v193, 2, v192
    v_lshl_add_u32 v192, v192, 2, v193
    v_lshrrev_b32 v193, 6, v191
    v_cmp_eq_u32 vcc, 4, v193
    s_nop 1
    v_cndmask_b32 v159, v159, v192, vcc
    v_lshl_add_u32 v159, v193, 6, v159
    v_bfe_u32 v193, v191, 3, 2
    v_lshl_add_u32 v159, v193, 4, v159
    v_mul_u32_u24 v159, 12288, v159
    v_lshl_add_u32 v159, v190, 4, v159
    v_add_u32 v190, 512, v1
    v_mul_u32_u24 v191, 5462, v190
    v_lshrrev_b32 v191, 16, v191
    v_mul_u32_u24 v192, 12, v191
    v_sub_u32 v190, v190, v192
    v_add_u32 v191, s30, v191
    v_bfe_u32 v192, v191, 5, 1
    v_bfe_u32 v193, v191, 2, 1
    v_lshl_add_u32 v192, v192, 1, v193
    v_and_b32 v193, 3, v191
    v_lshl_add_u32 v160, v193, 2, v192
    v_lshl_add_u32 v192, v192, 2, v193
    v_lshrrev_b32 v193, 6, v191
    v_cmp_eq_u32 vcc, 4, v193
    s_nop 1
    v_cndmask_b32 v160, v160, v192, vcc
    v_lshl_add_u32 v160, v193, 6, v160
    v_bfe_u32 v193, v191, 3, 2
    v_lshl_add_u32 v160, v193, 4, v160
    v_mul_u32_u24 v160, 12288, v160
    v_lshl_add_u32 v160, v190, 4, v160
    v_add_u32 v190, 576, v1
    v_mul_u32_u24 v191, 5462, v190
    v_lshrrev_b32 v191, 16, v191
    v_mul_u32_u24 v192, 12, v191
    v_sub_u32 v190, v190, v192
    v_add_u32 v191, s30, v191
    v_bfe_u32 v192, v191, 5, 1
    v_bfe_u32 v193, v191, 2, 1
    v_lshl_add_u32 v192, v192, 1, v193
    v_and_b32 v193, 3, v191
    v_lshl_add_u32 v161, v193, 2, v192
    v_lshl_add_u32 v192, v192, 2, v193
    v_lshrrev_b32 v193, 6, v191
    v_cmp_eq_u32 vcc, 4, v193
    s_nop 1
    v_cndmask_b32 v161, v161, v192, vcc
    v_lshl_add_u32 v161, v193, 6, v161
    v_bfe_u32 v193, v191, 3, 2
    v_lshl_add_u32 v161, v193, 4, v161
    v_mul_u32_u24 v161, 12288, v161
    v_lshl_add_u32 v161, v190, 4, v161
    v_add_u32 v190, 640, v1
    v_mul_u32_u24 v191, 5462, v190
    v_lshrrev_b32 v191, 16, v191
    v_mul_u32_u24 v192, 12, v191
    v_sub_u32 v190, v190, v192
    v_add_u32 v191, s30, v191
    v_bfe_u32 v192, v191, 5, 1
    v_bfe_u32 v193, v191, 2, 1
    v_lshl_add_u32 v192, v192, 1, v193
    v_and_b32 v193, 3, v191
    v_lshl_add_u32 v162, v193, 2, v192
    v_lshl_add_u32 v192, v192, 2, v193
    v_lshrrev_b32 v193, 6, v191
    v_cmp_eq_u32 vcc, 4, v193
    s_nop 1
    v_cndmask_b32 v162, v162, v192, vcc
    v_lshl_add_u32 v162, v193, 6, v162
    v_bfe_u32 v193, v191, 3, 2
    v_lshl_add_u32 v162, v193, 4, v162
    v_mul_u32_u24 v162, 12288, v162
    v_lshl_add_u32 v162, v190, 4, v162
    v_add_u32 v190, 704, v1
    v_mul_u32_u24 v191, 5462, v190
    v_lshrrev_b32 v191, 16, v191
    v_mul_u32_u24 v192, 12, v191
    v_sub_u32 v190, v190, v192
    v_add_u32 v191, s30, v191
    v_bfe_u32 v192, v191, 5, 1
    v_bfe_u32 v193, v191, 2, 1
    v_lshl_add_u32 v192, v192, 1, v193
    v_and_b32 v193, 3, v191
    v_lshl_add_u32 v163, v193, 2, v192
    v_lshl_add_u32 v192, v192, 2, v193
    v_lshrrev_b32 v193, 6, v191
    v_cmp_eq_u32 vcc, 4, v193
    s_nop 1
    v_cndmask_b32 v163, v163, v192, vcc
    v_lshl_add_u32 v163, v193, 6, v163
    v_bfe_u32 v193, v191, 3, 2
    v_lshl_add_u32 v163, v193, 4, v163
    v_mul_u32_u24 v163, 12288, v163
    v_lshl_add_u32 v163, v190, 4, v163
    v_add_u32 v190, 768, v1
    v_mul_u32_u24 v191, 5462, v190
    v_lshrrev_b32 v191, 16, v191
    v_mul_u32_u24 v192, 12, v191
    v_sub_u32 v190, v190, v192
    v_add_u32 v191, s30, v191
    v_bfe_u32 v192, v191, 5, 1
    v_bfe_u32 v193, v191, 2, 1
    v_lshl_add_u32 v192, v192, 1, v193
    v_and_b32 v193, 3, v191
    v_lshl_add_u32 v164, v193, 2, v192
    v_lshl_add_u32 v192, v192, 2, v193
    v_lshrrev_b32 v193, 6, v191
    v_cmp_eq_u32 vcc, 4, v193
    s_nop 1
    v_cndmask_b32 v164, v164, v192, vcc
    v_lshl_add_u32 v164, v193, 6, v164
    v_bfe_u32 v193, v191, 3, 2
    v_lshl_add_u32 v164, v193, 4, v164
    v_mul_u32_u24 v164, 12288, v164
    v_lshl_add_u32 v164, v190, 4, v164
    v_add_u32 v190, 832, v1
    v_mul_u32_u24 v191, 5462, v190
    v_lshrrev_b32 v191, 16, v191
    v_mul_u32_u24 v192, 12, v191
    v_sub_u32 v190, v190, v192
    v_add_u32 v191, s30, v191
    v_bfe_u32 v192, v191, 5, 1
    v_bfe_u32 v193, v191, 2, 1
    v_lshl_add_u32 v192, v192, 1, v193
    v_and_b32 v193, 3, v191
    v_lshl_add_u32 v165, v193, 2, v192
    v_lshl_add_u32 v192, v192, 2, v193
    v_lshrrev_b32 v193, 6, v191
    v_cmp_eq_u32 vcc, 4, v193
    s_nop 1
    v_cndmask_b32 v165, v165, v192, vcc
    v_lshl_add_u32 v165, v193, 6, v165
    v_bfe_u32 v193, v191, 3, 2
    v_lshl_add_u32 v165, v193, 4, v165
    v_mul_u32_u24 v165, 12288, v165
    v_lshl_add_u32 v165, v190, 4, v165
    v_add_u32 v190, 896, v1
    v_mul_u32_u24 v191, 5462, v190
    v_lshrrev_b32 v191, 16, v191
    v_mul_u32_u24 v192, 12, v191
    v_sub_u32 v190, v190, v192
    v_add_u32 v191, s30, v191
    v_bfe_u32 v192, v191, 5, 1
    v_bfe_u32 v193, v191, 2, 1
    v_lshl_add_u32 v192, v192, 1, v193
    v_and_b32 v193, 3, v191
    v_lshl_add_u32 v166, v193, 2, v192
    v_lshl_add_u32 v192, v192, 2, v193
    v_lshrrev_b32 v193, 6, v191
    v_cmp_eq_u32 vcc, 4, v193
    s_nop 1
    v_cndmask_b32 v166, v166, v192, vcc
    v_lshl_add_u32 v166, v193, 6, v166
    v_bfe_u32 v193, v191, 3, 2
    v_lshl_add_u32 v166, v193, 4, v166
    v_mul_u32_u24 v166, 12288, v166
    v_lshl_add_u32 v166, v190, 4, v166
    s_mov_b32 s4, s80
    s_and_b32 s5, s81, 0xffff
    s_mov_b32 s6, 7864320
    s_mov_b32 s7, 0x20000
    s_mul_i32 s31, s25, 15360
    s_add_u32 s31, s31, 0
    s_mov_b32 m0, s31
    s_add_u32 s31, s31, 1024
    buffer_load_dwordx4 v152, s[4:7], s34 offen lds
    s_mov_b32 m0, s31
    s_add_u32 s31, s31, 1024
    buffer_load_dwordx4 v153, s[4:7], s34 offen lds
    s_mov_b32 m0, s31
    s_add_u32 s31, s31, 1024
    buffer_load_dwordx4 v154, s[4:7], s34 offen lds
    s_mov_b32 m0, s31
    s_add_u32 s31, s31, 1024
    buffer_load_dwordx4 v155, s[4:7], s34 offen lds
    s_mov_b32 m0, s31
    s_add_u32 s31, s31, 1024
    buffer_load_dwordx4 v156, s[4:7], s34 offen lds
    s_mov_b32 m0, s31
    s_add_u32 s31, s31, 1024
    buffer_load_dwordx4 v157, s[4:7], s34 offen lds
    s_mov_b32 m0, s31
    s_add_u32 s31, s31, 1024
    buffer_load_dwordx4 v158, s[4:7], s34 offen lds
    s_mov_b32 m0, s31
    s_add_u32 s31, s31, 1024
    buffer_load_dwordx4 v159, s[4:7], s34 offen lds
    s_mov_b32 m0, s31
    s_add_u32 s31, s31, 1024
    buffer_load_dwordx4 v160, s[4:7], s34 offen lds
    s_mov_b32 m0, s31
    s_add_u32 s31, s31, 1024
    buffer_load_dwordx4 v161, s[4:7], s34 offen lds
    s_mov_b32 m0, s31
    s_add_u32 s31, s31, 1024
    buffer_load_dwordx4 v162, s[4:7], s34 offen lds
    s_mov_b32 m0, s31
    s_add_u32 s31, s31, 1024
    buffer_load_dwordx4 v163, s[4:7], s34 offen lds
    s_mov_b32 m0, s31
    s_add_u32 s31, s31, 1024
    buffer_load_dwordx4 v164, s[4:7], s34 offen lds
    s_mov_b32 m0, s31
    s_add_u32 s31, s31, 1024
    buffer_load_dwordx4 v165, s[4:7], s34 offen lds
    s_mov_b32 m0, s31
    s_add_u32 s31, s31, 1024
    buffer_load_dwordx4 v166, s[4:7], s34 offen lds
    s_mul_i32 s30, s25, 80
    s_add_u32 s30, s30, 320
    v_add_u32 v190, 0, v1
    v_mul_u32_u24 v191, 5462, v190
    v_lshrrev_b32 v191, 16, v191
    v_mul_u32_u24 v192, 12, v191
    v_sub_u32 v190, v190, v192
    v_add_u32 v191, s30, v191
    v_bfe_u32 v192, v191, 5, 1
    v_bfe_u32 v193, v191, 2, 1
    v_lshl_add_u32 v192, v192, 1, v193
    v_and_b32 v193, 3, v191
    v_lshl_add_u32 v167, v193, 2, v192
    v_lshl_add_u32 v192, v192, 2, v193
    v_lshrrev_b32 v193, 6, v191
    v_cmp_eq_u32 vcc, 9, v193
    s_nop 1
    v_cndmask_b32 v167, v167, v192, vcc
    v_lshl_add_u32 v167, v193, 6, v167
    v_bfe_u32 v193, v191, 3, 2
    v_lshl_add_u32 v167, v193, 4, v167
    v_mul_u32_u24 v167, 12288, v167
    v_lshl_add_u32 v167, v190, 4, v167
    v_add_u32 v190, 64, v1
    v_mul_u32_u24 v191, 5462, v190
    v_lshrrev_b32 v191, 16, v191
    v_mul_u32_u24 v192, 12, v191
    v_sub_u32 v190, v190, v192
    v_add_u32 v191, s30, v191
    v_bfe_u32 v192, v191, 5, 1
    v_bfe_u32 v193, v191, 2, 1
    v_lshl_add_u32 v192, v192, 1, v193
    v_and_b32 v193, 3, v191
    v_lshl_add_u32 v168, v193, 2, v192
    v_lshl_add_u32 v192, v192, 2, v193
    v_lshrrev_b32 v193, 6, v191
    v_cmp_eq_u32 vcc, 9, v193
    s_nop 1
    v_cndmask_b32 v168, v168, v192, vcc
    v_lshl_add_u32 v168, v193, 6, v168
    v_bfe_u32 v193, v191, 3, 2
    v_lshl_add_u32 v168, v193, 4, v168
    v_mul_u32_u24 v168, 12288, v168
    v_lshl_add_u32 v168, v190, 4, v168
    v_add_u32 v190, 128, v1
    v_mul_u32_u24 v191, 5462, v190
    v_lshrrev_b32 v191, 16, v191
    v_mul_u32_u24 v192, 12, v191
    v_sub_u32 v190, v190, v192
    v_add_u32 v191, s30, v191
    v_bfe_u32 v192, v191, 5, 1
    v_bfe_u32 v193, v191, 2, 1
    v_lshl_add_u32 v192, v192, 1, v193
    v_and_b32 v193, 3, v191
    v_lshl_add_u32 v169, v193, 2, v192
    v_lshl_add_u32 v192, v192, 2, v193
    v_lshrrev_b32 v193, 6, v191
    v_cmp_eq_u32 vcc, 9, v193
    s_nop 1
    v_cndmask_b32 v169, v169, v192, vcc
    v_lshl_add_u32 v169, v193, 6, v169
    v_bfe_u32 v193, v191, 3, 2
    v_lshl_add_u32 v169, v193, 4, v169
    v_mul_u32_u24 v169, 12288, v169
    v_lshl_add_u32 v169, v190, 4, v169
    v_add_u32 v190, 192, v1
    v_mul_u32_u24 v191, 5462, v190
    v_lshrrev_b32 v191, 16, v191
    v_mul_u32_u24 v192, 12, v191
    v_sub_u32 v190, v190, v192
    v_add_u32 v191, s30, v191
    v_bfe_u32 v192, v191, 5, 1
    v_bfe_u32 v193, v191, 2, 1
    v_lshl_add_u32 v192, v192, 1, v193
    v_and_b32 v193, 3, v191
    v_lshl_add_u32 v170, v193, 2, v192
    v_lshl_add_u32 v192, v192, 2, v193
    v_lshrrev_b32 v193, 6, v191
    v_cmp_eq_u32 vcc, 9, v193
    s_nop 1
    v_cndmask_b32 v170, v170, v192, vcc
    v_lshl_add_u32 v170, v193, 6, v170
    v_bfe_u32 v193, v191, 3, 2
    v_lshl_add_u32 v170, v193, 4, v170
    v_mul_u32_u24 v170, 12288, v170
    v_lshl_add_u32 v170, v190, 4, v170
    v_add_u32 v190, 256, v1
    v_mul_u32_u24 v191, 5462, v190
    v_lshrrev_b32 v191, 16, v191
    v_mul_u32_u24 v192, 12, v191
    v_sub_u32 v190, v190, v192
    v_add_u32 v191, s30, v191
    v_bfe_u32 v192, v191, 5, 1
    v_bfe_u32 v193, v191, 2, 1
    v_lshl_add_u32 v192, v192, 1, v193
    v_and_b32 v193, 3, v191
    v_lshl_add_u32 v171, v193, 2, v192
    v_lshl_add_u32 v192, v192, 2, v193
    v_lshrrev_b32 v193, 6, v191
    v_cmp_eq_u32 vcc, 9, v193
    s_nop 1
    v_cndmask_b32 v171, v171, v192, vcc
    v_lshl_add_u32 v171, v193, 6, v171
    v_bfe_u32 v193, v191, 3, 2
    v_lshl_add_u32 v171, v193, 4, v171
    v_mul_u32_u24 v171, 12288, v171
    v_lshl_add_u32 v171, v190, 4, v171
    v_add_u32 v190, 320, v1
    v_mul_u32_u24 v191, 5462, v190
    v_lshrrev_b32 v191, 16, v191
    v_mul_u32_u24 v192, 12, v191
    v_sub_u32 v190, v190, v192
    v_add_u32 v191, s30, v191
    v_bfe_u32 v192, v191, 5, 1
    v_bfe_u32 v193, v191, 2, 1
    v_lshl_add_u32 v192, v192, 1, v193
    v_and_b32 v193, 3, v191
    v_lshl_add_u32 v172, v193, 2, v192
    v_lshl_add_u32 v192, v192, 2, v193
    v_lshrrev_b32 v193, 6, v191
    v_cmp_eq_u32 vcc, 9, v193
    s_nop 1
    v_cndmask_b32 v172, v172, v192, vcc
    v_lshl_add_u32 v172, v193, 6, v172
    v_bfe_u32 v193, v191, 3, 2
    v_lshl_add_u32 v172, v193, 4, v172
    v_mul_u32_u24 v172, 12288, v172
    v_lshl_add_u32 v172, v190, 4, v172
    v_add_u32 v190, 384, v1
    v_mul_u32_u24 v191, 5462, v190
    v_lshrrev_b32 v191, 16, v191
    v_mul_u32_u24 v192, 12, v191
    v_sub_u32 v190, v190, v192
    v_add_u32 v191, s30, v191
    v_bfe_u32 v192, v191, 5, 1
    v_bfe_u32 v193, v191, 2, 1
    v_lshl_add_u32 v192, v192, 1, v193
    v_and_b32 v193, 3, v191
    v_lshl_add_u32 v173, v193, 2, v192
    v_lshl_add_u32 v192, v192, 2, v193
    v_lshrrev_b32 v193, 6, v191
    v_cmp_eq_u32 vcc, 9, v193
    s_nop 1
    v_cndmask_b32 v173, v173, v192, vcc
    v_lshl_add_u32 v173, v193, 6, v173
    v_bfe_u32 v193, v191, 3, 2
    v_lshl_add_u32 v173, v193, 4, v173
    v_mul_u32_u24 v173, 12288, v173
    v_lshl_add_u32 v173, v190, 4, v173
    v_add_u32 v190, 448, v1
    v_mul_u32_u24 v191, 5462, v190
    v_lshrrev_b32 v191, 16, v191
    v_mul_u32_u24 v192, 12, v191
    v_sub_u32 v190, v190, v192
    v_add_u32 v191, s30, v191
    v_bfe_u32 v192, v191, 5, 1
    v_bfe_u32 v193, v191, 2, 1
    v_lshl_add_u32 v192, v192, 1, v193
    v_and_b32 v193, 3, v191
    v_lshl_add_u32 v174, v193, 2, v192
    v_lshl_add_u32 v192, v192, 2, v193
    v_lshrrev_b32 v193, 6, v191
    v_cmp_eq_u32 vcc, 9, v193
    s_nop 1
    v_cndmask_b32 v174, v174, v192, vcc
    v_lshl_add_u32 v174, v193, 6, v174
    v_bfe_u32 v193, v191, 3, 2
    v_lshl_add_u32 v174, v193, 4, v174
    v_mul_u32_u24 v174, 12288, v174
    v_lshl_add_u32 v174, v190, 4, v174
    v_add_u32 v190, 512, v1
    v_mul_u32_u24 v191, 5462, v190
    v_lshrrev_b32 v191, 16, v191
    v_mul_u32_u24 v192, 12, v191
    v_sub_u32 v190, v190, v192
    v_add_u32 v191, s30, v191
    v_bfe_u32 v192, v191, 5, 1
    v_bfe_u32 v193, v191, 2, 1
    v_lshl_add_u32 v192, v192, 1, v193
    v_and_b32 v193, 3, v191
    v_lshl_add_u32 v175, v193, 2, v192
    v_lshl_add_u32 v192, v192, 2, v193
    v_lshrrev_b32 v193, 6, v191
    v_cmp_eq_u32 vcc, 9, v193
    s_nop 1
    v_cndmask_b32 v175, v175, v192, vcc
    v_lshl_add_u32 v175, v193, 6, v175
    v_bfe_u32 v193, v191, 3, 2
    v_lshl_add_u32 v175, v193, 4, v175
    v_mul_u32_u24 v175, 12288, v175
    v_lshl_add_u32 v175, v190, 4, v175
    v_add_u32 v190, 576, v1
    v_mul_u32_u24 v191, 5462, v190
    v_lshrrev_b32 v191, 16, v191
    v_mul_u32_u24 v192, 12, v191
    v_sub_u32 v190, v190, v192
    v_add_u32 v191, s30, v191
    v_bfe_u32 v192, v191, 5, 1
    v_bfe_u32 v193, v191, 2, 1
    v_lshl_add_u32 v192, v192, 1, v193
    v_and_b32 v193, 3, v191
    v_lshl_add_u32 v176, v193, 2, v192
    v_lshl_add_u32 v192, v192, 2, v193
    v_lshrrev_b32 v193, 6, v191
    v_cmp_eq_u32 vcc, 9, v193
    s_nop 1
    v_cndmask_b32 v176, v176, v192, vcc
    v_lshl_add_u32 v176, v193, 6, v176
    v_bfe_u32 v193, v191, 3, 2
    v_lshl_add_u32 v176, v193, 4, v176
    v_mul_u32_u24 v176, 12288, v176
    v_lshl_add_u32 v176, v190, 4, v176
    v_add_u32 v190, 640, v1
    v_mul_u32_u24 v191, 5462, v190
    v_lshrrev_b32 v191, 16, v191
    v_mul_u32_u24 v192, 12, v191
    v_sub_u32 v190, v190, v192
    v_add_u32 v191, s30, v191
    v_bfe_u32 v192, v191, 5, 1
    v_bfe_u32 v193, v191, 2, 1
    v_lshl_add_u32 v192, v192, 1, v193
    v_and_b32 v193, 3, v191
    v_lshl_add_u32 v177, v193, 2, v192
    v_lshl_add_u32 v192, v192, 2, v193
    v_lshrrev_b32 v193, 6, v191
    v_cmp_eq_u32 vcc, 9, v193
    s_nop 1
    v_cndmask_b32 v177, v177, v192, vcc
    v_lshl_add_u32 v177, v193, 6, v177
    v_bfe_u32 v193, v191, 3, 2
    v_lshl_add_u32 v177, v193, 4, v177
    v_mul_u32_u24 v177, 12288, v177
    v_lshl_add_u32 v177, v190, 4, v177
    v_add_u32 v190, 704, v1
    v_mul_u32_u24 v191, 5462, v190
    v_lshrrev_b32 v191, 16, v191
    v_mul_u32_u24 v192, 12, v191
    v_sub_u32 v190, v190, v192
    v_add_u32 v191, s30, v191
    v_bfe_u32 v192, v191, 5, 1
    v_bfe_u32 v193, v191, 2, 1
    v_lshl_add_u32 v192, v192, 1, v193
    v_and_b32 v193, 3, v191
    v_lshl_add_u32 v178, v193, 2, v192
    v_lshl_add_u32 v192, v192, 2, v193
    v_lshrrev_b32 v193, 6, v191
    v_cmp_eq_u32 vcc, 9, v193
    s_nop 1
    v_cndmask_b32 v178, v178, v192, vcc
    v_lshl_add_u32 v178, v193, 6, v178
    v_bfe_u32 v193, v191, 3, 2
    v_lshl_add_u32 v178, v193, 4, v178
    v_mul_u32_u24 v178, 12288, v178
    v_lshl_add_u32 v178, v190, 4, v178
    v_add_u32 v190, 768, v1
    v_mul_u32_u24 v191, 5462, v190
    v_lshrrev_b32 v191, 16, v191
    v_mul_u32_u24 v192, 12, v191
    v_sub_u32 v190, v190, v192
    v_add_u32 v191, s30, v191
    v_bfe_u32 v192, v191, 5, 1
    v_bfe_u32 v193, v191, 2, 1
    v_lshl_add_u32 v192, v192, 1, v193
    v_and_b32 v193, 3, v191
    v_lshl_add_u32 v179, v193, 2, v192
    v_lshl_add_u32 v192, v192, 2, v193
    v_lshrrev_b32 v193, 6, v191
    v_cmp_eq_u32 vcc, 9, v193
    s_nop 1
    v_cndmask_b32 v179, v179, v192, vcc
    v_lshl_add_u32 v179, v193, 6, v179
    v_bfe_u32 v193, v191, 3, 2
    v_lshl_add_u32 v179, v193, 4, v179
    v_mul_u32_u24 v179, 12288, v179
    v_lshl_add_u32 v179, v190, 4, v179
    v_add_u32 v190, 832, v1
    v_mul_u32_u24 v191, 5462, v190
    v_lshrrev_b32 v191, 16, v191
    v_mul_u32_u24 v192, 12, v191
    v_sub_u32 v190, v190, v192
    v_add_u32 v191, s30, v191
    v_bfe_u32 v192, v191, 5, 1
    v_bfe_u32 v193, v191, 2, 1
    v_lshl_add_u32 v192, v192, 1, v193
    v_and_b32 v193, 3, v191
    v_lshl_add_u32 v180, v193, 2, v192
    v_lshl_add_u32 v192, v192, 2, v193
    v_lshrrev_b32 v193, 6, v191
    v_cmp_eq_u32 vcc, 9, v193
    s_nop 1
    v_cndmask_b32 v180, v180, v192, vcc
    v_lshl_add_u32 v180, v193, 6, v180
    v_bfe_u32 v193, v191, 3, 2
    v_lshl_add_u32 v180, v193, 4, v180
    v_mul_u32_u24 v180, 12288, v180
    v_lshl_add_u32 v180, v190, 4, v180
    v_add_u32 v190, 896, v1
    v_mul_u32_u24 v191, 5462, v190
    v_lshrrev_b32 v191, 16, v191
    v_mul_u32_u24 v192, 12, v191
    v_sub_u32 v190, v190, v192
    v_add_u32 v191, s30, v191
    v_bfe_u32 v192, v191, 5, 1
    v_bfe_u32 v193, v191, 2, 1
    v_lshl_add_u32 v192, v192, 1, v193
    v_and_b32 v193, 3, v191
    v_lshl_add_u32 v181, v193, 2, v192
    v_lshl_add_u32 v192, v192, 2, v193
    v_lshrrev_b32 v193, 6, v191
    v_cmp_eq_u32 vcc, 9, v193
    s_nop 1
    v_cndmask_b32 v181, v181, v192, vcc
    v_lshl_add_u32 v181, v193, 6, v181
    v_bfe_u32 v193, v191, 3, 2
    v_lshl_add_u32 v181, v193, 4, v181
    v_mul_u32_u24 v181, 12288, v181
    v_lshl_add_u32 v181, v190, 4, v181
    s_mov_b32 s4, s80
    s_and_b32 s5, s81, 0xffff
    s_mov_b32 s6, 7864320
    s_mov_b32 s7, 0x20000
    s_mul_i32 s31, s25, 15360
    s_add_u32 s31, s31, 61440
    s_mov_b32 m0, s31
    s_add_u32 s31, s31, 1024
    buffer_load_dwordx4 v167, s[4:7], s34 offen lds
    s_mov_b32 m0, s31
    s_add_u32 s31, s31, 1024
    buffer_load_dwordx4 v168, s[4:7], s34 offen lds
    s_mov_b32 m0, s31
    s_add_u32 s31, s31, 1024
    buffer_load_dwordx4 v169, s[4:7], s34 offen lds
    s_mov_b32 m0, s31
    s_add_u32 s31, s31, 1024
    buffer_load_dwordx4 v170, s[4:7], s34 offen lds
    s_mov_b32 m0, s31
    s_add_u32 s31, s31, 1024
    buffer_load_dwordx4 v171, s[4:7], s34 offen lds
    s_mov_b32 m0, s31
    s_add_u32 s31, s31, 1024
    buffer_load_dwordx4 v172, s[4:7], s34 offen lds
    s_mov_b32 m0, s31
    s_add_u32 s31, s31, 1024
    buffer_load_dwordx4 v173, s[4:7], s34 offen lds
    s_mov_b32 m0, s31
    s_add_u32 s31, s31, 1024
    buffer_load_dwordx4 v174, s[4:7], s34 offen lds
    s_mov_b32 m0, s31
    s_add_u32 s31, s31, 1024
    buffer_load_dwordx4 v175, s[4:7], s34 offen lds
    s_mov_b32 m0, s31
    s_add_u32 s31, s31, 1024
    buffer_load_dwordx4 v176, s[4:7], s34 offen lds
    s_mov_b32 m0, s31
    s_add_u32 s31, s31, 1024
    buffer_load_dwordx4 v177, s[4:7], s34 offen lds
    s_mov_b32 m0, s31
    s_add_u32 s31, s31, 1024
    buffer_load_dwordx4 v178, s[4:7], s34 offen lds
    s_mov_b32 m0, s31
    s_add_u32 s31, s31, 1024
    buffer_load_dwordx4 v179, s[4:7], s34 offen lds
    s_mov_b32 m0, s31
    s_add_u32 s31, s31, 1024
    buffer_load_dwordx4 v180, s[4:7], s34 offen lds
    s_mov_b32 m0, s31
    s_add_u32 s31, s31, 1024
    buffer_load_dwordx4 v181, s[4:7], s34 offen lds
    v_add_u32 v190, 0, v1
    v_mul_u32_u24 v191, 1639, v190
    v_lshrrev_b32 v191, 16, v191
    v_mul_u32_u24 v192, 40, v191
    v_sub_u32 v190, v190, v192
    v_mul_u32_u24 v28, 1280, v191
    v_lshl_add_u32 v28, v190, 4, v28
    v_add_u32 v190, 64, v1
    v_mul_u32_u24 v191, 1639, v190
    v_lshrrev_b32 v191, 16, v191
    v_mul_u32_u24 v192, 40, v191
    v_sub_u32 v190, v190, v192
    v_mul_u32_u24 v29, 1280, v191
    v_lshl_add_u32 v29, v190, 4, v29
    v_add_u32 v190, 128, v1
    v_mul_u32_u24 v191, 1639, v190
    v_lshrrev_b32 v191, 16, v191
    v_mul_u32_u24 v192, 40, v191
    v_sub_u32 v190, v190, v192
    v_mul_u32_u24 v30, 1280, v191
    v_lshl_add_u32 v30, v190, 4, v30
    v_add_u32 v190, 192, v1
    v_mul_u32_u24 v191, 1639, v190
    v_lshrrev_b32 v191, 16, v191
    v_mul_u32_u24 v192, 40, v191
    v_sub_u32 v190, v190, v192
    v_mul_u32_u24 v31, 1280, v191
    v_lshl_add_u32 v31, v190, 4, v31
    v_add_u32 v190, 256, v1
    v_mul_u32_u24 v191, 1639, v190
    v_lshrrev_b32 v191, 16, v191
    v_mul_u32_u24 v192, 40, v191
    v_sub_u32 v190, v190, v192
    v_mul_u32_u24 v32, 1280, v191
    v_lshl_add_u32 v32, v190, 4, v32
    v_lshrrev_b32 v26, 1, v24
    v_and_b32 v27, 1, v24
    v_mul_u32_u24 v15, 400, v26
    v_lshl_add_u32 v15, v27, 6, v15
    v_lshl_add_u32 v15, v25, 4, v15
    v_add_u32 v15, 139264, v15
    v_mov_b32 v6, 0x4444
    v_mov_b32 v26, 0xeeee
    v_cmp_eq_u32 vcc, 1, v27
    s_nop 1
    v_cndmask_b32 v6, v6, v26, vcc
    s_mul_i32 s30, s51, 1536
    s_cmp_ge_u32 s25, 2
    s_cselect_b32 s31, 3072, 0
    s_cselect_b32 s32, 3, 2
    s_add_u32 s30, s30, s31
    s_add_u32 s30, s30, 133120
    v_lshlrev_b32 v7, 5, v24
    v_lshlrev_b32 v26, s32, v25
    v_add3_u32 v7, v7, v26, s30
    v_lshrrev_b32 v26, 2, v24
    v_lshl_add_u32 v26, v25, 2, v26
    v_lshlrev_b32 v26, 5, v26
    v_and_b32 v27, 1, v24
    v_lshl_add_u32 v8, v27, 3, v26
    v_add_u32 v8, 133120, v8
    v_and_b32 v27, 3, v24
    v_lshl_add_u32 v9, v27, 3, v26
    v_add_u32 v9, 136192, v9
    v_and_b32 v26, 7, v24
    v_lshl_add_u32 v26, v25, 3, v26
    v_lshlrev_b32 v11, 4, v26
    s_lshl_b32 s30, s25, 9
    v_add_u32 v10, s30, v11
    v_bfe_u32 v27, v24, 3, 1
    v_lshl_add_u32 v0, v27, 9, v11
    v_add_u32 v0, 512, v0
    v_lshl_add_u32 v11, v27, 11, v11
    v_mov_b32 v27, 2147483632
    s_cmp_lt_u32 s25, 3
    s_cselect_b32 s30, 8, 0
    v_cmp_gt_u32 vcc, s30, v24
    s_nop 1
    v_cndmask_b32 v10, v27, v10, vcc
    s_lshl_b32 s30, s25, 10
    v_add_u32 v12, s30, v2
    v_min_u32 v26, 8, v24
    v_mul_u32_u24 v14, 400, v26
    v_lshl_add_u32 v14, v25, 3, v14
    s_mul_i32 s30, s25, 96
    s_add_u32 s30, s30, 139264
    v_add_u32 v14, s30, v14
    s_lshl_b32 s30, s26, 4
    s_lshr_b32 s31, s22, 1
    s_mul_i32 s31, s31, 640
    s_lshl_b32 s32, s25, 2
    s_add_u32 s32, s32, s30
    v_lshrrev_b32 v26, 2, v24
    v_add_u32 v27, s32, v26
    v_mul_u32_u24 v16, 10240, v27
    v_add_u32 v16, s31, v16
    v_and_b32 v27, 3, v24
    v_lshl_add_u32 v16, v27, 4, v16
    v_lshl_add_u32 v16, v25, 7, v16
    v_add_u32 v26, s32, v25
    v_mul_u32_u24 v17, 10240, v26
    v_lshl_add_u32 v17, v24, 2, v17
    s_add_u32 s32, s31, 512
    v_add_u32 v17, s32, v17
    v_min_u32 v26, 9, v24
    s_mul_i32 s30, s25, 10
    v_add_u32 v26, s30, v26
    v_mul_u32_u24 v18, 2560, v25
    v_lshl_add_u32 v18, v26, 4, v18
    s_mul_i32 s30, s22, 10240
    v_add_u32 v18, s30, v18
    s_lshr_b32 s30, s22, 4
    s_mul_i32 s30, s30, 20
    s_and_b32 s31, s22, 15
    s_add_u32 s32, s30, s31
    s_lshl_b32 s32, s32, 8
    v_lshlrev_b32 v27, 3, v26
    v_add_u32 v19, s32, v27
    s_lshr_b32 s31, s31, 2
    s_add_u32 s30, s30, s31
    s_add_u32 s30, s30, 15
    s_lshl_b32 s30, s30, 8
    s_and_b32 s31, s22, 3
    s_lshl_b32 s31, s31, 6
    s_add_u32 s30, s30, s31
    v_add_u32 v27, s30, v27
    v_cmp_le_u32 vcc, 32, v26
    s_nop 1
    v_cndmask_b32 v19, v19, v27, vcc
    v_and_b32 v27, 1, v1
    v_cmp_eq_u32 vcc, 0, v27
    v_cmp_gt_u32 s[30:31], 10, v1
    s_and_b64 vcc, vcc, s[30:31]
    v_mov_b32 v27, 2147483632
    s_nop 1
    v_cndmask_b32 v19, v27, v19, vcc
    v_lshrrev_b32 v25, 4, v1
    s_mul_i32 s30, s25, 30720
    v_add_u32 v20, s30, v2
    v_lshrrev_b32 v26, 2, v24
    v_lshlrev_b32 v26, 1, v26
    v_and_b32 v27, 1, v24
    v_add_u32 v26, v26, v27
    v_lshl_add_u32 v26, v25, 3, v26
    v_lshlrev_b32 v21, 4, v26
    s_mul_i32 s30, s26, 1536
    v_add_u32 v21, s30, v21
    v_and_b32 v27, 3, v24
    v_cmp_gt_u32 vcc, 2, v27
    v_mov_b32 v27, 2147483632
    s_nop 1
    v_cndmask_b32 v21, v27, v21, vcc
    s_lshl_b32 s30, s20, 6
    s_add_u32 s31, s30, s23
    s_lshl_b32 s27, s31, 11
    s_add_u32 s27, s27, 180355072
    s_and_b32 s28, s31, 0xfffffffe
    s_lshl_b32 s28, s28, 11
    s_add_u32 s28, s28, 180355072
    s_lshl_b32 s29, s31, 12
    s_add_u32 s29, s29, 180617216
    s_and_b32 s32, s31, 0xfffffffe
    s_lshr_b32 s33, s25, 1
    s_add_u32 s32, s32, s33
    s_lshl_b32 s32, s32, 12
    s_lshl_b32 s33, s51, 11
    s_add_u32 s32, s32, s33
    s_add_u32 s37, s32, 180617216
    s_lshl_b32 s30, s20, 1
    s_add_u32 s31, s30, s21
    s_mul_i32 s38, s31, 327680
    s_add_u32 s38, s38, 181141504
    s_mul_i32 s39, s31, 675840
    s_add_u32 s39, s39, 182501376
    s_mul_i32 s32, s22, 640
    s_mul_i32 s33, s25, 160
    s_add_u32 s32, s32, s33
    s_add_u32 s32, s32, 185204736
    s_mul_i32 s40, s20, 40960
    s_add_u32 s40, s40, s32
    s_add_u32 s93, s40, 20480
    s_mul_i32 s30, s20, 2048
    s_add_u32 s30, s30, s24
    s_mul_i32 s42, s30, 12288
    s_add_u32 s43, s42, 100663296
    s_mul_i32 s31, s25, 3072
    s_add_u32 s43, s43, s31
    s_add_u32 s42, s42, 50331648
    s_mul_i32 s31, s26, 3072
    s_add_u32 s42, s42, s31
    s_mul_i32 s31, s51, 6144
    s_add_u32 s76, s42, s31
    s_add_u32 s76, s76, 786432
    s_mul_i32 s31, s26, 6144
    s_sub_u32 s53, s43, s31
    s_mul_i32 s53, s25, 3072
    s_sub_u32 s53, s43, s53
    s_add_u32 s53, s53, s31
    s_mul_i32 s31, s51, 3072
    s_add_u32 s53, s53, s31
    s_add_u32 s53, s53, 393216
    s_cmp_ge_u32 s25, 2
    s_cselect_b32 s76, s53, s76
    s_add_u32 s53, s25, 3
    s_and_b32 s53, s53, 3
    s_lshl_b32 s58, s53, 11
    s_add_u32 s42, s42, s58
    s_cmp_eq_u32 s53, 2
    s_cselect_b32 s31, 3072, 0
    s_add_u32 s42, s42, s31
    s_cmp_eq_u32 s53, 1
    s_cselect_b32 s77, 3072, 0
    s_add_u32 s58, s58, 147456
    s_mul_i32 s44, s30, 3072
    s_add_u32 s44, s44, 150994944
    s_mul_i32 s45, s30, 4096
    s_add_u32 s45, s45, 163577856
    s_lshl_b32 s31, s25, 10
    s_add_u32 s45, s45, s31
    s_mul_i32 s52, s25, 2560
    s_lshl_b32 s30, s20, 5
    s_add_u32 s30, s30, s24
    s_lshl_b32 s30, s30, 7
    s_lshl_b32 s31, s26, 4
    s_add_u32 s30, s30, s31
    s_lshl_b32 s31, s25, 2
    s_add_u32 s30, s30, s31
    s_add_u32 s96, s30, 182468608
    s_lshl_b32 s30, s20, 6
    s_add_u32 s30, s30, s24
    s_lshl_b32 s30, s30, 7
    s_add_u32 s100, s30, 182452224
    s_mov_b32 s101, 0
    v_bfe_u32 v26, v1, 3, 1
    v_lshlrev_b32 v26, 5, v26
    v_bfe_u32 v27, v1, 5, 1
    v_lshl_add_u32 v26, v27, 3, v26
    v_bfe_u32 v27, v1, 4, 1
    v_lshl_add_u32 v26, v27, 2, v26
    v_bfe_u32 v27, v1, 2, 1
    v_add_u32 v26, v26, v27
    v_and_b32 v27, 3, v1
    v_mul_u32_u24 v148, 192, v26
    v_lshl_add_u32 v148, v27, 3, v148
    v_mul_u32_u24 v149, 640, v26
    v_lshl_add_u32 v149, v27, 5, v149
    s_mul_i32 s34, s24, 384
    s_mul_i32 s30, s26, 192
    s_add_u32 s34, s34, s30
    s_waitcnt vmcnt(15)
    s_barrier
    s_mov_b32 s4, s78
    s_and_b32 s5, s79, 0xffff
    s_mov_b32 s6, 256
    s_mov_b32 s7, 0x20000
    s_cmp_lg_u32 s25, 0
    s_cbranch_scc1 M_ch_9
    v_mov_b32 v26, 1
    v_mov_b32 v27, 32
    s_mov_b64 exec, 1
    buffer_atomic_add v26, v27, s[4:7], 0 offen
    s_mov_b64 exec, -1
M_ch_9:
    s_lshr_b32 s30, s25, 1
    s_cmp_lg_u32 s30, 0
    s_cbranch_scc1 C_sk_10
    s_mul_i32 s30, s51, 96
    s_add_u32 s30, s30, 0
    s_cmp_eq_u32 s51, 1
    s_cbranch_scc1 C_od_11
    v_add_u32 v26, s30, v148
    s_add_u32 s30, s30, 32
    ds_read_b64_tr_b16 a[0:1], v26 offset:0
    ds_read_b64_tr_b16 a[2:3], v26 offset:384
    ds_read_b64_tr_b16 a[4:5], v26 offset:3072
    ds_read_b64_tr_b16 a[6:7], v26 offset:3456
    s_waitcnt lgkmcnt(8)
    ds_read_b64_tr_b16 a[8:9], v26 offset:12288
    ds_read_b64_tr_b16 a[10:11], v26 offset:12672
    ds_read_b64_tr_b16 a[12:13], v26 offset:15360
    ds_read_b64_tr_b16 a[14:15], v26 offset:15744
    s_waitcnt lgkmcnt(8)
    ds_read_b64_tr_b16 a[16:17], v26 offset:24576
    ds_read_b64_tr_b16 a[18:19], v26 offset:24960
    ds_read_b64_tr_b16 a[20:21], v26 offset:27648
    ds_read_b64_tr_b16 a[22:23], v26 offset:28032
    s_waitcnt lgkmcnt(8)
    ds_read_b64_tr_b16 a[24:25], v26 offset:36864
    ds_read_b64_tr_b16 a[26:27], v26 offset:37248
    ds_read_b64_tr_b16 a[28:29], v26 offset:39936
    ds_read_b64_tr_b16 a[30:31], v26 offset:40320
    s_waitcnt lgkmcnt(8)
    ds_read_b64_tr_b16 a[32:33], v26 offset:49152
    ds_read_b64_tr_b16 a[34:35], v26 offset:49536
    ds_read_b64_tr_b16 a[36:37], v26 offset:52224
    ds_read_b64_tr_b16 a[38:39], v26 offset:52608
    s_waitcnt lgkmcnt(8)
    v_add_u32 v26, s30, v148
    s_add_u32 s30, s30, 32
    ds_read_b64_tr_b16 a[80:81], v26 offset:0
    ds_read_b64_tr_b16 a[82:83], v26 offset:384
    ds_read_b64_tr_b16 a[84:85], v26 offset:3072
    ds_read_b64_tr_b16 a[86:87], v26 offset:3456
    s_waitcnt lgkmcnt(8)
    ds_read_b64_tr_b16 a[88:89], v26 offset:12288
    ds_read_b64_tr_b16 a[90:91], v26 offset:12672
    ds_read_b64_tr_b16 a[92:93], v26 offset:15360
    ds_read_b64_tr_b16 a[94:95], v26 offset:15744
    s_waitcnt lgkmcnt(8)
    ds_read_b64_tr_b16 a[96:97], v26 offset:24576
    ds_read_b64_tr_b16 a[98:99], v26 offset:24960
    ds_read_b64_tr_b16 a[100:101], v26 offset:27648
    ds_read_b64_tr_b16 a[102:103], v26 offset:28032
    s_waitcnt lgkmcnt(8)
    ds_read_b64_tr_b16 a[104:105], v26 offset:36864
    ds_read_b64_tr_b16 a[106:107], v26 offset:37248
    ds_read_b64_tr_b16 a[108:109], v26 offset:39936
    ds_read_b64_tr_b16 a[110:111], v26 offset:40320
    s_waitcnt lgkmcnt(8)
    ds_read_b64_tr_b16 a[112:113], v26 offset:49152
    ds_read_b64_tr_b16 a[114:115], v26 offset:49536
    ds_read_b64_tr_b16 a[116:117], v26 offset:52224
    ds_read_b64_tr_b16 a[118:119], v26 offset:52608
    s_waitcnt lgkmcnt(8)
    v_add_u32 v26, s30, v148
    s_add_u32 s30, s30, 32
    ds_read_b64_tr_b16 a[160:161], v26 offset:0
    ds_read_b64_tr_b16 a[162:163], v26 offset:384
    ds_read_b64_tr_b16 a[164:165], v26 offset:3072
    ds_read_b64_tr_b16 a[166:167], v26 offset:3456
    s_waitcnt lgkmcnt(8)
    ds_read_b64_tr_b16 a[168:169], v26 offset:12288
    ds_read_b64_tr_b16 a[170:171], v26 offset:12672
    ds_read_b64_tr_b16 a[172:173], v26 offset:15360
    ds_read_b64_tr_b16 a[174:175], v26 offset:15744
    s_waitcnt lgkmcnt(8)
    ds_read_b64_tr_b16 a[176:177], v26 offset:24576
    ds_read_b64_tr_b16 a[178:179], v26 offset:24960
    ds_read_b64_tr_b16 a[180:181], v26 offset:27648
    ds_read_b64_tr_b16 a[182:183], v26 offset:28032
    s_waitcnt lgkmcnt(8)
    ds_read_b64_tr_b16 a[184:185], v26 offset:36864
    ds_read_b64_tr_b16 a[186:187], v26 offset:37248
    ds_read_b64_tr_b16 a[188:189], v26 offset:39936
    ds_read_b64_tr_b16 a[190:191], v26 offset:40320
    s_waitcnt lgkmcnt(8)
    ds_read_b64_tr_b16 a[192:193], v26 offset:49152
    ds_read_b64_tr_b16 a[194:195], v26 offset:49536
    ds_read_b64_tr_b16 a[196:197], v26 offset:52224
    ds_read_b64_tr_b16 a[198:199], v26 offset:52608
    s_waitcnt lgkmcnt(8)
    s_branch C_sk_10
C_od_11:
    v_add_u32 v26, s30, v148
    s_add_u32 s30, s30, 32
    ds_read_b64_tr_b16 a[40:41], v26 offset:0
    ds_read_b64_tr_b16 a[42:43], v26 offset:384
    ds_read_b64_tr_b16 a[44:45], v26 offset:3072
    ds_read_b64_tr_b16 a[46:47], v26 offset:3456
    s_waitcnt lgkmcnt(8)
    ds_read_b64_tr_b16 a[48:49], v26 offset:12288
    ds_read_b64_tr_b16 a[50:51], v26 offset:12672
    ds_read_b64_tr_b16 a[52:53], v26 offset:15360
    ds_read_b64_tr_b16 a[54:55], v26 offset:15744
    s_waitcnt lgkmcnt(8)
    ds_read_b64_tr_b16 a[56:57], v26 offset:24576
    ds_read_b64_tr_b16 a[58:59], v26 offset:24960
    ds_read_b64_tr_b16 a[60:61], v26 offset:27648
    ds_read_b64_tr_b16 a[62:63], v26 offset:28032
    s_waitcnt lgkmcnt(8)
    ds_read_b64_tr_b16 a[64:65], v26 offset:36864
    ds_read_b64_tr_b16 a[66:67], v26 offset:37248
    ds_read_b64_tr_b16 a[68:69], v26 offset:39936
    ds_read_b64_tr_b16 a[70:71], v26 offset:40320
    s_waitcnt lgkmcnt(8)
    ds_read_b64_tr_b16 a[72:73], v26 offset:49152
    ds_read_b64_tr_b16 a[74:75], v26 offset:49536
    ds_read_b64_tr_b16 a[76:77], v26 offset:52224
    ds_read_b64_tr_b16 a[78:79], v26 offset:52608
    s_waitcnt lgkmcnt(8)
    v_add_u32 v26, s30, v148
    s_add_u32 s30, s30, 32
    ds_read_b64_tr_b16 a[120:121], v26 offset:0
    ds_read_b64_tr_b16 a[122:123], v26 offset:384
    ds_read_b64_tr_b16 a[124:125], v26 offset:3072
    ds_read_b64_tr_b16 a[126:127], v26 offset:3456
    s_waitcnt lgkmcnt(8)
    ds_read_b64_tr_b16 a[128:129], v26 offset:12288
    ds_read_b64_tr_b16 a[130:131], v26 offset:12672
    ds_read_b64_tr_b16 a[132:133], v26 offset:15360
    ds_read_b64_tr_b16 a[134:135], v26 offset:15744
    s_waitcnt lgkmcnt(8)
    ds_read_b64_tr_b16 a[136:137], v26 offset:24576
    ds_read_b64_tr_b16 a[138:139], v26 offset:24960
    ds_read_b64_tr_b16 a[140:141], v26 offset:27648
    ds_read_b64_tr_b16 a[142:143], v26 offset:28032
    s_waitcnt lgkmcnt(8)
    ds_read_b64_tr_b16 a[144:145], v26 offset:36864
    ds_read_b64_tr_b16 a[146:147], v26 offset:37248
    ds_read_b64_tr_b16 a[148:149], v26 offset:39936
    ds_read_b64_tr_b16 a[150:151], v26 offset:40320
    s_waitcnt lgkmcnt(8)
    ds_read_b64_tr_b16 a[152:153], v26 offset:49152
    ds_read_b64_tr_b16 a[154:155], v26 offset:49536
    ds_read_b64_tr_b16 a[156:157], v26 offset:52224
    ds_read_b64_tr_b16 a[158:159], v26 offset:52608
    s_waitcnt lgkmcnt(8)
    v_add_u32 v26, s30, v148
    s_add_u32 s30, s30, 32
    ds_read_b64_tr_b16 a[200:201], v26 offset:0
    ds_read_b64_tr_b16 a[202:203], v26 offset:384
    ds_read_b64_tr_b16 a[204:205], v26 offset:3072
    ds_read_b64_tr_b16 a[206:207], v26 offset:3456
    s_waitcnt lgkmcnt(8)
    ds_read_b64_tr_b16 a[208:209], v26 offset:12288
    ds_read_b64_tr_b16 a[210:211], v26 offset:12672
    ds_read_b64_tr_b16 a[212:213], v26 offset:15360
    ds_read_b64_tr_b16 a[214:215], v26 offset:15744
    s_waitcnt lgkmcnt(8)
    ds_read_b64_tr_b16 a[216:217], v26 offset:24576
    ds_read_b64_tr_b16 a[218:219], v26 offset:24960
    ds_read_b64_tr_b16 a[220:221], v26 offset:27648
    ds_read_b64_tr_b16 a[222:223], v26 offset:28032
    s_waitcnt lgkmcnt(8)
    ds_read_b64_tr_b16 a[224:225], v26 offset:36864
    ds_read_b64_tr_b16 a[226:227], v26 offset:37248
    ds_read_b64_tr_b16 a[228:229], v26 offset:39936
    ds_read_b64_tr_b16 a[230:231], v26 offset:40320
    s_waitcnt lgkmcnt(8)
    ds_read_b64_tr_b16 a[232:233], v26 offset:49152
    ds_read_b64_tr_b16 a[234:235], v26 offset:49536
    ds_read_b64_tr_b16 a[236:237], v26 offset:52224
    ds_read_b64_tr_b16 a[238:239], v26 offset:52608
    s_waitcnt lgkmcnt(8)
C_sk_10:
    s_waitcnt lgkmcnt(0)
    s_barrier
    s_mov_b32 s4, s82
    s_and_b32 s5, s83, 0xffff
    s_mov_b32 s6, 7864320
    s_mov_b32 s7, 0x20000
    s_mul_i32 s31, s25, 15360
    s_add_u32 s31, s31, 0
    s_mov_b32 m0, s31
    s_add_u32 s31, s31, 1024
    buffer_load_dwordx4 v152, s[4:7], s34 offen lds
    s_mov_b32 m0, s31
    s_add_u32 s31, s31, 1024
    buffer_load_dwordx4 v153, s[4:7], s34 offen lds
    s_mov_b32 m0, s31
    s_add_u32 s31, s31, 1024
    buffer_load_dwordx4 v154, s[4:7], s34 offen lds
    s_mov_b32 m0, s31
    s_add_u32 s31, s31, 1024
    buffer_load_dwordx4 v155, s[4:7], s34 offen lds
    s_mov_b32 m0, s31
    s_add_u32 s31, s31, 1024
    buffer_load_dwordx4 v156, s[4:7], s34 offen lds
    s_mov_b32 m0, s31
    s_add_u32 s31, s31, 1024
    buffer_load_dwordx4 v157, s[4:7], s34 offen lds
    s_mov_b32 m0, s31
    s_add_u32 s31, s31, 1024
    buffer_load_dwordx4 v158, s[4:7], s34 offen lds
    s_mov_b32 m0, s31
    s_add_u32 s31, s31, 1024
    buffer_load_dwordx4 v159, s[4:7], s34 offen lds
    s_mov_b32 m0, s31
    s_add_u32 s31, s31, 1024
    buffer_load_dwordx4 v160, s[4:7], s34 offen lds
    s_mov_b32 m0, s31
    s_add_u32 s31, s31, 1024
    buffer_load_dwordx4 v161, s[4:7], s34 offen lds
    s_mov_b32 m0, s31
    s_add_u32 s31, s31, 1024
    buffer_load_dwordx4 v162, s[4:7], s34 offen lds
    s_mov_b32 m0, s31
    s_add_u32 s31, s31, 1024
    buffer_load_dwordx4 v163, s[4:7], s34 offen lds
    s_mov_b32 m0, s31
    s_add_u32 s31, s31, 1024
    buffer_load_dwordx4 v164, s[4:7], s34 offen lds
    s_mov_b32 m0, s31
    s_add_u32 s31, s31, 1024
    buffer_load_dwordx4 v165, s[4:7], s34 offen lds
    s_mov_b32 m0, s31
    s_add_u32 s31, s31, 1024
    buffer_load_dwordx4 v166, s[4:7], s34 offen lds
    s_waitcnt vmcnt(15)
    s_barrier
    s_lshr_b32 s30, s25, 1
    s_cmp_lg_u32 s30, 0
    s_cbranch_scc1 C_sk_12
    s_mul_i32 s30, s51, 96
    s_add_u32 s30, s30, 61440
    s_cmp_eq_u32 s51, 1
    s_cbranch_scc1 C_od_13
    v_add_u32 v26, s30, v148
    s_add_u32 s30, s30, 32
    ds_read_b64_tr_b16 a[40:41], v26 offset:0
    ds_read_b64_tr_b16 a[42:43], v26 offset:384
    ds_read_b64_tr_b16 a[44:45], v26 offset:3072
    ds_read_b64_tr_b16 a[46:47], v26 offset:3456
    s_waitcnt lgkmcnt(8)
    ds_read_b64_tr_b16 a[48:49], v26 offset:12288
    ds_read_b64_tr_b16 a[50:51], v26 offset:12672
    ds_read_b64_tr_b16 a[52:53], v26 offset:15360
    ds_read_b64_tr_b16 a[54:55], v26 offset:15744
    s_waitcnt lgkmcnt(8)
    ds_read_b64_tr_b16 a[56:57], v26 offset:24576
    ds_read_b64_tr_b16 a[58:59], v26 offset:24960
    ds_read_b64_tr_b16 a[60:61], v26 offset:27648
    ds_read_b64_tr_b16 a[62:63], v26 offset:28032
    s_waitcnt lgkmcnt(8)
    ds_read_b64_tr_b16 a[64:65], v26 offset:36864
    ds_read_b64_tr_b16 a[66:67], v26 offset:37248
    ds_read_b64_tr_b16 a[68:69], v26 offset:39936
    ds_read_b64_tr_b16 a[70:71], v26 offset:40320
    s_waitcnt lgkmcnt(8)
    ds_read_b64_tr_b16 a[72:73], v26 offset:49152
    ds_read_b64_tr_b16 a[74:75], v26 offset:49536
    ds_read_b64_tr_b16 a[76:77], v26 offset:52224
    ds_read_b64_tr_b16 a[78:79], v26 offset:52608
    s_waitcnt lgkmcnt(8)
    v_add_u32 v26, s30, v148
    s_add_u32 s30, s30, 32
    ds_read_b64_tr_b16 a[120:121], v26 offset:0
    ds_read_b64_tr_b16 a[122:123], v26 offset:384
    ds_read_b64_tr_b16 a[124:125], v26 offset:3072
    ds_read_b64_tr_b16 a[126:127], v26 offset:3456
    s_waitcnt lgkmcnt(8)
    ds_read_b64_tr_b16 a[128:129], v26 offset:12288
    ds_read_b64_tr_b16 a[130:131], v26 offset:12672
    ds_read_b64_tr_b16 a[132:133], v26 offset:15360
    ds_read_b64_tr_b16 a[134:135], v26 offset:15744
    s_waitcnt lgkmcnt(8)
    ds_read_b64_tr_b16 a[136:137], v26 offset:24576
    ds_read_b64_tr_b16 a[138:139], v26 offset:24960
    ds_read_b64_tr_b16 a[140:141], v26 offset:27648
    ds_read_b64_tr_b16 a[142:143], v26 offset:28032
    s_waitcnt lgkmcnt(8)
    ds_read_b64_tr_b16 a[144:145], v26 offset:36864
    ds_read_b64_tr_b16 a[146:147], v26 offset:37248
    ds_read_b64_tr_b16 a[148:149], v26 offset:39936
    ds_read_b64_tr_b16 a[150:151], v26 offset:40320
    s_waitcnt lgkmcnt(8)
    ds_read_b64_tr_b16 a[152:153], v26 offset:49152
    ds_read_b64_tr_b16 a[154:155], v26 offset:49536
    ds_read_b64_tr_b16 a[156:157], v26 offset:52224
    ds_read_b64_tr_b16 a[158:159], v26 offset:52608
    s_waitcnt lgkmcnt(8)
    v_add_u32 v26, s30, v148
    s_add_u32 s30, s30, 32
    ds_read_b64_tr_b16 a[200:201], v26 offset:0
    ds_read_b64_tr_b16 a[202:203], v26 offset:384
    ds_read_b64_tr_b16 a[204:205], v26 offset:3072
    ds_read_b64_tr_b16 a[206:207], v26 offset:3456
    s_waitcnt lgkmcnt(8)
    ds_read_b64_tr_b16 a[208:209], v26 offset:12288
    ds_read_b64_tr_b16 a[210:211], v26 offset:12672
    ds_read_b64_tr_b16 a[212:213], v26 offset:15360
    ds_read_b64_tr_b16 a[214:215], v26 offset:15744
    s_waitcnt lgkmcnt(8)
    ds_read_b64_tr_b16 a[216:217], v26 offset:24576
    ds_read_b64_tr_b16 a[218:219], v26 offset:24960
    ds_read_b64_tr_b16 a[220:221], v26 offset:27648
    ds_read_b64_tr_b16 a[222:223], v26 offset:28032
    s_waitcnt lgkmcnt(8)
    ds_read_b64_tr_b16 a[224:225], v26 offset:36864
    ds_read_b64_tr_b16 a[226:227], v26 offset:37248
    ds_read_b64_tr_b16 a[228:229], v26 offset:39936
    ds_read_b64_tr_b16 a[230:231], v26 offset:40320
    s_waitcnt lgkmcnt(8)
    ds_read_b64_tr_b16 a[232:233], v26 offset:49152
    ds_read_b64_tr_b16 a[234:235], v26 offset:49536
    ds_read_b64_tr_b16 a[236:237], v26 offset:52224
    ds_read_b64_tr_b16 a[238:239], v26 offset:52608
    s_waitcnt lgkmcnt(8)
    s_branch C_sk_12
C_od_13:
    v_add_u32 v26, s30, v148
    s_add_u32 s30, s30, 32
    ds_read_b64_tr_b16 a[0:1], v26 offset:0
    ds_read_b64_tr_b16 a[2:3], v26 offset:384
    ds_read_b64_tr_b16 a[4:5], v26 offset:3072
    ds_read_b64_tr_b16 a[6:7], v26 offset:3456
    s_waitcnt lgkmcnt(8)
    ds_read_b64_tr_b16 a[8:9], v26 offset:12288
    ds_read_b64_tr_b16 a[10:11], v26 offset:12672
    ds_read_b64_tr_b16 a[12:13], v26 offset:15360
    ds_read_b64_tr_b16 a[14:15], v26 offset:15744
    s_waitcnt lgkmcnt(8)
    ds_read_b64_tr_b16 a[16:17], v26 offset:24576
    ds_read_b64_tr_b16 a[18:19], v26 offset:24960
    ds_read_b64_tr_b16 a[20:21], v26 offset:27648
    ds_read_b64_tr_b16 a[22:23], v26 offset:28032
    s_waitcnt lgkmcnt(8)
    ds_read_b64_tr_b16 a[24:25], v26 offset:36864
    ds_read_b64_tr_b16 a[26:27], v26 offset:37248
    ds_read_b64_tr_b16 a[28:29], v26 offset:39936
    ds_read_b64_tr_b16 a[30:31], v26 offset:40320
    s_waitcnt lgkmcnt(8)
    ds_read_b64_tr_b16 a[32:33], v26 offset:49152
    ds_read_b64_tr_b16 a[34:35], v26 offset:49536
    ds_read_b64_tr_b16 a[36:37], v26 offset:52224
    ds_read_b64_tr_b16 a[38:39], v26 offset:52608
    s_waitcnt lgkmcnt(8)
    v_add_u32 v26, s30, v148
    s_add_u32 s30, s30, 32
    ds_read_b64_tr_b16 a[80:81], v26 offset:0
    ds_read_b64_tr_b16 a[82:83], v26 offset:384
    ds_read_b64_tr_b16 a[84:85], v26 offset:3072
    ds_read_b64_tr_b16 a[86:87], v26 offset:3456
    s_waitcnt lgkmcnt(8)
    ds_read_b64_tr_b16 a[88:89], v26 offset:12288
    ds_read_b64_tr_b16 a[90:91], v26 offset:12672
    ds_read_b64_tr_b16 a[92:93], v26 offset:15360
    ds_read_b64_tr_b16 a[94:95], v26 offset:15744
    s_waitcnt lgkmcnt(8)
    ds_read_b64_tr_b16 a[96:97], v26 offset:24576
    ds_read_b64_tr_b16 a[98:99], v26 offset:24960
    ds_read_b64_tr_b16 a[100:101], v26 offset:27648
    ds_read_b64_tr_b16 a[102:103], v26 offset:28032
    s_waitcnt lgkmcnt(8)
    ds_read_b64_tr_b16 a[104:105], v26 offset:36864
    ds_read_b64_tr_b16 a[106:107], v26 offset:37248
    ds_read_b64_tr_b16 a[108:109], v26 offset:39936
    ds_read_b64_tr_b16 a[110:111], v26 offset:40320
    s_waitcnt lgkmcnt(8)
    ds_read_b64_tr_b16 a[112:113], v26 offset:49152
    ds_read_b64_tr_b16 a[114:115], v26 offset:49536
    ds_read_b64_tr_b16 a[116:117], v26 offset:52224
    ds_read_b64_tr_b16 a[118:119], v26 offset:52608
    s_waitcnt lgkmcnt(8)
    v_add_u32 v26, s30, v148
    s_add_u32 s30, s30, 32
    ds_read_b64_tr_b16 a[160:161], v26 offset:0
    ds_read_b64_tr_b16 a[162:163], v26 offset:384
    ds_read_b64_tr_b16 a[164:165], v26 offset:3072
    ds_read_b64_tr_b16 a[166:167], v26 offset:3456
    s_waitcnt lgkmcnt(8)
    ds_read_b64_tr_b16 a[168:169], v26 offset:12288
    ds_read_b64_tr_b16 a[170:171], v26 offset:12672
    ds_read_b64_tr_b16 a[172:173], v26 offset:15360
    ds_read_b64_tr_b16 a[174:175], v26 offset:15744
    s_waitcnt lgkmcnt(8)
    ds_read_b64_tr_b16 a[176:177], v26 offset:24576
    ds_read_b64_tr_b16 a[178:179], v26 offset:24960
    ds_read_b64_tr_b16 a[180:181], v26 offset:27648
    ds_read_b64_tr_b16 a[182:183], v26 offset:28032
    s_waitcnt lgkmcnt(8)
    ds_read_b64_tr_b16 a[184:185], v26 offset:36864
    ds_read_b64_tr_b16 a[186:187], v26 offset:37248
    ds_read_b64_tr_b16 a[188:189], v26 offset:39936
    ds_read_b64_tr_b16 a[190:191], v26 offset:40320
    s_waitcnt lgkmcnt(8)
    ds_read_b64_tr_b16 a[192:193], v26 offset:49152
    ds_read_b64_tr_b16 a[194:195], v26 offset:49536
    ds_read_b64_tr_b16 a[196:197], v26 offset:52224
    ds_read_b64_tr_b16 a[198:199], v26 offset:52608
    s_waitcnt lgkmcnt(8)
C_sk_12:
    s_waitcnt lgkmcnt(0)
    s_barrier
    s_mov_b32 s4, s82
    s_and_b32 s5, s83, 0xffff
    s_mov_b32 s6, 7864320
    s_mov_b32 s7, 0x20000
    s_mul_i32 s31, s25, 15360
    s_add_u32 s31, s31, 61440
    s_mov_b32 m0, s31
    s_add_u32 s31, s31, 1024
    buffer_load_dwordx4 v167, s[4:7], s34 offen lds
    s_mov_b32 m0, s31
    s_add_u32 s31, s31, 1024
    buffer_load_dwordx4 v168, s[4:7], s34 offen lds
    s_mov_b32 m0, s31
    s_add_u32 s31, s31, 1024
    buffer_load_dwordx4 v169, s[4:7], s34 offen lds
    s_mov_b32 m0, s31
    s_add_u32 s31, s31, 1024
    buffer_load_dwordx4 v170, s[4:7], s34 offen lds
    s_mov_b32 m0, s31
    s_add_u32 s31, s31, 1024
    buffer_load_dwordx4 v171, s[4:7], s34 offen lds
    s_mov_b32 m0, s31
    s_add_u32 s31, s31, 1024
    buffer_load_dwordx4 v172, s[4:7], s34 offen lds
    s_mov_b32 m0, s31
    s_add_u32 s31, s31, 1024
    buffer_load_dwordx4 v173, s[4:7], s34 offen lds
    s_mov_b32 m0, s31
    s_add_u32 s31, s31, 1024
    buffer_load_dwordx4 v174, s[4:7], s34 offen lds
    s_mov_b32 m0, s31
    s_add_u32 s31, s31, 1024
    buffer_load_dwordx4 v175, s[4:7], s34 offen lds
    s_mov_b32 m0, s31
    s_add_u32 s31, s31, 1024
    buffer_load_dwordx4 v176, s[4:7], s34 offen lds
    s_mov_b32 m0, s31
    s_add_u32 s31, s31, 1024
    buffer_load_dwordx4 v177, s[4:7], s34 offen lds
    s_mov_b32 m0, s31
    s_add_u32 s31, s31, 1024
    buffer_load_dwordx4 v178, s[4:7], s34 offen lds
    s_mov_b32 m0, s31
    s_add_u32 s31, s31, 1024
    buffer_load_dwordx4 v179, s[4:7], s34 offen lds
    s_mov_b32 m0, s31
    s_add_u32 s31, s31, 1024
    buffer_load_dwordx4 v180, s[4:7], s34 offen lds
    s_mov_b32 m0, s31
    s_add_u32 s31, s31, 1024
    buffer_load_dwordx4 v181, s[4:7], s34 offen lds
    s_mov_b32 s4, s88
    s_and_b32 s5, s89, 0xffff
    s_mov_b32 s6, 10240
    s_mov_b32 s7, 0x20000
    s_mul_i32 s30, s25, 3072
    s_add_u32 m0, s30, 151552
    s_nop 0
    buffer_load_dwordx4 v2, s[4:7], s30 offen offset:0 lds
    buffer_load_dwordx4 v2, s[4:7], s30 offen offset:1024 lds
    buffer_load_dwordx4 v2, s[4:7], s30 offen offset:2048 lds
    s_waitcnt vmcnt(18)
    s_barrier
    s_lshr_b32 s30, s25, 1
    s_cmp_lg_u32 s30, 1
    s_cbranch_scc1 C_sk_14
    s_mul_i32 s30, s51, 96
    s_add_u32 s30, s30, 0
    s_cmp_eq_u32 s51, 1
    s_cbranch_scc1 C_od_15
    v_add_u32 v26, s30, v148
    s_add_u32 s30, s30, 32
    ds_read_b64_tr_b16 a[0:1], v26 offset:0
    ds_read_b64_tr_b16 a[2:3], v26 offset:384
    ds_read_b64_tr_b16 a[4:5], v26 offset:3072
    ds_read_b64_tr_b16 a[6:7], v26 offset:3456
    s_waitcnt lgkmcnt(8)
    ds_read_b64_tr_b16 a[8:9], v26 offset:12288
    ds_read_b64_tr_b16 a[10:11], v26 offset:12672
    ds_read_b64_tr_b16 a[12:13], v26 offset:15360
    ds_read_b64_tr_b16 a[14:15], v26 offset:15744
    s_waitcnt lgkmcnt(8)
    ds_read_b64_tr_b16 a[16:17], v26 offset:24576
    ds_read_b64_tr_b16 a[18:19], v26 offset:24960
    ds_read_b64_tr_b16 a[20:21], v26 offset:27648
    ds_read_b64_tr_b16 a[22:23], v26 offset:28032
    s_waitcnt lgkmcnt(8)
    ds_read_b64_tr_b16 a[24:25], v26 offset:36864
    ds_read_b64_tr_b16 a[26:27], v26 offset:37248
    ds_read_b64_tr_b16 a[28:29], v26 offset:39936
    ds_read_b64_tr_b16 a[30:31], v26 offset:40320
    s_waitcnt lgkmcnt(8)
    ds_read_b64_tr_b16 a[32:33], v26 offset:49152
    ds_read_b64_tr_b16 a[34:35], v26 offset:49536
    ds_read_b64_tr_b16 a[36:37], v26 offset:52224
    ds_read_b64_tr_b16 a[38:39], v26 offset:52608
    s_waitcnt lgkmcnt(8)
    v_add_u32 v26, s30, v148
    s_add_u32 s30, s30, 32
    ds_read_b64_tr_b16 a[80:81], v26 offset:0
    ds_read_b64_tr_b16 a[82:83], v26 offset:384
    ds_read_b64_tr_b16 a[84:85], v26 offset:3072
    ds_read_b64_tr_b16 a[86:87], v26 offset:3456
    s_waitcnt lgkmcnt(8)
    ds_read_b64_tr_b16 a[88:89], v26 offset:12288
    ds_read_b64_tr_b16 a[90:91], v26 offset:12672
    ds_read_b64_tr_b16 a[92:93], v26 offset:15360
    ds_read_b64_tr_b16 a[94:95], v26 offset:15744
    s_waitcnt lgkmcnt(8)
    ds_read_b64_tr_b16 a[96:97], v26 offset:24576
    ds_read_b64_tr_b16 a[98:99], v26 offset:24960
    ds_read_b64_tr_b16 a[100:101], v26 offset:27648
    ds_read_b64_tr_b16 a[102:103], v26 offset:28032
    s_waitcnt lgkmcnt(8)
    ds_read_b64_tr_b16 a[104:105], v26 offset:36864
    ds_read_b64_tr_b16 a[106:107], v26 offset:37248
    ds_read_b64_tr_b16 a[108:109], v26 offset:39936
    ds_read_b64_tr_b16 a[110:111], v26 offset:40320
    s_waitcnt lgkmcnt(8)
    ds_read_b64_tr_b16 a[112:113], v26 offset:49152
    ds_read_b64_tr_b16 a[114:115], v26 offset:49536
    ds_read_b64_tr_b16 a[116:117], v26 offset:52224
    ds_read_b64_tr_b16 a[118:119], v26 offset:52608
    s_waitcnt lgkmcnt(8)
    v_add_u32 v26, s30, v148
    s_add_u32 s30, s30, 32
    ds_read_b64_tr_b16 a[160:161], v26 offset:0
    ds_read_b64_tr_b16 a[162:163], v26 offset:384
    ds_read_b64_tr_b16 a[164:165], v26 offset:3072
    ds_read_b64_tr_b16 a[166:167], v26 offset:3456
    s_waitcnt lgkmcnt(8)
    ds_read_b64_tr_b16 a[168:169], v26 offset:12288
    ds_read_b64_tr_b16 a[170:171], v26 offset:12672
    ds_read_b64_tr_b16 a[172:173], v26 offset:15360
    ds_read_b64_tr_b16 a[174:175], v26 offset:15744
    s_waitcnt lgkmcnt(8)
    ds_read_b64_tr_b16 a[176:177], v26 offset:24576
    ds_read_b64_tr_b16 a[178:179], v26 offset:24960
    ds_read_b64_tr_b16 a[180:181], v26 offset:27648
    ds_read_b64_tr_b16 a[182:183], v26 offset:28032
    s_waitcnt lgkmcnt(8)
    ds_read_b64_tr_b16 a[184:185], v26 offset:36864
    ds_read_b64_tr_b16 a[186:187], v26 offset:37248
    ds_read_b64_tr_b16 a[188:189], v26 offset:39936
    ds_read_b64_tr_b16 a[190:191], v26 offset:40320
    s_waitcnt lgkmcnt(8)
    ds_read_b64_tr_b16 a[192:193], v26 offset:49152
    ds_read_b64_tr_b16 a[194:195], v26 offset:49536
    ds_read_b64_tr_b16 a[196:197], v26 offset:52224
    ds_read_b64_tr_b16 a[198:199], v26 offset:52608
    s_waitcnt lgkmcnt(8)
    s_branch C_sk_14
C_od_15:
    v_add_u32 v26, s30, v148
    s_add_u32 s30, s30, 32
    ds_read_b64_tr_b16 a[40:41], v26 offset:0
    ds_read_b64_tr_b16 a[42:43], v26 offset:384
    ds_read_b64_tr_b16 a[44:45], v26 offset:3072
    ds_read_b64_tr_b16 a[46:47], v26 offset:3456
    s_waitcnt lgkmcnt(8)
    ds_read_b64_tr_b16 a[48:49], v26 offset:12288
    ds_read_b64_tr_b16 a[50:51], v26 offset:12672
    ds_read_b64_tr_b16 a[52:53], v26 offset:15360
    ds_read_b64_tr_b16 a[54:55], v26 offset:15744
    s_waitcnt lgkmcnt(8)
    ds_read_b64_tr_b16 a[56:57], v26 offset:24576
    ds_read_b64_tr_b16 a[58:59], v26 offset:24960
    ds_read_b64_tr_b16 a[60:61], v26 offset:27648
    ds_read_b64_tr_b16 a[62:63], v26 offset:28032
    s_waitcnt lgkmcnt(8)
    ds_read_b64_tr_b16 a[64:65], v26 offset:36864
    ds_read_b64_tr_b16 a[66:67], v26 offset:37248
    ds_read_b64_tr_b16 a[68:69], v26 offset:39936
    ds_read_b64_tr_b16 a[70:71], v26 offset:40320
    s_waitcnt lgkmcnt(8)
    ds_read_b64_tr_b16 a[72:73], v26 offset:49152
    ds_read_b64_tr_b16 a[74:75], v26 offset:49536
    ds_read_b64_tr_b16 a[76:77], v26 offset:52224
    ds_read_b64_tr_b16 a[78:79], v26 offset:52608
    s_waitcnt lgkmcnt(8)
    v_add_u32 v26, s30, v148
    s_add_u32 s30, s30, 32
    ds_read_b64_tr_b16 a[120:121], v26 offset:0
    ds_read_b64_tr_b16 a[122:123], v26 offset:384
    ds_read_b64_tr_b16 a[124:125], v26 offset:3072
    ds_read_b64_tr_b16 a[126:127], v26 offset:3456
    s_waitcnt lgkmcnt(8)
    ds_read_b64_tr_b16 a[128:129], v26 offset:12288
    ds_read_b64_tr_b16 a[130:131], v26 offset:12672
    ds_read_b64_tr_b16 a[132:133], v26 offset:15360
    ds_read_b64_tr_b16 a[134:135], v26 offset:15744
    s_waitcnt lgkmcnt(8)
    ds_read_b64_tr_b16 a[136:137], v26 offset:24576
    ds_read_b64_tr_b16 a[138:139], v26 offset:24960
    ds_read_b64_tr_b16 a[140:141], v26 offset:27648
    ds_read_b64_tr_b16 a[142:143], v26 offset:28032
    s_waitcnt lgkmcnt(8)
    ds_read_b64_tr_b16 a[144:145], v26 offset:36864
    ds_read_b64_tr_b16 a[146:147], v26 offset:37248
    ds_read_b64_tr_b16 a[148:149], v26 offset:39936
    ds_read_b64_tr_b16 a[150:151], v26 offset:40320
    s_waitcnt lgkmcnt(8)
    ds_read_b64_tr_b16 a[152:153], v26 offset:49152
    ds_read_b64_tr_b16 a[154:155], v26 offset:49536
    ds_read_b64_tr_b16 a[156:157], v26 offset:52224
    ds_read_b64_tr_b16 a[158:159], v26 offset:52608
    s_waitcnt lgkmcnt(8)
    v_add_u32 v26, s30, v148
    s_add_u32 s30, s30, 32
    ds_read_b64_tr_b16 a[200:201], v26 offset:0
    ds_read_b64_tr_b16 a[202:203], v26 offset:384
    ds_read_b64_tr_b16 a[204:205], v26 offset:3072
    ds_read_b64_tr_b16 a[206:207], v26 offset:3456
    s_waitcnt lgkmcnt(8)
    ds_read_b64_tr_b16 a[208:209], v26 offset:12288
    ds_read_b64_tr_b16 a[210:211], v26 offset:12672
    ds_read_b64_tr_b16 a[212:213], v26 offset:15360
    ds_read_b64_tr_b16 a[214:215], v26 offset:15744
    s_waitcnt lgkmcnt(8)
    ds_read_b64_tr_b16 a[216:217], v26 offset:24576
    ds_read_b64_tr_b16 a[218:219], v26 offset:24960
    ds_read_b64_tr_b16 a[220:221], v26 offset:27648
    ds_read_b64_tr_b16 a[222:223], v26 offset:28032
    s_waitcnt lgkmcnt(8)
    ds_read_b64_tr_b16 a[224:225], v26 offset:36864
    ds_read_b64_tr_b16 a[226:227], v26 offset:37248
    ds_read_b64_tr_b16 a[228:229], v26 offset:39936
    ds_read_b64_tr_b16 a[230:231], v26 offset:40320
    s_waitcnt lgkmcnt(8)
    ds_read_b64_tr_b16 a[232:233], v26 offset:49152
    ds_read_b64_tr_b16 a[234:235], v26 offset:49536
    ds_read_b64_tr_b16 a[236:237], v26 offset:52224
    ds_read_b64_tr_b16 a[238:239], v26 offset:52608
    s_waitcnt lgkmcnt(8)
C_sk_14:
    s_waitcnt lgkmcnt(0)
    s_barrier
    s_mov_b32 s4, s84
    s_and_b32 s5, s85, 0xffff
    s_mov_b32 s6, 7864320
    s_mov_b32 s7, 0x20000
    s_mul_i32 s31, s25, 15360
    s_add_u32 s31, s31, 0
    s_mov_b32 m0, s31
    s_add_u32 s31, s31, 1024
    buffer_load_dwordx4 v152, s[4:7], s34 offen lds
    s_mov_b32 m0, s31
    s_add_u32 s31, s31, 1024
    buffer_load_dwordx4 v153, s[4:7], s34 offen lds
    s_mov_b32 m0, s31
    s_add_u32 s31, s31, 1024
    buffer_load_dwordx4 v154, s[4:7], s34 offen lds
    s_mov_b32 m0, s31
    s_add_u32 s31, s31, 1024
    buffer_load_dwordx4 v155, s[4:7], s34 offen lds
    s_mov_b32 m0, s31
    s_add_u32 s31, s31, 1024
    buffer_load_dwordx4 v156, s[4:7], s34 offen lds
    s_mov_b32 m0, s31
    s_add_u32 s31, s31, 1024
    buffer_load_dwordx4 v157, s[4:7], s34 offen lds
    s_mov_b32 m0, s31
    s_add_u32 s31, s31, 1024
    buffer_load_dwordx4 v158, s[4:7], s34 offen lds
    s_mov_b32 m0, s31
    s_add_u32 s31, s31, 1024
    buffer_load_dwordx4 v159, s[4:7], s34 offen lds
    s_mov_b32 m0, s31
    s_add_u32 s31, s31, 1024
    buffer_load_dwordx4 v160, s[4:7], s34 offen lds
    s_mov_b32 m0, s31
    s_add_u32 s31, s31, 1024
    buffer_load_dwordx4 v161, s[4:7], s34 offen lds
    s_mov_b32 m0, s31
    s_add_u32 s31, s31, 1024
    buffer_load_dwordx4 v162, s[4:7], s34 offen lds
    s_mov_b32 m0, s31
    s_add_u32 s31, s31, 1024
    buffer_load_dwordx4 v163, s[4:7], s34 offen lds
    s_mov_b32 m0, s31
    s_add_u32 s31, s31, 1024
    buffer_load_dwordx4 v164, s[4:7], s34 offen lds
    s_mov_b32 m0, s31
    s_add_u32 s31, s31, 1024
    buffer_load_dwordx4 v165, s[4:7], s34 offen lds
    s_mov_b32 m0, s31
    s_add_u32 s31, s31, 1024
    buffer_load_dwordx4 v166, s[4:7], s34 offen lds
    s_waitcnt vmcnt(15)
    s_barrier
    s_lshr_b32 s30, s25, 1
    s_cmp_lg_u32 s30, 1
    s_cbranch_scc1 C_sk_16
    s_mul_i32 s30, s51, 96
    s_add_u32 s30, s30, 61440
    s_cmp_eq_u32 s51, 1
    s_cbranch_scc1 C_od_17
    v_add_u32 v26, s30, v148
    s_add_u32 s30, s30, 32
    ds_read_b64_tr_b16 a[40:41], v26 offset:0
    ds_read_b64_tr_b16 a[42:43], v26 offset:384
    ds_read_b64_tr_b16 a[44:45], v26 offset:3072
    ds_read_b64_tr_b16 a[46:47], v26 offset:3456
    s_waitcnt lgkmcnt(8)
    ds_read_b64_tr_b16 a[48:49], v26 offset:12288
    ds_read_b64_tr_b16 a[50:51], v26 offset:12672
    ds_read_b64_tr_b16 a[52:53], v26 offset:15360
    ds_read_b64_tr_b16 a[54:55], v26 offset:15744
    s_waitcnt lgkmcnt(8)
    ds_read_b64_tr_b16 a[56:57], v26 offset:24576
    ds_read_b64_tr_b16 a[58:59], v26 offset:24960
    ds_read_b64_tr_b16 a[60:61], v26 offset:27648
    ds_read_b64_tr_b16 a[62:63], v26 offset:28032
    s_waitcnt lgkmcnt(8)
    ds_read_b64_tr_b16 a[64:65], v26 offset:36864
    ds_read_b64_tr_b16 a[66:67], v26 offset:37248
    ds_read_b64_tr_b16 a[68:69], v26 offset:39936
    ds_read_b64_tr_b16 a[70:71], v26 offset:40320
    s_waitcnt lgkmcnt(8)
    ds_read_b64_tr_b16 a[72:73], v26 offset:49152
    ds_read_b64_tr_b16 a[74:75], v26 offset:49536
    ds_read_b64_tr_b16 a[76:77], v26 offset:52224
    ds_read_b64_tr_b16 a[78:79], v26 offset:52608
    s_waitcnt lgkmcnt(8)
    v_add_u32 v26, s30, v148
    s_add_u32 s30, s30, 32
    ds_read_b64_tr_b16 a[120:121], v26 offset:0
    ds_read_b64_tr_b16 a[122:123], v26 offset:384
    ds_read_b64_tr_b16 a[124:125], v26 offset:3072
    ds_read_b64_tr_b16 a[126:127], v26 offset:3456
    s_waitcnt lgkmcnt(8)
    ds_read_b64_tr_b16 a[128:129], v26 offset:12288
    ds_read_b64_tr_b16 a[130:131], v26 offset:12672
    ds_read_b64_tr_b16 a[132:133], v26 offset:15360
    ds_read_b64_tr_b16 a[134:135], v26 offset:15744
    s_waitcnt lgkmcnt(8)
    ds_read_b64_tr_b16 a[136:137], v26 offset:24576
    ds_read_b64_tr_b16 a[138:139], v26 offset:24960
    ds_read_b64_tr_b16 a[140:141], v26 offset:27648
    ds_read_b64_tr_b16 a[142:143], v26 offset:28032
    s_waitcnt lgkmcnt(8)
    ds_read_b64_tr_b16 a[144:145], v26 offset:36864
    ds_read_b64_tr_b16 a[146:147], v26 offset:37248
    ds_read_b64_tr_b16 a[148:149], v26 offset:39936
    ds_read_b64_tr_b16 a[150:151], v26 offset:40320
    s_waitcnt lgkmcnt(8)
    ds_read_b64_tr_b16 a[152:153], v26 offset:49152
    ds_read_b64_tr_b16 a[154:155], v26 offset:49536
    ds_read_b64_tr_b16 a[156:157], v26 offset:52224
    ds_read_b64_tr_b16 a[158:159], v26 offset:52608
    s_waitcnt lgkmcnt(8)
    v_add_u32 v26, s30, v148
    s_add_u32 s30, s30, 32
    ds_read_b64_tr_b16 a[200:201], v26 offset:0
    ds_read_b64_tr_b16 a[202:203], v26 offset:384
    ds_read_b64_tr_b16 a[204:205], v26 offset:3072
    ds_read_b64_tr_b16 a[206:207], v26 offset:3456
    s_waitcnt lgkmcnt(8)
    ds_read_b64_tr_b16 a[208:209], v26 offset:12288
    ds_read_b64_tr_b16 a[210:211], v26 offset:12672
    ds_read_b64_tr_b16 a[212:213], v26 offset:15360
    ds_read_b64_tr_b16 a[214:215], v26 offset:15744
    s_waitcnt lgkmcnt(8)
    ds_read_b64_tr_b16 a[216:217], v26 offset:24576
    ds_read_b64_tr_b16 a[218:219], v26 offset:24960
    ds_read_b64_tr_b16 a[220:221], v26 offset:27648
    ds_read_b64_tr_b16 a[222:223], v26 offset:28032
    s_waitcnt lgkmcnt(8)
    ds_read_b64_tr_b16 a[224:225], v26 offset:36864
    ds_read_b64_tr_b16 a[226:227], v26 offset:37248
    ds_read_b64_tr_b16 a[228:229], v26 offset:39936
    ds_read_b64_tr_b16 a[230:231], v26 offset:40320
    s_waitcnt lgkmcnt(8)
    ds_read_b64_tr_b16 a[232:233], v26 offset:49152
    ds_read_b64_tr_b16 a[234:235], v26 offset:49536
    ds_read_b64_tr_b16 a[236:237], v26 offset:52224
    ds_read_b64_tr_b16 a[238:239], v26 offset:52608
    s_waitcnt lgkmcnt(8)
    s_branch C_sk_16
C_od_17:
    v_add_u32 v26, s30, v148
    s_add_u32 s30, s30, 32
    ds_read_b64_tr_b16 a[0:1], v26 offset:0
    ds_read_b64_tr_b16 a[2:3], v26 offset:384
    ds_read_b64_tr_b16 a[4:5], v26 offset:3072
    ds_read_b64_tr_b16 a[6:7], v26 offset:3456
    s_waitcnt lgkmcnt(8)
    ds_read_b64_tr_b16 a[8:9], v26 offset:12288
    ds_read_b64_tr_b16 a[10:11], v26 offset:12672
    ds_read_b64_tr_b16 a[12:13], v26 offset:15360
    ds_read_b64_tr_b16 a[14:15], v26 offset:15744
    s_waitcnt lgkmcnt(8)
    ds_read_b64_tr_b16 a[16:17], v26 offset:24576
    ds_read_b64_tr_b16 a[18:19], v26 offset:24960
    ds_read_b64_tr_b16 a[20:21], v26 offset:27648
    ds_read_b64_tr_b16 a[22:23], v26 offset:28032
    s_waitcnt lgkmcnt(8)
    ds_read_b64_tr_b16 a[24:25], v26 offset:36864
    ds_read_b64_tr_b16 a[26:27], v26 offset:37248
    ds_read_b64_tr_b16 a[28:29], v26 offset:39936
    ds_read_b64_tr_b16 a[30:31], v26 offset:40320
    s_waitcnt lgkmcnt(8)
    ds_read_b64_tr_b16 a[32:33], v26 offset:49152
    ds_read_b64_tr_b16 a[34:35], v26 offset:49536
    ds_read_b64_tr_b16 a[36:37], v26 offset:52224
    ds_read_b64_tr_b16 a[38:39], v26 offset:52608
    s_waitcnt lgkmcnt(8)
    v_add_u32 v26, s30, v148
    s_add_u32 s30, s30, 32
    ds_read_b64_tr_b16 a[80:81], v26 offset:0
    ds_read_b64_tr_b16 a[82:83], v26 offset:384
    ds_read_b64_tr_b16 a[84:85], v26 offset:3072
    ds_read_b64_tr_b16 a[86:87], v26 offset:3456
    s_waitcnt lgkmcnt(8)
    ds_read_b64_tr_b16 a[88:89], v26 offset:12288
    ds_read_b64_tr_b16 a[90:91], v26 offset:12672
    ds_read_b64_tr_b16 a[92:93], v26 offset:15360
    ds_read_b64_tr_b16 a[94:95], v26 offset:15744
    s_waitcnt lgkmcnt(8)
    ds_read_b64_tr_b16 a[96:97], v26 offset:24576
    ds_read_b64_tr_b16 a[98:99], v26 offset:24960
    ds_read_b64_tr_b16 a[100:101], v26 offset:27648
    ds_read_b64_tr_b16 a[102:103], v26 offset:28032
    s_waitcnt lgkmcnt(8)
    ds_read_b64_tr_b16 a[104:105], v26 offset:36864
    ds_read_b64_tr_b16 a[106:107], v26 offset:37248
    ds_read_b64_tr_b16 a[108:109], v26 offset:39936
    ds_read_b64_tr_b16 a[110:111], v26 offset:40320
    s_waitcnt lgkmcnt(8)
    ds_read_b64_tr_b16 a[112:113], v26 offset:49152
    ds_read_b64_tr_b16 a[114:115], v26 offset:49536
    ds_read_b64_tr_b16 a[116:117], v26 offset:52224
    ds_read_b64_tr_b16 a[118:119], v26 offset:52608
    s_waitcnt lgkmcnt(8)
    v_add_u32 v26, s30, v148
    s_add_u32 s30, s30, 32
    ds_read_b64_tr_b16 a[160:161], v26 offset:0
    ds_read_b64_tr_b16 a[162:163], v26 offset:384
    ds_read_b64_tr_b16 a[164:165], v26 offset:3072
    ds_read_b64_tr_b16 a[166:167], v26 offset:3456
    s_waitcnt lgkmcnt(8)
    ds_read_b64_tr_b16 a[168:169], v26 offset:12288
    ds_read_b64_tr_b16 a[170:171], v26 offset:12672
    ds_read_b64_tr_b16 a[172:173], v26 offset:15360
    ds_read_b64_tr_b16 a[174:175], v26 offset:15744
    s_waitcnt lgkmcnt(8)
    ds_read_b64_tr_b16 a[176:177], v26 offset:24576
    ds_read_b64_tr_b16 a[178:179], v26 offset:24960
    ds_read_b64_tr_b16 a[180:181], v26 offset:27648
    ds_read_b64_tr_b16 a[182:183], v26 offset:28032
    s_waitcnt lgkmcnt(8)
    ds_read_b64_tr_b16 a[184:185], v26 offset:36864
    ds_read_b64_tr_b16 a[186:187], v26 offset:37248
    ds_read_b64_tr_b16 a[188:189], v26 offset:39936
    ds_read_b64_tr_b16 a[190:191], v26 offset:40320
    s_waitcnt lgkmcnt(8)
    ds_read_b64_tr_b16 a[192:193], v26 offset:49152
    ds_read_b64_tr_b16 a[194:195], v26 offset:49536
    ds_read_b64_tr_b16 a[196:197], v26 offset:52224
    ds_read_b64_tr_b16 a[198:199], v26 offset:52608
    s_waitcnt lgkmcnt(8)
C_sk_16:
    s_waitcnt lgkmcnt(0)
    s_barrier
    s_mov_b32 s4, s84
    s_and_b32 s5, s85, 0xffff
    s_mov_b32 s6, 7864320
    s_mov_b32 s7, 0x20000
    s_mul_i32 s31, s25, 15360
    s_add_u32 s31, s31, 61440
    s_mov_b32 m0, s31
    s_add_u32 s31, s31, 1024
    buffer_load_dwordx4 v167, s[4:7], s34 offen lds
    s_mov_b32 m0, s31
    s_add_u32 s31, s31, 1024
    buffer_load_dwordx4 v168, s[4:7], s34 offen lds
    s_mov_b32 m0, s31
    s_add_u32 s31, s31, 1024
    buffer_load_dwordx4 v169, s[4:7], s34 offen lds
    s_mov_b32 m0, s31
    s_add_u32 s31, s31, 1024
    buffer_load_dwordx4 v170, s[4:7], s34 offen lds
    s_mov_b32 m0, s31
    s_add_u32 s31, s31, 1024
    buffer_load_dwordx4 v171, s[4:7], s34 offen lds
    s_mov_b32 m0, s31
    s_add_u32 s31, s31, 1024
    buffer_load_dwordx4 v172, s[4:7], s34 offen lds
    s_mov_b32 m0, s31
    s_add_u32 s31, s31, 1024
    buffer_load_dwordx4 v173, s[4:7], s34 offen lds
    s_mov_b32 m0, s31
    s_add_u32 s31, s31, 1024
    buffer_load_dwordx4 v174, s[4:7], s34 offen lds
    s_mov_b32 m0, s31
    s_add_u32 s31, s31, 1024
    buffer_load_dwordx4 v175, s[4:7], s34 offen lds
    s_mov_b32 m0, s31
    s_add_u32 s31, s31, 1024
    buffer_load_dwordx4 v176, s[4:7], s34 offen lds
    s_mov_b32 m0, s31
    s_add_u32 s31, s31, 1024
    buffer_load_dwordx4 v177, s[4:7], s34 offen lds
    s_mov_b32 m0, s31
    s_add_u32 s31, s31, 1024
    buffer_load_dwordx4 v178, s[4:7], s34 offen lds
    s_mov_b32 m0, s31
    s_add_u32 s31, s31, 1024
    buffer_load_dwordx4 v179, s[4:7], s34 offen lds
    s_mov_b32 m0, s31
    s_add_u32 s31, s31, 1024
    buffer_load_dwordx4 v180, s[4:7], s34 offen lds
    s_mov_b32 m0, s31
    s_add_u32 s31, s31, 1024
    buffer_load_dwordx4 v181, s[4:7], s34 offen lds
    s_mov_b32 s30, 0x05040100
    s_mov_b32 s31, 0x07060302
    v_add_u32 v26, 0, v5
    v_bfe_u32 v27, v26, 1, 3
    v_mul_u32_u24 v27, 1280, v27
    v_lshrrev_b32 v24, 4, v26
    v_min_u32 v24, 39, v24
    v_lshl_add_u32 v27, v24, 5, v27
    v_add_u32 v27, 151552, v27
    v_and_b32 v25, 1, v26
    v_lshl_add_u32 v190, v25, 2, v27
    v_lshl_add_u32 v191, v25, 4, v27
    v_cmp_le_u32 vcc, 20, v24
    v_subrev_u32 v25, 20, v24
    ds_read2_b32 v[200:201], v190 offset0:0 offset1:2
    v_cndmask_b32 v24, v24, v25, vcc
    ds_read2_b32 v[202:203], v190 offset0:4 offset1:6
    ds_read_b128 v[208:211], v191
    v_cmp_le_u32 vcc, 16, v24
    v_lshlrev_b32 v26, 4, v26
    v_add_u32 v26, 122880, v26
    s_waitcnt lgkmcnt(0)
    v_perm_b32 v204, v201, v200, s30
    v_perm_b32 v205, v203, v202, s30
    v_perm_b32 v206, v201, v200, s31
    v_perm_b32 v207, v203, v202, s31
    v_cndmask_b32 v208, v204, v208, vcc
    v_min_u32 v208, -2, v208
    v_cndmask_b32 v209, v205, v209, vcc
    v_min_u32 v209, -2, v209
    v_cndmask_b32 v210, v206, v210, vcc
    v_min_u32 v210, -2, v210
    v_cndmask_b32 v211, v207, v211, vcc
    v_min_u32 v211, -2, v211
    ds_write_b128 v26, v[208:211]
    v_add_u32 v26, 256, v5
    v_bfe_u32 v27, v26, 1, 3
    v_mul_u32_u24 v27, 1280, v27
    v_lshrrev_b32 v24, 4, v26
    v_min_u32 v24, 39, v24
    v_lshl_add_u32 v27, v24, 5, v27
    v_add_u32 v27, 151552, v27
    v_and_b32 v25, 1, v26
    v_lshl_add_u32 v190, v25, 2, v27
    v_lshl_add_u32 v191, v25, 4, v27
    v_cmp_le_u32 vcc, 20, v24
    v_subrev_u32 v25, 20, v24
    ds_read2_b32 v[212:213], v190 offset0:0 offset1:2
    v_cndmask_b32 v24, v24, v25, vcc
    ds_read2_b32 v[214:215], v190 offset0:4 offset1:6
    ds_read_b128 v[220:223], v191
    v_cmp_le_u32 vcc, 16, v24
    v_lshlrev_b32 v26, 4, v26
    v_add_u32 v26, 122880, v26
    s_waitcnt lgkmcnt(0)
    v_perm_b32 v216, v213, v212, s30
    v_perm_b32 v217, v215, v214, s30
    v_perm_b32 v218, v213, v212, s31
    v_perm_b32 v219, v215, v214, s31
    v_cndmask_b32 v220, v216, v220, vcc
    v_min_u32 v220, -2, v220
    v_cndmask_b32 v221, v217, v221, vcc
    v_min_u32 v221, -2, v221
    v_cndmask_b32 v222, v218, v222, vcc
    v_min_u32 v222, -2, v222
    v_cndmask_b32 v223, v219, v223, vcc
    v_min_u32 v223, -2, v223
    ds_write_b128 v26, v[220:223]
    v_add_u32 v26, 512, v5
    v_bfe_u32 v27, v26, 1, 3
    v_mul_u32_u24 v27, 1280, v27
    v_lshrrev_b32 v24, 4, v26
    v_min_u32 v24, 39, v24
    v_lshl_add_u32 v27, v24, 5, v27
    v_add_u32 v27, 151552, v27
    v_and_b32 v25, 1, v26
    v_lshl_add_u32 v190, v25, 2, v27
    v_lshl_add_u32 v191, v25, 4, v27
    v_cmp_le_u32 vcc, 20, v24
    v_subrev_u32 v25, 20, v24
    ds_read2_b32 v[224:225], v190 offset0:0 offset1:2
    v_cndmask_b32 v24, v24, v25, vcc
    ds_read2_b32 v[226:227], v190 offset0:4 offset1:6
    ds_read_b128 v[232:235], v191
    v_cmp_le_u32 vcc, 16, v24
    v_lshlrev_b32 v26, 4, v26
    v_add_u32 v26, 122880, v26
    s_waitcnt lgkmcnt(0)
    v_perm_b32 v228, v225, v224, s30
    v_perm_b32 v229, v227, v226, s30
    v_perm_b32 v230, v225, v224, s31
    v_perm_b32 v231, v227, v226, s31
    v_cndmask_b32 v232, v228, v232, vcc
    v_min_u32 v232, -2, v232
    v_cndmask_b32 v233, v229, v233, vcc
    v_min_u32 v233, -2, v233
    v_cndmask_b32 v234, v230, v234, vcc
    v_min_u32 v234, -2, v234
    v_cndmask_b32 v235, v231, v235, vcc
    v_min_u32 v235, -2, v235
    s_cmp_ge_u32 s25, 2
    s_cbranch_scc1 C_m0
    ds_write_b128 v26, v[232:235]
C_m0:
    s_waitcnt vmcnt(15)
    s_barrier
    s_lshr_b32 s30, s25, 1
    s_add_u32 s30, s30, s25
    s_lshl_b32 s30, s30, 5
    s_add_u32 s30, s30, 0
    s_lshr_b32 s31, s25, 1
    s_mul_i32 s31, s31, 96
    s_add_u32 s31, s31, 64
    s_cmp_eq_u32 s51, 1
    s_cbranch_scc1 C_od_19
    v_add_u32 v26, s30, v148
    ds_read_b64_tr_b16 a[240:241], v26 offset:0
    ds_read_b64_tr_b16 a[242:243], v26 offset:384
    ds_read_b64_tr_b16 a[244:245], v26 offset:3072
    ds_read_b64_tr_b16 a[246:247], v26 offset:3456
    s_waitcnt lgkmcnt(8)
    ds_read_b64_tr_b16 a[248:249], v26 offset:12288
    ds_read_b64_tr_b16 a[250:251], v26 offset:12672
    ds_read_b64_tr_b16 a[252:253], v26 offset:15360
    ds_read_b64_tr_b16 a[254:255], v26 offset:15744
    s_waitcnt lgkmcnt(8)
    ds_read_b64_tr_b16 v[152:153], v26 offset:24576
    ds_read_b64_tr_b16 v[154:155], v26 offset:24960
    ds_read_b64_tr_b16 v[156:157], v26 offset:27648
    ds_read_b64_tr_b16 v[158:159], v26 offset:28032
    s_waitcnt lgkmcnt(8)
    ds_read_b64_tr_b16 v[160:161], v26 offset:36864
    ds_read_b64_tr_b16 v[162:163], v26 offset:37248
    ds_read_b64_tr_b16 v[164:165], v26 offset:39936
    ds_read_b64_tr_b16 v[166:167], v26 offset:40320
    s_waitcnt lgkmcnt(8)
    ds_read_b64_tr_b16 v[168:169], v26 offset:49152
    ds_read_b64_tr_b16 v[170:171], v26 offset:49536
    ds_read_b64_tr_b16 v[172:173], v26 offset:52224
    ds_read_b64_tr_b16 v[174:175], v26 offset:52608
    s_waitcnt lgkmcnt(8)
    v_add_u32 v26, s31, v148
    ds_read_b64_tr_b16 v[216:217], v26 offset:0
    ds_read_b64_tr_b16 v[218:219], v26 offset:384
    ds_read_b64_tr_b16 v[220:221], v26 offset:3072
    ds_read_b64_tr_b16 v[222:223], v26 offset:3456
    s_waitcnt lgkmcnt(8)
    ds_read_b64_tr_b16 v[224:225], v26 offset:12288
    ds_read_b64_tr_b16 v[226:227], v26 offset:12672
    ds_read_b64_tr_b16 v[228:229], v26 offset:15360
    ds_read_b64_tr_b16 v[230:231], v26 offset:15744
    s_waitcnt lgkmcnt(8)
    ds_read_b64_tr_b16 v[232:233], v26 offset:24576
    ds_read_b64_tr_b16 v[234:235], v26 offset:24960
    ds_read_b64_tr_b16 v[236:237], v26 offset:27648
    ds_read_b64_tr_b16 v[238:239], v26 offset:28032
    s_waitcnt lgkmcnt(8)
    ds_read_b64_tr_b16 v[240:241], v26 offset:36864
    ds_read_b64_tr_b16 v[242:243], v26 offset:37248
    ds_read_b64_tr_b16 v[244:245], v26 offset:39936
    ds_read_b64_tr_b16 v[246:247], v26 offset:40320
    s_waitcnt lgkmcnt(8)
    ds_read_b64_tr_b16 v[248:249], v26 offset:49152
    ds_read_b64_tr_b16 v[250:251], v26 offset:49536
    ds_read_b64_tr_b16 v[252:253], v26 offset:52224
    ds_read_b64_tr_b16 v[254:255], v26 offset:52608
    s_waitcnt lgkmcnt(8)
    s_branch C_sk_18
C_od_19:
    v_add_u32 v26, s30, v148
    ds_read_b64_tr_b16 v[176:177], v26 offset:0
    ds_read_b64_tr_b16 v[178:179], v26 offset:384
    ds_read_b64_tr_b16 v[180:181], v26 offset:3072
    ds_read_b64_tr_b16 v[182:183], v26 offset:3456
    s_waitcnt lgkmcnt(8)
    ds_read_b64_tr_b16 v[184:185], v26 offset:12288
    ds_read_b64_tr_b16 v[186:187], v26 offset:12672
    ds_read_b64_tr_b16 v[188:189], v26 offset:15360
    ds_read_b64_tr_b16 v[190:191], v26 offset:15744
    s_waitcnt lgkmcnt(8)
    ds_read_b64_tr_b16 v[192:193], v26 offset:24576
    ds_read_b64_tr_b16 v[194:195], v26 offset:24960
    ds_read_b64_tr_b16 v[196:197], v26 offset:27648
    ds_read_b64_tr_b16 v[198:199], v26 offset:28032
    s_waitcnt lgkmcnt(8)
    ds_read_b64_tr_b16 v[200:201], v26 offset:36864
    ds_read_b64_tr_b16 v[202:203], v26 offset:37248
    ds_read_b64_tr_b16 v[204:205], v26 offset:39936
    ds_read_b64_tr_b16 v[206:207], v26 offset:40320
    s_waitcnt lgkmcnt(8)
    ds_read_b64_tr_b16 v[208:209], v26 offset:49152
    ds_read_b64_tr_b16 v[210:211], v26 offset:49536
    ds_read_b64_tr_b16 v[212:213], v26 offset:52224
    ds_read_b64_tr_b16 v[214:215], v26 offset:52608
    s_waitcnt lgkmcnt(8)
C_sk_18:
    s_waitcnt lgkmcnt(0)
    s_barrier
    s_mov_b32 s4, s86
    s_and_b32 s5, s87, 0xffff
    s_mov_b32 s6, 7864320
    s_mov_b32 s7, 0x20000
    s_mul_i32 s30, s24, 245760
    s_mul_i32 s31, s26, 640
    s_add_u32 s30, s30, s31
    s_mul_i32 s31, s25, 30720
    s_add_u32 s30, s30, s31
    s_add_u32 s30, s30, 0
    s_mul_i32 s31, s25, 15360
    s_add_u32 s31, s31, 0
    s_mov_b32 m0, s31
    s_add_u32 s31, s31, 1024
    buffer_load_dwordx4 v28, s[4:7], s30 offen lds
    s_mov_b32 m0, s31
    s_add_u32 s31, s31, 1024
    buffer_load_dwordx4 v29, s[4:7], s30 offen lds
    s_mov_b32 m0, s31
    s_add_u32 s31, s31, 1024
    buffer_load_dwordx4 v30, s[4:7], s30 offen lds
    s_mov_b32 m0, s31
    s_add_u32 s31, s31, 1024
    buffer_load_dwordx4 v31, s[4:7], s30 offen lds
    s_mov_b32 m0, s31
    s_add_u32 s31, s31, 1024
    buffer_load_dwordx4 v32, s[4:7], s30 offen lds
    s_add_u32 s30, s30, 10240
    s_mov_b32 m0, s31
    s_add_u32 s31, s31, 1024
    buffer_load_dwordx4 v28, s[4:7], s30 offen lds
    s_mov_b32 m0, s31
    s_add_u32 s31, s31, 1024
    buffer_load_dwordx4 v29, s[4:7], s30 offen lds
    s_mov_b32 m0, s31
    s_add_u32 s31, s31, 1024
    buffer_load_dwordx4 v30, s[4:7], s30 offen lds
    s_mov_b32 m0, s31
    s_add_u32 s31, s31, 1024
    buffer_load_dwordx4 v31, s[4:7], s30 offen lds
    s_mov_b32 m0, s31
    s_add_u32 s31, s31, 1024
    buffer_load_dwordx4 v32, s[4:7], s30 offen lds
    s_add_u32 s30, s30, 10240
    s_mov_b32 m0, s31
    s_add_u32 s31, s31, 1024
    buffer_load_dwordx4 v28, s[4:7], s30 offen lds
    s_mov_b32 m0, s31
    s_add_u32 s31, s31, 1024
    buffer_load_dwordx4 v29, s[4:7], s30 offen lds
    s_mov_b32 m0, s31
    s_add_u32 s31, s31, 1024
    buffer_load_dwordx4 v30, s[4:7], s30 offen lds
    s_mov_b32 m0, s31
    s_add_u32 s31, s31, 1024
    buffer_load_dwordx4 v31, s[4:7], s30 offen lds
    s_mov_b32 m0, s31
    s_add_u32 s31, s31, 1024
    buffer_load_dwordx4 v32, s[4:7], s30 offen lds
    s_add_u32 s30, s30, 10240
    s_waitcnt vmcnt(15)
    s_barrier
    s_lshr_b32 s30, s25, 1
    s_add_u32 s30, s30, s25
    s_lshl_b32 s30, s30, 5
    s_add_u32 s30, s30, 61440
    s_lshr_b32 s31, s25, 1
    s_mul_i32 s31, s31, 96
    s_add_u32 s31, s31, 61504
    s_cmp_eq_u32 s51, 1
    s_cbranch_scc1 C_od_21
    v_add_u32 v26, s30, v148
    ds_read_b64_tr_b16 v[176:177], v26 offset:0
    ds_read_b64_tr_b16 v[178:179], v26 offset:384
    ds_read_b64_tr_b16 v[180:181], v26 offset:3072
    ds_read_b64_tr_b16 v[182:183], v26 offset:3456
    s_waitcnt lgkmcnt(8)
    ds_read_b64_tr_b16 v[184:185], v26 offset:12288
    ds_read_b64_tr_b16 v[186:187], v26 offset:12672
    ds_read_b64_tr_b16 v[188:189], v26 offset:15360
    ds_read_b64_tr_b16 v[190:191], v26 offset:15744
    s_waitcnt lgkmcnt(8)
    ds_read_b64_tr_b16 v[192:193], v26 offset:24576
    ds_read_b64_tr_b16 v[194:195], v26 offset:24960
    ds_read_b64_tr_b16 v[196:197], v26 offset:27648
    ds_read_b64_tr_b16 v[198:199], v26 offset:28032
    s_waitcnt lgkmcnt(8)
    ds_read_b64_tr_b16 v[200:201], v26 offset:36864
    ds_read_b64_tr_b16 v[202:203], v26 offset:37248
    ds_read_b64_tr_b16 v[204:205], v26 offset:39936
    ds_read_b64_tr_b16 v[206:207], v26 offset:40320
    s_waitcnt lgkmcnt(8)
    ds_read_b64_tr_b16 v[208:209], v26 offset:49152
    ds_read_b64_tr_b16 v[210:211], v26 offset:49536
    ds_read_b64_tr_b16 v[212:213], v26 offset:52224
    ds_read_b64_tr_b16 v[214:215], v26 offset:52608
    s_waitcnt lgkmcnt(8)
    s_branch C_sk_20
C_od_21:
    v_add_u32 v26, s30, v148
    ds_read_b64_tr_b16 a[240:241], v26 offset:0
    ds_read_b64_tr_b16 a[242:243], v26 offset:384
    ds_read_b64_tr_b16 a[244:245], v26 offset:3072
    ds_read_b64_tr_b16 a[246:247], v26 offset:3456
    s_waitcnt lgkmcnt(8)
    ds_read_b64_tr_b16 a[248:249], v26 offset:12288
    ds_read_b64_tr_b16 a[250:251], v26 offset:12672
    ds_read_b64_tr_b16 a[252:253], v26 offset:15360
    ds_read_b64_tr_b16 a[254:255], v26 offset:15744
    s_waitcnt lgkmcnt(8)
    ds_read_b64_tr_b16 v[152:153], v26 offset:24576
    ds_read_b64_tr_b16 v[154:155], v26 offset:24960
    ds_read_b64_tr_b16 v[156:157], v26 offset:27648
    ds_read_b64_tr_b16 v[158:159], v26 offset:28032
    s_waitcnt lgkmcnt(8)
    ds_read_b64_tr_b16 v[160:161], v26 offset:36864
    ds_read_b64_tr_b16 v[162:163], v26 offset:37248
    ds_read_b64_tr_b16 v[164:165], v26 offset:39936
    ds_read_b64_tr_b16 v[166:167], v26 offset:40320
    s_waitcnt lgkmcnt(8)
    ds_read_b64_tr_b16 v[168:169], v26 offset:49152
    ds_read_b64_tr_b16 v[170:171], v26 offset:49536
    ds_read_b64_tr_b16 v[172:173], v26 offset:52224
    ds_read_b64_tr_b16 v[174:175], v26 offset:52608
    s_waitcnt lgkmcnt(8)
    v_add_u32 v26, s31, v148
    ds_read_b64_tr_b16 v[216:217], v26 offset:0
    ds_read_b64_tr_b16 v[218:219], v26 offset:384
    ds_read_b64_tr_b16 v[220:221], v26 offset:3072
    ds_read_b64_tr_b16 v[222:223], v26 offset:3456
    s_waitcnt lgkmcnt(8)
    ds_read_b64_tr_b16 v[224:225], v26 offset:12288
    ds_read_b64_tr_b16 v[226:227], v26 offset:12672
    ds_read_b64_tr_b16 v[228:229], v26 offset:15360
    ds_read_b64_tr_b16 v[230:231], v26 offset:15744
    s_waitcnt lgkmcnt(8)
    ds_read_b64_tr_b16 v[232:233], v26 offset:24576
    ds_read_b64_tr_b16 v[234:235], v26 offset:24960
    ds_read_b64_tr_b16 v[236:237], v26 offset:27648
    ds_read_b64_tr_b16 v[238:239], v26 offset:28032
    s_waitcnt lgkmcnt(8)
    ds_read_b64_tr_b16 v[240:241], v26 offset:36864
    ds_read_b64_tr_b16 v[242:243], v26 offset:37248
    ds_read_b64_tr_b16 v[244:245], v26 offset:39936
    ds_read_b64_tr_b16 v[246:247], v26 offset:40320
    s_waitcnt lgkmcnt(8)
    ds_read_b64_tr_b16 v[248:249], v26 offset:49152
    ds_read_b64_tr_b16 v[250:251], v26 offset:49536
    ds_read_b64_tr_b16 v[252:253], v26 offset:52224
    ds_read_b64_tr_b16 v[254:255], v26 offset:52608
    s_waitcnt lgkmcnt(8)
C_sk_20:
    s_waitcnt lgkmcnt(0)
    s_barrier
    s_mov_b32 s4, s86
    s_and_b32 s5, s87, 0xffff
    s_mov_b32 s6, 7864320
    s_mov_b32 s7, 0x20000
    s_mul_i32 s30, s24, 245760
    s_mul_i32 s31, s26, 640
    s_add_u32 s30, s30, s31
    s_mul_i32 s31, s25, 30720
    s_add_u32 s30, s30, s31
    s_add_u32 s30, s30, 122880
    s_mul_i32 s31, s25, 15360
    s_add_u32 s31, s31, 61440
    s_mov_b32 m0, s31
    s_add_u32 s31, s31, 1024
    buffer_load_dwordx4 v28, s[4:7], s30 offen lds
    s_mov_b32 m0, s31
    s_add_u32 s31, s31, 1024
    buffer_load_dwordx4 v29, s[4:7], s30 offen lds
    s_mov_b32 m0, s31
    s_add_u32 s31, s31, 1024
    buffer_load_dwordx4 v30, s[4:7], s30 offen lds
    s_mov_b32 m0, s31
    s_add_u32 s31, s31, 1024
    buffer_load_dwordx4 v31, s[4:7], s30 offen lds
    s_mov_b32 m0, s31
    s_add_u32 s31, s31, 1024
    buffer_load_dwordx4 v32, s[4:7], s30 offen lds
    s_add_u32 s30, s30, 10240
    s_mov_b32 m0, s31
    s_add_u32 s31, s31, 1024
    buffer_load_dwordx4 v28, s[4:7], s30 offen lds
    s_mov_b32 m0, s31
    s_add_u32 s31, s31, 1024
    buffer_load_dwordx4 v29, s[4:7], s30 offen lds
    s_mov_b32 m0, s31
    s_add_u32 s31, s31, 1024
    buffer_load_dwordx4 v30, s[4:7], s30 offen lds
    s_mov_b32 m0, s31
    s_add_u32 s31, s31, 1024
    buffer_load_dwordx4 v31, s[4:7], s30 offen lds
    s_mov_b32 m0, s31
    s_add_u32 s31, s31, 1024
    buffer_load_dwordx4 v32, s[4:7], s30 offen lds
    s_add_u32 s30, s30, 10240
    s_mov_b32 m0, s31
    s_add_u32 s31, s31, 1024
    buffer_load_dwordx4 v28, s[4:7], s30 offen lds
    s_mov_b32 m0, s31
    s_add_u32 s31, s31, 1024
    buffer_load_dwordx4 v29, s[4:7], s30 offen lds
    s_mov_b32 m0, s31
    s_add_u32 s31, s31, 1024
    buffer_load_dwordx4 v30, s[4:7], s30 offen lds
    s_mov_b32 m0, s31
    s_add_u32 s31, s31, 1024
    buffer_load_dwordx4 v31, s[4:7], s30 offen lds
    s_mov_b32 m0, s31
    s_add_u32 s31, s31, 1024
    buffer_load_dwordx4 v32, s[4:7], s30 offen lds
    s_add_u32 s30, s30, 10240
    s_mov_b32 s34, 3000000
    s_mov_b32 s4, s78
    s_and_b32 s5, s79, 0xffff
    s_mov_b32 s6, 256
    s_mov_b32 s7, 0x20000
    s_lshr_b32 s31, s3, 5
M_pu:
    v_mbcnt_lo_u32_b32 v26, -1, 0
    v_and_b32 v26, 7, v26
    v_lshlrev_b32 v26, 2, v26
    buffer_load_dword v27, v26, s[4:7], 0 offen sc1
    s_waitcnt vmcnt(0)
    v_readlane_b32 s60, v27, 0
    v_readlane_b32 s61, v27, 1
    v_readlane_b32 s62, v27, 2
    v_readlane_b32 s63, v27, 3
    v_readlane_b32 s64, v27, 4
    v_readlane_b32 s65, v27, 5
    v_readlane_b32 s66, v27, 6
    v_readlane_b32 s67, v27, 7
    s_mov_b32 s68, 0
    s_nop 1
    s_add_u32 s68, s68, s60
    s_add_u32 s68, s68, s61
    s_add_u32 s68, s68, s62
    s_add_u32 s68, s68, s63
    s_add_u32 s68, s68, s64
    s_add_u32 s68, s68, s65
    s_add_u32 s68, s68, s66
    s_add_u32 s68, s68, s67
    s_mov_b32 s30, s60
    s_cmp_eq_u32 s31, 1
    s_cselect_b32 s30, s61, s30
    s_cmp_eq_u32 s31, 2
    s_cselect_b32 s30, s62, s30
    s_cmp_eq_u32 s31, 3
    s_cselect_b32 s30, s63, s30
    s_cmp_ge_u32 s30, 32
    s_cbranch_scc1 M_pu2
    s_sub_u32 s34, s34, 1
    s_cbranch_scc1 C_abort
    s_cmp_lg_u32 s68, 256
    s_cbranch_scc1 M_pu
    s_mov_b32 s36, 0
M_pu2:
    s_mov_b32 s4, s78
    s_and_b32 s5, s79, 0xffff
    s_mov_b32 s6, 256
    s_mov_b32 s7, 0x20000
    v_mov_b32 v26, 32
M_wc_22:
    buffer_load_dword v27, v26, s[4:7], 0 offen sc1
    s_sub_u32 s34, s34, 1
    s_cbranch_scc1 C_abort
    s_waitcnt vmcnt(0)
    v_readfirstlane_b32 s30, v27
    s_cmp_eq_u32 s30, 256
    s_cbranch_scc1 M_wc_23
    s_sleep 4
    s_branch M_wc_22
M_wc_23:
    s_cmp_ge_u32 s101, 2
    s_cbranch_scc1 C_kw_25
    v_and_b32 v26, 3, v1
    v_lshlrev_b32 v26, 2, v26
    v_bfe_u32 v27, v1, 2, 1
    v_lshl_add_u32 v26, v27, 12, v26
C_kw_24:
    buffer_load_dword v27, v26, s[8:11], s100 offen sc1
    s_sub_u32 s34, s34, 1
    s_cbranch_scc1 C_abort
    s_waitcnt vmcnt(0)
    s_nop 1
    v_min_u32_dpp v27, v27, v27 row_shl:1 row_mask:0xf bank_mask:0xf
    s_nop 1
    v_min_u32_dpp v27, v27, v27 row_shl:2 row_mask:0xf bank_mask:0xf
    s_nop 1
    v_min_u32_dpp v27, v27, v27 row_shl:4 row_mask:0xf bank_mask:0xf
    s_nop 1
    v_readfirstlane_b32 s101, v27
    s_cmp_ge_u32 s101, 2
    s_cbranch_scc1 C_kw_25
    s_sleep 2
    s_branch C_kw_24
C_kw_25:
    v_mov_b32 v26, 2147483632
    s_cmp_eq_u32 s25, 0
    s_cselect_b64 vcc, -1, 0
    s_cmp_eq_u32 s25, 2
    s_cselect_b32 s30, 3072, 0
    v_cndmask_b32 v151, v2, v26, vcc
    s_add_u32 s31, s30, 147456
    v_add_u32 v150, s31, v2
    s_mov_b32 m0, s58
    s_add_u32 s30, s42, s77
    buffer_load_dwordx4 v151, s[8:11], s42 offen lds
    buffer_load_dwordx4 v151, s[8:11], s30 offen offset:1024 lds
    s_add_u32 s42, s42, 393216
    s_xor_b32 s58, s58, 0x2000
    s_waitcnt vmcnt(0) lgkmcnt(0)
    s_barrier
    s_lshl_b32 s30, s25, 7
    v_add_u32 v27, s30, v149
    s_lshl_b32 s30, s25, 5
    s_add_u32 s30, s30, 512
    v_and_b32 v24, 3, v1
    v_mul_u32_u24 v24, 24, v24
    v_sub_u32 v24, v149, v24
    v_add_u32 v24, s30, v24
    v_add_u32 v26, 0, v27
    v_add_u32 v25, 0, v24
    ds_read_b64_tr_b16 v[36:37], v26 offset:0
    ds_read_b64_tr_b16 v[38:39], v26 offset:1280
    ds_read_b64_tr_b16 v[40:41], v26 offset:10240
    ds_read_b64_tr_b16 v[42:43], v26 offset:11520
    s_waitcnt lgkmcnt(8)
    ds_read_b64_tr_b16 v[44:45], v26 offset:8
    ds_read_b64_tr_b16 v[46:47], v26 offset:1288
    ds_read_b64_tr_b16 v[48:49], v26 offset:10248
    ds_read_b64_tr_b16 v[50:51], v26 offset:11528
    s_waitcnt lgkmcnt(8)
    ds_read_b64_tr_b16 v[52:53], v26 offset:16
    ds_read_b64_tr_b16 v[54:55], v26 offset:1296
    ds_read_b64_tr_b16 v[56:57], v26 offset:10256
    ds_read_b64_tr_b16 v[58:59], v26 offset:11536
    s_waitcnt lgkmcnt(8)
    ds_read_b64_tr_b16 v[60:61], v26 offset:24
    ds_read_b64_tr_b16 v[62:63], v26 offset:1304
    ds_read_b64_tr_b16 v[64:65], v26 offset:10264
    ds_read_b64_tr_b16 v[66:67], v26 offset:11544
    s_waitcnt lgkmcnt(8)
    ds_read_b64_tr_b16 v[28:29], v25 offset:0
    ds_read_b64_tr_b16 v[30:31], v25 offset:1280
    ds_read_b64_tr_b16 v[32:33], v25 offset:10240
    ds_read_b64_tr_b16 v[34:35], v25 offset:11520
    s_waitcnt lgkmcnt(8)
    v_add_u32 v26, 40960, v27
    v_add_u32 v25, 40960, v24
    ds_read_b64_tr_b16 v[76:77], v26 offset:0
    ds_read_b64_tr_b16 v[78:79], v26 offset:1280
    ds_read_b64_tr_b16 v[80:81], v26 offset:10240
    ds_read_b64_tr_b16 v[82:83], v26 offset:11520
    s_waitcnt lgkmcnt(8)
    ds_read_b64_tr_b16 v[84:85], v26 offset:8
    ds_read_b64_tr_b16 v[86:87], v26 offset:1288
    ds_read_b64_tr_b16 v[88:89], v26 offset:10248
    ds_read_b64_tr_b16 v[90:91], v26 offset:11528
    s_waitcnt lgkmcnt(8)
    ds_read_b64_tr_b16 v[92:93], v26 offset:16
    ds_read_b64_tr_b16 v[94:95], v26 offset:1296
    ds_read_b64_tr_b16 v[96:97], v26 offset:10256
    ds_read_b64_tr_b16 v[98:99], v26 offset:11536
    s_waitcnt lgkmcnt(8)
    ds_read_b64_tr_b16 v[100:101], v26 offset:24
    ds_read_b64_tr_b16 v[102:103], v26 offset:1304
    ds_read_b64_tr_b16 v[104:105], v26 offset:10264
    ds_read_b64_tr_b16 v[106:107], v26 offset:11544
    s_waitcnt lgkmcnt(8)
    ds_read_b64_tr_b16 v[68:69], v25 offset:0
    ds_read_b64_tr_b16 v[70:71], v25 offset:1280
    ds_read_b64_tr_b16 v[72:73], v25 offset:10240
    ds_read_b64_tr_b16 v[74:75], v25 offset:11520
    s_waitcnt lgkmcnt(8)
    v_add_u32 v26, 81920, v27
    v_add_u32 v25, 81920, v24
    ds_read_b64_tr_b16 v[116:117], v26 offset:0
    ds_read_b64_tr_b16 v[118:119], v26 offset:1280
    ds_read_b64_tr_b16 v[120:121], v26 offset:10240
    ds_read_b64_tr_b16 v[122:123], v26 offset:11520
    s_waitcnt lgkmcnt(8)
    ds_read_b64_tr_b16 v[124:125], v26 offset:8
    ds_read_b64_tr_b16 v[126:127], v26 offset:1288
    ds_read_b64_tr_b16 v[128:129], v26 offset:10248
    ds_read_b64_tr_b16 v[130:131], v26 offset:11528
    s_waitcnt lgkmcnt(8)
    ds_read_b64_tr_b16 v[132:133], v26 offset:16
    ds_read_b64_tr_b16 v[134:135], v26 offset:1296
    ds_read_b64_tr_b16 v[136:137], v26 offset:10256
    ds_read_b64_tr_b16 v[138:139], v26 offset:11536
    s_waitcnt lgkmcnt(8)
    ds_read_b64_tr_b16 v[140:141], v26 offset:24
    ds_read_b64_tr_b16 v[142:143], v26 offset:1304
    ds_read_b64_tr_b16 v[144:145], v26 offset:10264
    ds_read_b64_tr_b16 v[146:147], v26 offset:11544
    s_waitcnt lgkmcnt(8)
    ds_read_b64_tr_b16 v[108:109], v25 offset:0
    ds_read_b64_tr_b16 v[110:111], v25 offset:1280
    ds_read_b64_tr_b16 v[112:113], v25 offset:10240
    ds_read_b64_tr_b16 v[114:115], v25 offset:11520
    s_waitcnt lgkmcnt(8)
    s_waitcnt lgkmcnt(0)
    s_barrier
    ds_write_b128 v20, v[28:31] offset:0
    ds_write_b128 v20, v[32:35] offset:1024
    ds_write_b128 v20, v[36:39] offset:2048
    ds_write_b128 v20, v[40:43] offset:3072
    ds_write_b128 v20, v[44:47] offset:4096
    ds_write_b128 v20, v[48:51] offset:5120
    ds_write_b128 v20, v[52:55] offset:6144
    ds_write_b128 v20, v[56:59] offset:7168
    ds_write_b128 v20, v[60:63] offset:8192
    ds_write_b128 v20, v[64:67] offset:9216
    ds_write_b128 v20, v[68:71] offset:10240
    ds_write_b128 v20, v[72:75] offset:11264
    ds_write_b128 v20, v[76:79] offset:12288
    ds_write_b128 v20, v[80:83] offset:13312
    ds_write_b128 v20, v[84:87] offset:14336
    ds_write_b128 v20, v[88:91] offset:15360
    ds_write_b128 v20, v[92:95] offset:16384
    ds_write_b128 v20, v[96:99] offset:17408
    ds_write_b128 v20, v[100:103] offset:18432
    ds_write_b128 v20, v[104:107] offset:19456
    ds_write_b128 v20, v[108:111] offset:20480
    ds_write_b128 v20, v[112:115] offset:21504
    ds_write_b128 v20, v[116:119] offset:22528
    ds_write_b128 v20, v[120:123] offset:23552
    ds_write_b128 v20, v[124:127] offset:24576
    ds_write_b128 v20, v[128:131] offset:25600
    ds_write_b128 v20, v[132:135] offset:26624
    ds_write_b128 v20, v[136:139] offset:27648
    ds_write_b128 v20, v[140:143] offset:28672
    ds_write_b128 v20, v[144:147] offset:29696
    s_mov_b32 s33, 0
    s_mov_b32 s35, -1
    s_mov_b32 s50, 0x3dd53b95
    s_mov_b32 s48, 0x3f80
    s_mov_b32 s49, 0x3f800000
    s_add_u32 s53, s52, 122880
    v_add_u32 v5, s53, v2
    v_add_u32 v24, s53, v13
    v_and_b32 v25, 15, v1
    v_lshlrev_b32 v25, 4, v25
    v_lshrrev_b32 v26, 5, v1
    v_lshl_add_u32 v25, v26, 3, v25
    s_mov_b32 s54, 0x03ff03ff
    s_mov_b32 s55, 0x03ff03ff
    s_mov_b32 s56, 0
    s_mov_b32 s57, 0
    s_sub_u32 s44, s44, 98304
    s_sub_u32 s45, s45, 131072
    s_mov_b32 s94, 0x3ff
    s_mov_b32 s95, 0x3ff
    v_mov_b32 v23, 1
    s_waitcnt vmcnt(0) lgkmcnt(0)
    s_cmp_eq_u32 s36, 1
    s_cbranch_scc0 C_impure
    v_mov_b32 v116, 0
    v_mov_b32 v117, 0
    v_mov_b32 v118, 0
    v_mov_b32 v119, 0
    v_mov_b32 v120, 0
    v_mov_b32 v121, 0
    v_mov_b32 v122, 0
    v_mov_b32 v123, 0
    v_mov_b32 v124, 0
    v_mov_b32 v125, 0
    v_mov_b32 v126, 0
    v_mov_b32 v127, 0
    v_mov_b32 v128, 0
    v_mov_b32 v129, 0
    v_mov_b32 v130, 0
    v_mov_b32 v131, 0
    v_mov_b32 v132, 0
    v_mov_b32 v133, 0
    v_mov_b32 v134, 0
    v_mov_b32 v135, 0
    s_branch CP_ready
CP_step:
    v_mov_b32 v22, v22
    s_nop 2
    v_mov_b32 v22, v22
    s_nop 2
    v_mov_b32 v22, v22
    s_nop 2
    v_mov_b32 v22, v22
    s_nop 2
    v_mov_b32 v22, v22
    s_nop 2
    v_mov_b32 v22, v22
    s_nop 2
    v_mov_b32 v22, v22
    s_nop 2
    v_mov_b32 v22, v22
    s_nop 2
    v_mov_b32 v22, v22
    s_nop 2
    v_mov_b32 v22, v22
    s_nop 2
    v_mov_b32 v22, v22
    s_nop 2
    v_mov_b32 v22, v22
    s_nop 2
    v_mov_b32 v22, v22
    s_nop 2
    v_mov_b32 v22, v22
    s_nop 2
    v_mov_b32 v22, v22
    s_nop 2
    v_mov_b32 v22, v22
    s_nop 2
    v_mov_b32 v22, v22
    s_nop 2
    v_mov_b32 v22, v22
    s_nop 2
    v_mov_b32 v22, v22
    s_nop 2
    v_mov_b32 v22, v22
    s_nop 2
    v_mov_b32 v22, v22
    s_nop 2
    v_mov_b32 v22, v22
    s_nop 2
    s_add_u32 s30, s39, s52
    buffer_load_dwordx4 v[52:55], v2, s[8:11], s30 offen sc1
    buffer_load_dwordx4 v[56:59], v2, s[8:11], s30 offen offset:1024 sc1
    buffer_load_dwordx2 v[60:61], v13, s[8:11], s30 offen offset:2048 sc1
    v_mov_b32 v22, v22
    s_nop 2
    v_mov_b32 v22, v22
    s_nop 2
    v_mov_b32 v22, v22
    s_nop 2
    v_mov_b32 v22, v22
    s_nop 2
    v_mov_b32 v22, v22
    s_nop 2
    v_mov_b32 v22, v22
    s_nop 2
    s_add_u32 s30, s39, s52
    buffer_load_dwordx4 v[52:55], v2, s[8:11], s30 offen sc1
    buffer_load_dwordx4 v[56:59], v2, s[8:11], s30 offen offset:1024 sc1
    buffer_load_dwordx2 v[60:61], v13, s[8:11], s30 offen offset:2048 sc1
    v_mov_b32 v22, v22
    s_nop 2
    v_mov_b32 v22, v22
    s_nop 2
    v_mov_b32 v22, v22
    s_nop 2
    v_mov_b32 v22, v22
    s_nop 2
    v_mov_b32 v22, v22
    s_nop 2
    v_mov_b32 v22, v22
    s_nop 2
    s_waitcnt vmcnt(3)
    v_max3_u32 v26, v52, v56, v60
    v_cmp_eq_u32 vcc, -1, v26
    s_cbranch_vccnz CP_L_s
CP_L_m:
    ds_write_b128 v5, v[52:55]
    ds_write_b128 v5, v[56:59] offset:1024
    ds_write_b64 v24, v[60:61] offset:2048
    s_waitcnt lgkmcnt(0)
CP_ready:
    s_barrier
    ds_read_b128 v[76:79], v3 offset:0
    ds_read_b128 v[80:83], v3 offset:1024
    ds_read_b128 v[84:87], v3 offset:2048
    s_cmp_eq_u32 s56, 0
    s_cbranch_scc1 CP_s0_26
    buffer_store_dwordx4 v[144:147], v2, s[8:11], s45 offen sc1
CP_s0_26:
    s_cmp_eq_u32 s57, 0
    s_cbranch_scc1 CP_s1_27
    buffer_store_dwordx4 v[28:31], v21, s[8:11], s44 offen offset:0 sc1
    buffer_store_dwordx4 v[32:35], v21, s[8:11], s44 offen offset:512 sc1
    buffer_store_dwordx4 v[36:39], v21, s[8:11], s44 offen offset:1024 sc1
CP_s1_27:
    s_waitcnt lgkmcnt(2)
    v_smfmac_f32_16x16x64_bf16 v[116:119], v[76:79], a[0:7], v6
    ds_read_b128 v[88:91], v3 offset:3072
    v_smfmac_f32_16x16x64_bf16 v[120:123], v[76:79], a[80:87], v6
    v_smfmac_f32_16x16x64_bf16 v[124:127], v[76:79], a[160:167], v6
    s_waitcnt lgkmcnt(2)
    v_smfmac_f32_16x16x64_bf16 v[116:119], v[80:83], a[8:15], v6
    ds_read_b128 v[92:95], v3 offset:4096
    v_smfmac_f32_16x16x64_bf16 v[120:123], v[80:83], a[88:95], v6
    buffer_load_dwordx4 v[40:43], v2, s[8:11], s43 offen offset:0
    v_smfmac_f32_16x16x64_bf16 v[124:127], v[80:83], a[168:175], v6
    s_waitcnt lgkmcnt(2)
    v_smfmac_f32_16x16x64_bf16 v[116:119], v[84:87], a[16:23], v6
    ds_read_b128 v[96:99], v4 offset:0
    v_smfmac_f32_16x16x64_bf16 v[120:123], v[84:87], a[96:103], v6
    buffer_load_dwordx4 v[44:47], v2, s[8:11], s43 offen offset:1024
    v_smfmac_f32_16x16x64_bf16 v[124:127], v[84:87], a[176:183], v6
    s_waitcnt lgkmcnt(2)
    v_smfmac_f32_16x16x64_bf16 v[116:119], v[88:91], a[24:31], v6
    ds_read_b128 v[100:103], v4 offset:1024
    v_smfmac_f32_16x16x64_bf16 v[120:123], v[88:91], a[104:111], v6
    buffer_load_dwordx4 v[48:51], v2, s[8:11], s43 offen offset:2048
    v_smfmac_f32_16x16x64_bf16 v[124:127], v[88:91], a[184:191], v6
    s_waitcnt lgkmcnt(2)
    v_smfmac_f32_16x16x64_bf16 v[116:119], v[92:95], a[32:39], v6
    ds_read_b128 v[104:107], v4 offset:2048
    v_smfmac_f32_16x16x64_bf16 v[120:123], v[92:95], a[112:119], v6
    s_mov_b32 m0, s58
    s_add_u32 s30, s42, s77
    buffer_load_dwordx4 v151, s[8:11], s42 offen lds
    v_smfmac_f32_16x16x64_bf16 v[124:127], v[92:95], a[192:199], v6
    s_waitcnt lgkmcnt(2)
    v_smfmac_f32_16x16x64_bf16 v[116:119], v[96:99], a[40:47], v6
    ds_read_b128 v[108:111], v4 offset:3072
    v_smfmac_f32_16x16x64_bf16 v[120:123], v[96:99], a[120:127], v6
    s_add_u32 s31, s39, 10240
    buffer_load_dword v26, v19, s[8:11], s31 offen
    v_smfmac_f32_16x16x64_bf16 v[124:127], v[96:99], a[200:207], v6
    s_waitcnt lgkmcnt(2)
    v_smfmac_f32_16x16x64_bf16 v[116:119], v[100:103], a[48:55], v6
    ds_read_b128 v[112:115], v4 offset:4096
    v_smfmac_f32_16x16x64_bf16 v[120:123], v[100:103], a[128:135], v6
    buffer_load_dwordx4 v151, s[8:11], s30 offen offset:1024 lds
    s_add_u32 s42, s42, 393216
    s_xor_b32 s58, s58, 0x2000
    v_smfmac_f32_16x16x64_bf16 v[124:127], v[100:103], a[208:215], v6
    s_waitcnt lgkmcnt(2)
    v_smfmac_f32_16x16x64_bf16 v[116:119], v[104:107], a[56:63], v6
    v_smfmac_f32_16x16x64_bf16 v[120:123], v[104:107], a[136:143], v6
    v_smfmac_f32_16x16x64_bf16 v[124:127], v[104:107], a[216:223], v6
    s_waitcnt lgkmcnt(1)
    v_smfmac_f32_16x16x64_bf16 v[116:119], v[108:111], a[64:71], v6
    v_smfmac_f32_16x16x64_bf16 v[120:123], v[108:111], a[144:151], v6
    v_smfmac_f32_16x16x64_bf16 v[124:127], v[108:111], a[224:231], v6
    s_waitcnt lgkmcnt(0)
    v_smfmac_f32_16x16x64_bf16 v[116:119], v[112:115], a[72:79], v6
    v_smfmac_f32_16x16x64_bf16 v[120:123], v[112:115], a[152:159], v6
    v_smfmac_f32_16x16x64_bf16 v[124:127], v[112:115], a[232:239], v6
    s_nop 5
    v_add_f32 v116, v116, v117
    v_add_f32 v118, v118, v119
    v_cvt_pk_bf16_f32 v116, v116, v118
    ds_write_b32 v7, v116 offset:0
    v_add_f32 v120, v120, v121
    v_add_f32 v122, v122, v123
    v_cvt_pk_bf16_f32 v120, v120, v122
    ds_write_b32 v7, v120 offset:512
    v_add_f32 v124, v124, v125
    v_add_f32 v126, v126, v127
    v_cvt_pk_bf16_f32 v124, v124, v126
    ds_write_b32 v7, v124 offset:1024
    ds_read_b128 v[28:31], v150 offset:0
    ds_read_b128 v[32:35], v150 offset:1024
    ds_read_b128 v[36:39], v150 offset:2048
    v_xor_b32 v150, 0x2000, v150
    v_smfmac_f32_16x16x64_bf16 v[128:131], v[76:79], a[240:247], v6
    v_smfmac_f32_16x16x64_bf16 v[128:131], v[80:83], a[248:255], v6
    v_smfmac_f32_16x16x64_bf16 v[128:131], v[84:87], v[152:159], v6
    s_waitcnt lgkmcnt(3)
    s_barrier
    ds_read_b64_tr_b16 v[136:137], v8 offset:0
    ds_read_b64_tr_b16 v[138:139], v8 offset:512
    ds_read_b64_tr_b16 v[140:141], v8 offset:1536
    ds_read_b64_tr_b16 v[142:143], v8 offset:2048
    ds_read_b64_tr_b16 v[144:145], v8 offset:1024
    ds_read_b64_tr_b16 v[146:147], v8 offset:2560
    s_cmp_lg_u32 s25, 0
    s_cbranch_scc1 CP_nk_28
    ds_read_b64_tr_b16 v[28:29], v9 offset:0
    ds_read_b64_tr_b16 v[30:31], v9 offset:512
    ds_read_b64_tr_b16 v[32:33], v9 offset:1536
    ds_read_b64_tr_b16 v[34:35], v9 offset:2048
    ds_read_b64_tr_b16 v[36:37], v9 offset:1024
    ds_read_b64_tr_b16 v[38:39], v9 offset:2560
CP_nk_28:
    v_smfmac_f32_16x16x64_bf16 v[128:131], v[88:91], v[160:167], v6
    v_smfmac_f32_16x16x64_bf16 v[128:131], v[92:95], v[168:175], v6
    v_smfmac_f32_16x16x64_bf16 v[128:131], v[96:99], v[176:183], v6
    v_smfmac_f32_16x16x64_bf16 v[128:131], v[100:103], v[184:191], v6
    v_smfmac_f32_16x16x64_bf16 v[128:131], v[104:107], v[192:199], v6
    v_smfmac_f32_16x16x64_bf16 v[128:131], v[108:111], v[200:207], v6
    s_waitcnt lgkmcnt(0)
    v_mfma_f32_16x16x32_bf16 v[116:119], v[28:31], v[136:139], 0
    v_mfma_f32_16x16x32_bf16 v[116:119], v[32:35], v[140:143], v[116:119]
    v_mfma_f32_16x16x32_bf16 v[116:119], v[36:39], v[144:147], v[116:119]
    v_smfmac_f32_16x16x64_bf16 v[128:131], v[112:115], v[208:215], v6
    s_nop 6
    v_bfi_b32 v116, 1, v23, v116
    buffer_store_dwordx4 v[116:119], v10, s[8:11], s27 offen
    v_smfmac_f32_16x16x64_bf16 v[132:135], v[76:79], v[216:223], v6
    v_smfmac_f32_16x16x64_bf16 v[132:135], v[80:83], v[224:231], v6
    v_smfmac_f32_16x16x64_bf16 v[132:135], v[84:87], v[232:239], v6
    v_smfmac_f32_16x16x64_bf16 v[132:135], v[88:91], v[240:247], v6
    v_smfmac_f32_16x16x64_bf16 v[132:135], v[92:95], v[248:255], v6
    v_mov_b32 v22, v22
    s_nop 2
    buffer_load_dwordx4 v[52:55], v0, s[8:11], s28 offen sc1
    buffer_load_dwordx4 v[56:59], v0, s[8:11], s28 offen offset:2048 sc1
    buffer_load_dwordx2 v[60:61], v11, s[8:11], s28 offen sc1
    s_nop 1
    v_add_f32 v128, v128, v129
    v_add_f32 v129, v130, v131
    v_bfi_b32 v128, 1, v23, v128
    s_nop 2
    v_add_f32 v130, v132, v133
    v_add_f32 v131, v134, v135
    buffer_store_dwordx4 v[128:131], v12, s[8:11], s29 offen
    v_mov_b32 v22, v22
    s_nop 2
    v_mov_b32 v22, v22
    s_nop 2
    v_mov_b32 v22, v22
    s_nop 2
    buffer_load_dwordx4 v[52:55], v0, s[8:11], s28 offen sc1
    buffer_load_dwordx4 v[56:59], v0, s[8:11], s28 offen offset:2048 sc1
    buffer_load_dwordx2 v[60:61], v11, s[8:11], s28 offen sc1
    ds_read_b128 v[76:79], v20 offset:0
    ds_read_b128 v[80:83], v20 offset:1024
    ds_read_b128 v[84:87], v20 offset:2048
    ds_read_b128 v[88:91], v20 offset:3072
    s_waitcnt vmcnt(4)
    v_xor_b32 v26, s35, v52
    v_bitop3_b32 v26, v26, v56, s35 bitop3:0xf6
    v_bitop3_b32 v26, v26, v60, s35 bitop3:0xf6
    v_and_b32 v26, 1, v26
    v_cmp_ne_u32 vcc, 0, v26
    s_cbranch_vccnz CP_S_s
CP_S_m:
    v_add_f32 v144, v52, v56
    v_add_f32 v145, v53, v57
    v_add_f32 v146, v54, v58
    v_add_f32 v147, v55, v59
    v_add_f32_dpp v148, v60, v60 row_ror:8 row_mask:0xf bank_mask:0xf
    v_add_f32_dpp v149, v61, v61 row_ror:8 row_mask:0xf bank_mask:0xf
    buffer_load_dwordx4 v[52:55], v2, s[8:11], s37 offen offset:0 sc1
    buffer_load_dwordx4 v[56:59], v2, s[8:11], s37 offen offset:1024 sc1
    v_max3_f32 v72, v144, v145, v146
    v_max3_f32 v73, v147, v148, v149
    v_max_f32 v72, v72, v73
    s_nop 1
    v_max_f32_dpp v72, v72, v72 row_ror:8 row_mask:0xf bank_mask:0xf
    ds_read_b128 v[92:95], v20 offset:4096
    v_mov_b32 v73, v72
    s_nop 1
    v_permlane32_swap_b32 v72, v73
    v_max_f32 v72, v72, v73
    v_mov_b32 v73, v72
    ds_read_b128 v[96:99], v20 offset:5120
    s_nop 1
    v_permlane16_swap_b32 v72, v73
    v_max_f32 v72, v72, v73
    v_mul_f32 v75, s50, v72
    v_fma_f32 v144, v144, s50, -v75
    ds_read_b128 v[100:103], v20 offset:6144
    v_fma_f32 v145, v145, s50, -v75
    v_fma_f32 v146, v146, s50, -v75
    v_fma_f32 v147, v147, s50, -v75
    v_fma_f32 v148, v148, s50, -v75
    v_fma_f32 v149, v149, s50, -v75
    ds_read_b128 v[104:107], v20 offset:7168
    buffer_load_dwordx4 v[52:55], v2, s[8:11], s37 offen offset:0 sc1
    buffer_load_dwordx4 v[56:59], v2, s[8:11], s37 offen offset:1024 sc1
    v_exp_f32 v144, v144
    v_exp_f32 v145, v145
    v_exp_f32 v146, v146
    ds_read_b128 v[108:111], v20 offset:8192
    v_exp_f32 v147, v147
    v_exp_f32 v148, v148
    v_exp_f32 v149, v149
    v_cvt_pk_bf16_f32 v128, v144, v145
    v_cvt_pk_bf16_f32 v129, v146, v147
    ds_read_b128 v[112:115], v20 offset:9216
    v_cvt_pk_bf16_f32 v132, v148, v149
    v_mov_b32_dpp v130, v128 row_ror:8 row_mask:0xf bank_mask:0xf
    v_mov_b32_dpp v131, v129 row_ror:8 row_mask:0xf bank_mask:0xf
    v_cvt_pk_bf16_f32 v133, v148, v149
    v_cvt_pk_bf16_f32 v134, v148, v149
    ds_read_b128 v[136:139], v20 offset:10240
    v_cvt_pk_bf16_f32 v63, v148, v149
    v_add_f32 v74, v144, v145
    v_mfma_f32_16x16x32_bf16 v[116:119], v[40:43], v[128:131], 0
    v_mfma_f32_16x16x32_bf16 v[120:123], v[44:47], v[128:131], 0
    v_mfma_f32_16x16x32_bf16 v[124:127], v[48:51], v[128:131], 0
    ds_read_b128 v[140:143], v20 offset:11264
    v_add_f32 v73, v146, v147
    v_add_f32 v74, v74, v73
    v_add_f32 v73, v148, v149
    v_mov_b32 v135, 0
    v_add_f32_dpp v74, v74, v74 row_ror:8 row_mask:0xf bank_mask:0xf
    v_add_f32 v74, v74, v73
    v_mov_b32 v73, v74
    v_mov_b32 v62, 0
    s_nop 0
    v_permlane32_swap_b32 v74, v73
    v_add_f32 v74, v74, v73
    v_mov_b32 v73, v74
    s_nop 1
    v_permlane16_swap_b32 v74, v73
    v_add_f32 v74, v74, v73
    v_rcp_f32 v74, v74
    s_waitcnt vmcnt(2)
    v_xor_b32 v26, s35, v52
    v_bitop3_b32 v26, v26, v56, s35 bitop3:0xf6
    v_and_b32 v26, 1, v26
    v_cmp_ne_u32 vcc, 0, v26
    s_cbranch_vccnz CP_redoV
CP_okV:
    v_cvt_pk_bf16_f32 v144, v52, v53
    v_cvt_pk_bf16_f32 v145, v56, v57
    v_cvt_pk_bf16_f32 v146, v54, v55
    v_cvt_pk_bf16_f32 v147, v58, v59
    s_nop 0
    v_mfma_f32_16x16x16_bf16 v[116:119], v[144:145], v[134:135], v[116:119]
    v_mfma_f32_16x16x16_bf16 v[120:123], v[144:145], v[62:63], v[120:123]
    v_mfma_f32_16x16x16_bf16 v[124:127], v[146:147], v[132:133], v[124:127]
    ds_read_b128 v[40:43], v20 offset:12288
    ds_read_b128 v[44:47], v20 offset:13312
    s_nop 5
    v_pk_mul_f32 v[116:117], v[116:117], v[74:75] op_sel_hi:[1,0]
    v_pk_mul_f32 v[118:119], v[118:119], v[74:75] op_sel_hi:[1,0]
    v_cvt_pk_bf16_f32 v116, v116, v117
    v_cvt_pk_bf16_f32 v117, v118, v119
    ds_write_b64 v14, v[116:117] offset:0
    v_pk_mul_f32 v[120:121], v[120:121], v[74:75] op_sel_hi:[1,0]
    v_pk_mul_f32 v[122:123], v[122:123], v[74:75] op_sel_hi:[1,0]
    v_cvt_pk_bf16_f32 v120, v120, v121
    v_cvt_pk_bf16_f32 v121, v122, v123
    ds_write_b64 v14, v[120:121] offset:32
    v_pk_mul_f32 v[124:125], v[124:125], v[74:75] op_sel_hi:[1,0]
    v_pk_mul_f32 v[126:127], v[126:127], v[74:75] op_sel_hi:[1,0]
    v_cvt_pk_bf16_f32 v124, v124, v125
    v_cvt_pk_bf16_f32 v125, v126, v127
    ds_write_b64 v14, v[124:125] offset:64
    s_waitcnt vmcnt(0)
    v_mov_b32 v52, 0
    v_mov_b32 v53, 0
    v_mov_b32 v54, 0
    v_mov_b32 v55, 0
    v_mov_b32 v56, 0
    v_mov_b32 v57, 0
    v_mov_b32 v58, 0
    v_mov_b32 v59, 0
    v_mov_b32 v60, 0
    v_mov_b32 v61, 0
    v_mov_b32 v62, 0
    v_mov_b32 v63, 0
    v_mov_b32 v64, 0
    v_mov_b32 v65, 0
    v_mov_b32 v66, 0
    v_mov_b32 v67, 0
    v_mov_b32 v68, 0
    v_mov_b32 v69, 0
    v_mov_b32 v70, 0
    v_mov_b32 v71, 0
    s_waitcnt lgkmcnt(0)
    s_barrier
    ds_read_b128 v[116:119], v15 offset:0
    ds_read_b128 v[120:123], v15 offset:128
    ds_read_b128 v[124:127], v15 offset:256
    ds_read_b128 v[128:131], v20 offset:14336
    ds_read_b128 v[132:135], v20 offset:15360
    s_cmp_eq_u32 s33, 63
    s_cbranch_scc1 C_last
    s_add_u32 s43, s43, 393216
    v_mov_b32 v27, s33
    buffer_store_dword v27, v22, s[8:11], s96 offen sc1
    s_waitcnt lgkmcnt(4)
    v_smfmac_f32_16x16x64_bf16 v[68:71], v[116:119], v[76:83], v6
    ds_read_b128 v[76:79], v20 offset:16384
    ds_read_b128 v[80:83], v20 offset:17408
    v_smfmac_f32_16x16x64_bf16 v[52:55], v[116:119], v[84:91], v6
    ds_read_b128 v[84:87], v20 offset:18432
    ds_read_b128 v[88:91], v20 offset:19456
    v_smfmac_f32_16x16x64_bf16 v[56:59], v[116:119], v[92:99], v6
    ds_read_b128 v[92:95], v20 offset:20480
    ds_read_b128 v[96:99], v20 offset:21504
    v_smfmac_f32_16x16x64_bf16 v[60:63], v[116:119], v[100:107], v6
    ds_read_b128 v[100:103], v20 offset:22528
    ds_read_b128 v[104:107], v20 offset:23552
    v_smfmac_f32_16x16x64_bf16 v[64:67], v[116:119], v[108:115], v6
    ds_read_b128 v[108:111], v20 offset:24576
    ds_read_b128 v[112:115], v20 offset:25600
    s_waitcnt lgkmcnt(13)
    v_smfmac_f32_16x16x64_bf16 v[68:71], v[120:123], v[136:143], v6
    ds_read_b128 v[136:139], v20 offset:26624
    ds_read_b128 v[140:143], v20 offset:27648
    v_smfmac_f32_16x16x64_bf16 v[52:55], v[120:123], v[40:47], v6
    ds_read_b128 v[40:43], v20 offset:28672
    ds_read_b128 v[44:47], v20 offset:29696
    s_waitcnt lgkmcnt(14)
    v_smfmac_f32_16x16x64_bf16 v[56:59], v[120:123], v[128:135], v6
    s_waitcnt lgkmcnt(12)
    v_smfmac_f32_16x16x64_bf16 v[60:63], v[120:123], v[76:83], v6
    s_waitcnt lgkmcnt(10)
    v_smfmac_f32_16x16x64_bf16 v[64:67], v[120:123], v[84:91], v6
    s_waitcnt lgkmcnt(8)
    v_smfmac_f32_16x16x64_bf16 v[68:71], v[124:127], v[92:99], v6
    s_waitcnt lgkmcnt(6)
    v_smfmac_f32_16x16x64_bf16 v[52:55], v[124:127], v[100:107], v6
    s_waitcnt lgkmcnt(4)
    v_smfmac_f32_16x16x64_bf16 v[56:59], v[124:127], v[108:115], v6
    s_waitcnt lgkmcnt(2)
    v_smfmac_f32_16x16x64_bf16 v[60:63], v[124:127], v[136:143], v6
    s_waitcnt lgkmcnt(0)
    v_smfmac_f32_16x16x64_bf16 v[64:67], v[124:127], v[40:47], v6
    s_nop 3
    v_add_f32 v136, v68, v69
    v_add_f32 v137, v70, v71
    v_bfi_b32 v136, 1, v23, v136
    v_bfi_b32 v137, 1, v23, v137
    buffer_store_dword v136, v17, s[8:11], s38 offen
    buffer_store_dword v137, v17, s[8:11], s38 offen offset:64
    v_add_f32 v128, v52, v53
    v_add_f32 v132, v54, v55
    v_bfi_b32 v128, 1, v23, v128
    v_bfi_b32 v132, 1, v23, v132
    v_add_f32 v129, v56, v57
    v_add_f32 v133, v58, v59
    v_add_f32 v130, v60, v61
    v_add_f32 v134, v62, v63
    v_add_f32 v131, v64, v65
    v_add_f32 v135, v66, v67
    buffer_store_dwordx4 v[128:131], v16, s[8:11], s38 offen
    buffer_store_dwordx4 v[132:135], v16, s[8:11], s38 offen offset:64
    s_and_b32 s30, s33, 2
    s_or_b32 s30, s30, s21
    s_xor_b32 s41, s30, 1
    v_mov_b32 v27, s30
    v_mov_b32 v22, v22
    s_nop 2
    v_mov_b32 v22, v22
    s_nop 2
    v_mov_b32 v22, v22
    s_nop 2
    v_mov_b32 v22, v22
    s_nop 2
    v_mov_b32 v22, v22
    s_nop 2
    v_mov_b32 v22, v22
    s_nop 2
    v_mov_b32 v22, v22
    s_nop 2
    v_mov_b32 v22, v22
    s_nop 2
    v_mov_b32 v22, v22
    s_nop 2
    v_mov_b32 v22, v22
    s_nop 2
    v_mov_b32 v22, v22
    s_nop 2
    v_mov_b32 v22, v22
    s_nop 2
    v_mov_b32 v22, v22
    s_nop 2
    v_mov_b32 v22, v22
    s_nop 2
    v_mov_b32 v22, v22
    s_nop 2
    v_mov_b32 v22, v22
    s_nop 2
    v_mov_b32 v22, v22
    s_nop 2
    v_mov_b32 v22, v22
    s_nop 2
    v_mov_b32 v22, v22
    s_nop 2
    v_mov_b32 v22, v22
    s_nop 2
    v_mov_b32 v22, v22
    s_nop 2
    v_mov_b32 v22, v22
    s_nop 2
    s_mov_b64 exec, s[54:55]
    buffer_load_dwordx4 v[76:79], v18, s[8:11], s38 offen offset:0 sc1
    buffer_load_dwordx4 v[80:83], v18, s[8:11], s38 offen offset:640 sc1
    buffer_load_dwordx4 v[84:87], v18, s[8:11], s38 offen offset:1280 sc1
    buffer_load_dwordx4 v[88:91], v18, s[8:11], s38 offen offset:1920 sc1
    v_mov_b32 v22, v22
    s_nop 2
    v_mov_b32 v22, v22
    s_nop 2
    v_mov_b32 v22, v22
    s_nop 2
    v_mov_b32 v22, v22
    s_nop 2
    v_mov_b32 v22, v22
    s_nop 2
    v_mov_b32 v22, v22
    s_nop 2
    v_mov_b32 v22, v22
    s_nop 2
    v_mov_b32 v22, v22
    s_nop 2
    v_mov_b32 v22, v22
    s_nop 2
    v_mov_b32 v22, v22
    s_nop 2
    buffer_load_dwordx4 v[76:79], v18, s[8:11], s38 offen offset:0 sc1
    buffer_load_dwordx4 v[80:83], v18, s[8:11], s38 offen offset:640 sc1
    buffer_load_dwordx4 v[84:87], v18, s[8:11], s38 offen offset:1280 sc1
    buffer_load_dwordx4 v[88:91], v18, s[8:11], s38 offen offset:1920 sc1
    v_mov_b32 v22, v22
    s_nop 2
    v_mov_b32 v22, v22
    s_nop 2
    v_mov_b32 v22, v22
    s_nop 2
    v_mov_b32 v22, v22
    s_nop 2
    v_mov_b32 v22, v22
    s_nop 2
    v_mov_b32 v22, v22
    s_nop 2
    s_waitcnt vmcnt(4)
    v_xor_b32 v26, s35, v76
    v_bitop3_b32 v26, v26, v80, s35 bitop3:0xf6
    v_bitop3_b32 v26, v26, v84, s35 bitop3:0xf6
    v_bitop3_b32 v26, v26, v88, s35 bitop3:0xf6
    v_and_b32 v26, 1, v26
    v_cmp_ne_u32 vcc, 0, v26
    s_cbranch_vccnz CP_R_s
CP_R_m:
    s_mov_b64 exec, -1
    v_pk_add_f32 v[108:109], v[76:77], v[80:81]
    v_pk_add_f32 v[112:113], v[84:85], v[88:89]
    v_pk_add_f32 v[110:111], v[78:79], v[82:83]
    v_pk_add_f32 v[114:115], v[86:87], v[90:91]
    v_pk_add_f32 v[108:109], v[108:109], v[112:113]
    v_pk_add_f32 v[110:111], v[110:111], v[114:115]
    s_nop 0
    s_nop 0
    v_permlane32_swap_b32 v108, v110
    v_permlane32_swap_b32 v109, v111
    v_add_f32 v108, v108, v110
    v_add_f32 v109, v109, v111
    v_mov_b32 v110, v108
    v_mov_b32 v111, v109
    s_nop 0
    v_permlane16_swap_b32 v108, v110
    v_permlane16_swap_b32 v109, v111
    v_add_f32 v108, v108, v110
    v_add_f32 v109, v109, v111
    v_bfi_b32 v136, 7, v27, v108
    v_mov_b32 v137, v109
    s_mov_b64 exec, s[94:95]
    buffer_atomic_swap_x2 v[136:137], v25, s[8:11], s40 offen sc0
    s_mov_b64 exec, -1
    s_add_u32 s39, s39, 10240
    s_add_u32 s33, s33, 1
    s_add_u32 s44, s44, 98304
    s_add_u32 s45, s45, 131072
    s_not_b32 s35, s35
    s_lshr_b32 s30, s25, 1
    s_cmp_eq_u32 s30, s26
    s_cselect_b32 s56, 1, 0
    s_cmp_eq_u32 s25, 0
    s_cselect_b32 s57, 1, 0
    v_xor_b32 v23, 1, v23
    v_mov_b32 v116, 0
    v_mov_b32 v117, 0
    v_mov_b32 v118, 0
    v_mov_b32 v119, 0
    v_mov_b32 v120, 0
    v_mov_b32 v121, 0
    v_mov_b32 v122, 0
    v_mov_b32 v123, 0
    v_mov_b32 v124, 0
    v_mov_b32 v125, 0
    v_mov_b32 v126, 0
    v_mov_b32 v127, 0
    v_mov_b32 v128, 0
    v_mov_b32 v129, 0
    v_mov_b32 v130, 0
    v_mov_b32 v131, 0
    v_mov_b32 v132, 0
    v_mov_b32 v133, 0
    v_mov_b32 v134, 0
    v_mov_b32 v135, 0
    s_add_u32 s30, s33, 2
    s_min_u32 s53, s30, 64
    s_cmp_ge_u32 s101, s53
    s_cbranch_scc1 CP_kw_33
    v_and_b32 v26, 3, v1
    v_lshlrev_b32 v26, 2, v26
    v_bfe_u32 v27, v1, 2, 1
    v_lshl_add_u32 v26, v27, 12, v26
CP_kw_32:
    buffer_load_dword v27, v26, s[8:11], s100 offen sc1
    s_sub_u32 s34, s34, 1
    s_cbranch_scc1 C_abort
    s_waitcnt vmcnt(0)
    s_nop 1
    v_min_u32_dpp v27, v27, v27 row_shl:1 row_mask:0xf bank_mask:0xf
    s_nop 1
    v_min_u32_dpp v27, v27, v27 row_shl:2 row_mask:0xf bank_mask:0xf
    s_nop 1
    v_min_u32_dpp v27, v27, v27 row_shl:4 row_mask:0xf bank_mask:0xf
    s_nop 1
    v_readfirstlane_b32 s101, v27
    s_cmp_ge_u32 s101, s53
    s_cbranch_scc1 CP_kw_33
    s_sleep 2
    s_branch CP_kw_32
CP_kw_33:
    s_mov_b64 exec, s[94:95]
    v_mov_b32 v138, 0
    v_mov_b32 v139, 0
    buffer_atomic_or_x2 v[138:139], v25, s[8:11], s40 offen sc0
    v_mov_b32 v22, v22
    s_nop 2
    v_mov_b32 v22, v22
    s_nop 2
    v_mov_b32 v22, v22
    s_nop 2
    v_mov_b32 v22, v22
    s_nop 2
    v_mov_b32 v22, v22
    s_nop 2
    v_mov_b32 v22, v22
    s_nop 2
    v_mov_b32 v22, v22
    s_nop 2
    v_mov_b32 v22, v22
    s_nop 2
    v_mov_b32 v22, v22
    s_nop 2
    v_mov_b32 v22, v22
    s_nop 2
    v_mov_b32 v140, 0
    v_mov_b32 v141, 0
    buffer_atomic_or_x2 v[140:141], v25, s[8:11], s40 offen sc0
    v_mov_b32 v22, v22
    s_nop 2
    v_mov_b32 v22, v22
    s_nop 2
    v_mov_b32 v22, v22
    s_nop 2
    v_mov_b32 v22, v22
    s_nop 2
    v_mov_b32 v22, v22
    s_nop 2
    v_mov_b32 v22, v22
    s_nop 2
    v_mov_b32 v22, v22
    s_nop 2
    v_mov_b32 v22, v22
    s_nop 2
    v_mov_b32 v22, v22
    s_nop 2
    v_mov_b32 v22, v22
    s_nop 2
    v_mov_b32 v142, 0
    v_mov_b32 v143, 0
    buffer_atomic_or_x2 v[142:143], v25, s[8:11], s40 offen sc0
    v_mov_b32 v22, v22
    s_nop 2
    v_mov_b32 v22, v22
    s_nop 2
    s_waitcnt vmcnt(3)
    v_and_b32 v26, 7, v136
    v_cmp_ne_u32 vcc, s41, v26
    s_cbranch_vccz CP_X_ok
    s_mov_b64 exec, vcc
CP_X_l:
    s_waitcnt vmcnt(2)
    v_mov_b32 v136, v138
    v_mov_b32 v137, v139
    v_and_b32 v26, 7, v138
    v_cmp_ne_u32 vcc, s41, v26
    s_cbranch_vccz CP_X_ok
    s_mov_b64 exec, vcc
    v_mov_b32 v138, 0
    v_mov_b32 v139, 0
    buffer_atomic_or_x2 v[138:139], v25, s[8:11], s40 offen sc0
    v_mov_b32 v22, v22
    s_nop 2
    v_mov_b32 v22, v22
    s_nop 2
    s_waitcnt vmcnt(2)
    v_mov_b32 v136, v140
    v_mov_b32 v137, v141
    v_and_b32 v26, 7, v140
    v_cmp_ne_u32 vcc, s41, v26
    s_cbranch_vccz CP_X_ok
    s_mov_b64 exec, vcc
    v_mov_b32 v140, 0
    v_mov_b32 v141, 0
    buffer_atomic_or_x2 v[140:141], v25, s[8:11], s40 offen sc0
    v_mov_b32 v22, v22
    s_nop 2
    v_mov_b32 v22, v22
    s_nop 2
    s_waitcnt vmcnt(2)
    v_mov_b32 v136, v142
    v_mov_b32 v137, v143
    v_and_b32 v26, 7, v142
    v_cmp_ne_u32 vcc, s41, v26
    s_cbranch_vccz CP_X_ok
    s_mov_b64 exec, vcc
    v_mov_b32 v142, 0
    v_mov_b32 v143, 0
    buffer_atomic_or_x2 v[142:143], v25, s[8:11], s40 offen sc0
    s_sub_u32 s34, s34, 1
    s_cbranch_scc1 C_abort
    v_mov_b32 v22, v22
    s_nop 2
    v_mov_b32 v22, v22
    s_nop 2
    s_branch CP_X_l
CP_X_ok:
    s_mov_b64 exec, -1
    s_mov_b32 s30, s40
    s_mov_b32 s40, s93
    s_mov_b32 s93, s30
    v_pk_add_f32 v[112:113], v[108:109], v[136:137]
    v_cvt_pk_bf16_f32 v112, v112, v113
    v_min_u32 v112, -2, v112
    v_mov_b32 v113, v112
    s_nop 1
    v_permlane32_swap_b32 v112, v113
    s_nop 0
    s_nop 0
    v_mov_b32_dpp v114, v112 row_shl:1 row_mask:0xf bank_mask:0xf
    v_mov_b32_dpp v115, v113 row_shl:1 row_mask:0xf bank_mask:0xf
    buffer_store_dwordx4 v[112:115], v19, s[8:11], s39 offen
    s_branch CP_step
CP_L_s:
    s_mov_b64 exec, vcc
    s_add_u32 s30, s39, s52
    buffer_load_dwordx4 v[52:55], v2, s[8:11], s30 offen sc1
    buffer_load_dwordx4 v[56:59], v2, s[8:11], s30 offen offset:1024 sc1
    buffer_load_dwordx2 v[60:61], v13, s[8:11], s30 offen offset:2048 sc1
    s_sub_u32 s34, s34, 1
    s_cbranch_scc1 C_abort
    v_mov_b32 v22, v22
    s_nop 2
    s_waitcnt vmcnt(3)
    v_max3_u32 v26, v52, v56, v60
    v_cmp_eq_u32 vcc, -1, v26
    s_cbranch_vccnz CP_L_s
    s_mov_b64 exec, -1
    s_branch CP_L_m
CP_S_s:
    s_mov_b64 exec, vcc
    buffer_load_dwordx4 v[52:55], v0, s[8:11], s28 offen sc1
    buffer_load_dwordx4 v[56:59], v0, s[8:11], s28 offen offset:2048 sc1
    buffer_load_dwordx2 v[60:61], v11, s[8:11], s28 offen sc1
    s_sub_u32 s34, s34, 1
    s_cbranch_scc1 C_abort
    v_mov_b32 v22, v22
    s_nop 2
    s_waitcnt vmcnt(3)
    v_xor_b32 v26, s35, v52
    v_bitop3_b32 v26, v26, v56, s35 bitop3:0xf6
    v_bitop3_b32 v26, v26, v60, s35 bitop3:0xf6
    v_and_b32 v26, 1, v26
    v_cmp_ne_u32 vcc, 0, v26
    s_cbranch_vccnz CP_S_s
    s_mov_b64 exec, -1
    s_branch CP_S_m
CP_R_s:
    s_mov_b64 exec, vcc
    buffer_load_dwordx4 v[76:79], v18, s[8:11], s38 offen offset:0 sc1
    buffer_load_dwordx4 v[80:83], v18, s[8:11], s38 offen offset:640 sc1
    buffer_load_dwordx4 v[84:87], v18, s[8:11], s38 offen offset:1280 sc1
    buffer_load_dwordx4 v[88:91], v18, s[8:11], s38 offen offset:1920 sc1
    s_sub_u32 s34, s34, 1
    s_cbranch_scc1 C_abort
    v_mov_b32 v22, v22
    s_nop 2
    s_waitcnt vmcnt(4)
    v_xor_b32 v26, s35, v76
    v_bitop3_b32 v26, v26, v80, s35 bitop3:0xf6
    v_bitop3_b32 v26, v26, v84, s35 bitop3:0xf6
    v_bitop3_b32 v26, v26, v88, s35 bitop3:0xf6
    v_and_b32 v26, 1, v26
    v_cmp_ne_u32 vcc, 0, v26
    s_cbranch_vccnz CP_R_s
    s_mov_b64 exec, -1
    s_branch CP_R_m
CP_redoV:
    s_mov_b64 exec, vcc
    buffer_load_dwordx4 v[52:55], v2, s[8:11], s37 offen offset:0 sc1
    buffer_load_dwordx4 v[56:59], v2, s[8:11], s37 offen offset:1024 sc1
    s_sub_u32 s34, s34, 1
    s_cbranch_scc1 C_abort
    v_mov_b32 v22, v22
    s_nop 2
    s_waitcnt vmcnt(2)
    v_xor_b32 v26, s35, v52
    v_bitop3_b32 v26, v26, v56, s35 bitop3:0xf6
    v_and_b32 v26, 1, v26
    v_cmp_ne_u32 vcc, 0, v26
    s_cbranch_vccnz CP_redoV
    s_mov_b64 exec, -1
    s_branch CP_okV
C_impure:
    v_mov_b32 v116, 0
    v_mov_b32 v117, 0
    v_mov_b32 v118, 0
    v_mov_b32 v119, 0
    v_mov_b32 v120, 0
    v_mov_b32 v121, 0
    v_mov_b32 v122, 0
    v_mov_b32 v123, 0
    v_mov_b32 v124, 0
    v_mov_b32 v125, 0
    v_mov_b32 v126, 0
    v_mov_b32 v127, 0
    v_mov_b32 v128, 0
    v_mov_b32 v129, 0
    v_mov_b32 v130, 0
    v_mov_b32 v131, 0
    v_mov_b32 v132, 0
    v_mov_b32 v133, 0
    v_mov_b32 v134, 0
    v_mov_b32 v135, 0
    s_branch CI_ready
CI_step:
    v_mov_b32 v22, v22
    s_nop 2
    v_mov_b32 v22, v22
    s_nop 2
    v_mov_b32 v22, v22
    s_nop 2
    v_mov_b32 v22, v22
    s_nop 2
    v_mov_b32 v22, v22
    s_nop 2
    v_mov_b32 v22, v22
    s_nop 2
    v_mov_b32 v22, v22
    s_nop 2
    v_mov_b32 v22, v22
    s_nop 2
    v_mov_b32 v22, v22
    s_nop 2
    v_mov_b32 v22, v22
    s_nop 2
    v_mov_b32 v22, v22
    s_nop 2
    v_mov_b32 v22, v22
    s_nop 2
    v_mov_b32 v22, v22
    s_nop 2
    v_mov_b32 v22, v22
    s_nop 2
    v_mov_b32 v22, v22
    s_nop 2
    v_mov_b32 v22, v22
    s_nop 2
    v_mov_b32 v22, v22
    s_nop 2
    v_mov_b32 v22, v22
    s_nop 2
    v_mov_b32 v22, v22
    s_nop 2
    v_mov_b32 v22, v22
    s_nop 2
    v_mov_b32 v22, v22
    s_nop 2
    v_mov_b32 v22, v22
    s_nop 2
    s_add_u32 s30, s39, s52
    buffer_load_dwordx4 v[52:55], v2, s[8:11], s30 offen sc1
    buffer_load_dwordx4 v[56:59], v2, s[8:11], s30 offen offset:1024 sc1
    buffer_load_dwordx2 v[60:61], v13, s[8:11], s30 offen offset:2048 sc1
    v_mov_b32 v22, v22
    s_nop 2
    v_mov_b32 v22, v22
    s_nop 2
    v_mov_b32 v22, v22
    s_nop 2
    v_mov_b32 v22, v22
    s_nop 2
    v_mov_b32 v22, v22
    s_nop 2
    v_mov_b32 v22, v22
    s_nop 2
    s_add_u32 s30, s39, s52
    buffer_load_dwordx4 v[52:55], v2, s[8:11], s30 offen sc1
    buffer_load_dwordx4 v[56:59], v2, s[8:11], s30 offen offset:1024 sc1
    buffer_load_dwordx2 v[60:61], v13, s[8:11], s30 offen offset:2048 sc1
    v_mov_b32 v22, v22
    s_nop 2
    v_mov_b32 v22, v22
    s_nop 2
    v_mov_b32 v22, v22
    s_nop 2
    v_mov_b32 v22, v22
    s_nop 2
    v_mov_b32 v22, v22
    s_nop 2
    v_mov_b32 v22, v22
    s_nop 2
    s_waitcnt vmcnt(3)
    v_max3_u32 v26, v52, v56, v60
    v_cmp_eq_u32 vcc, -1, v26
    s_cbranch_vccnz CI_L_s
CI_L_m:
    ds_write_b128 v5, v[52:55]
    ds_write_b128 v5, v[56:59] offset:1024
    ds_write_b64 v24, v[60:61] offset:2048
    s_waitcnt lgkmcnt(0)
CI_ready:
    s_barrier
    ds_read_b128 v[76:79], v3 offset:0
    ds_read_b128 v[80:83], v3 offset:1024
    ds_read_b128 v[84:87], v3 offset:2048
    s_cmp_eq_u32 s56, 0
    s_cbranch_scc1 CI_s0_34
    buffer_store_dwordx4 v[144:147], v2, s[8:11], s45 offen sc1
CI_s0_34:
    s_cmp_eq_u32 s57, 0
    s_cbranch_scc1 CI_s1_35
    buffer_store_dwordx4 v[28:31], v21, s[8:11], s44 offen offset:0 sc1
    buffer_store_dwordx4 v[32:35], v21, s[8:11], s44 offen offset:512 sc1
    buffer_store_dwordx4 v[36:39], v21, s[8:11], s44 offen offset:1024 sc1
CI_s1_35:
    s_waitcnt lgkmcnt(2)
    v_smfmac_f32_16x16x64_bf16 v[116:119], v[76:79], a[0:7], v6
    ds_read_b128 v[88:91], v3 offset:3072
    v_smfmac_f32_16x16x64_bf16 v[120:123], v[76:79], a[80:87], v6
    v_smfmac_f32_16x16x64_bf16 v[124:127], v[76:79], a[160:167], v6
    s_waitcnt lgkmcnt(2)
    v_smfmac_f32_16x16x64_bf16 v[116:119], v[80:83], a[8:15], v6
    ds_read_b128 v[92:95], v3 offset:4096
    v_smfmac_f32_16x16x64_bf16 v[120:123], v[80:83], a[88:95], v6
    buffer_load_dwordx4 v[40:43], v2, s[8:11], s43 offen offset:0
    v_smfmac_f32_16x16x64_bf16 v[124:127], v[80:83], a[168:175], v6
    s_waitcnt lgkmcnt(2)
    v_smfmac_f32_16x16x64_bf16 v[116:119], v[84:87], a[16:23], v6
    ds_read_b128 v[96:99], v4 offset:0
    v_smfmac_f32_16x16x64_bf16 v[120:123], v[84:87], a[96:103], v6
    buffer_load_dwordx4 v[44:47], v2, s[8:11], s43 offen offset:1024
    v_smfmac_f32_16x16x64_bf16 v[124:127], v[84:87], a[176:183], v6
    s_waitcnt lgkmcnt(2)
    v_smfmac_f32_16x16x64_bf16 v[116:119], v[88:91], a[24:31], v6
    ds_read_b128 v[100:103], v4 offset:1024
    v_smfmac_f32_16x16x64_bf16 v[120:123], v[88:91], a[104:111], v6
    buffer_load_dwordx4 v[48:51], v2, s[8:11], s43 offen offset:2048
    v_smfmac_f32_16x16x64_bf16 v[124:127], v[88:91], a[184:191], v6
    s_waitcnt lgkmcnt(2)
    v_smfmac_f32_16x16x64_bf16 v[116:119], v[92:95], a[32:39], v6
    ds_read_b128 v[104:107], v4 offset:2048
    v_smfmac_f32_16x16x64_bf16 v[120:123], v[92:95], a[112:119], v6
    s_mov_b32 m0, s58
    s_add_u32 s30, s42, s77
    buffer_load_dwordx4 v151, s[8:11], s42 offen lds
    v_smfmac_f32_16x16x64_bf16 v[124:127], v[92:95], a[192:199], v6
    s_waitcnt lgkmcnt(2)
    v_smfmac_f32_16x16x64_bf16 v[116:119], v[96:99], a[40:47], v6
    ds_read_b128 v[108:111], v4 offset:3072
    v_smfmac_f32_16x16x64_bf16 v[120:123], v[96:99], a[120:127], v6
    s_add_u32 s31, s39, 10240
    buffer_load_dword v26, v19, s[8:11], s31 offen
    v_smfmac_f32_16x16x64_bf16 v[124:127], v[96:99], a[200:207], v6
    s_waitcnt lgkmcnt(2)
    v_smfmac_f32_16x16x64_bf16 v[116:119], v[100:103], a[48:55], v6
    ds_read_b128 v[112:115], v4 offset:4096
    v_smfmac_f32_16x16x64_bf16 v[120:123], v[100:103], a[128:135], v6
    buffer_load_dwordx4 v151, s[8:11], s30 offen offset:1024 lds
    s_add_u32 s42, s42, 393216
    s_xor_b32 s58, s58, 0x2000
    v_smfmac_f32_16x16x64_bf16 v[124:127], v[100:103], a[208:215], v6
    s_waitcnt lgkmcnt(2)
    v_smfmac_f32_16x16x64_bf16 v[116:119], v[104:107], a[56:63], v6
    v_smfmac_f32_16x16x64_bf16 v[120:123], v[104:107], a[136:143], v6
    v_smfmac_f32_16x16x64_bf16 v[124:127], v[104:107], a[216:223], v6
    s_waitcnt lgkmcnt(1)
    v_smfmac_f32_16x16x64_bf16 v[116:119], v[108:111], a[64:71], v6
    v_smfmac_f32_16x16x64_bf16 v[120:123], v[108:111], a[144:151], v6
    v_smfmac_f32_16x16x64_bf16 v[124:127], v[108:111], a[224:231], v6
    s_waitcnt lgkmcnt(0)
    v_smfmac_f32_16x16x64_bf16 v[116:119], v[112:115], a[72:79], v6
    v_smfmac_f32_16x16x64_bf16 v[120:123], v[112:115], a[152:159], v6
    v_smfmac_f32_16x16x64_bf16 v[124:127], v[112:115], a[232:239], v6
    s_nop 5
    v_add_f32 v116, v116, v117
    v_add_f32 v118, v118, v119
    v_cvt_pk_bf16_f32 v116, v116, v118
    ds_write_b32 v7, v116 offset:0
    v_add_f32 v120, v120, v121
    v_add_f32 v122, v122, v123
    v_cvt_pk_bf16_f32 v120, v120, v122
    ds_write_b32 v7, v120 offset:512
    v_add_f32 v124, v124, v125
    v_add_f32 v126, v126, v127
    v_cvt_pk_bf16_f32 v124, v124, v126
    ds_write_b32 v7, v124 offset:1024
    ds_read_b128 v[28:31], v150 offset:0
    ds_read_b128 v[32:35], v150 offset:1024
    ds_read_b128 v[36:39], v150 offset:2048
    v_xor_b32 v150, 0x2000, v150
    v_smfmac_f32_16x16x64_bf16 v[128:131], v[76:79], a[240:247], v6
    v_smfmac_f32_16x16x64_bf16 v[128:131], v[80:83], a[248:255], v6
    v_smfmac_f32_16x16x64_bf16 v[128:131], v[84:87], v[152:159], v6
    s_waitcnt lgkmcnt(3)
    s_barrier
    ds_read_b64_tr_b16 v[136:137], v8 offset:0
    ds_read_b64_tr_b16 v[138:139], v8 offset:512
    ds_read_b64_tr_b16 v[140:141], v8 offset:1536
    ds_read_b64_tr_b16 v[142:143], v8 offset:2048
    ds_read_b64_tr_b16 v[144:145], v8 offset:1024
    ds_read_b64_tr_b16 v[146:147], v8 offset:2560
    s_cmp_lg_u32 s25, 0
    s_cbranch_scc1 CI_nk_36
    ds_read_b64_tr_b16 v[28:29], v9 offset:0
    ds_read_b64_tr_b16 v[30:31], v9 offset:512
    ds_read_b64_tr_b16 v[32:33], v9 offset:1536
    ds_read_b64_tr_b16 v[34:35], v9 offset:2048
    ds_read_b64_tr_b16 v[36:37], v9 offset:1024
    ds_read_b64_tr_b16 v[38:39], v9 offset:2560
CI_nk_36:
    v_smfmac_f32_16x16x64_bf16 v[128:131], v[88:91], v[160:167], v6
    v_smfmac_f32_16x16x64_bf16 v[128:131], v[92:95], v[168:175], v6
    v_smfmac_f32_16x16x64_bf16 v[128:131], v[96:99], v[176:183], v6
    v_smfmac_f32_16x16x64_bf16 v[128:131], v[100:103], v[184:191], v6
    v_smfmac_f32_16x16x64_bf16 v[128:131], v[104:107], v[192:199], v6
    v_smfmac_f32_16x16x64_bf16 v[128:131], v[108:111], v[200:207], v6
    s_waitcnt lgkmcnt(0)
    v_mfma_f32_16x16x32_bf16 v[116:119], v[28:31], v[136:139], 0
    v_mfma_f32_16x16x32_bf16 v[116:119], v[32:35], v[140:143], v[116:119]
    v_mfma_f32_16x16x32_bf16 v[116:119], v[36:39], v[144:147], v[116:119]
    v_smfmac_f32_16x16x64_bf16 v[128:131], v[112:115], v[208:215], v6
    s_nop 6
    v_bfi_b32 v116, 1, v23, v116
    buffer_store_dwordx4 v[116:119], v10, s[8:11], s27 offen sc1
    v_smfmac_f32_16x16x64_bf16 v[132:135], v[76:79], v[216:223], v6
    v_smfmac_f32_16x16x64_bf16 v[132:135], v[80:83], v[224:231], v6
    v_smfmac_f32_16x16x64_bf16 v[132:135], v[84:87], v[232:239], v6
    v_smfmac_f32_16x16x64_bf16 v[132:135], v[88:91], v[240:247], v6
    v_smfmac_f32_16x16x64_bf16 v[132:135], v[92:95], v[248:255], v6
    v_mov_b32 v22, v22
    s_nop 2
    buffer_load_dwordx4 v[52:55], v0, s[8:11], s28 offen sc1
    buffer_load_dwordx4 v[56:59], v0, s[8:11], s28 offen offset:2048 sc1
    buffer_load_dwordx2 v[60:61], v11, s[8:11], s28 offen sc1
    s_nop 1
    v_add_f32 v128, v128, v129
    v_add_f32 v129, v130, v131
    v_bfi_b32 v128, 1, v23, v128
    s_nop 2
    v_add_f32 v130, v132, v133
    v_add_f32 v131, v134, v135
    buffer_store_dwordx4 v[128:131], v12, s[8:11], s29 offen sc1
    v_mov_b32 v22, v22
    s_nop 2
    v_mov_b32 v22, v22
    s_nop 2
    v_mov_b32 v22, v22
    s_nop 2
    buffer_load_dwordx4 v[52:55], v0, s[8:11], s28 offen sc1
    buffer_load_dwordx4 v[56:59], v0, s[8:11], s28 offen offset:2048 sc1
    buffer_load_dwordx2 v[60:61], v11, s[8:11], s28 offen sc1
    ds_read_b128 v[76:79], v20 offset:0
    ds_read_b128 v[80:83], v20 offset:1024
    ds_read_b128 v[84:87], v20 offset:2048
    ds_read_b128 v[88:91], v20 offset:3072
    s_waitcnt vmcnt(4)
    v_xor_b32 v26, s35, v52
    v_bitop3_b32 v26, v26, v56, s35 bitop3:0xf6
    v_bitop3_b32 v26, v26, v60, s35 bitop3:0xf6
    v_and_b32 v26, 1, v26
    v_cmp_ne_u32 vcc, 0, v26
    s_cbranch_vccnz CI_S_s
CI_S_m:
    v_add_f32 v144, v52, v56
    v_add_f32 v145, v53, v57
    v_add_f32 v146, v54, v58
    v_add_f32 v147, v55, v59
    v_add_f32_dpp v148, v60, v60 row_ror:8 row_mask:0xf bank_mask:0xf
    v_add_f32_dpp v149, v61, v61 row_ror:8 row_mask:0xf bank_mask:0xf
    buffer_load_dwordx4 v[52:55], v2, s[8:11], s37 offen offset:0 sc1
    buffer_load_dwordx4 v[56:59], v2, s[8:11], s37 offen offset:1024 sc1
    v_max3_f32 v72, v144, v145, v146
    v_max3_f32 v73, v147, v148, v149
    v_max_f32 v72, v72, v73
    s_nop 1
    v_max_f32_dpp v72, v72, v72 row_ror:8 row_mask:0xf bank_mask:0xf
    ds_read_b128 v[92:95], v20 offset:4096
    v_mov_b32 v73, v72
    s_nop 1
    v_permlane32_swap_b32 v72, v73
    v_max_f32 v72, v72, v73
    v_mov_b32 v73, v72
    ds_read_b128 v[96:99], v20 offset:5120
    s_nop 1
    v_permlane16_swap_b32 v72, v73
    v_max_f32 v72, v72, v73
    v_mul_f32 v75, s50, v72
    v_fma_f32 v144, v144, s50, -v75
    ds_read_b128 v[100:103], v20 offset:6144
    v_fma_f32 v145, v145, s50, -v75
    v_fma_f32 v146, v146, s50, -v75
    v_fma_f32 v147, v147, s50, -v75
    v_fma_f32 v148, v148, s50, -v75
    v_fma_f32 v149, v149, s50, -v75
    ds_read_b128 v[104:107], v20 offset:7168
    buffer_load_dwordx4 v[52:55], v2, s[8:11], s37 offen offset:0 sc1
    buffer_load_dwordx4 v[56:59], v2, s[8:11], s37 offen offset:1024 sc1
    v_exp_f32 v144, v144
    v_exp_f32 v145, v145
    v_exp_f32 v146, v146
    ds_read_b128 v[108:111], v20 offset:8192
    v_exp_f32 v147, v147
    v_exp_f32 v148, v148
    v_exp_f32 v149, v149
    v_cvt_pk_bf16_f32 v128, v144, v145
    v_cvt_pk_bf16_f32 v129, v146, v147
    ds_read_b128 v[112:115], v20 offset:9216
    v_cvt_pk_bf16_f32 v132, v148, v149
    v_mov_b32_dpp v130, v128 row_ror:8 row_mask:0xf bank_mask:0xf
    v_mov_b32_dpp v131, v129 row_ror:8 row_mask:0xf bank_mask:0xf
    v_cvt_pk_bf16_f32 v133, v148, v149
    v_cvt_pk_bf16_f32 v134, v148, v149
    ds_read_b128 v[136:139], v20 offset:10240
    v_cvt_pk_bf16_f32 v63, v148, v149
    v_add_f32 v74, v144, v145
    v_mfma_f32_16x16x32_bf16 v[116:119], v[40:43], v[128:131], 0
    v_mfma_f32_16x16x32_bf16 v[120:123], v[44:47], v[128:131], 0
    v_mfma_f32_16x16x32_bf16 v[124:127], v[48:51], v[128:131], 0
    ds_read_b128 v[140:143], v20 offset:11264
    v_add_f32 v73, v146, v147
    v_add_f32 v74, v74, v73
    v_add_f32 v73, v148, v149
    v_mov_b32 v135, 0
    v_add_f32_dpp v74, v74, v74 row_ror:8 row_mask:0xf bank_mask:0xf
    v_add_f32 v74, v74, v73
    v_mov_b32 v73, v74
    v_mov_b32 v62, 0
    s_nop 0
    v_permlane32_swap_b32 v74, v73
    v_add_f32 v74, v74, v73
    v_mov_b32 v73, v74
    s_nop 1
    v_permlane16_swap_b32 v74, v73
    v_add_f32 v74, v74, v73
    v_rcp_f32 v74, v74
    s_waitcnt vmcnt(2)
    v_xor_b32 v26, s35, v52
    v_bitop3_b32 v26, v26, v56, s35 bitop3:0xf6
    v_and_b32 v26, 1, v26
    v_cmp_ne_u32 vcc, 0, v26
    s_cbranch_vccnz CI_redoV
CI_okV:
    v_cvt_pk_bf16_f32 v144, v52, v53
    v_cvt_pk_bf16_f32 v145, v56, v57
    v_cvt_pk_bf16_f32 v146, v54, v55
    v_cvt_pk_bf16_f32 v147, v58, v59
    s_nop 0
    v_mfma_f32_16x16x16_bf16 v[116:119], v[144:145], v[134:135], v[116:119]
    v_mfma_f32_16x16x16_bf16 v[120:123], v[144:145], v[62:63], v[120:123]
    v_mfma_f32_16x16x16_bf16 v[124:127], v[146:147], v[132:133], v[124:127]
    ds_read_b128 v[40:43], v20 offset:12288
    ds_read_b128 v[44:47], v20 offset:13312
    s_nop 5
    v_pk_mul_f32 v[116:117], v[116:117], v[74:75] op_sel_hi:[1,0]
    v_pk_mul_f32 v[118:119], v[118:119], v[74:75] op_sel_hi:[1,0]
    v_cvt_pk_bf16_f32 v116, v116, v117
    v_cvt_pk_bf16_f32 v117, v118, v119
    ds_write_b64 v14, v[116:117] offset:0
    v_pk_mul_f32 v[120:121], v[120:121], v[74:75] op_sel_hi:[1,0]
    v_pk_mul_f32 v[122:123], v[122:123], v[74:75] op_sel_hi:[1,0]
    v_cvt_pk_bf16_f32 v120, v120, v121
    v_cvt_pk_bf16_f32 v121, v122, v123
    ds_write_b64 v14, v[120:121] offset:32
    v_pk_mul_f32 v[124:125], v[124:125], v[74:75] op_sel_hi:[1,0]
    v_pk_mul_f32 v[126:127], v[126:127], v[74:75] op_sel_hi:[1,0]
    v_cvt_pk_bf16_f32 v124, v124, v125
    v_cvt_pk_bf16_f32 v125, v126, v127
    ds_write_b64 v14, v[124:125] offset:64
    s_waitcnt vmcnt(0)
    v_mov_b32 v52, 0
    v_mov_b32 v53, 0
    v_mov_b32 v54, 0
    v_mov_b32 v55, 0
    v_mov_b32 v56, 0
    v_mov_b32 v57, 0
    v_mov_b32 v58, 0
    v_mov_b32 v59, 0
    v_mov_b32 v60, 0
    v_mov_b32 v61, 0
    v_mov_b32 v62, 0
    v_mov_b32 v63, 0
    v_mov_b32 v64, 0
    v_mov_b32 v65, 0
    v_mov_b32 v66, 0
    v_mov_b32 v67, 0
    v_mov_b32 v68, 0
    v_mov_b32 v69, 0
    v_mov_b32 v70, 0
    v_mov_b32 v71, 0
    s_waitcnt lgkmcnt(0)
    s_barrier
    ds_read_b128 v[116:119], v15 offset:0
    ds_read_b128 v[120:123], v15 offset:128
    ds_read_b128 v[124:127], v15 offset:256
    ds_read_b128 v[128:131], v20 offset:14336
    ds_read_b128 v[132:135], v20 offset:15360
    s_cmp_eq_u32 s33, 63
    s_cbranch_scc1 C_last
    s_add_u32 s43, s43, 393216
    v_mov_b32 v27, s33
    buffer_store_dword v27, v22, s[8:11], s96 offen sc1
    s_waitcnt lgkmcnt(4)
    v_smfmac_f32_16x16x64_bf16 v[68:71], v[116:119], v[76:83], v6
    ds_read_b128 v[76:79], v20 offset:16384
    ds_read_b128 v[80:83], v20 offset:17408
    v_smfmac_f32_16x16x64_bf16 v[52:55], v[116:119], v[84:91], v6
    ds_read_b128 v[84:87], v20 offset:18432
    ds_read_b128 v[88:91], v20 offset:19456
    v_smfmac_f32_16x16x64_bf16 v[56:59], v[116:119], v[92:99], v6
    ds_read_b128 v[92:95], v20 offset:20480
    ds_read_b128 v[96:99], v20 offset:21504
    v_smfmac_f32_16x16x64_bf16 v[60:63], v[116:119], v[100:107], v6
    ds_read_b128 v[100:103], v20 offset:22528
    ds_read_b128 v[104:107], v20 offset:23552
    v_smfmac_f32_16x16x64_bf16 v[64:67], v[116:119], v[108:115], v6
    ds_read_b128 v[108:111], v20 offset:24576
    ds_read_b128 v[112:115], v20 offset:25600
    s_waitcnt lgkmcnt(13)
    v_smfmac_f32_16x16x64_bf16 v[68:71], v[120:123], v[136:143], v6
    ds_read_b128 v[136:139], v20 offset:26624
    ds_read_b128 v[140:143], v20 offset:27648
    v_smfmac_f32_16x16x64_bf16 v[52:55], v[120:123], v[40:47], v6
    ds_read_b128 v[40:43], v20 offset:28672
    ds_read_b128 v[44:47], v20 offset:29696
    s_waitcnt lgkmcnt(14)
    v_smfmac_f32_16x16x64_bf16 v[56:59], v[120:123], v[128:135], v6
    s_waitcnt lgkmcnt(12)
    v_smfmac_f32_16x16x64_bf16 v[60:63], v[120:123], v[76:83], v6
    s_waitcnt lgkmcnt(10)
    v_smfmac_f32_16x16x64_bf16 v[64:67], v[120:123], v[84:91], v6
    s_waitcnt lgkmcnt(8)
    v_smfmac_f32_16x16x64_bf16 v[68:71], v[124:127], v[92:99], v6
    s_waitcnt lgkmcnt(6)
    v_smfmac_f32_16x16x64_bf16 v[52:55], v[124:127], v[100:107], v6
    s_waitcnt lgkmcnt(4)
    v_smfmac_f32_16x16x64_bf16 v[56:59], v[124:127], v[108:115], v6
    s_waitcnt lgkmcnt(2)
    v_smfmac_f32_16x16x64_bf16 v[60:63], v[124:127], v[136:143], v6
    s_waitcnt lgkmcnt(0)
    v_smfmac_f32_16x16x64_bf16 v[64:67], v[124:127], v[40:47], v6
    s_nop 3
    v_add_f32 v136, v68, v69
    v_add_f32 v137, v70, v71
    v_bfi_b32 v136, 1, v23, v136
    v_bfi_b32 v137, 1, v23, v137
    buffer_store_dword v136, v17, s[8:11], s38 offen sc1
    buffer_store_dword v137, v17, s[8:11], s38 offen offset:64 sc1
    v_add_f32 v128, v52, v53
    v_add_f32 v132, v54, v55
    v_bfi_b32 v128, 1, v23, v128
    v_bfi_b32 v132, 1, v23, v132
    v_add_f32 v129, v56, v57
    v_add_f32 v133, v58, v59
    v_add_f32 v130, v60, v61
    v_add_f32 v134, v62, v63
    v_add_f32 v131, v64, v65
    v_add_f32 v135, v66, v67
    buffer_store_dwordx4 v[128:131], v16, s[8:11], s38 offen sc1
    buffer_store_dwordx4 v[132:135], v16, s[8:11], s38 offen offset:64 sc1
    s_and_b32 s30, s33, 2
    s_or_b32 s30, s30, s21
    s_xor_b32 s41, s30, 1
    v_mov_b32 v27, s30
    v_mov_b32 v22, v22
    s_nop 2
    v_mov_b32 v22, v22
    s_nop 2
    v_mov_b32 v22, v22
    s_nop 2
    v_mov_b32 v22, v22
    s_nop 2
    v_mov_b32 v22, v22
    s_nop 2
    v_mov_b32 v22, v22
    s_nop 2
    v_mov_b32 v22, v22
    s_nop 2
    v_mov_b32 v22, v22
    s_nop 2
    v_mov_b32 v22, v22
    s_nop 2
    v_mov_b32 v22, v22
    s_nop 2
    v_mov_b32 v22, v22
    s_nop 2
    v_mov_b32 v22, v22
    s_nop 2
    v_mov_b32 v22, v22
    s_nop 2
    v_mov_b32 v22, v22
    s_nop 2
    v_mov_b32 v22, v22
    s_nop 2
    v_mov_b32 v22, v22
    s_nop 2
    v_mov_b32 v22, v22
    s_nop 2
    v_mov_b32 v22, v22
    s_nop 2
    v_mov_b32 v22, v22
    s_nop 2
    v_mov_b32 v22, v22
    s_nop 2
    v_mov_b32 v22, v22
    s_nop 2
    v_mov_b32 v22, v22
    s_nop 2
    s_mov_b64 exec, s[54:55]
    buffer_load_dwordx4 v[76:79], v18, s[8:11], s38 offen offset:0 sc1
    buffer_load_dwordx4 v[80:83], v18, s[8:11], s38 offen offset:640 sc1
    buffer_load_dwordx4 v[84:87], v18, s[8:11], s38 offen offset:1280 sc1
    buffer_load_dwordx4 v[88:91], v18, s[8:11], s38 offen offset:1920 sc1
    v_mov_b32 v22, v22
    s_nop 2
    v_mov_b32 v22, v22
    s_nop 2
    v_mov_b32 v22, v22
    s_nop 2
    v_mov_b32 v22, v22
    s_nop 2
    v_mov_b32 v22, v22
    s_nop 2
    v_mov_b32 v22, v22
    s_nop 2
    v_mov_b32 v22, v22
    s_nop 2
    v_mov_b32 v22, v22
    s_nop 2
    v_mov_b32 v22, v22
    s_nop 2
    v_mov_b32 v22, v22
    s_nop 2
    buffer_load_dwordx4 v[76:79], v18, s[8:11], s38 offen offset:0 sc1
    buffer_load_dwordx4 v[80:83], v18, s[8:11], s38 offen offset:640 sc1
    buffer_load_dwordx4 v[84:87], v18, s[8:11], s38 offen offset:1280 sc1
    buffer_load_dwordx4 v[88:91], v18, s[8:11], s38 offen offset:1920 sc1
    v_mov_b32 v22, v22
    s_nop 2
    v_mov_b32 v22, v22
    s_nop 2
    v_mov_b32 v22, v22
    s_nop 2
    v_mov_b32 v22, v22
    s_nop 2
    v_mov_b32 v22, v22
    s_nop 2
    v_mov_b32 v22, v22
    s_nop 2
    s_waitcnt vmcnt(4)
    v_xor_b32 v26, s35, v76
    v_bitop3_b32 v26, v26, v80, s35 bitop3:0xf6
    v_bitop3_b32 v26, v26, v84, s35 bitop3:0xf6
    v_bitop3_b32 v26, v26, v88, s35 bitop3:0xf6
    v_and_b32 v26, 1, v26
    v_cmp_ne_u32 vcc, 0, v26
    s_cbranch_vccnz CI_R_s
CI_R_m:
    s_mov_b64 exec, -1
    v_pk_add_f32 v[108:109], v[76:77], v[80:81]
    v_pk_add_f32 v[112:113], v[84:85], v[88:89]
    v_pk_add_f32 v[110:111], v[78:79], v[82:83]
    v_pk_add_f32 v[114:115], v[86:87], v[90:91]
    v_pk_add_f32 v[108:109], v[108:109], v[112:113]
    v_pk_add_f32 v[110:111], v[110:111], v[114:115]
    s_nop 0
    s_nop 0
    v_permlane32_swap_b32 v108, v110
    v_permlane32_swap_b32 v109, v111
    v_add_f32 v108, v108, v110
    v_add_f32 v109, v109, v111
    v_mov_b32 v110, v108
    v_mov_b32 v111, v109
    s_nop 0
    v_permlane16_swap_b32 v108, v110
    v_permlane16_swap_b32 v109, v111
    v_add_f32 v108, v108, v110
    v_add_f32 v109, v109, v111
    v_bfi_b32 v136, 7, v27, v108
    v_mov_b32 v137, v109
    s_mov_b64 exec, s[94:95]
    buffer_atomic_swap_x2 v[136:137], v25, s[8:11], s40 offen sc0
    s_mov_b64 exec, -1
    s_add_u32 s39, s39, 10240
    s_add_u32 s33, s33, 1
    s_add_u32 s44, s44, 98304
    s_add_u32 s45, s45, 131072
    s_not_b32 s35, s35
    s_lshr_b32 s30, s25, 1
    s_cmp_eq_u32 s30, s26
    s_cselect_b32 s56, 1, 0
    s_cmp_eq_u32 s25, 0
    s_cselect_b32 s57, 1, 0
    v_xor_b32 v23, 1, v23
    v_mov_b32 v116, 0
    v_mov_b32 v117, 0
    v_mov_b32 v118, 0
    v_mov_b32 v119, 0
    v_mov_b32 v120, 0
    v_mov_b32 v121, 0
    v_mov_b32 v122, 0
    v_mov_b32 v123, 0
    v_mov_b32 v124, 0
    v_mov_b32 v125, 0
    v_mov_b32 v126, 0
    v_mov_b32 v127, 0
    v_mov_b32 v128, 0
    v_mov_b32 v129, 0
    v_mov_b32 v130, 0
    v_mov_b32 v131, 0
    v_mov_b32 v132, 0
    v_mov_b32 v133, 0
    v_mov_b32 v134, 0
    v_mov_b32 v135, 0
    s_add_u32 s30, s33, 2
    s_min_u32 s53, s30, 64
    s_cmp_ge_u32 s101, s53
    s_cbranch_scc1 CI_kw_41
    v_and_b32 v26, 3, v1
    v_lshlrev_b32 v26, 2, v26
    v_bfe_u32 v27, v1, 2, 1
    v_lshl_add_u32 v26, v27, 12, v26
CI_kw_40:
    buffer_load_dword v27, v26, s[8:11], s100 offen sc1
    s_sub_u32 s34, s34, 1
    s_cbranch_scc1 C_abort
    s_waitcnt vmcnt(0)
    s_nop 1
    v_min_u32_dpp v27, v27, v27 row_shl:1 row_mask:0xf bank_mask:0xf
    s_nop 1
    v_min_u32_dpp v27, v27, v27 row_shl:2 row_mask:0xf bank_mask:0xf
    s_nop 1
    v_min_u32_dpp v27, v27, v27 row_shl:4 row_mask:0xf bank_mask:0xf
    s_nop 1
    v_readfirstlane_b32 s101, v27
    s_cmp_ge_u32 s101, s53
    s_cbranch_scc1 CI_kw_41
    s_sleep 2
    s_branch CI_kw_40
CI_kw_41:
    s_mov_b64 exec, s[94:95]
    v_mov_b32 v138, 0
    v_mov_b32 v139, 0
    buffer_atomic_or_x2 v[138:139], v25, s[8:11], s40 offen sc0
    v_mov_b32 v22, v22
    s_nop 2
    v_mov_b32 v22, v22
    s_nop 2
    v_mov_b32 v22, v22
    s_nop 2
    v_mov_b32 v22, v22
    s_nop 2
    v_mov_b32 v22, v22
    s_nop 2
    v_mov_b32 v22, v22
    s_nop 2
    v_mov_b32 v22, v22
    s_nop 2
    v_mov_b32 v22, v22
    s_nop 2
    v_mov_b32 v22, v22
    s_nop 2
    v_mov_b32 v22, v22
    s_nop 2
    v_mov_b32 v140, 0
    v_mov_b32 v141, 0
    buffer_atomic_or_x2 v[140:141], v25, s[8:11], s40 offen sc0
    v_mov_b32 v22, v22
    s_nop 2
    v_mov_b32 v22, v22
    s_nop 2
    v_mov_b32 v22, v22
    s_nop 2
    v_mov_b32 v22, v22
    s_nop 2
    v_mov_b32 v22, v22
    s_nop 2
    v_mov_b32 v22, v22
    s_nop 2
    v_mov_b32 v22, v22
    s_nop 2
    v_mov_b32 v22, v22
    s_nop 2
    v_mov_b32 v22, v22
    s_nop 2
    v_mov_b32 v22, v22
    s_nop 2
    v_mov_b32 v142, 0
    v_mov_b32 v143, 0
    buffer_atomic_or_x2 v[142:143], v25, s[8:11], s40 offen sc0
    v_mov_b32 v22, v22
    s_nop 2
    v_mov_b32 v22, v22
    s_nop 2
    s_waitcnt vmcnt(3)
    v_and_b32 v26, 7, v136
    v_cmp_ne_u32 vcc, s41, v26
    s_cbranch_vccz CI_X_ok
    s_mov_b64 exec, vcc
CI_X_l:
    s_waitcnt vmcnt(2)
    v_mov_b32 v136, v138
    v_mov_b32 v137, v139
    v_and_b32 v26, 7, v138
    v_cmp_ne_u32 vcc, s41, v26
    s_cbranch_vccz CI_X_ok
    s_mov_b64 exec, vcc
    v_mov_b32 v138, 0
    v_mov_b32 v139, 0
    buffer_atomic_or_x2 v[138:139], v25, s[8:11], s40 offen sc0
    v_mov_b32 v22, v22
    s_nop 2
    v_mov_b32 v22, v22
    s_nop 2
    s_waitcnt vmcnt(2)
    v_mov_b32 v136, v140
    v_mov_b32 v137, v141
    v_and_b32 v26, 7, v140
    v_cmp_ne_u32 vcc, s41, v26
    s_cbranch_vccz CI_X_ok
    s_mov_b64 exec, vcc
    v_mov_b32 v140, 0
    v_mov_b32 v141, 0
    buffer_atomic_or_x2 v[140:141], v25, s[8:11], s40 offen sc0
    v_mov_b32 v22, v22
    s_nop 2
    v_mov_b32 v22, v22
    s_nop 2
    s_waitcnt vmcnt(2)
    v_mov_b32 v136, v142
    v_mov_b32 v137, v143
    v_and_b32 v26, 7, v142
    v_cmp_ne_u32 vcc, s41, v26
    s_cbranch_vccz CI_X_ok
    s_mov_b64 exec, vcc
    v_mov_b32 v142, 0
    v_mov_b32 v143, 0
    buffer_atomic_or_x2 v[142:143], v25, s[8:11], s40 offen sc0
    s_sub_u32 s34, s34, 1
    s_cbranch_scc1 C_abort
    v_mov_b32 v22, v22
    s_nop 2
    v_mov_b32 v22, v22
    s_nop 2
    s_branch CI_X_l
CI_X_ok:
    s_mov_b64 exec, -1
    s_mov_b32 s30, s40
    s_mov_b32 s40, s93
    s_mov_b32 s93, s30
    v_pk_add_f32 v[112:113], v[108:109], v[136:137]
    v_cvt_pk_bf16_f32 v112, v112, v113
    v_min_u32 v112, -2, v112
    v_mov_b32 v113, v112
    s_nop 1
    v_permlane32_swap_b32 v112, v113
    s_nop 0
    s_nop 0
    v_mov_b32_dpp v114, v112 row_shl:1 row_mask:0xf bank_mask:0xf
    v_mov_b32_dpp v115, v113 row_shl:1 row_mask:0xf bank_mask:0xf
    buffer_store_dwordx4 v[112:115], v19, s[8:11], s39 offen sc1
    s_branch CI_step
CI_L_s:
    s_mov_b64 exec, vcc
    s_add_u32 s30, s39, s52
    buffer_load_dwordx4 v[52:55], v2, s[8:11], s30 offen sc1
    buffer_load_dwordx4 v[56:59], v2, s[8:11], s30 offen offset:1024 sc1
    buffer_load_dwordx2 v[60:61], v13, s[8:11], s30 offen offset:2048 sc1
    s_sub_u32 s34, s34, 1
    s_cbranch_scc1 C_abort
    v_mov_b32 v22, v22
    s_nop 2
    s_waitcnt vmcnt(3)
    v_max3_u32 v26, v52, v56, v60
    v_cmp_eq_u32 vcc, -1, v26
    s_cbranch_vccnz CI_L_s
    s_mov_b64 exec, -1
    s_branch CI_L_m
CI_S_s:
    s_mov_b64 exec, vcc
    buffer_load_dwordx4 v[52:55], v0, s[8:11], s28 offen sc1
    buffer_load_dwordx4 v[56:59], v0, s[8:11], s28 offen offset:2048 sc1
    buffer_load_dwordx2 v[60:61], v11, s[8:11], s28 offen sc1
    s_sub_u32 s34, s34, 1
    s_cbranch_scc1 C_abort
    v_mov_b32 v22, v22
    s_nop 2
    s_waitcnt vmcnt(3)
    v_xor_b32 v26, s35, v52
    v_bitop3_b32 v26, v26, v56, s35 bitop3:0xf6
    v_bitop3_b32 v26, v26, v60, s35 bitop3:0xf6
    v_and_b32 v26, 1, v26
    v_cmp_ne_u32 vcc, 0, v26
    s_cbranch_vccnz CI_S_s
    s_mov_b64 exec, -1
    s_branch CI_S_m
CI_R_s:
    s_mov_b64 exec, vcc
    buffer_load_dwordx4 v[76:79], v18, s[8:11], s38 offen offset:0 sc1
    buffer_load_dwordx4 v[80:83], v18, s[8:11], s38 offen offset:640 sc1
    buffer_load_dwordx4 v[84:87], v18, s[8:11], s38 offen offset:1280 sc1
    buffer_load_dwordx4 v[88:91], v18, s[8:11], s38 offen offset:1920 sc1
    s_sub_u32 s34, s34, 1
    s_cbranch_scc1 C_abort
    v_mov_b32 v22, v22
    s_nop 2
    s_waitcnt vmcnt(4)
    v_xor_b32 v26, s35, v76
    v_bitop3_b32 v26, v26, v80, s35 bitop3:0xf6
    v_bitop3_b32 v26, v26, v84, s35 bitop3:0xf6
    v_bitop3_b32 v26, v26, v88, s35 bitop3:0xf6
    v_and_b32 v26, 1, v26
    v_cmp_ne_u32 vcc, 0, v26
    s_cbranch_vccnz CI_R_s
    s_mov_b64 exec, -1
    s_branch CI_R_m
CI_redoV:
    s_mov_b64 exec, vcc
    buffer_load_dwordx4 v[52:55], v2, s[8:11], s37 offen offset:0 sc1
    buffer_load_dwordx4 v[56:59], v2, s[8:11], s37 offen offset:1024 sc1
    s_sub_u32 s34, s34, 1
    s_cbranch_scc1 C_abort
    v_mov_b32 v22, v22
    s_nop 2
    s_waitcnt vmcnt(2)
    v_xor_b32 v26, s35, v52
    v_bitop3_b32 v26, v26, v56, s35 bitop3:0xf6
    v_and_b32 v26, 1, v26
    v_cmp_ne_u32 vcc, 0, v26
    s_cbranch_vccnz CI_redoV
    s_mov_b64 exec, -1
    s_branch CI_okV
C_last:
    s_add_u32 s44, s44, 98304
    s_add_u32 s45, s45, 131072
    s_cmp_lg_u32 s25, 0
    s_cbranch_scc1 C_lk_42
    buffer_store_dwordx4 v[28:31], v21, s[8:11], s44 offen offset:0 sc1
    buffer_store_dwordx4 v[32:35], v21, s[8:11], s44 offen offset:512 sc1
    buffer_store_dwordx4 v[36:39], v21, s[8:11], s44 offen offset:1024 sc1
C_lk_42:
    s_lshr_b32 s30, s25, 1
    s_cmp_lg_u32 s30, s26
    s_cbranch_scc1 C_lv_43
    buffer_store_dwordx4 v[144:147], v2, s[8:11], s45 offen sc1
C_lv_43:
    s_waitcnt vmcnt(0)
    v_mov_b32 v27, 64
    buffer_store_dword v27, v22, s[8:11], s96 offen sc1
C_abort:
C_fin:
    s_waitcnt vmcnt(0) lgkmcnt(0)
    s_branch G_end
M_gemm:
    s_cmp_eq_u32 s21, 0
    s_cselect_b64 s[44:45], s[82:83], s[84:85]
    s_mov_b32 s8, s42
    s_and_b32 s9, s43, 0xffff
    s_mov_b32 s10, 2621440
    s_mov_b32 s11, 0x20000
    s_mov_b32 s12, s44
    s_and_b32 s13, s45, 0xffff
    s_mov_b32 s14, 7864320
    s_mov_b32 s15, 0x20000
    s_mov_b32 s16, s46
    s_and_b32 s17, s47, 0xffff
    s_mov_b32 s18, 268435456
    s_mov_b32 s19, 0x20000
    s_mov_b32 s23, 0
    s_mov_b32 s24, 64
    s_mul_i32 s26, s21, 50331648
    s_add_u32 s26, s26, 50331648
    s_mul_i32 s4, s20, 25165824
    s_add_u32 s26, s26, s4
    s_mul_i32 s4, s22, 12288
    s_add_u32 s26, s26, s4
    s_sub_u32 s4, s3, 128
    s_lshl_b32 s40, s4, 7
    s_lshl_b32 s4, s25, 2
    s_add_u32 s40, s40, s4
    s_add_u32 s40, s40, 182452224
    v_and_b32 v1, 63, v0
    v_lshlrev_b32 v1, 4, v1
    s_lshl_b32 s4, s22, 2
    s_add_u32 s4, s4, s25
    s_mul_i32 s4, s4, 20480
    buffer_load_dwordx4 v[128:131], v1, s[8:11], s4 offen offset:0
    buffer_load_dwordx4 v[132:135], v1, s[8:11], s4 offen offset:1024
    buffer_load_dwordx4 v[136:139], v1, s[8:11], s4 offen offset:2048
    buffer_load_dwordx4 v[140:143], v1, s[8:11], s4 offen offset:3072
    s_add_u32 s4, s4, 4096
    buffer_load_dwordx4 v[144:147], v1, s[8:11], s4 offen offset:0
    buffer_load_dwordx4 v[148:151], v1, s[8:11], s4 offen offset:1024
    buffer_load_dwordx4 v[152:155], v1, s[8:11], s4 offen offset:2048
    buffer_load_dwordx4 v[156:159], v1, s[8:11], s4 offen offset:3072
    s_add_u32 s4, s4, 4096
    buffer_load_dwordx4 v[160:163], v1, s[8:11], s4 offen offset:0
    buffer_load_dwordx4 v[164:167], v1, s[8:11], s4 offen offset:1024
    buffer_load_dwordx4 v[168:171], v1, s[8:11], s4 offen offset:2048
    buffer_load_dwordx4 v[172:175], v1, s[8:11], s4 offen offset:3072
    s_add_u32 s4, s4, 4096
    buffer_load_dwordx4 v[176:179], v1, s[8:11], s4 offen offset:0
    buffer_load_dwordx4 v[180:183], v1, s[8:11], s4 offen offset:1024
    buffer_load_dwordx4 v[184:187], v1, s[8:11], s4 offen offset:2048
    buffer_load_dwordx4 v[188:191], v1, s[8:11], s4 offen offset:3072
    s_add_u32 s4, s4, 4096
    buffer_load_dwordx4 v[192:195], v1, s[8:11], s4 offen offset:0
    buffer_load_dwordx4 v[196:199], v1, s[8:11], s4 offen offset:1024
    buffer_load_dwordx4 v[200:203], v1, s[8:11], s4 offen offset:2048
    buffer_load_dwordx4 v[204:207], v1, s[8:11], s4 offen offset:3072
    s_add_u32 s4, s4, 4096
    s_cmp_eq_u32 s21, 1
    s_cbranch_scc1 M_V
    v_and_b32 v1, 63, v0
    v_lshlrev_b32 v11, 4, v1
    v_add_u32 v12, 0, v1
    v_mul_u32_u24 v13, 2731, v12
    v_lshrrev_b32 v13, 16, v13
    v_mul_u32_u24 v14, 24, v13
    v_sub_u32 v14, v12, v14
    v_mul_u32_u24 v3, 12288, v13
    v_lshl_add_u32 v3, v14, 4, v3
    v_add_u32 v12, 64, v1
    v_mul_u32_u24 v13, 2731, v12
    v_lshrrev_b32 v13, 16, v13
    v_mul_u32_u24 v14, 24, v13
    v_sub_u32 v14, v12, v14
    v_mul_u32_u24 v4, 12288, v13
    v_lshl_add_u32 v4, v14, 4, v4
    v_add_u32 v12, 128, v1
    v_mul_u32_u24 v13, 2731, v12
    v_lshrrev_b32 v13, 16, v13
    v_mul_u32_u24 v14, 24, v13
    v_sub_u32 v14, v12, v14
    v_mul_u32_u24 v5, 12288, v13
    v_lshl_add_u32 v5, v14, 4, v5
    v_lshrrev_b32 v12, 4, v1
    v_lshlrev_b32 v12, 3, v12
    v_bfe_u32 v13, v1, 2, 2
    v_add_u32 v12, v12, v13
    v_mul_u32_u24 v8, 384, v12
    v_and_b32 v12, 3, v1
    v_lshl_add_u32 v8, v12, 3, v8
    s_mul_i32 s30, s25, 96
    v_add_u32 v8, s30, v8
    s_mul_i32 s27, s22, 384
    s_waitcnt lgkmcnt(0)
    s_barrier
    s_mul_i32 s30, s25, 393216
    s_add_u32 s30, s30, s27
    s_add_u32 s30, s30, 0
    s_mul_i32 s31, s25, 12288
    s_add_u32 s31, s31, 0
    s_mov_b32 m0, s31
    s_add_u32 s31, s31, 1024
    buffer_load_dwordx4 v3, s[12:15], s30 offen lds
    s_mov_b32 m0, s31
    s_add_u32 s31, s31, 1024
    buffer_load_dwordx4 v4, s[12:15], s30 offen lds
    s_mov_b32 m0, s31
    s_add_u32 s31, s31, 1024
    buffer_load_dwordx4 v5, s[12:15], s30 offen lds
    s_add_u32 s30, s30, 98304
    s_mov_b32 m0, s31
    s_add_u32 s31, s31, 1024
    buffer_load_dwordx4 v3, s[12:15], s30 offen lds
    s_mov_b32 m0, s31
    s_add_u32 s31, s31, 1024
    buffer_load_dwordx4 v4, s[12:15], s30 offen lds
    s_mov_b32 m0, s31
    s_add_u32 s31, s31, 1024
    buffer_load_dwordx4 v5, s[12:15], s30 offen lds
    s_add_u32 s30, s30, 98304
    s_mov_b32 m0, s31
    s_add_u32 s31, s31, 1024
    buffer_load_dwordx4 v3, s[12:15], s30 offen lds
    s_mov_b32 m0, s31
    s_add_u32 s31, s31, 1024
    buffer_load_dwordx4 v4, s[12:15], s30 offen lds
    s_mov_b32 m0, s31
    s_add_u32 s31, s31, 1024
    buffer_load_dwordx4 v5, s[12:15], s30 offen lds
    s_add_u32 s30, s30, 98304
    s_mov_b32 m0, s31
    s_add_u32 s31, s31, 1024
    buffer_load_dwordx4 v3, s[12:15], s30 offen lds
    s_mov_b32 m0, s31
    s_add_u32 s31, s31, 1024
    buffer_load_dwordx4 v4, s[12:15], s30 offen lds
    s_mov_b32 m0, s31
    s_add_u32 s31, s31, 1024
    buffer_load_dwordx4 v5, s[12:15], s30 offen lds
    s_add_u32 s30, s30, 98304
    s_mul_i32 s30, s25, 393216
    s_add_u32 s30, s30, s27
    s_add_u32 s30, s30, 1572864
    s_mul_i32 s31, s25, 12288
    s_add_u32 s31, s31, 49152
    s_mov_b32 m0, s31
    s_add_u32 s31, s31, 1024
    buffer_load_dwordx4 v3, s[12:15], s30 offen lds
    s_mov_b32 m0, s31
    s_add_u32 s31, s31, 1024
    buffer_load_dwordx4 v4, s[12:15], s30 offen lds
    s_mov_b32 m0, s31
    s_add_u32 s31, s31, 1024
    buffer_load_dwordx4 v5, s[12:15], s30 offen lds
    s_add_u32 s30, s30, 98304
    s_mov_b32 m0, s31
    s_add_u32 s31, s31, 1024
    buffer_load_dwordx4 v3, s[12:15], s30 offen lds
    s_mov_b32 m0, s31
    s_add_u32 s31, s31, 1024
    buffer_load_dwordx4 v4, s[12:15], s30 offen lds
    s_mov_b32 m0, s31
    s_add_u32 s31, s31, 1024
    buffer_load_dwordx4 v5, s[12:15], s30 offen lds
    s_add_u32 s30, s30, 98304
    s_mov_b32 m0, s31
    s_add_u32 s31, s31, 1024
    buffer_load_dwordx4 v3, s[12:15], s30 offen lds
    s_mov_b32 m0, s31
    s_add_u32 s31, s31, 1024
    buffer_load_dwordx4 v4, s[12:15], s30 offen lds
    s_mov_b32 m0, s31
    s_add_u32 s31, s31, 1024
    buffer_load_dwordx4 v5, s[12:15], s30 offen lds
    s_add_u32 s30, s30, 98304
    s_mov_b32 m0, s31
    s_add_u32 s31, s31, 1024
    buffer_load_dwordx4 v3, s[12:15], s30 offen lds
    s_mov_b32 m0, s31
    s_add_u32 s31, s31, 1024
    buffer_load_dwordx4 v4, s[12:15], s30 offen lds
    s_mov_b32 m0, s31
    s_add_u32 s31, s31, 1024
    buffer_load_dwordx4 v5, s[12:15], s30 offen lds
    s_add_u32 s30, s30, 98304
    s_mul_i32 s30, s25, 393216
    s_add_u32 s30, s30, s27
    s_add_u32 s30, s30, 3145728
    s_mul_i32 s31, s25, 12288
    s_add_u32 s31, s31, 98304
    s_mov_b32 m0, s31
    s_add_u32 s31, s31, 1024
    buffer_load_dwordx4 v3, s[12:15], s30 offen lds
    s_mov_b32 m0, s31
    s_add_u32 s31, s31, 1024
    buffer_load_dwordx4 v4, s[12:15], s30 offen lds
    s_mov_b32 m0, s31
    s_add_u32 s31, s31, 1024
    buffer_load_dwordx4 v5, s[12:15], s30 offen lds
    s_add_u32 s30, s30, 98304
    s_mov_b32 m0, s31
    s_add_u32 s31, s31, 1024
    buffer_load_dwordx4 v3, s[12:15], s30 offen lds
    s_mov_b32 m0, s31
    s_add_u32 s31, s31, 1024
    buffer_load_dwordx4 v4, s[12:15], s30 offen lds
    s_mov_b32 m0, s31
    s_add_u32 s31, s31, 1024
    buffer_load_dwordx4 v5, s[12:15], s30 offen lds
    s_add_u32 s30, s30, 98304
    s_mov_b32 m0, s31
    s_add_u32 s31, s31, 1024
    buffer_load_dwordx4 v3, s[12:15], s30 offen lds
    s_mov_b32 m0, s31
    s_add_u32 s31, s31, 1024
    buffer_load_dwordx4 v4, s[12:15], s30 offen lds
    s_mov_b32 m0, s31
    s_add_u32 s31, s31, 1024
    buffer_load_dwordx4 v5, s[12:15], s30 offen lds
    s_add_u32 s30, s30, 98304
    s_mov_b32 m0, s31
    s_add_u32 s31, s31, 1024
    buffer_load_dwordx4 v3, s[12:15], s30 offen lds
    s_mov_b32 m0, s31
    s_add_u32 s31, s31, 1024
    buffer_load_dwordx4 v4, s[12:15], s30 offen lds
    s_mov_b32 m0, s31
    s_add_u32 s31, s31, 1024
    buffer_load_dwordx4 v5, s[12:15], s30 offen lds
    s_add_u32 s30, s30, 98304
    s_waitcnt vmcnt(24)
    s_barrier
    s_mov_b32 s4, s78
    s_and_b32 s5, s79, 0xffff
    s_mov_b32 s6, 256
    s_mov_b32 s7, 0x20000
    s_cmp_lg_u32 s25, 0
    s_cbranch_scc1 M_ch_44
    v_mov_b32 v26, 1
    v_mov_b32 v27, 32
    s_mov_b64 exec, 1
    buffer_atomic_add v26, v27, s[4:7], 0 offen
    s_mov_b64 exec, -1
M_ch_44:
    v_add_u32 v12, 0, v8
    ds_read_b64_tr_b16 a[0:1], v12 offset:0
    ds_read_b64_tr_b16 a[2:3], v12 offset:1536
    s_waitcnt lgkmcnt(8)
    ds_read_b64_tr_b16 a[4:5], v12 offset:32
    ds_read_b64_tr_b16 a[6:7], v12 offset:1568
    s_waitcnt lgkmcnt(8)
    ds_read_b64_tr_b16 a[8:9], v12 offset:64
    ds_read_b64_tr_b16 a[10:11], v12 offset:1600
    s_waitcnt lgkmcnt(8)
    ds_read_b64_tr_b16 a[12:13], v12 offset:12288
    ds_read_b64_tr_b16 a[14:15], v12 offset:13824
    s_waitcnt lgkmcnt(8)
    ds_read_b64_tr_b16 a[16:17], v12 offset:12320
    ds_read_b64_tr_b16 a[18:19], v12 offset:13856
    s_waitcnt lgkmcnt(8)
    ds_read_b64_tr_b16 a[20:21], v12 offset:12352
    ds_read_b64_tr_b16 a[22:23], v12 offset:13888
    s_waitcnt lgkmcnt(8)
    ds_read_b64_tr_b16 a[24:25], v12 offset:24576
    ds_read_b64_tr_b16 a[26:27], v12 offset:26112
    s_waitcnt lgkmcnt(8)
    ds_read_b64_tr_b16 a[28:29], v12 offset:24608
    ds_read_b64_tr_b16 a[30:31], v12 offset:26144
    s_waitcnt lgkmcnt(8)
    ds_read_b64_tr_b16 a[32:33], v12 offset:24640
    ds_read_b64_tr_b16 a[34:35], v12 offset:26176
    s_waitcnt lgkmcnt(8)
    ds_read_b64_tr_b16 a[36:37], v12 offset:36864
    ds_read_b64_tr_b16 a[38:39], v12 offset:38400
    s_waitcnt lgkmcnt(8)
    ds_read_b64_tr_b16 a[40:41], v12 offset:36896
    ds_read_b64_tr_b16 a[42:43], v12 offset:38432
    s_waitcnt lgkmcnt(8)
    ds_read_b64_tr_b16 a[44:45], v12 offset:36928
    ds_read_b64_tr_b16 a[46:47], v12 offset:38464
    s_waitcnt lgkmcnt(8)
    s_waitcnt lgkmcnt(0)
    s_barrier
    s_mul_i32 s30, s25, 393216
    s_add_u32 s30, s30, s27
    s_add_u32 s30, s30, 4718592
    s_mul_i32 s31, s25, 12288
    s_add_u32 s31, s31, 0
    s_mov_b32 m0, s31
    s_add_u32 s31, s31, 1024
    buffer_load_dwordx4 v3, s[12:15], s30 offen lds
    s_mov_b32 m0, s31
    s_add_u32 s31, s31, 1024
    buffer_load_dwordx4 v4, s[12:15], s30 offen lds
    s_mov_b32 m0, s31
    s_add_u32 s31, s31, 1024
    buffer_load_dwordx4 v5, s[12:15], s30 offen lds
    s_add_u32 s30, s30, 98304
    s_mov_b32 m0, s31
    s_add_u32 s31, s31, 1024
    buffer_load_dwordx4 v3, s[12:15], s30 offen lds
    s_mov_b32 m0, s31
    s_add_u32 s31, s31, 1024
    buffer_load_dwordx4 v4, s[12:15], s30 offen lds
    s_mov_b32 m0, s31
    s_add_u32 s31, s31, 1024
    buffer_load_dwordx4 v5, s[12:15], s30 offen lds
    s_add_u32 s30, s30, 98304
    s_mov_b32 m0, s31
    s_add_u32 s31, s31, 1024
    buffer_load_dwordx4 v3, s[12:15], s30 offen lds
    s_mov_b32 m0, s31
    s_add_u32 s31, s31, 1024
    buffer_load_dwordx4 v4, s[12:15], s30 offen lds
    s_mov_b32 m0, s31
    s_add_u32 s31, s31, 1024
    buffer_load_dwordx4 v5, s[12:15], s30 offen lds
    s_add_u32 s30, s30, 98304
    s_mov_b32 m0, s31
    s_add_u32 s31, s31, 1024
    buffer_load_dwordx4 v3, s[12:15], s30 offen lds
    s_mov_b32 m0, s31
    s_add_u32 s31, s31, 1024
    buffer_load_dwordx4 v4, s[12:15], s30 offen lds
    s_mov_b32 m0, s31
    s_add_u32 s31, s31, 1024
    buffer_load_dwordx4 v5, s[12:15], s30 offen lds
    s_add_u32 s30, s30, 98304
    s_waitcnt vmcnt(24)
    s_barrier
    v_add_u32 v12, 49152, v8
    ds_read_b64_tr_b16 a[48:49], v12 offset:0
    ds_read_b64_tr_b16 a[50:51], v12 offset:1536
    s_waitcnt lgkmcnt(8)
    ds_read_b64_tr_b16 a[52:53], v12 offset:32
    ds_read_b64_tr_b16 a[54:55], v12 offset:1568
    s_waitcnt lgkmcnt(8)
    ds_read_b64_tr_b16 a[56:57], v12 offset:64
    ds_read_b64_tr_b16 a[58:59], v12 offset:1600
    s_waitcnt lgkmcnt(8)
    ds_read_b64_tr_b16 a[60:61], v12 offset:12288
    ds_read_b64_tr_b16 a[62:63], v12 offset:13824
    s_waitcnt lgkmcnt(8)
    ds_read_b64_tr_b16 a[64:65], v12 offset:12320
    ds_read_b64_tr_b16 a[66:67], v12 offset:13856
    s_waitcnt lgkmcnt(8)
    ds_read_b64_tr_b16 a[68:69], v12 offset:12352
    ds_read_b64_tr_b16 a[70:71], v12 offset:13888
    s_waitcnt lgkmcnt(8)
    ds_read_b64_tr_b16 a[72:73], v12 offset:24576
    ds_read_b64_tr_b16 a[74:75], v12 offset:26112
    s_waitcnt lgkmcnt(8)
    ds_read_b64_tr_b16 a[76:77], v12 offset:24608
    ds_read_b64_tr_b16 a[78:79], v12 offset:26144
    s_waitcnt lgkmcnt(8)
    ds_read_b64_tr_b16 a[80:81], v12 offset:24640
    ds_read_b64_tr_b16 a[82:83], v12 offset:26176
    s_waitcnt lgkmcnt(8)
    ds_read_b64_tr_b16 a[84:85], v12 offset:36864
    ds_read_b64_tr_b16 a[86:87], v12 offset:38400
    s_waitcnt lgkmcnt(8)
    ds_read_b64_tr_b16 a[88:89], v12 offset:36896
    ds_read_b64_tr_b16 a[90:91], v12 offset:38432
    s_waitcnt lgkmcnt(8)
    ds_read_b64_tr_b16 a[92:93], v12 offset:36928
    ds_read_b64_tr_b16 a[94:95], v12 offset:38464
    s_waitcnt lgkmcnt(8)
    s_waitcnt lgkmcnt(0)
    s_barrier
    s_mul_i32 s30, s25, 393216
    s_add_u32 s30, s30, s27
    s_add_u32 s30, s30, 6291456
    s_mul_i32 s31, s25, 12288
    s_add_u32 s31, s31, 49152
    s_mov_b32 m0, s31
    s_add_u32 s31, s31, 1024
    buffer_load_dwordx4 v3, s[12:15], s30 offen lds
    s_mov_b32 m0, s31
    s_add_u32 s31, s31, 1024
    buffer_load_dwordx4 v4, s[12:15], s30 offen lds
    s_mov_b32 m0, s31
    s_add_u32 s31, s31, 1024
    buffer_load_dwordx4 v5, s[12:15], s30 offen lds
    s_add_u32 s30, s30, 98304
    s_mov_b32 m0, s31
    s_add_u32 s31, s31, 1024
    buffer_load_dwordx4 v3, s[12:15], s30 offen lds
    s_mov_b32 m0, s31
    s_add_u32 s31, s31, 1024
    buffer_load_dwordx4 v4, s[12:15], s30 offen lds
    s_mov_b32 m0, s31
    s_add_u32 s31, s31, 1024
    buffer_load_dwordx4 v5, s[12:15], s30 offen lds
    s_add_u32 s30, s30, 98304
    s_mov_b32 m0, s31
    s_add_u32 s31, s31, 1024
    buffer_load_dwordx4 v3, s[12:15], s30 offen lds
    s_mov_b32 m0, s31
    s_add_u32 s31, s31, 1024
    buffer_load_dwordx4 v4, s[12:15], s30 offen lds
    s_mov_b32 m0, s31
    s_add_u32 s31, s31, 1024
    buffer_load_dwordx4 v5, s[12:15], s30 offen lds
    s_add_u32 s30, s30, 98304
    s_mov_b32 m0, s31
    s_add_u32 s31, s31, 1024
    buffer_load_dwordx4 v3, s[12:15], s30 offen lds
    s_mov_b32 m0, s31
    s_add_u32 s31, s31, 1024
    buffer_load_dwordx4 v4, s[12:15], s30 offen lds
    s_mov_b32 m0, s31
    s_add_u32 s31, s31, 1024
    buffer_load_dwordx4 v5, s[12:15], s30 offen lds
    s_add_u32 s30, s30, 98304
    s_waitcnt vmcnt(24)
    s_barrier
    v_add_u32 v12, 98304, v8
    ds_read_b64_tr_b16 a[96:97], v12 offset:0
    ds_read_b64_tr_b16 a[98:99], v12 offset:1536
    s_waitcnt lgkmcnt(8)
    ds_read_b64_tr_b16 a[100:101], v12 offset:32
    ds_read_b64_tr_b16 a[102:103], v12 offset:1568
    s_waitcnt lgkmcnt(8)
    ds_read_b64_tr_b16 a[104:105], v12 offset:64
    ds_read_b64_tr_b16 a[106:107], v12 offset:1600
    s_waitcnt lgkmcnt(8)
    ds_read_b64_tr_b16 a[108:109], v12 offset:12288
    ds_read_b64_tr_b16 a[110:111], v12 offset:13824
    s_waitcnt lgkmcnt(8)
    ds_read_b64_tr_b16 a[112:113], v12 offset:12320
    ds_read_b64_tr_b16 a[114:115], v12 offset:13856
    s_waitcnt lgkmcnt(8)
    ds_read_b64_tr_b16 a[116:117], v12 offset:12352
    ds_read_b64_tr_b16 a[118:119], v12 offset:13888
    s_waitcnt lgkmcnt(8)
    ds_read_b64_tr_b16 a[120:121], v12 offset:24576
    ds_read_b64_tr_b16 a[122:123], v12 offset:26112
    s_waitcnt lgkmcnt(8)
    ds_read_b64_tr_b16 a[124:125], v12 offset:24608
    ds_read_b64_tr_b16 a[126:127], v12 offset:26144
    s_waitcnt lgkmcnt(8)
    ds_read_b64_tr_b16 a[128:129], v12 offset:24640
    ds_read_b64_tr_b16 a[130:131], v12 offset:26176
    s_waitcnt lgkmcnt(8)
    ds_read_b64_tr_b16 a[132:133], v12 offset:36864
    ds_read_b64_tr_b16 a[134:135], v12 offset:38400
    s_waitcnt lgkmcnt(8)
    ds_read_b64_tr_b16 a[136:137], v12 offset:36896
    ds_read_b64_tr_b16 a[138:139], v12 offset:38432
    s_waitcnt lgkmcnt(8)
    ds_read_b64_tr_b16 a[140:141], v12 offset:36928
    ds_read_b64_tr_b16 a[142:143], v12 offset:38464
    s_waitcnt lgkmcnt(8)
    s_waitcnt lgkmcnt(0)
    s_barrier
    s_waitcnt vmcnt(12)
    s_barrier
    v_add_u32 v12, 0, v8
    ds_read_b64_tr_b16 a[144:145], v12 offset:0
    ds_read_b64_tr_b16 a[146:147], v12 offset:1536
    s_waitcnt lgkmcnt(8)
    ds_read_b64_tr_b16 a[148:149], v12 offset:32
    ds_read_b64_tr_b16 a[150:151], v12 offset:1568
    s_waitcnt lgkmcnt(8)
    ds_read_b64_tr_b16 a[152:153], v12 offset:64
    ds_read_b64_tr_b16 a[154:155], v12 offset:1600
    s_waitcnt lgkmcnt(8)
    ds_read_b64_tr_b16 a[156:157], v12 offset:12288
    ds_read_b64_tr_b16 a[158:159], v12 offset:13824
    s_waitcnt lgkmcnt(8)
    ds_read_b64_tr_b16 a[160:161], v12 offset:12320
    ds_read_b64_tr_b16 a[162:163], v12 offset:13856
    s_waitcnt lgkmcnt(8)
    ds_read_b64_tr_b16 a[164:165], v12 offset:12352
    ds_read_b64_tr_b16 a[166:167], v12 offset:13888
    s_waitcnt lgkmcnt(8)
    ds_read_b64_tr_b16 a[168:169], v12 offset:24576
    ds_read_b64_tr_b16 a[170:171], v12 offset:26112
    s_waitcnt lgkmcnt(8)
    ds_read_b64_tr_b16 a[172:173], v12 offset:24608
    ds_read_b64_tr_b16 a[174:175], v12 offset:26144
    s_waitcnt lgkmcnt(8)
    ds_read_b64_tr_b16 a[176:177], v12 offset:24640
    ds_read_b64_tr_b16 a[178:179], v12 offset:26176
    s_waitcnt lgkmcnt(8)
    ds_read_b64_tr_b16 a[180:181], v12 offset:36864
    ds_read_b64_tr_b16 a[182:183], v12 offset:38400
    s_waitcnt lgkmcnt(8)
    ds_read_b64_tr_b16 a[184:185], v12 offset:36896
    ds_read_b64_tr_b16 a[186:187], v12 offset:38432
    s_waitcnt lgkmcnt(8)
    ds_read_b64_tr_b16 a[188:189], v12 offset:36928
    ds_read_b64_tr_b16 a[190:191], v12 offset:38464
    s_waitcnt lgkmcnt(8)
    s_waitcnt lgkmcnt(0)
    s_barrier
    s_waitcnt vmcnt(0)
    s_barrier
    v_add_u32 v12, 49152, v8
    ds_read_b64_tr_b16 a[192:193], v12 offset:0
    ds_read_b64_tr_b16 a[194:195], v12 offset:1536
    s_waitcnt lgkmcnt(8)
    ds_read_b64_tr_b16 a[196:197], v12 offset:32
    ds_read_b64_tr_b16 a[198:199], v12 offset:1568
    s_waitcnt lgkmcnt(8)
    ds_read_b64_tr_b16 a[200:201], v12 offset:64
    ds_read_b64_tr_b16 a[202:203], v12 offset:1600
    s_waitcnt lgkmcnt(8)
    ds_read_b64_tr_b16 a[204:205], v12 offset:12288
    ds_read_b64_tr_b16 a[206:207], v12 offset:13824
    s_waitcnt lgkmcnt(8)
    ds_read_b64_tr_b16 a[208:209], v12 offset:12320
    ds_read_b64_tr_b16 a[210:211], v12 offset:13856
    s_waitcnt lgkmcnt(8)
    ds_read_b64_tr_b16 a[212:213], v12 offset:12352
    ds_read_b64_tr_b16 a[214:215], v12 offset:13888
    s_waitcnt lgkmcnt(8)
    ds_read_b64_tr_b16 a[216:217], v12 offset:24576
    ds_read_b64_tr_b16 a[218:219], v12 offset:26112
    s_waitcnt lgkmcnt(8)
    ds_read_b64_tr_b16 a[220:221], v12 offset:24608
    ds_read_b64_tr_b16 a[222:223], v12 offset:26144
    s_waitcnt lgkmcnt(8)
    ds_read_b64_tr_b16 a[224:225], v12 offset:24640
    ds_read_b64_tr_b16 a[226:227], v12 offset:26176
    s_waitcnt lgkmcnt(8)
    ds_read_b64_tr_b16 a[228:229], v12 offset:36864
    ds_read_b64_tr_b16 a[230:231], v12 offset:38400
    s_waitcnt lgkmcnt(8)
    ds_read_b64_tr_b16 a[232:233], v12 offset:36896
    ds_read_b64_tr_b16 a[234:235], v12 offset:38432
    s_waitcnt lgkmcnt(8)
    ds_read_b64_tr_b16 a[236:237], v12 offset:36928
    ds_read_b64_tr_b16 a[238:239], v12 offset:38464
    s_waitcnt lgkmcnt(8)
    s_waitcnt lgkmcnt(0)
    s_barrier
    s_mul_i32 s30, s25, 640
    v_add_u32 v12, s30, v1
    v_add_u32 v12, 0, v12
    v_mul_u32_u24 v13, 3277, v12
    v_lshrrev_b32 v13, 18, v13
    v_mul_u32_u24 v14, 80, v13
    v_sub_u32 v14, v12, v14
    v_and_b32 v15, 15, v13
    v_xor_b32 v14, v14, v15
    v_mul_u32_u24 v100, 1280, v13
    v_lshl_add_u32 v100, v14, 4, v100
    v_add_u32 v12, s30, v1
    v_add_u32 v12, 64, v12
    v_mul_u32_u24 v13, 3277, v12
    v_lshrrev_b32 v13, 18, v13
    v_mul_u32_u24 v14, 80, v13
    v_sub_u32 v14, v12, v14
    v_and_b32 v15, 15, v13
    v_xor_b32 v14, v14, v15
    v_mul_u32_u24 v101, 1280, v13
    v_lshl_add_u32 v101, v14, 4, v101
    v_add_u32 v12, s30, v1
    v_add_u32 v12, 128, v12
    v_mul_u32_u24 v13, 3277, v12
    v_lshrrev_b32 v13, 18, v13
    v_mul_u32_u24 v14, 80, v13
    v_sub_u32 v14, v12, v14
    v_and_b32 v15, 15, v13
    v_xor_b32 v14, v14, v15
    v_mul_u32_u24 v102, 1280, v13
    v_lshl_add_u32 v102, v14, 4, v102
    v_add_u32 v12, s30, v1
    v_add_u32 v12, 192, v12
    v_mul_u32_u24 v13, 3277, v12
    v_lshrrev_b32 v13, 18, v13
    v_mul_u32_u24 v14, 80, v13
    v_sub_u32 v14, v12, v14
    v_and_b32 v15, 15, v13
    v_xor_b32 v14, v14, v15
    v_mul_u32_u24 v103, 1280, v13
    v_lshl_add_u32 v103, v14, 4, v103
    v_add_u32 v12, s30, v1
    v_add_u32 v12, 256, v12
    v_mul_u32_u24 v13, 3277, v12
    v_lshrrev_b32 v13, 18, v13
    v_mul_u32_u24 v14, 80, v13
    v_sub_u32 v14, v12, v14
    v_and_b32 v15, 15, v13
    v_xor_b32 v14, v14, v15
    v_mul_u32_u24 v104, 1280, v13
    v_lshl_add_u32 v104, v14, 4, v104
    v_add_u32 v12, s30, v1
    v_add_u32 v12, 320, v12
    v_mul_u32_u24 v13, 3277, v12
    v_lshrrev_b32 v13, 18, v13
    v_mul_u32_u24 v14, 80, v13
    v_sub_u32 v14, v12, v14
    v_and_b32 v15, 15, v13
    v_xor_b32 v14, v14, v15
    v_mul_u32_u24 v105, 1280, v13
    v_lshl_add_u32 v105, v14, 4, v105
    v_add_u32 v12, s30, v1
    v_add_u32 v12, 384, v12
    v_mul_u32_u24 v13, 3277, v12
    v_lshrrev_b32 v13, 18, v13
    v_mul_u32_u24 v14, 80, v13
    v_sub_u32 v14, v12, v14
    v_and_b32 v15, 15, v13
    v_xor_b32 v14, v14, v15
    v_mul_u32_u24 v106, 1280, v13
    v_lshl_add_u32 v106, v14, 4, v106
    v_add_u32 v12, s30, v1
    v_add_u32 v12, 448, v12
    v_mul_u32_u24 v13, 3277, v12
    v_lshrrev_b32 v13, 18, v13
    v_mul_u32_u24 v14, 80, v13
    v_sub_u32 v14, v12, v14
    v_and_b32 v15, 15, v13
    v_xor_b32 v14, v14, v15
    v_mul_u32_u24 v107, 1280, v13
    v_lshl_add_u32 v107, v14, 4, v107
    v_add_u32 v12, s30, v1
    v_add_u32 v12, 512, v12
    v_mul_u32_u24 v13, 3277, v12
    v_lshrrev_b32 v13, 18, v13
    v_mul_u32_u24 v14, 80, v13
    v_sub_u32 v14, v12, v14
    v_and_b32 v15, 15, v13
    v_xor_b32 v14, v14, v15
    v_mul_u32_u24 v108, 1280, v13
    v_lshl_add_u32 v108, v14, 4, v108
    v_add_u32 v12, s30, v1
    v_add_u32 v12, 576, v12
    v_mul_u32_u24 v13, 3277, v12
    v_lshrrev_b32 v13, 18, v13
    v_mul_u32_u24 v14, 80, v13
    v_sub_u32 v14, v12, v14
    v_and_b32 v15, 15, v13
    v_xor_b32 v14, v14, v15
    v_mul_u32_u24 v109, 1280, v13
    v_lshl_add_u32 v109, v14, 4, v109
    s_mul_i32 s33, s25, 10240
    v_lshrrev_b32 v12, 4, v1
    v_add_u32 v12, 0, v12
    v_and_b32 v13, 15, v1
    v_xor_b32 v12, v12, v13
    v_mul_u32_u24 v120, 1280, v13
    v_lshl_add_u32 v120, v12, 4, v120
    v_lshrrev_b32 v12, 4, v1
    v_add_u32 v12, 4, v12
    v_and_b32 v13, 15, v1
    v_xor_b32 v12, v12, v13
    v_mul_u32_u24 v121, 1280, v13
    v_lshl_add_u32 v121, v12, 4, v121
    v_lshrrev_b32 v12, 4, v1
    v_add_u32 v12, 8, v12
    v_and_b32 v13, 15, v1
    v_xor_b32 v12, v12, v13
    v_mul_u32_u24 v122, 1280, v13
    v_lshl_add_u32 v122, v12, 4, v122
    v_lshrrev_b32 v12, 4, v1
    v_add_u32 v12, 12, v12
    v_and_b32 v13, 15, v1
    v_xor_b32 v12, v12, v13
    v_mul_u32_u24 v123, 1280, v13
    v_lshl_add_u32 v123, v12, 4, v123
    s_mov_b32 s4, s78
    s_and_b32 s5, s79, 0xffff
    s_mov_b32 s6, 256
    s_mov_b32 s7, 0x20000
    v_mov_b32 v126, 32
M_wc_45:
    buffer_load_dword v127, v126, s[4:7], 0 offen sc1
    s_sub_u32 s34, s34, 1
    s_cbranch_scc1 G_end
    s_waitcnt vmcnt(0)
    v_readfirstlane_b32 s30, v127
    s_cmp_eq_u32 s30, 256
    s_cbranch_scc1 M_wc_46
    s_sleep 4
    s_branch M_wc_45
M_wc_46:
    v_mov_b32 v2, 0
    v_mov_b32 v14, 2147483632
    v_cmp_eq_u32 vcc, 0, v1
    s_nop 1
    v_cndmask_b32 v2, v14, v2, vcc
    s_mul_i32 s28, s23, 40960
    s_mov_b32 s29, 0
    s_add_u32 s35, s29, s33
    s_mov_b32 m0, s35
    s_add_u32 s35, s35, 1024
    buffer_load_dwordx4 v100, s[8:11], s28 offen lds
    s_mov_b32 m0, s35
    s_add_u32 s35, s35, 1024
    buffer_load_dwordx4 v101, s[8:11], s28 offen lds
    s_mov_b32 m0, s35
    s_add_u32 s35, s35, 1024
    buffer_load_dwordx4 v102, s[8:11], s28 offen lds
    s_mov_b32 m0, s35
    s_add_u32 s35, s35, 1024
    buffer_load_dwordx4 v103, s[8:11], s28 offen lds
    s_mov_b32 m0, s35
    s_add_u32 s35, s35, 1024
    buffer_load_dwordx4 v104, s[8:11], s28 offen lds
    s_mov_b32 m0, s35
    s_add_u32 s35, s35, 1024
    buffer_load_dwordx4 v105, s[8:11], s28 offen lds
    s_mov_b32 m0, s35
    s_add_u32 s35, s35, 1024
    buffer_load_dwordx4 v106, s[8:11], s28 offen lds
    s_mov_b32 m0, s35
    s_add_u32 s35, s35, 1024
    buffer_load_dwordx4 v107, s[8:11], s28 offen lds
    s_mov_b32 m0, s35
    s_add_u32 s35, s35, 1024
    buffer_load_dwordx4 v108, s[8:11], s28 offen lds
    s_mov_b32 m0, s35
    s_add_u32 s35, s35, 1024
    buffer_load_dwordx4 v109, s[8:11], s28 offen lds
    s_add_u32 s28, s28, 40960
    s_add_u32 s29, s29, 40960
    s_cmp_eq_u32 s29, 122880
    s_cselect_b32 s29, 0, s29
    s_add_u32 s35, s29, s33
    s_mov_b32 m0, s35
    s_add_u32 s35, s35, 1024
    buffer_load_dwordx4 v100, s[8:11], s28 offen lds
    s_mov_b32 m0, s35
    s_add_u32 s35, s35, 1024
    buffer_load_dwordx4 v101, s[8:11], s28 offen lds
    s_mov_b32 m0, s35
    s_add_u32 s35, s35, 1024
    buffer_load_dwordx4 v102, s[8:11], s28 offen lds
    s_mov_b32 m0, s35
    s_add_u32 s35, s35, 1024
    buffer_load_dwordx4 v103, s[8:11], s28 offen lds
    s_mov_b32 m0, s35
    s_add_u32 s35, s35, 1024
    buffer_load_dwordx4 v104, s[8:11], s28 offen lds
    s_mov_b32 m0, s35
    s_add_u32 s35, s35, 1024
    buffer_load_dwordx4 v105, s[8:11], s28 offen lds
    s_mov_b32 m0, s35
    s_add_u32 s35, s35, 1024
    buffer_load_dwordx4 v106, s[8:11], s28 offen lds
    s_mov_b32 m0, s35
    s_add_u32 s35, s35, 1024
    buffer_load_dwordx4 v107, s[8:11], s28 offen lds
    s_mov_b32 m0, s35
    s_add_u32 s35, s35, 1024
    buffer_load_dwordx4 v108, s[8:11], s28 offen lds
    s_mov_b32 m0, s35
    s_add_u32 s35, s35, 1024
    buffer_load_dwordx4 v109, s[8:11], s28 offen lds
    s_add_u32 s28, s28, 40960
    s_add_u32 s29, s29, 40960
    s_cmp_eq_u32 s29, 122880
    s_cselect_b32 s29, 0, s29
    s_lshr_b32 s30, s25, 1
    s_mul_i32 s30, s30, 3
    s_and_b32 s31, s25, 1
    s_add_u32 s36, s30, s31
    s_lshl_b32 s36, s36, 10
    s_add_u32 s36, s36, 0
    v_add_u32 v9, s36, v11
    s_add_u32 s30, s30, 2
    s_lshl_b32 s30, s30, 10
    s_lshl_b32 s31, s31, 3
    s_add_u32 s30, s30, s31
    s_add_u32 s30, s30, 0
    v_add_u32 v10, s30, v11
    v_mov_b32 v112, v120
    v_add_u32 v116, 40960, v120
    v_mov_b32 v113, v121
    v_add_u32 v117, 40960, v121
    v_mov_b32 v114, v122
    v_add_u32 v118, 40960, v122
    v_mov_b32 v115, v123
    v_add_u32 v119, 40960, v123
    s_mov_b32 s37, 81920
    s_mov_b32 s38, 0
    s_sub_u32 s26, s26, 393216
    s_waitcnt vmcnt(10)
    s_barrier
    ds_read_b128 v[64:67], v112 offset:0
    ds_read_b128 v[68:71], v112 offset:20480
    ds_read_b128 v[72:75], v113 offset:0
    ds_read_b128 v[76:79], v113 offset:20480
    ds_read_b128 v[80:83], v114 offset:0
    ds_read_b128 v[84:87], v114 offset:20480
    s_waitcnt lgkmcnt(4)
    v_mfma_f32_16x16x32_bf16 v[16:19], a[0:3], v[64:67], 0
    v_mfma_f32_16x16x32_bf16 v[20:23], a[4:7], v[64:67], 0
    v_mfma_f32_16x16x32_bf16 v[24:27], a[8:11], v[64:67], 0
    v_mfma_f32_16x16x32_bf16 v[28:31], a[0:3], v[68:71], 0
    v_mfma_f32_16x16x32_bf16 v[32:35], a[4:7], v[68:71], 0
    v_mfma_f32_16x16x32_bf16 v[36:39], a[8:11], v[68:71], 0
    ds_read_b128 v[64:67], v115 offset:0
    ds_read_b128 v[68:71], v115 offset:20480
    s_waitcnt lgkmcnt(4)
    v_mfma_f32_16x16x32_bf16 v[16:19], a[12:15], v[72:75], v[16:19]
    v_mfma_f32_16x16x32_bf16 v[20:23], a[16:19], v[72:75], v[20:23]
    v_mfma_f32_16x16x32_bf16 v[24:27], a[20:23], v[72:75], v[24:27]
    v_mfma_f32_16x16x32_bf16 v[28:31], a[12:15], v[76:79], v[28:31]
    v_mfma_f32_16x16x32_bf16 v[32:35], a[16:19], v[76:79], v[32:35]
    v_mfma_f32_16x16x32_bf16 v[36:39], a[20:23], v[76:79], v[36:39]
    ds_read_b128 v[72:75], v112 offset:256
    ds_read_b128 v[76:79], v112 offset:20736
    s_waitcnt lgkmcnt(4)
    v_mfma_f32_16x16x32_bf16 v[16:19], a[24:27], v[80:83], v[16:19]
    v_mfma_f32_16x16x32_bf16 v[20:23], a[28:31], v[80:83], v[20:23]
    v_mfma_f32_16x16x32_bf16 v[24:27], a[32:35], v[80:83], v[24:27]
    v_mfma_f32_16x16x32_bf16 v[28:31], a[24:27], v[84:87], v[28:31]
    v_mfma_f32_16x16x32_bf16 v[32:35], a[28:31], v[84:87], v[32:35]
    v_mfma_f32_16x16x32_bf16 v[36:39], a[32:35], v[84:87], v[36:39]
    ds_read_b128 v[80:83], v113 offset:256
    ds_read_b128 v[84:87], v113 offset:20736
    s_waitcnt lgkmcnt(4)
    v_mfma_f32_16x16x32_bf16 v[16:19], a[36:39], v[64:67], v[16:19]
    v_mfma_f32_16x16x32_bf16 v[20:23], a[40:43], v[64:67], v[20:23]
    v_mfma_f32_16x16x32_bf16 v[24:27], a[44:47], v[64:67], v[24:27]
    v_mfma_f32_16x16x32_bf16 v[28:31], a[36:39], v[68:71], v[28:31]
    v_mfma_f32_16x16x32_bf16 v[32:35], a[40:43], v[68:71], v[32:35]
    v_mfma_f32_16x16x32_bf16 v[36:39], a[44:47], v[68:71], v[36:39]
    ds_read_b128 v[64:67], v114 offset:256
    ds_read_b128 v[68:71], v114 offset:20736
    s_waitcnt lgkmcnt(4)
    v_mfma_f32_16x16x32_bf16 v[16:19], a[48:51], v[72:75], v[16:19]
    v_mfma_f32_16x16x32_bf16 v[20:23], a[52:55], v[72:75], v[20:23]
    v_mfma_f32_16x16x32_bf16 v[24:27], a[56:59], v[72:75], v[24:27]
    v_mfma_f32_16x16x32_bf16 v[28:31], a[48:51], v[76:79], v[28:31]
    v_mfma_f32_16x16x32_bf16 v[32:35], a[52:55], v[76:79], v[32:35]
    v_mfma_f32_16x16x32_bf16 v[36:39], a[56:59], v[76:79], v[36:39]
    ds_read_b128 v[72:75], v115 offset:256
    ds_read_b128 v[76:79], v115 offset:20736
    s_waitcnt lgkmcnt(4)
    v_mfma_f32_16x16x32_bf16 v[16:19], a[60:63], v[80:83], v[16:19]
    v_mfma_f32_16x16x32_bf16 v[20:23], a[64:67], v[80:83], v[20:23]
    v_mfma_f32_16x16x32_bf16 v[24:27], a[68:71], v[80:83], v[24:27]
    v_mfma_f32_16x16x32_bf16 v[28:31], a[60:63], v[84:87], v[28:31]
    v_mfma_f32_16x16x32_bf16 v[32:35], a[64:67], v[84:87], v[32:35]
    v_mfma_f32_16x16x32_bf16 v[36:39], a[68:71], v[84:87], v[36:39]
    ds_read_b128 v[80:83], v112 offset:512
    ds_read_b128 v[84:87], v112 offset:20992
    s_waitcnt lgkmcnt(4)
    v_mfma_f32_16x16x32_bf16 v[16:19], a[72:75], v[64:67], v[16:19]
    v_mfma_f32_16x16x32_bf16 v[20:23], a[76:79], v[64:67], v[20:23]
    v_mfma_f32_16x16x32_bf16 v[24:27], a[80:83], v[64:67], v[24:27]
    v_mfma_f32_16x16x32_bf16 v[28:31], a[72:75], v[68:71], v[28:31]
    v_mfma_f32_16x16x32_bf16 v[32:35], a[76:79], v[68:71], v[32:35]
    v_mfma_f32_16x16x32_bf16 v[36:39], a[80:83], v[68:71], v[36:39]
    ds_read_b128 v[64:67], v113 offset:512
    ds_read_b128 v[68:71], v113 offset:20992
    s_waitcnt lgkmcnt(4)
    v_mfma_f32_16x16x32_bf16 v[16:19], a[84:87], v[72:75], v[16:19]
    v_mfma_f32_16x16x32_bf16 v[20:23], a[88:91], v[72:75], v[20:23]
    v_mfma_f32_16x16x32_bf16 v[24:27], a[92:95], v[72:75], v[24:27]
    v_mfma_f32_16x16x32_bf16 v[28:31], a[84:87], v[76:79], v[28:31]
    v_mfma_f32_16x16x32_bf16 v[32:35], a[88:91], v[76:79], v[32:35]
    v_mfma_f32_16x16x32_bf16 v[36:39], a[92:95], v[76:79], v[36:39]
    ds_read_b128 v[72:75], v114 offset:512
    ds_read_b128 v[76:79], v114 offset:20992
    s_waitcnt lgkmcnt(4)
    v_mfma_f32_16x16x32_bf16 v[16:19], a[96:99], v[80:83], v[16:19]
    v_mfma_f32_16x16x32_bf16 v[20:23], a[100:103], v[80:83], v[20:23]
    v_mfma_f32_16x16x32_bf16 v[24:27], a[104:107], v[80:83], v[24:27]
    v_mfma_f32_16x16x32_bf16 v[28:31], a[96:99], v[84:87], v[28:31]
    v_mfma_f32_16x16x32_bf16 v[32:35], a[100:103], v[84:87], v[32:35]
    v_mfma_f32_16x16x32_bf16 v[36:39], a[104:107], v[84:87], v[36:39]
    ds_read_b128 v[80:83], v115 offset:512
    ds_read_b128 v[84:87], v115 offset:20992
    s_waitcnt lgkmcnt(4)
    v_mfma_f32_16x16x32_bf16 v[16:19], a[108:111], v[64:67], v[16:19]
    v_mfma_f32_16x16x32_bf16 v[20:23], a[112:115], v[64:67], v[20:23]
    v_mfma_f32_16x16x32_bf16 v[24:27], a[116:119], v[64:67], v[24:27]
    v_mfma_f32_16x16x32_bf16 v[28:31], a[108:111], v[68:71], v[28:31]
    v_mfma_f32_16x16x32_bf16 v[32:35], a[112:115], v[68:71], v[32:35]
    v_mfma_f32_16x16x32_bf16 v[36:39], a[116:119], v[68:71], v[36:39]
    ds_read_b128 v[64:67], v112 offset:768
    ds_read_b128 v[68:71], v112 offset:21248
    s_waitcnt vmcnt(0)
    s_barrier
    s_add_u32 s35, s29, s33
    s_waitcnt lgkmcnt(4)
    v_mfma_f32_16x16x32_bf16 v[16:19], a[120:123], v[72:75], v[16:19]
    v_mfma_f32_16x16x32_bf16 v[20:23], a[124:127], v[72:75], v[20:23]
    s_mov_b32 m0, s35
    s_add_u32 s35, s35, 1024
    buffer_load_dwordx4 v100, s[8:11], s28 offen lds
    v_mfma_f32_16x16x32_bf16 v[24:27], a[128:131], v[72:75], v[24:27]
    v_mfma_f32_16x16x32_bf16 v[28:31], a[120:123], v[76:79], v[28:31]
    v_mfma_f32_16x16x32_bf16 v[32:35], a[124:127], v[76:79], v[32:35]
    v_mfma_f32_16x16x32_bf16 v[36:39], a[128:131], v[76:79], v[36:39]
    ds_read_b128 v[72:75], v113 offset:768
    ds_read_b128 v[76:79], v113 offset:21248
    s_waitcnt lgkmcnt(4)
    v_mfma_f32_16x16x32_bf16 v[16:19], a[132:135], v[80:83], v[16:19]
    v_mfma_f32_16x16x32_bf16 v[20:23], a[136:139], v[80:83], v[20:23]
    s_mov_b32 m0, s35
    s_add_u32 s35, s35, 1024
    buffer_load_dwordx4 v101, s[8:11], s28 offen lds
    v_mfma_f32_16x16x32_bf16 v[24:27], a[140:143], v[80:83], v[24:27]
    v_mfma_f32_16x16x32_bf16 v[28:31], a[132:135], v[84:87], v[28:31]
    v_mfma_f32_16x16x32_bf16 v[32:35], a[136:139], v[84:87], v[32:35]
    v_mfma_f32_16x16x32_bf16 v[36:39], a[140:143], v[84:87], v[36:39]
    ds_read_b128 v[80:83], v114 offset:768
    ds_read_b128 v[84:87], v114 offset:21248
    s_waitcnt lgkmcnt(4)
    v_mfma_f32_16x16x32_bf16 v[16:19], a[144:147], v[64:67], v[16:19]
    v_mfma_f32_16x16x32_bf16 v[20:23], a[148:151], v[64:67], v[20:23]
    s_mov_b32 m0, s35
    s_add_u32 s35, s35, 1024
    buffer_load_dwordx4 v102, s[8:11], s28 offen lds
    v_mfma_f32_16x16x32_bf16 v[24:27], a[152:155], v[64:67], v[24:27]
    v_mfma_f32_16x16x32_bf16 v[28:31], a[144:147], v[68:71], v[28:31]
    v_mfma_f32_16x16x32_bf16 v[32:35], a[148:151], v[68:71], v[32:35]
    v_mfma_f32_16x16x32_bf16 v[36:39], a[152:155], v[68:71], v[36:39]
    ds_read_b128 v[64:67], v115 offset:768
    ds_read_b128 v[68:71], v115 offset:21248
    s_waitcnt lgkmcnt(4)
    v_mfma_f32_16x16x32_bf16 v[16:19], a[156:159], v[72:75], v[16:19]
    v_mfma_f32_16x16x32_bf16 v[20:23], a[160:163], v[72:75], v[20:23]
    s_mov_b32 m0, s35
    s_add_u32 s35, s35, 1024
    buffer_load_dwordx4 v103, s[8:11], s28 offen lds
    v_mfma_f32_16x16x32_bf16 v[24:27], a[164:167], v[72:75], v[24:27]
    v_mfma_f32_16x16x32_bf16 v[28:31], a[156:159], v[76:79], v[28:31]
    v_mfma_f32_16x16x32_bf16 v[32:35], a[160:163], v[76:79], v[32:35]
    v_mfma_f32_16x16x32_bf16 v[36:39], a[164:167], v[76:79], v[36:39]
    ds_read_b128 v[72:75], v112 offset:1024
    ds_read_b128 v[76:79], v112 offset:21504
    s_waitcnt lgkmcnt(4)
    v_mfma_f32_16x16x32_bf16 v[16:19], a[168:171], v[80:83], v[16:19]
    v_mfma_f32_16x16x32_bf16 v[20:23], a[172:175], v[80:83], v[20:23]
    s_mov_b32 m0, s35
    s_add_u32 s35, s35, 1024
    buffer_load_dwordx4 v104, s[8:11], s28 offen lds
    v_mfma_f32_16x16x32_bf16 v[24:27], a[176:179], v[80:83], v[24:27]
    v_mfma_f32_16x16x32_bf16 v[28:31], a[168:171], v[84:87], v[28:31]
    v_mfma_f32_16x16x32_bf16 v[32:35], a[172:175], v[84:87], v[32:35]
    v_mfma_f32_16x16x32_bf16 v[36:39], a[176:179], v[84:87], v[36:39]
    ds_read_b128 v[80:83], v113 offset:1024
    ds_read_b128 v[84:87], v113 offset:21504
    s_waitcnt lgkmcnt(4)
    v_mfma_f32_16x16x32_bf16 v[16:19], a[180:183], v[64:67], v[16:19]
    v_mfma_f32_16x16x32_bf16 v[20:23], a[184:187], v[64:67], v[20:23]
    s_mov_b32 m0, s35
    s_add_u32 s35, s35, 1024
    buffer_load_dwordx4 v105, s[8:11], s28 offen lds
    v_mfma_f32_16x16x32_bf16 v[24:27], a[188:191], v[64:67], v[24:27]
    v_mfma_f32_16x16x32_bf16 v[28:31], a[180:183], v[68:71], v[28:31]
    v_mfma_f32_16x16x32_bf16 v[32:35], a[184:187], v[68:71], v[32:35]
    v_mfma_f32_16x16x32_bf16 v[36:39], a[188:191], v[68:71], v[36:39]
    ds_read_b128 v[64:67], v114 offset:1024
    ds_read_b128 v[68:71], v114 offset:21504
    s_waitcnt lgkmcnt(4)
    v_mfma_f32_16x16x32_bf16 v[16:19], a[192:195], v[72:75], v[16:19]
    v_mfma_f32_16x16x32_bf16 v[20:23], a[196:199], v[72:75], v[20:23]
    s_mov_b32 m0, s35
    s_add_u32 s35, s35, 1024
    buffer_load_dwordx4 v106, s[8:11], s28 offen lds
    v_mfma_f32_16x16x32_bf16 v[24:27], a[200:203], v[72:75], v[24:27]
    v_mfma_f32_16x16x32_bf16 v[28:31], a[192:195], v[76:79], v[28:31]
    v_mfma_f32_16x16x32_bf16 v[32:35], a[196:199], v[76:79], v[32:35]
    v_mfma_f32_16x16x32_bf16 v[36:39], a[200:203], v[76:79], v[36:39]
    ds_read_b128 v[72:75], v115 offset:1024
    ds_read_b128 v[76:79], v115 offset:21504
    s_waitcnt lgkmcnt(4)
    v_mfma_f32_16x16x32_bf16 v[16:19], a[204:207], v[80:83], v[16:19]
    v_mfma_f32_16x16x32_bf16 v[20:23], a[208:211], v[80:83], v[20:23]
    s_mov_b32 m0, s35
    s_add_u32 s35, s35, 1024
    buffer_load_dwordx4 v107, s[8:11], s28 offen lds
    v_mfma_f32_16x16x32_bf16 v[24:27], a[212:215], v[80:83], v[24:27]
    v_mfma_f32_16x16x32_bf16 v[28:31], a[204:207], v[84:87], v[28:31]
    v_mfma_f32_16x16x32_bf16 v[32:35], a[208:211], v[84:87], v[32:35]
    v_mfma_f32_16x16x32_bf16 v[36:39], a[212:215], v[84:87], v[36:39]
    ds_read_b128 v[80:83], v116 offset:0
    ds_read_b128 v[84:87], v116 offset:20480
    s_waitcnt lgkmcnt(4)
    v_mfma_f32_16x16x32_bf16 v[16:19], a[216:219], v[64:67], v[16:19]
    v_mfma_f32_16x16x32_bf16 v[20:23], a[220:223], v[64:67], v[20:23]
    s_mov_b32 m0, s35
    s_add_u32 s35, s35, 1024
    buffer_load_dwordx4 v108, s[8:11], s28 offen lds
    v_mfma_f32_16x16x32_bf16 v[24:27], a[224:227], v[64:67], v[24:27]
    v_mfma_f32_16x16x32_bf16 v[28:31], a[216:219], v[68:71], v[28:31]
    v_mfma_f32_16x16x32_bf16 v[32:35], a[220:223], v[68:71], v[32:35]
    v_mfma_f32_16x16x32_bf16 v[36:39], a[224:227], v[68:71], v[36:39]
    ds_read_b128 v[64:67], v117 offset:0
    ds_read_b128 v[68:71], v117 offset:20480
    s_waitcnt lgkmcnt(4)
    v_mfma_f32_16x16x32_bf16 v[16:19], a[228:231], v[72:75], v[16:19]
    v_mfma_f32_16x16x32_bf16 v[20:23], a[232:235], v[72:75], v[20:23]
    s_mov_b32 m0, s35
    s_add_u32 s35, s35, 1024
    buffer_load_dwordx4 v109, s[8:11], s28 offen lds
    v_mfma_f32_16x16x32_bf16 v[24:27], a[236:239], v[72:75], v[24:27]
    v_mfma_f32_16x16x32_bf16 v[28:31], a[228:231], v[76:79], v[28:31]
    v_mfma_f32_16x16x32_bf16 v[32:35], a[232:235], v[76:79], v[32:35]
    v_mfma_f32_16x16x32_bf16 v[36:39], a[236:239], v[76:79], v[36:39]
    s_add_u32 s28, s28, 40960
    s_add_u32 s29, s29, 40960
    s_cmp_eq_u32 s29, 122880
    s_cselect_b32 s29, 0, s29
    v_mov_b32 v112, v116
    v_add_u32 v116, s37, v120
    v_mov_b32 v113, v117
    v_add_u32 v117, s37, v121
    v_mov_b32 v114, v118
    v_add_u32 v118, s37, v122
    v_mov_b32 v115, v119
    v_add_u32 v119, s37, v123
    s_add_u32 s37, s37, 40960
    s_cmp_eq_u32 s37, 122880
    s_cselect_b32 s37, 0, s37
    s_add_u32 s26, s26, 393216
    s_add_u32 s38, s38, 1
PK_loop:
    s_cmp_ge_u32 s38, s24
    s_cbranch_scc1 PK_fin0
    ds_read_b128 v[72:75], v114 offset:0
    ds_read_b128 v[76:79], v114 offset:20480
    s_waitcnt lgkmcnt(4)
    v_mfma_f32_16x16x32_bf16 v[40:43], a[0:3], v[80:83], 0
    v_mfma_f32_16x16x32_bf16 v[44:47], a[4:7], v[80:83], 0
    v_mfma_f32_16x16x32_bf16 v[48:51], a[8:11], v[80:83], 0
    v_mfma_f32_16x16x32_bf16 v[52:55], a[0:3], v[84:87], 0
    v_mfma_f32_16x16x32_bf16 v[56:59], a[4:7], v[84:87], 0
    v_mfma_f32_16x16x32_bf16 v[60:63], a[8:11], v[84:87], 0
    ds_read_b128 v[80:83], v115 offset:0
    ds_read_b128 v[84:87], v115 offset:20480
    s_waitcnt lgkmcnt(4)
    v_mfma_f32_16x16x32_bf16 v[40:43], a[12:15], v[64:67], v[40:43]
    v_cvt_pk_bf16_f32 v88, v16, v17
    v_cvt_pk_bf16_f32 v89, v18, v19
    v_mfma_f32_16x16x32_bf16 v[44:47], a[16:19], v[64:67], v[44:47]
    v_mfma_f32_16x16x32_bf16 v[48:51], a[20:23], v[64:67], v[48:51]
    v_cvt_pk_bf16_f32 v90, v20, v21
    v_cvt_pk_bf16_f32 v91, v22, v23
    v_mfma_f32_16x16x32_bf16 v[52:55], a[12:15], v[68:71], v[52:55]
    v_mfma_f32_16x16x32_bf16 v[56:59], a[16:19], v[68:71], v[56:59]
    buffer_store_dwordx4 v[88:91], v9, s[16:19], s26 offen sc1
    v_mfma_f32_16x16x32_bf16 v[60:63], a[20:23], v[68:71], v[60:63]
    ds_read_b128 v[64:67], v112 offset:256
    ds_read_b128 v[68:71], v112 offset:20736
    s_waitcnt lgkmcnt(4)
    v_mfma_f32_16x16x32_bf16 v[40:43], a[24:27], v[72:75], v[40:43]
    v_cvt_pk_bf16_f32 v92, v24, v25
    v_cvt_pk_bf16_f32 v93, v26, v27
    v_mfma_f32_16x16x32_bf16 v[44:47], a[28:31], v[72:75], v[44:47]
    v_mfma_f32_16x16x32_bf16 v[48:51], a[32:35], v[72:75], v[48:51]
    buffer_store_dwordx2 v[92:93], v10, s[16:19], s26 offen sc1
    v_mfma_f32_16x16x32_bf16 v[52:55], a[24:27], v[76:79], v[52:55]
    v_mfma_f32_16x16x32_bf16 v[56:59], a[28:31], v[76:79], v[56:59]
    v_cvt_pk_bf16_f32 v94, v28, v29
    v_cvt_pk_bf16_f32 v95, v30, v31
    v_mfma_f32_16x16x32_bf16 v[60:63], a[32:35], v[76:79], v[60:63]
    ds_read_b128 v[72:75], v113 offset:256
    ds_read_b128 v[76:79], v113 offset:20736
    s_waitcnt lgkmcnt(4)
    v_mfma_f32_16x16x32_bf16 v[40:43], a[36:39], v[80:83], v[40:43]
    v_cvt_pk_bf16_f32 v96, v32, v33
    v_cvt_pk_bf16_f32 v97, v34, v35
    v_mfma_f32_16x16x32_bf16 v[44:47], a[40:43], v[80:83], v[44:47]
    v_mfma_f32_16x16x32_bf16 v[48:51], a[44:47], v[80:83], v[48:51]
    s_add_u32 s39, s26, 6144
    buffer_store_dwordx4 v[94:97], v9, s[16:19], s39 offen sc1
    v_mfma_f32_16x16x32_bf16 v[52:55], a[36:39], v[84:87], v[52:55]
    v_mfma_f32_16x16x32_bf16 v[56:59], a[40:43], v[84:87], v[56:59]
    v_cvt_pk_bf16_f32 v98, v36, v37
    v_cvt_pk_bf16_f32 v99, v38, v39
    v_mfma_f32_16x16x32_bf16 v[60:63], a[44:47], v[84:87], v[60:63]
    ds_read_b128 v[80:83], v114 offset:256
    ds_read_b128 v[84:87], v114 offset:20736
    s_waitcnt lgkmcnt(4)
    v_mfma_f32_16x16x32_bf16 v[40:43], a[48:51], v[64:67], v[40:43]
    buffer_store_dwordx2 v[98:99], v10, s[16:19], s39 offen sc1
    v_mfma_f32_16x16x32_bf16 v[44:47], a[52:55], v[64:67], v[44:47]
    v_mfma_f32_16x16x32_bf16 v[48:51], a[56:59], v[64:67], v[48:51]
    v_mfma_f32_16x16x32_bf16 v[52:55], a[48:51], v[68:71], v[52:55]
    v_mfma_f32_16x16x32_bf16 v[56:59], a[52:55], v[68:71], v[56:59]
    v_mfma_f32_16x16x32_bf16 v[60:63], a[56:59], v[68:71], v[60:63]
    ds_read_b128 v[64:67], v115 offset:256
    ds_read_b128 v[68:71], v115 offset:20736
    s_waitcnt lgkmcnt(4)
    v_mfma_f32_16x16x32_bf16 v[40:43], a[60:63], v[72:75], v[40:43]
    v_mfma_f32_16x16x32_bf16 v[44:47], a[64:67], v[72:75], v[44:47]
    v_mfma_f32_16x16x32_bf16 v[48:51], a[68:71], v[72:75], v[48:51]
    v_mfma_f32_16x16x32_bf16 v[52:55], a[60:63], v[76:79], v[52:55]
    v_mfma_f32_16x16x32_bf16 v[56:59], a[64:67], v[76:79], v[56:59]
    v_mfma_f32_16x16x32_bf16 v[60:63], a[68:71], v[76:79], v[60:63]
    ds_read_b128 v[72:75], v112 offset:512
    ds_read_b128 v[76:79], v112 offset:20992
    s_waitcnt lgkmcnt(4)
    v_mfma_f32_16x16x32_bf16 v[40:43], a[72:75], v[80:83], v[40:43]
    v_mfma_f32_16x16x32_bf16 v[44:47], a[76:79], v[80:83], v[44:47]
    v_mfma_f32_16x16x32_bf16 v[48:51], a[80:83], v[80:83], v[48:51]
    v_mfma_f32_16x16x32_bf16 v[52:55], a[72:75], v[84:87], v[52:55]
    v_mfma_f32_16x16x32_bf16 v[56:59], a[76:79], v[84:87], v[56:59]
    v_mfma_f32_16x16x32_bf16 v[60:63], a[80:83], v[84:87], v[60:63]
    ds_read_b128 v[80:83], v113 offset:512
    ds_read_b128 v[84:87], v113 offset:20992
    s_waitcnt lgkmcnt(4)
    v_mfma_f32_16x16x32_bf16 v[40:43], a[84:87], v[64:67], v[40:43]
    v_mfma_f32_16x16x32_bf16 v[44:47], a[88:91], v[64:67], v[44:47]
    v_mfma_f32_16x16x32_bf16 v[48:51], a[92:95], v[64:67], v[48:51]
    v_mfma_f32_16x16x32_bf16 v[52:55], a[84:87], v[68:71], v[52:55]
    v_mfma_f32_16x16x32_bf16 v[56:59], a[88:91], v[68:71], v[56:59]
    v_mfma_f32_16x16x32_bf16 v[60:63], a[92:95], v[68:71], v[60:63]
    ds_read_b128 v[64:67], v114 offset:512
    ds_read_b128 v[68:71], v114 offset:20992
    s_waitcnt lgkmcnt(4)
    v_mfma_f32_16x16x32_bf16 v[40:43], a[96:99], v[72:75], v[40:43]
    v_mfma_f32_16x16x32_bf16 v[44:47], a[100:103], v[72:75], v[44:47]
    v_mfma_f32_16x16x32_bf16 v[48:51], a[104:107], v[72:75], v[48:51]
    v_mfma_f32_16x16x32_bf16 v[52:55], a[96:99], v[76:79], v[52:55]
    v_mfma_f32_16x16x32_bf16 v[56:59], a[100:103], v[76:79], v[56:59]
    v_mfma_f32_16x16x32_bf16 v[60:63], a[104:107], v[76:79], v[60:63]
    ds_read_b128 v[72:75], v115 offset:512
    ds_read_b128 v[76:79], v115 offset:20992
    s_waitcnt lgkmcnt(4)
    v_mfma_f32_16x16x32_bf16 v[40:43], a[108:111], v[80:83], v[40:43]
    v_mfma_f32_16x16x32_bf16 v[44:47], a[112:115], v[80:83], v[44:47]
    v_mfma_f32_16x16x32_bf16 v[48:51], a[116:119], v[80:83], v[48:51]
    v_mfma_f32_16x16x32_bf16 v[52:55], a[108:111], v[84:87], v[52:55]
    v_mfma_f32_16x16x32_bf16 v[56:59], a[112:115], v[84:87], v[56:59]
    v_mfma_f32_16x16x32_bf16 v[60:63], a[116:119], v[84:87], v[60:63]
    ds_read_b128 v[80:83], v112 offset:768
    ds_read_b128 v[84:87], v112 offset:21248
    s_waitcnt vmcnt(4)
    s_barrier
    s_add_u32 s35, s29, s33
    s_sub_u32 s30, s38, 1
    v_mov_b32 v14, s30
    buffer_store_dword v14, v2, s[16:19], s40 offen sc1
    s_waitcnt lgkmcnt(4)
    v_mfma_f32_16x16x32_bf16 v[40:43], a[120:123], v[64:67], v[40:43]
    v_mfma_f32_16x16x32_bf16 v[44:47], a[124:127], v[64:67], v[44:47]
    s_mov_b32 m0, s35
    s_add_u32 s35, s35, 1024
    buffer_load_dwordx4 v100, s[8:11], s28 offen lds
    v_mfma_f32_16x16x32_bf16 v[48:51], a[128:131], v[64:67], v[48:51]
    v_mfma_f32_16x16x32_bf16 v[52:55], a[120:123], v[68:71], v[52:55]
    v_mfma_f32_16x16x32_bf16 v[56:59], a[124:127], v[68:71], v[56:59]
    v_mfma_f32_16x16x32_bf16 v[60:63], a[128:131], v[68:71], v[60:63]
    ds_read_b128 v[64:67], v113 offset:768
    ds_read_b128 v[68:71], v113 offset:21248
    s_waitcnt lgkmcnt(4)
    v_mfma_f32_16x16x32_bf16 v[40:43], a[132:135], v[72:75], v[40:43]
    v_mfma_f32_16x16x32_bf16 v[44:47], a[136:139], v[72:75], v[44:47]
    s_mov_b32 m0, s35
    s_add_u32 s35, s35, 1024
    buffer_load_dwordx4 v101, s[8:11], s28 offen lds
    v_mfma_f32_16x16x32_bf16 v[48:51], a[140:143], v[72:75], v[48:51]
    v_mfma_f32_16x16x32_bf16 v[52:55], a[132:135], v[76:79], v[52:55]
    v_mfma_f32_16x16x32_bf16 v[56:59], a[136:139], v[76:79], v[56:59]
    v_mfma_f32_16x16x32_bf16 v[60:63], a[140:143], v[76:79], v[60:63]
    ds_read_b128 v[72:75], v114 offset:768
    ds_read_b128 v[76:79], v114 offset:21248
    s_waitcnt lgkmcnt(4)
    v_mfma_f32_16x16x32_bf16 v[40:43], a[144:147], v[80:83], v[40:43]
    v_mfma_f32_16x16x32_bf16 v[44:47], a[148:151], v[80:83], v[44:47]
    s_mov_b32 m0, s35
    s_add_u32 s35, s35, 1024
    buffer_load_dwordx4 v102, s[8:11], s28 offen lds
    v_mfma_f32_16x16x32_bf16 v[48:51], a[152:155], v[80:83], v[48:51]
    v_mfma_f32_16x16x32_bf16 v[52:55], a[144:147], v[84:87], v[52:55]
    v_mfma_f32_16x16x32_bf16 v[56:59], a[148:151], v[84:87], v[56:59]
    v_mfma_f32_16x16x32_bf16 v[60:63], a[152:155], v[84:87], v[60:63]
    ds_read_b128 v[80:83], v115 offset:768
    ds_read_b128 v[84:87], v115 offset:21248
    s_waitcnt lgkmcnt(4)
    v_mfma_f32_16x16x32_bf16 v[40:43], a[156:159], v[64:67], v[40:43]
    v_mfma_f32_16x16x32_bf16 v[44:47], a[160:163], v[64:67], v[44:47]
    s_mov_b32 m0, s35
    s_add_u32 s35, s35, 1024
    buffer_load_dwordx4 v103, s[8:11], s28 offen lds
    v_mfma_f32_16x16x32_bf16 v[48:51], a[164:167], v[64:67], v[48:51]
    v_mfma_f32_16x16x32_bf16 v[52:55], a[156:159], v[68:71], v[52:55]
    v_mfma_f32_16x16x32_bf16 v[56:59], a[160:163], v[68:71], v[56:59]
    v_mfma_f32_16x16x32_bf16 v[60:63], a[164:167], v[68:71], v[60:63]
    ds_read_b128 v[64:67], v112 offset:1024
    ds_read_b128 v[68:71], v112 offset:21504
    s_waitcnt lgkmcnt(4)
    v_mfma_f32_16x16x32_bf16 v[40:43], a[168:171], v[72:75], v[40:43]
    v_mfma_f32_16x16x32_bf16 v[44:47], a[172:175], v[72:75], v[44:47]
    s_mov_b32 m0, s35
    s_add_u32 s35, s35, 1024
    buffer_load_dwordx4 v104, s[8:11], s28 offen lds
    v_mfma_f32_16x16x32_bf16 v[48:51], a[176:179], v[72:75], v[48:51]
    v_mfma_f32_16x16x32_bf16 v[52:55], a[168:171], v[76:79], v[52:55]
    v_mfma_f32_16x16x32_bf16 v[56:59], a[172:175], v[76:79], v[56:59]
    v_mfma_f32_16x16x32_bf16 v[60:63], a[176:179], v[76:79], v[60:63]
    ds_read_b128 v[72:75], v113 offset:1024
    ds_read_b128 v[76:79], v113 offset:21504
    s_waitcnt lgkmcnt(4)
    v_mfma_f32_16x16x32_bf16 v[40:43], a[180:183], v[80:83], v[40:43]
    v_mfma_f32_16x16x32_bf16 v[44:47], a[184:187], v[80:83], v[44:47]
    s_mov_b32 m0, s35
    s_add_u32 s35, s35, 1024
    buffer_load_dwordx4 v105, s[8:11], s28 offen lds
    v_mfma_f32_16x16x32_bf16 v[48:51], a[188:191], v[80:83], v[48:51]
    v_mfma_f32_16x16x32_bf16 v[52:55], a[180:183], v[84:87], v[52:55]
    v_mfma_f32_16x16x32_bf16 v[56:59], a[184:187], v[84:87], v[56:59]
    v_mfma_f32_16x16x32_bf16 v[60:63], a[188:191], v[84:87], v[60:63]
    ds_read_b128 v[80:83], v114 offset:1024
    ds_read_b128 v[84:87], v114 offset:21504
    s_waitcnt lgkmcnt(4)
    v_mfma_f32_16x16x32_bf16 v[40:43], a[192:195], v[64:67], v[40:43]
    v_mfma_f32_16x16x32_bf16 v[44:47], a[196:199], v[64:67], v[44:47]
    s_mov_b32 m0, s35
    s_add_u32 s35, s35, 1024
    buffer_load_dwordx4 v106, s[8:11], s28 offen lds
    v_mfma_f32_16x16x32_bf16 v[48:51], a[200:203], v[64:67], v[48:51]
    v_mfma_f32_16x16x32_bf16 v[52:55], a[192:195], v[68:71], v[52:55]
    v_mfma_f32_16x16x32_bf16 v[56:59], a[196:199], v[68:71], v[56:59]
    v_mfma_f32_16x16x32_bf16 v[60:63], a[200:203], v[68:71], v[60:63]
    ds_read_b128 v[64:67], v115 offset:1024
    ds_read_b128 v[68:71], v115 offset:21504
    s_waitcnt lgkmcnt(4)
    v_mfma_f32_16x16x32_bf16 v[40:43], a[204:207], v[72:75], v[40:43]
    v_mfma_f32_16x16x32_bf16 v[44:47], a[208:211], v[72:75], v[44:47]
    s_mov_b32 m0, s35
    s_add_u32 s35, s35, 1024
    buffer_load_dwordx4 v107, s[8:11], s28 offen lds
    v_mfma_f32_16x16x32_bf16 v[48:51], a[212:215], v[72:75], v[48:51]
    v_mfma_f32_16x16x32_bf16 v[52:55], a[204:207], v[76:79], v[52:55]
    v_mfma_f32_16x16x32_bf16 v[56:59], a[208:211], v[76:79], v[56:59]
    v_mfma_f32_16x16x32_bf16 v[60:63], a[212:215], v[76:79], v[60:63]
    ds_read_b128 v[72:75], v116 offset:0
    ds_read_b128 v[76:79], v116 offset:20480
    s_waitcnt lgkmcnt(4)
    v_mfma_f32_16x16x32_bf16 v[40:43], a[216:219], v[80:83], v[40:43]
    v_mfma_f32_16x16x32_bf16 v[44:47], a[220:223], v[80:83], v[44:47]
    s_mov_b32 m0, s35
    s_add_u32 s35, s35, 1024
    buffer_load_dwordx4 v108, s[8:11], s28 offen lds
    v_mfma_f32_16x16x32_bf16 v[48:51], a[224:227], v[80:83], v[48:51]
    v_mfma_f32_16x16x32_bf16 v[52:55], a[216:219], v[84:87], v[52:55]
    v_mfma_f32_16x16x32_bf16 v[56:59], a[220:223], v[84:87], v[56:59]
    v_mfma_f32_16x16x32_bf16 v[60:63], a[224:227], v[84:87], v[60:63]
    ds_read_b128 v[80:83], v117 offset:0
    ds_read_b128 v[84:87], v117 offset:20480
    s_cmp_gt_u32 s38, 2
    s_cbranch_scc1 PK_ef_47
    s_waitcnt vmcnt(10)
    v_mov_b32 v14, s38
    buffer_store_dword v14, v2, s[16:19], s40 offen sc1
PK_ef_47:
    s_waitcnt lgkmcnt(4)
    v_mfma_f32_16x16x32_bf16 v[40:43], a[228:231], v[64:67], v[40:43]
    v_mfma_f32_16x16x32_bf16 v[44:47], a[232:235], v[64:67], v[44:47]
    s_mov_b32 m0, s35
    s_add_u32 s35, s35, 1024
    buffer_load_dwordx4 v109, s[8:11], s28 offen lds
    v_mfma_f32_16x16x32_bf16 v[48:51], a[236:239], v[64:67], v[48:51]
    v_mfma_f32_16x16x32_bf16 v[52:55], a[228:231], v[68:71], v[52:55]
    v_mfma_f32_16x16x32_bf16 v[56:59], a[232:235], v[68:71], v[56:59]
    v_mfma_f32_16x16x32_bf16 v[60:63], a[236:239], v[68:71], v[60:63]
    s_add_u32 s28, s28, 40960
    s_add_u32 s29, s29, 40960
    s_cmp_eq_u32 s29, 122880
    s_cselect_b32 s29, 0, s29
    v_mov_b32 v112, v116
    v_add_u32 v116, s37, v120
    v_mov_b32 v113, v117
    v_add_u32 v117, s37, v121
    v_mov_b32 v114, v118
    v_add_u32 v118, s37, v122
    v_mov_b32 v115, v119
    v_add_u32 v119, s37, v123
    s_add_u32 s37, s37, 40960
    s_cmp_eq_u32 s37, 122880
    s_cselect_b32 s37, 0, s37
    s_add_u32 s26, s26, 393216
    s_add_u32 s38, s38, 1
    s_cmp_ge_u32 s38, s24
    s_cbranch_scc1 PK_fin1
    ds_read_b128 v[64:67], v114 offset:0
    ds_read_b128 v[68:71], v114 offset:20480
    s_waitcnt lgkmcnt(4)
    v_mfma_f32_16x16x32_bf16 v[16:19], a[0:3], v[72:75], 0
    v_mfma_f32_16x16x32_bf16 v[20:23], a[4:7], v[72:75], 0
    v_mfma_f32_16x16x32_bf16 v[24:27], a[8:11], v[72:75], 0
    v_mfma_f32_16x16x32_bf16 v[28:31], a[0:3], v[76:79], 0
    v_mfma_f32_16x16x32_bf16 v[32:35], a[4:7], v[76:79], 0
    v_mfma_f32_16x16x32_bf16 v[36:39], a[8:11], v[76:79], 0
    ds_read_b128 v[72:75], v115 offset:0
    ds_read_b128 v[76:79], v115 offset:20480
    s_waitcnt lgkmcnt(4)
    v_mfma_f32_16x16x32_bf16 v[16:19], a[12:15], v[80:83], v[16:19]
    v_cvt_pk_bf16_f32 v88, v40, v41
    v_cvt_pk_bf16_f32 v89, v42, v43
    v_mfma_f32_16x16x32_bf16 v[20:23], a[16:19], v[80:83], v[20:23]
    v_mfma_f32_16x16x32_bf16 v[24:27], a[20:23], v[80:83], v[24:27]
    v_cvt_pk_bf16_f32 v90, v44, v45
    v_cvt_pk_bf16_f32 v91, v46, v47
    v_mfma_f32_16x16x32_bf16 v[28:31], a[12:15], v[84:87], v[28:31]
    v_mfma_f32_16x16x32_bf16 v[32:35], a[16:19], v[84:87], v[32:35]
    buffer_store_dwordx4 v[88:91], v9, s[16:19], s26 offen sc1
    v_mfma_f32_16x16x32_bf16 v[36:39], a[20:23], v[84:87], v[36:39]
    ds_read_b128 v[80:83], v112 offset:256
    ds_read_b128 v[84:87], v112 offset:20736
    s_waitcnt lgkmcnt(4)
    v_mfma_f32_16x16x32_bf16 v[16:19], a[24:27], v[64:67], v[16:19]
    v_cvt_pk_bf16_f32 v92, v48, v49
    v_cvt_pk_bf16_f32 v93, v50, v51
    v_mfma_f32_16x16x32_bf16 v[20:23], a[28:31], v[64:67], v[20:23]
    v_mfma_f32_16x16x32_bf16 v[24:27], a[32:35], v[64:67], v[24:27]
    buffer_store_dwordx2 v[92:93], v10, s[16:19], s26 offen sc1
    v_mfma_f32_16x16x32_bf16 v[28:31], a[24:27], v[68:71], v[28:31]
    v_mfma_f32_16x16x32_bf16 v[32:35], a[28:31], v[68:71], v[32:35]
    v_cvt_pk_bf16_f32 v94, v52, v53
    v_cvt_pk_bf16_f32 v95, v54, v55
    v_mfma_f32_16x16x32_bf16 v[36:39], a[32:35], v[68:71], v[36:39]
    ds_read_b128 v[64:67], v113 offset:256
    ds_read_b128 v[68:71], v113 offset:20736
    s_waitcnt lgkmcnt(4)
    v_mfma_f32_16x16x32_bf16 v[16:19], a[36:39], v[72:75], v[16:19]
    v_cvt_pk_bf16_f32 v96, v56, v57
    v_cvt_pk_bf16_f32 v97, v58, v59
    v_mfma_f32_16x16x32_bf16 v[20:23], a[40:43], v[72:75], v[20:23]
    v_mfma_f32_16x16x32_bf16 v[24:27], a[44:47], v[72:75], v[24:27]
    s_add_u32 s39, s26, 6144
    buffer_store_dwordx4 v[94:97], v9, s[16:19], s39 offen sc1
    v_mfma_f32_16x16x32_bf16 v[28:31], a[36:39], v[76:79], v[28:31]
    v_mfma_f32_16x16x32_bf16 v[32:35], a[40:43], v[76:79], v[32:35]
    v_cvt_pk_bf16_f32 v98, v60, v61
    v_cvt_pk_bf16_f32 v99, v62, v63
    v_mfma_f32_16x16x32_bf16 v[36:39], a[44:47], v[76:79], v[36:39]
    ds_read_b128 v[72:75], v114 offset:256
    ds_read_b128 v[76:79], v114 offset:20736
    s_waitcnt lgkmcnt(4)
    v_mfma_f32_16x16x32_bf16 v[16:19], a[48:51], v[80:83], v[16:19]
    buffer_store_dwordx2 v[98:99], v10, s[16:19], s39 offen sc1
    v_mfma_f32_16x16x32_bf16 v[20:23], a[52:55], v[80:83], v[20:23]
    v_mfma_f32_16x16x32_bf16 v[24:27], a[56:59], v[80:83], v[24:27]
    v_mfma_f32_16x16x32_bf16 v[28:31], a[48:51], v[84:87], v[28:31]
    v_mfma_f32_16x16x32_bf16 v[32:35], a[52:55], v[84:87], v[32:35]
    v_mfma_f32_16x16x32_bf16 v[36:39], a[56:59], v[84:87], v[36:39]
    ds_read_b128 v[80:83], v115 offset:256
    ds_read_b128 v[84:87], v115 offset:20736
    s_waitcnt lgkmcnt(4)
    v_mfma_f32_16x16x32_bf16 v[16:19], a[60:63], v[64:67], v[16:19]
    v_mfma_f32_16x16x32_bf16 v[20:23], a[64:67], v[64:67], v[20:23]
    v_mfma_f32_16x16x32_bf16 v[24:27], a[68:71], v[64:67], v[24:27]
    v_mfma_f32_16x16x32_bf16 v[28:31], a[60:63], v[68:71], v[28:31]
    v_mfma_f32_16x16x32_bf16 v[32:35], a[64:67], v[68:71], v[32:35]
    v_mfma_f32_16x16x32_bf16 v[36:39], a[68:71], v[68:71], v[36:39]
    ds_read_b128 v[64:67], v112 offset:512
    ds_read_b128 v[68:71], v112 offset:20992
    s_waitcnt lgkmcnt(4)
    v_mfma_f32_16x16x32_bf16 v[16:19], a[72:75], v[72:75], v[16:19]
    v_mfma_f32_16x16x32_bf16 v[20:23], a[76:79], v[72:75], v[20:23]
    v_mfma_f32_16x16x32_bf16 v[24:27], a[80:83], v[72:75], v[24:27]
    v_mfma_f32_16x16x32_bf16 v[28:31], a[72:75], v[76:79], v[28:31]
    v_mfma_f32_16x16x32_bf16 v[32:35], a[76:79], v[76:79], v[32:35]
    v_mfma_f32_16x16x32_bf16 v[36:39], a[80:83], v[76:79], v[36:39]
    ds_read_b128 v[72:75], v113 offset:512
    ds_read_b128 v[76:79], v113 offset:20992
    s_waitcnt lgkmcnt(4)
    v_mfma_f32_16x16x32_bf16 v[16:19], a[84:87], v[80:83], v[16:19]
    v_mfma_f32_16x16x32_bf16 v[20:23], a[88:91], v[80:83], v[20:23]
    v_mfma_f32_16x16x32_bf16 v[24:27], a[92:95], v[80:83], v[24:27]
    v_mfma_f32_16x16x32_bf16 v[28:31], a[84:87], v[84:87], v[28:31]
    v_mfma_f32_16x16x32_bf16 v[32:35], a[88:91], v[84:87], v[32:35]
    v_mfma_f32_16x16x32_bf16 v[36:39], a[92:95], v[84:87], v[36:39]
    ds_read_b128 v[80:83], v114 offset:512
    ds_read_b128 v[84:87], v114 offset:20992
    s_waitcnt lgkmcnt(4)
    v_mfma_f32_16x16x32_bf16 v[16:19], a[96:99], v[64:67], v[16:19]
    v_mfma_f32_16x16x32_bf16 v[20:23], a[100:103], v[64:67], v[20:23]
    v_mfma_f32_16x16x32_bf16 v[24:27], a[104:107], v[64:67], v[24:27]
    v_mfma_f32_16x16x32_bf16 v[28:31], a[96:99], v[68:71], v[28:31]
    v_mfma_f32_16x16x32_bf16 v[32:35], a[100:103], v[68:71], v[32:35]
    v_mfma_f32_16x16x32_bf16 v[36:39], a[104:107], v[68:71], v[36:39]
    ds_read_b128 v[64:67], v115 offset:512
    ds_read_b128 v[68:71], v115 offset:20992
    s_waitcnt lgkmcnt(4)
    v_mfma_f32_16x16x32_bf16 v[16:19], a[108:111], v[72:75], v[16:19]
    v_mfma_f32_16x16x32_bf16 v[20:23], a[112:115], v[72:75], v[20:23]
    v_mfma_f32_16x16x32_bf16 v[24:27], a[116:119], v[72:75], v[24:27]
    v_mfma_f32_16x16x32_bf16 v[28:31], a[108:111], v[76:79], v[28:31]
    v_mfma_f32_16x16x32_bf16 v[32:35], a[112:115], v[76:79], v[32:35]
    v_mfma_f32_16x16x32_bf16 v[36:39], a[116:119], v[76:79], v[36:39]
    ds_read_b128 v[72:75], v112 offset:768
    ds_read_b128 v[76:79], v112 offset:21248
    s_waitcnt vmcnt(4)
    s_barrier
    s_add_u32 s35, s29, s33
    s_sub_u32 s30, s38, 1
    v_mov_b32 v14, s30
    buffer_store_dword v14, v2, s[16:19], s40 offen sc1
    s_waitcnt lgkmcnt(4)
    v_mfma_f32_16x16x32_bf16 v[16:19], a[120:123], v[80:83], v[16:19]
    v_mfma_f32_16x16x32_bf16 v[20:23], a[124:127], v[80:83], v[20:23]
    s_mov_b32 m0, s35
    s_add_u32 s35, s35, 1024
    buffer_load_dwordx4 v100, s[8:11], s28 offen lds
    v_mfma_f32_16x16x32_bf16 v[24:27], a[128:131], v[80:83], v[24:27]
    v_mfma_f32_16x16x32_bf16 v[28:31], a[120:123], v[84:87], v[28:31]
    v_mfma_f32_16x16x32_bf16 v[32:35], a[124:127], v[84:87], v[32:35]
    v_mfma_f32_16x16x32_bf16 v[36:39], a[128:131], v[84:87], v[36:39]
    ds_read_b128 v[80:83], v113 offset:768
    ds_read_b128 v[84:87], v113 offset:21248
    s_waitcnt lgkmcnt(4)
    v_mfma_f32_16x16x32_bf16 v[16:19], a[132:135], v[64:67], v[16:19]
    v_mfma_f32_16x16x32_bf16 v[20:23], a[136:139], v[64:67], v[20:23]
    s_mov_b32 m0, s35
    s_add_u32 s35, s35, 1024
    buffer_load_dwordx4 v101, s[8:11], s28 offen lds
    v_mfma_f32_16x16x32_bf16 v[24:27], a[140:143], v[64:67], v[24:27]
    v_mfma_f32_16x16x32_bf16 v[28:31], a[132:135], v[68:71], v[28:31]
    v_mfma_f32_16x16x32_bf16 v[32:35], a[136:139], v[68:71], v[32:35]
    v_mfma_f32_16x16x32_bf16 v[36:39], a[140:143], v[68:71], v[36:39]
    ds_read_b128 v[64:67], v114 offset:768
    ds_read_b128 v[68:71], v114 offset:21248
    s_waitcnt lgkmcnt(4)
    v_mfma_f32_16x16x32_bf16 v[16:19], a[144:147], v[72:75], v[16:19]
    v_mfma_f32_16x16x32_bf16 v[20:23], a[148:151], v[72:75], v[20:23]
    s_mov_b32 m0, s35
    s_add_u32 s35, s35, 1024
    buffer_load_dwordx4 v102, s[8:11], s28 offen lds
    v_mfma_f32_16x16x32_bf16 v[24:27], a[152:155], v[72:75], v[24:27]
    v_mfma_f32_16x16x32_bf16 v[28:31], a[144:147], v[76:79], v[28:31]
    v_mfma_f32_16x16x32_bf16 v[32:35], a[148:151], v[76:79], v[32:35]
    v_mfma_f32_16x16x32_bf16 v[36:39], a[152:155], v[76:79], v[36:39]
    ds_read_b128 v[72:75], v115 offset:768
    ds_read_b128 v[76:79], v115 offset:21248
    s_waitcnt lgkmcnt(4)
    v_mfma_f32_16x16x32_bf16 v[16:19], a[156:159], v[80:83], v[16:19]
    v_mfma_f32_16x16x32_bf16 v[20:23], a[160:163], v[80:83], v[20:23]
    s_mov_b32 m0, s35
    s_add_u32 s35, s35, 1024
    buffer_load_dwordx4 v103, s[8:11], s28 offen lds
    v_mfma_f32_16x16x32_bf16 v[24:27], a[164:167], v[80:83], v[24:27]
    v_mfma_f32_16x16x32_bf16 v[28:31], a[156:159], v[84:87], v[28:31]
    v_mfma_f32_16x16x32_bf16 v[32:35], a[160:163], v[84:87], v[32:35]
    v_mfma_f32_16x16x32_bf16 v[36:39], a[164:167], v[84:87], v[36:39]
    ds_read_b128 v[80:83], v112 offset:1024
    ds_read_b128 v[84:87], v112 offset:21504
    s_waitcnt lgkmcnt(4)
    v_mfma_f32_16x16x32_bf16 v[16:19], a[168:171], v[64:67], v[16:19]
    v_mfma_f32_16x16x32_bf16 v[20:23], a[172:175], v[64:67], v[20:23]
    s_mov_b32 m0, s35
    s_add_u32 s35, s35, 1024
    buffer_load_dwordx4 v104, s[8:11], s28 offen lds
    v_mfma_f32_16x16x32_bf16 v[24:27], a[176:179], v[64:67], v[24:27]
    v_mfma_f32_16x16x32_bf16 v[28:31], a[168:171], v[68:71], v[28:31]
    v_mfma_f32_16x16x32_bf16 v[32:35], a[172:175], v[68:71], v[32:35]
    v_mfma_f32_16x16x32_bf16 v[36:39], a[176:179], v[68:71], v[36:39]
    ds_read_b128 v[64:67], v113 offset:1024
    ds_read_b128 v[68:71], v113 offset:21504
    s_waitcnt lgkmcnt(4)
    v_mfma_f32_16x16x32_bf16 v[16:19], a[180:183], v[72:75], v[16:19]
    v_mfma_f32_16x16x32_bf16 v[20:23], a[184:187], v[72:75], v[20:23]
    s_mov_b32 m0, s35
    s_add_u32 s35, s35, 1024
    buffer_load_dwordx4 v105, s[8:11], s28 offen lds
    v_mfma_f32_16x16x32_bf16 v[24:27], a[188:191], v[72:75], v[24:27]
    v_mfma_f32_16x16x32_bf16 v[28:31], a[180:183], v[76:79], v[28:31]
    v_mfma_f32_16x16x32_bf16 v[32:35], a[184:187], v[76:79], v[32:35]
    v_mfma_f32_16x16x32_bf16 v[36:39], a[188:191], v[76:79], v[36:39]
    ds_read_b128 v[72:75], v114 offset:1024
    ds_read_b128 v[76:79], v114 offset:21504
    s_waitcnt lgkmcnt(4)
    v_mfma_f32_16x16x32_bf16 v[16:19], a[192:195], v[80:83], v[16:19]
    v_mfma_f32_16x16x32_bf16 v[20:23], a[196:199], v[80:83], v[20:23]
    s_mov_b32 m0, s35
    s_add_u32 s35, s35, 1024
    buffer_load_dwordx4 v106, s[8:11], s28 offen lds
    v_mfma_f32_16x16x32_bf16 v[24:27], a[200:203], v[80:83], v[24:27]
    v_mfma_f32_16x16x32_bf16 v[28:31], a[192:195], v[84:87], v[28:31]
    v_mfma_f32_16x16x32_bf16 v[32:35], a[196:199], v[84:87], v[32:35]
    v_mfma_f32_16x16x32_bf16 v[36:39], a[200:203], v[84:87], v[36:39]
    ds_read_b128 v[80:83], v115 offset:1024
    ds_read_b128 v[84:87], v115 offset:21504
    s_waitcnt lgkmcnt(4)
    v_mfma_f32_16x16x32_bf16 v[16:19], a[204:207], v[64:67], v[16:19]
    v_mfma_f32_16x16x32_bf16 v[20:23], a[208:211], v[64:67], v[20:23]
    s_mov_b32 m0, s35
    s_add_u32 s35, s35, 1024
    buffer_load_dwordx4 v107, s[8:11], s28 offen lds
    v_mfma_f32_16x16x32_bf16 v[24:27], a[212:215], v[64:67], v[24:27]
    v_mfma_f32_16x16x32_bf16 v[28:31], a[204:207], v[68:71], v[28:31]
    v_mfma_f32_16x16x32_bf16 v[32:35], a[208:211], v[68:71], v[32:35]
    v_mfma_f32_16x16x32_bf16 v[36:39], a[212:215], v[68:71], v[36:39]
    ds_read_b128 v[64:67], v116 offset:0
    ds_read_b128 v[68:71], v116 offset:20480
    s_waitcnt lgkmcnt(4)
    v_mfma_f32_16x16x32_bf16 v[16:19], a[216:219], v[72:75], v[16:19]
    v_mfma_f32_16x16x32_bf16 v[20:23], a[220:223], v[72:75], v[20:23]
    s_mov_b32 m0, s35
    s_add_u32 s35, s35, 1024
    buffer_load_dwordx4 v108, s[8:11], s28 offen lds
    v_mfma_f32_16x16x32_bf16 v[24:27], a[224:227], v[72:75], v[24:27]
    v_mfma_f32_16x16x32_bf16 v[28:31], a[216:219], v[76:79], v[28:31]
    v_mfma_f32_16x16x32_bf16 v[32:35], a[220:223], v[76:79], v[32:35]
    v_mfma_f32_16x16x32_bf16 v[36:39], a[224:227], v[76:79], v[36:39]
    ds_read_b128 v[72:75], v117 offset:0
    ds_read_b128 v[76:79], v117 offset:20480
    s_cmp_gt_u32 s38, 2
    s_cbranch_scc1 PK_ef_48
    s_waitcnt vmcnt(10)
    v_mov_b32 v14, s38
    buffer_store_dword v14, v2, s[16:19], s40 offen sc1
PK_ef_48:
    s_waitcnt lgkmcnt(4)
    v_mfma_f32_16x16x32_bf16 v[16:19], a[228:231], v[80:83], v[16:19]
    v_mfma_f32_16x16x32_bf16 v[20:23], a[232:235], v[80:83], v[20:23]
    s_mov_b32 m0, s35
    s_add_u32 s35, s35, 1024
    buffer_load_dwordx4 v109, s[8:11], s28 offen lds
    v_mfma_f32_16x16x32_bf16 v[24:27], a[236:239], v[80:83], v[24:27]
    v_mfma_f32_16x16x32_bf16 v[28:31], a[228:231], v[84:87], v[28:31]
    v_mfma_f32_16x16x32_bf16 v[32:35], a[232:235], v[84:87], v[32:35]
    v_mfma_f32_16x16x32_bf16 v[36:39], a[236:239], v[84:87], v[36:39]
    s_add_u32 s28, s28, 40960
    s_add_u32 s29, s29, 40960
    s_cmp_eq_u32 s29, 122880
    s_cselect_b32 s29, 0, s29
    v_mov_b32 v112, v116
    v_add_u32 v116, s37, v120
    v_mov_b32 v113, v117
    v_add_u32 v117, s37, v121
    v_mov_b32 v114, v118
    v_add_u32 v118, s37, v122
    v_mov_b32 v115, v119
    v_add_u32 v119, s37, v123
    s_add_u32 s37, s37, 40960
    s_cmp_eq_u32 s37, 122880
    s_cselect_b32 s37, 0, s37
    s_add_u32 s26, s26, 393216
    s_add_u32 s38, s38, 1
    s_cmp_ge_u32 s38, s24
    s_cbranch_scc1 PK_fin0
    ds_read_b128 v[80:83], v114 offset:0
    ds_read_b128 v[84:87], v114 offset:20480
    s_waitcnt lgkmcnt(4)
    v_mfma_f32_16x16x32_bf16 v[40:43], a[0:3], v[64:67], 0
    v_mfma_f32_16x16x32_bf16 v[44:47], a[4:7], v[64:67], 0
    v_mfma_f32_16x16x32_bf16 v[48:51], a[8:11], v[64:67], 0
    v_mfma_f32_16x16x32_bf16 v[52:55], a[0:3], v[68:71], 0
    v_mfma_f32_16x16x32_bf16 v[56:59], a[4:7], v[68:71], 0
    v_mfma_f32_16x16x32_bf16 v[60:63], a[8:11], v[68:71], 0
    ds_read_b128 v[64:67], v115 offset:0
    ds_read_b128 v[68:71], v115 offset:20480
    s_waitcnt lgkmcnt(4)
    v_mfma_f32_16x16x32_bf16 v[40:43], a[12:15], v[72:75], v[40:43]
    v_cvt_pk_bf16_f32 v88, v16, v17
    v_cvt_pk_bf16_f32 v89, v18, v19
    v_mfma_f32_16x16x32_bf16 v[44:47], a[16:19], v[72:75], v[44:47]
    v_mfma_f32_16x16x32_bf16 v[48:51], a[20:23], v[72:75], v[48:51]
    v_cvt_pk_bf16_f32 v90, v20, v21
    v_cvt_pk_bf16_f32 v91, v22, v23
    v_mfma_f32_16x16x32_bf16 v[52:55], a[12:15], v[76:79], v[52:55]
    v_mfma_f32_16x16x32_bf16 v[56:59], a[16:19], v[76:79], v[56:59]
    buffer_store_dwordx4 v[88:91], v9, s[16:19], s26 offen sc1
    v_mfma_f32_16x16x32_bf16 v[60:63], a[20:23], v[76:79], v[60:63]
    ds_read_b128 v[72:75], v112 offset:256
    ds_read_b128 v[76:79], v112 offset:20736
    s_waitcnt lgkmcnt(4)
    v_mfma_f32_16x16x32_bf16 v[40:43], a[24:27], v[80:83], v[40:43]
    v_cvt_pk_bf16_f32 v92, v24, v25
    v_cvt_pk_bf16_f32 v93, v26, v27
    v_mfma_f32_16x16x32_bf16 v[44:47], a[28:31], v[80:83], v[44:47]
    v_mfma_f32_16x16x32_bf16 v[48:51], a[32:35], v[80:83], v[48:51]
    buffer_store_dwordx2 v[92:93], v10, s[16:19], s26 offen sc1
    v_mfma_f32_16x16x32_bf16 v[52:55], a[24:27], v[84:87], v[52:55]
    v_mfma_f32_16x16x32_bf16 v[56:59], a[28:31], v[84:87], v[56:59]
    v_cvt_pk_bf16_f32 v94, v28, v29
    v_cvt_pk_bf16_f32 v95, v30, v31
    v_mfma_f32_16x16x32_bf16 v[60:63], a[32:35], v[84:87], v[60:63]
    ds_read_b128 v[80:83], v113 offset:256
    ds_read_b128 v[84:87], v113 offset:20736
    s_waitcnt lgkmcnt(4)
    v_mfma_f32_16x16x32_bf16 v[40:43], a[36:39], v[64:67], v[40:43]
    v_cvt_pk_bf16_f32 v96, v32, v33
    v_cvt_pk_bf16_f32 v97, v34, v35
    v_mfma_f32_16x16x32_bf16 v[44:47], a[40:43], v[64:67], v[44:47]
    v_mfma_f32_16x16x32_bf16 v[48:51], a[44:47], v[64:67], v[48:51]
    s_add_u32 s39, s26, 6144
    buffer_store_dwordx4 v[94:97], v9, s[16:19], s39 offen sc1
    v_mfma_f32_16x16x32_bf16 v[52:55], a[36:39], v[68:71], v[52:55]
    v_mfma_f32_16x16x32_bf16 v[56:59], a[40:43], v[68:71], v[56:59]
    v_cvt_pk_bf16_f32 v98, v36, v37
    v_cvt_pk_bf16_f32 v99, v38, v39
    v_mfma_f32_16x16x32_bf16 v[60:63], a[44:47], v[68:71], v[60:63]
    ds_read_b128 v[64:67], v114 offset:256
    ds_read_b128 v[68:71], v114 offset:20736
    s_waitcnt lgkmcnt(4)
    v_mfma_f32_16x16x32_bf16 v[40:43], a[48:51], v[72:75], v[40:43]
    buffer_store_dwordx2 v[98:99], v10, s[16:19], s39 offen sc1
    v_mfma_f32_16x16x32_bf16 v[44:47], a[52:55], v[72:75], v[44:47]
    v_mfma_f32_16x16x32_bf16 v[48:51], a[56:59], v[72:75], v[48:51]
    v_mfma_f32_16x16x32_bf16 v[52:55], a[48:51], v[76:79], v[52:55]
    v_mfma_f32_16x16x32_bf16 v[56:59], a[52:55], v[76:79], v[56:59]
    v_mfma_f32_16x16x32_bf16 v[60:63], a[56:59], v[76:79], v[60:63]
    ds_read_b128 v[72:75], v115 offset:256
    ds_read_b128 v[76:79], v115 offset:20736
    s_waitcnt lgkmcnt(4)
    v_mfma_f32_16x16x32_bf16 v[40:43], a[60:63], v[80:83], v[40:43]
    v_mfma_f32_16x16x32_bf16 v[44:47], a[64:67], v[80:83], v[44:47]
    v_mfma_f32_16x16x32_bf16 v[48:51], a[68:71], v[80:83], v[48:51]
    v_mfma_f32_16x16x32_bf16 v[52:55], a[60:63], v[84:87], v[52:55]
    v_mfma_f32_16x16x32_bf16 v[56:59], a[64:67], v[84:87], v[56:59]
    v_mfma_f32_16x16x32_bf16 v[60:63], a[68:71], v[84:87], v[60:63]
    ds_read_b128 v[80:83], v112 offset:512
    ds_read_b128 v[84:87], v112 offset:20992
    s_waitcnt lgkmcnt(4)
    v_mfma_f32_16x16x32_bf16 v[40:43], a[72:75], v[64:67], v[40:43]
    v_mfma_f32_16x16x32_bf16 v[44:47], a[76:79], v[64:67], v[44:47]
    v_mfma_f32_16x16x32_bf16 v[48:51], a[80:83], v[64:67], v[48:51]
    v_mfma_f32_16x16x32_bf16 v[52:55], a[72:75], v[68:71], v[52:55]
    v_mfma_f32_16x16x32_bf16 v[56:59], a[76:79], v[68:71], v[56:59]
    v_mfma_f32_16x16x32_bf16 v[60:63], a[80:83], v[68:71], v[60:63]
    ds_read_b128 v[64:67], v113 offset:512
    ds_read_b128 v[68:71], v113 offset:20992
    s_waitcnt lgkmcnt(4)
    v_mfma_f32_16x16x32_bf16 v[40:43], a[84:87], v[72:75], v[40:43]
    v_mfma_f32_16x16x32_bf16 v[44:47], a[88:91], v[72:75], v[44:47]
    v_mfma_f32_16x16x32_bf16 v[48:51], a[92:95], v[72:75], v[48:51]
    v_mfma_f32_16x16x32_bf16 v[52:55], a[84:87], v[76:79], v[52:55]
    v_mfma_f32_16x16x32_bf16 v[56:59], a[88:91], v[76:79], v[56:59]
    v_mfma_f32_16x16x32_bf16 v[60:63], a[92:95], v[76:79], v[60:63]
    ds_read_b128 v[72:75], v114 offset:512
    ds_read_b128 v[76:79], v114 offset:20992
    s_waitcnt lgkmcnt(4)
    v_mfma_f32_16x16x32_bf16 v[40:43], a[96:99], v[80:83], v[40:43]
    v_mfma_f32_16x16x32_bf16 v[44:47], a[100:103], v[80:83], v[44:47]
    v_mfma_f32_16x16x32_bf16 v[48:51], a[104:107], v[80:83], v[48:51]
    v_mfma_f32_16x16x32_bf16 v[52:55], a[96:99], v[84:87], v[52:55]
    v_mfma_f32_16x16x32_bf16 v[56:59], a[100:103], v[84:87], v[56:59]
    v_mfma_f32_16x16x32_bf16 v[60:63], a[104:107], v[84:87], v[60:63]
    ds_read_b128 v[80:83], v115 offset:512
    ds_read_b128 v[84:87], v115 offset:20992
    s_waitcnt lgkmcnt(4)
    v_mfma_f32_16x16x32_bf16 v[40:43], a[108:111], v[64:67], v[40:43]
    v_mfma_f32_16x16x32_bf16 v[44:47], a[112:115], v[64:67], v[44:47]
    v_mfma_f32_16x16x32_bf16 v[48:51], a[116:119], v[64:67], v[48:51]
    v_mfma_f32_16x16x32_bf16 v[52:55], a[108:111], v[68:71], v[52:55]
    v_mfma_f32_16x16x32_bf16 v[56:59], a[112:115], v[68:71], v[56:59]
    v_mfma_f32_16x16x32_bf16 v[60:63], a[116:119], v[68:71], v[60:63]
    ds_read_b128 v[64:67], v112 offset:768
    ds_read_b128 v[68:71], v112 offset:21248
    s_waitcnt vmcnt(4)
    s_barrier
    s_add_u32 s35, s29, s33
    s_sub_u32 s30, s38, 1
    v_mov_b32 v14, s30
    buffer_store_dword v14, v2, s[16:19], s40 offen sc1
    s_waitcnt lgkmcnt(4)
    v_mfma_f32_16x16x32_bf16 v[40:43], a[120:123], v[72:75], v[40:43]
    v_mfma_f32_16x16x32_bf16 v[44:47], a[124:127], v[72:75], v[44:47]
    s_mov_b32 m0, s35
    s_add_u32 s35, s35, 1024
    buffer_load_dwordx4 v100, s[8:11], s28 offen lds
    v_mfma_f32_16x16x32_bf16 v[48:51], a[128:131], v[72:75], v[48:51]
    v_mfma_f32_16x16x32_bf16 v[52:55], a[120:123], v[76:79], v[52:55]
    v_mfma_f32_16x16x32_bf16 v[56:59], a[124:127], v[76:79], v[56:59]
    v_mfma_f32_16x16x32_bf16 v[60:63], a[128:131], v[76:79], v[60:63]
    ds_read_b128 v[72:75], v113 offset:768
    ds_read_b128 v[76:79], v113 offset:21248
    s_waitcnt lgkmcnt(4)
    v_mfma_f32_16x16x32_bf16 v[40:43], a[132:135], v[80:83], v[40:43]
    v_mfma_f32_16x16x32_bf16 v[44:47], a[136:139], v[80:83], v[44:47]
    s_mov_b32 m0, s35
    s_add_u32 s35, s35, 1024
    buffer_load_dwordx4 v101, s[8:11], s28 offen lds
    v_mfma_f32_16x16x32_bf16 v[48:51], a[140:143], v[80:83], v[48:51]
    v_mfma_f32_16x16x32_bf16 v[52:55], a[132:135], v[84:87], v[52:55]
    v_mfma_f32_16x16x32_bf16 v[56:59], a[136:139], v[84:87], v[56:59]
    v_mfma_f32_16x16x32_bf16 v[60:63], a[140:143], v[84:87], v[60:63]
    ds_read_b128 v[80:83], v114 offset:768
    ds_read_b128 v[84:87], v114 offset:21248
    s_waitcnt lgkmcnt(4)
    v_mfma_f32_16x16x32_bf16 v[40:43], a[144:147], v[64:67], v[40:43]
    v_mfma_f32_16x16x32_bf16 v[44:47], a[148:151], v[64:67], v[44:47]
    s_mov_b32 m0, s35
    s_add_u32 s35, s35, 1024
    buffer_load_dwordx4 v102, s[8:11], s28 offen lds
    v_mfma_f32_16x16x32_bf16 v[48:51], a[152:155], v[64:67], v[48:51]
    v_mfma_f32_16x16x32_bf16 v[52:55], a[144:147], v[68:71], v[52:55]
    v_mfma_f32_16x16x32_bf16 v[56:59], a[148:151], v[68:71], v[56:59]
    v_mfma_f32_16x16x32_bf16 v[60:63], a[152:155], v[68:71], v[60:63]
    ds_read_b128 v[64:67], v115 offset:768
    ds_read_b128 v[68:71], v115 offset:21248
    s_waitcnt lgkmcnt(4)
    v_mfma_f32_16x16x32_bf16 v[40:43], a[156:159], v[72:75], v[40:43]
    v_mfma_f32_16x16x32_bf16 v[44:47], a[160:163], v[72:75], v[44:47]
    s_mov_b32 m0, s35
    s_add_u32 s35, s35, 1024
    buffer_load_dwordx4 v103, s[8:11], s28 offen lds
    v_mfma_f32_16x16x32_bf16 v[48:51], a[164:167], v[72:75], v[48:51]
    v_mfma_f32_16x16x32_bf16 v[52:55], a[156:159], v[76:79], v[52:55]
    v_mfma_f32_16x16x32_bf16 v[56:59], a[160:163], v[76:79], v[56:59]
    v_mfma_f32_16x16x32_bf16 v[60:63], a[164:167], v[76:79], v[60:63]
    ds_read_b128 v[72:75], v112 offset:1024
    ds_read_b128 v[76:79], v112 offset:21504
    s_waitcnt lgkmcnt(4)
    v_mfma_f32_16x16x32_bf16 v[40:43], a[168:171], v[80:83], v[40:43]
    v_mfma_f32_16x16x32_bf16 v[44:47], a[172:175], v[80:83], v[44:47]
    s_mov_b32 m0, s35
    s_add_u32 s35, s35, 1024
    buffer_load_dwordx4 v104, s[8:11], s28 offen lds
    v_mfma_f32_16x16x32_bf16 v[48:51], a[176:179], v[80:83], v[48:51]
    v_mfma_f32_16x16x32_bf16 v[52:55], a[168:171], v[84:87], v[52:55]
    v_mfma_f32_16x16x32_bf16 v[56:59], a[172:175], v[84:87], v[56:59]
    v_mfma_f32_16x16x32_bf16 v[60:63], a[176:179], v[84:87], v[60:63]
    ds_read_b128 v[80:83], v113 offset:1024
    ds_read_b128 v[84:87], v113 offset:21504
    s_waitcnt lgkmcnt(4)
    v_mfma_f32_16x16x32_bf16 v[40:43], a[180:183], v[64:67], v[40:43]
    v_mfma_f32_16x16x32_bf16 v[44:47], a[184:187], v[64:67], v[44:47]
    s_mov_b32 m0, s35
    s_add_u32 s35, s35, 1024
    buffer_load_dwordx4 v105, s[8:11], s28 offen lds
    v_mfma_f32_16x16x32_bf16 v[48:51], a[188:191], v[64:67], v[48:51]
    v_mfma_f32_16x16x32_bf16 v[52:55], a[180:183], v[68:71], v[52:55]
    v_mfma_f32_16x16x32_bf16 v[56:59], a[184:187], v[68:71], v[56:59]
    v_mfma_f32_16x16x32_bf16 v[60:63], a[188:191], v[68:71], v[60:63]
    ds_read_b128 v[64:67], v114 offset:1024
    ds_read_b128 v[68:71], v114 offset:21504
    s_waitcnt lgkmcnt(4)
    v_mfma_f32_16x16x32_bf16 v[40:43], a[192:195], v[72:75], v[40:43]
    v_mfma_f32_16x16x32_bf16 v[44:47], a[196:199], v[72:75], v[44:47]
    s_mov_b32 m0, s35
    s_add_u32 s35, s35, 1024
    buffer_load_dwordx4 v106, s[8:11], s28 offen lds
    v_mfma_f32_16x16x32_bf16 v[48:51], a[200:203], v[72:75], v[48:51]
    v_mfma_f32_16x16x32_bf16 v[52:55], a[192:195], v[76:79], v[52:55]
    v_mfma_f32_16x16x32_bf16 v[56:59], a[196:199], v[76:79], v[56:59]
    v_mfma_f32_16x16x32_bf16 v[60:63], a[200:203], v[76:79], v[60:63]
    ds_read_b128 v[72:75], v115 offset:1024
    ds_read_b128 v[76:79], v115 offset:21504
    s_waitcnt lgkmcnt(4)
    v_mfma_f32_16x16x32_bf16 v[40:43], a[204:207], v[80:83], v[40:43]
    v_mfma_f32_16x16x32_bf16 v[44:47], a[208:211], v[80:83], v[44:47]
    s_mov_b32 m0, s35
    s_add_u32 s35, s35, 1024
    buffer_load_dwordx4 v107, s[8:11], s28 offen lds
    v_mfma_f32_16x16x32_bf16 v[48:51], a[212:215], v[80:83], v[48:51]
    v_mfma_f32_16x16x32_bf16 v[52:55], a[204:207], v[84:87], v[52:55]
    v_mfma_f32_16x16x32_bf16 v[56:59], a[208:211], v[84:87], v[56:59]
    v_mfma_f32_16x16x32_bf16 v[60:63], a[212:215], v[84:87], v[60:63]
    ds_read_b128 v[80:83], v116 offset:0
    ds_read_b128 v[84:87], v116 offset:20480
    s_waitcnt lgkmcnt(4)
    v_mfma_f32_16x16x32_bf16 v[40:43], a[216:219], v[64:67], v[40:43]
    v_mfma_f32_16x16x32_bf16 v[44:47], a[220:223], v[64:67], v[44:47]
    s_mov_b32 m0, s35
    s_add_u32 s35, s35, 1024
    buffer_load_dwordx4 v108, s[8:11], s28 offen lds
    v_mfma_f32_16x16x32_bf16 v[48:51], a[224:227], v[64:67], v[48:51]
    v_mfma_f32_16x16x32_bf16 v[52:55], a[216:219], v[68:71], v[52:55]
    v_mfma_f32_16x16x32_bf16 v[56:59], a[220:223], v[68:71], v[56:59]
    v_mfma_f32_16x16x32_bf16 v[60:63], a[224:227], v[68:71], v[60:63]
    ds_read_b128 v[64:67], v117 offset:0
    ds_read_b128 v[68:71], v117 offset:20480
    s_cmp_gt_u32 s38, 2
    s_cbranch_scc1 PK_ef_49
    s_waitcnt vmcnt(10)
    v_mov_b32 v14, s38
    buffer_store_dword v14, v2, s[16:19], s40 offen sc1
PK_ef_49:
    s_waitcnt lgkmcnt(4)
    v_mfma_f32_16x16x32_bf16 v[40:43], a[228:231], v[72:75], v[40:43]
    v_mfma_f32_16x16x32_bf16 v[44:47], a[232:235], v[72:75], v[44:47]
    s_mov_b32 m0, s35
    s_add_u32 s35, s35, 1024
    buffer_load_dwordx4 v109, s[8:11], s28 offen lds
    v_mfma_f32_16x16x32_bf16 v[48:51], a[236:239], v[72:75], v[48:51]
    v_mfma_f32_16x16x32_bf16 v[52:55], a[228:231], v[76:79], v[52:55]
    v_mfma_f32_16x16x32_bf16 v[56:59], a[232:235], v[76:79], v[56:59]
    v_mfma_f32_16x16x32_bf16 v[60:63], a[236:239], v[76:79], v[60:63]
    s_add_u32 s28, s28, 40960
    s_add_u32 s29, s29, 40960
    s_cmp_eq_u32 s29, 122880
    s_cselect_b32 s29, 0, s29
    v_mov_b32 v112, v116
    v_add_u32 v116, s37, v120
    v_mov_b32 v113, v117
    v_add_u32 v117, s37, v121
    v_mov_b32 v114, v118
    v_add_u32 v118, s37, v122
    v_mov_b32 v115, v119
    v_add_u32 v119, s37, v123
    s_add_u32 s37, s37, 40960
    s_cmp_eq_u32 s37, 122880
    s_cselect_b32 s37, 0, s37
    s_add_u32 s26, s26, 393216
    s_add_u32 s38, s38, 1
    s_cmp_ge_u32 s38, s24
    s_cbranch_scc1 PK_fin1
    ds_read_b128 v[72:75], v114 offset:0
    ds_read_b128 v[76:79], v114 offset:20480
    s_waitcnt lgkmcnt(4)
    v_mfma_f32_16x16x32_bf16 v[16:19], a[0:3], v[80:83], 0
    v_mfma_f32_16x16x32_bf16 v[20:23], a[4:7], v[80:83], 0
    v_mfma_f32_16x16x32_bf16 v[24:27], a[8:11], v[80:83], 0
    v_mfma_f32_16x16x32_bf16 v[28:31], a[0:3], v[84:87], 0
    v_mfma_f32_16x16x32_bf16 v[32:35], a[4:7], v[84:87], 0
    v_mfma_f32_16x16x32_bf16 v[36:39], a[8:11], v[84:87], 0
    ds_read_b128 v[80:83], v115 offset:0
    ds_read_b128 v[84:87], v115 offset:20480
    s_waitcnt lgkmcnt(4)
    v_mfma_f32_16x16x32_bf16 v[16:19], a[12:15], v[64:67], v[16:19]
    v_cvt_pk_bf16_f32 v88, v40, v41
    v_cvt_pk_bf16_f32 v89, v42, v43
    v_mfma_f32_16x16x32_bf16 v[20:23], a[16:19], v[64:67], v[20:23]
    v_mfma_f32_16x16x32_bf16 v[24:27], a[20:23], v[64:67], v[24:27]
    v_cvt_pk_bf16_f32 v90, v44, v45
    v_cvt_pk_bf16_f32 v91, v46, v47
    v_mfma_f32_16x16x32_bf16 v[28:31], a[12:15], v[68:71], v[28:31]
    v_mfma_f32_16x16x32_bf16 v[32:35], a[16:19], v[68:71], v[32:35]
    buffer_store_dwordx4 v[88:91], v9, s[16:19], s26 offen sc1
    v_mfma_f32_16x16x32_bf16 v[36:39], a[20:23], v[68:71], v[36:39]
    ds_read_b128 v[64:67], v112 offset:256
    ds_read_b128 v[68:71], v112 offset:20736
    s_waitcnt lgkmcnt(4)
    v_mfma_f32_16x16x32_bf16 v[16:19], a[24:27], v[72:75], v[16:19]
    v_cvt_pk_bf16_f32 v92, v48, v49
    v_cvt_pk_bf16_f32 v93, v50, v51
    v_mfma_f32_16x16x32_bf16 v[20:23], a[28:31], v[72:75], v[20:23]
    v_mfma_f32_16x16x32_bf16 v[24:27], a[32:35], v[72:75], v[24:27]
    buffer_store_dwordx2 v[92:93], v10, s[16:19], s26 offen sc1
    v_mfma_f32_16x16x32_bf16 v[28:31], a[24:27], v[76:79], v[28:31]
    v_mfma_f32_16x16x32_bf16 v[32:35], a[28:31], v[76:79], v[32:35]
    v_cvt_pk_bf16_f32 v94, v52, v53
    v_cvt_pk_bf16_f32 v95, v54, v55
    v_mfma_f32_16x16x32_bf16 v[36:39], a[32:35], v[76:79], v[36:39]
    ds_read_b128 v[72:75], v113 offset:256
    ds_read_b128 v[76:79], v113 offset:20736
    s_waitcnt lgkmcnt(4)
    v_mfma_f32_16x16x32_bf16 v[16:19], a[36:39], v[80:83], v[16:19]
    v_cvt_pk_bf16_f32 v96, v56, v57
    v_cvt_pk_bf16_f32 v97, v58, v59
    v_mfma_f32_16x16x32_bf16 v[20:23], a[40:43], v[80:83], v[20:23]
    v_mfma_f32_16x16x32_bf16 v[24:27], a[44:47], v[80:83], v[24:27]
    s_add_u32 s39, s26, 6144
    buffer_store_dwordx4 v[94:97], v9, s[16:19], s39 offen sc1
    v_mfma_f32_16x16x32_bf16 v[28:31], a[36:39], v[84:87], v[28:31]
    v_mfma_f32_16x16x32_bf16 v[32:35], a[40:43], v[84:87], v[32:35]
    v_cvt_pk_bf16_f32 v98, v60, v61
    v_cvt_pk_bf16_f32 v99, v62, v63
    v_mfma_f32_16x16x32_bf16 v[36:39], a[44:47], v[84:87], v[36:39]
    ds_read_b128 v[80:83], v114 offset:256
    ds_read_b128 v[84:87], v114 offset:20736
    s_waitcnt lgkmcnt(4)
    v_mfma_f32_16x16x32_bf16 v[16:19], a[48:51], v[64:67], v[16:19]
    buffer_store_dwordx2 v[98:99], v10, s[16:19], s39 offen sc1
    v_mfma_f32_16x16x32_bf16 v[20:23], a[52:55], v[64:67], v[20:23]
    v_mfma_f32_16x16x32_bf16 v[24:27], a[56:59], v[64:67], v[24:27]
    v_mfma_f32_16x16x32_bf16 v[28:31], a[48:51], v[68:71], v[28:31]
    v_mfma_f32_16x16x32_bf16 v[32:35], a[52:55], v[68:71], v[32:35]
    v_mfma_f32_16x16x32_bf16 v[36:39], a[56:59], v[68:71], v[36:39]
    ds_read_b128 v[64:67], v115 offset:256
    ds_read_b128 v[68:71], v115 offset:20736
    s_waitcnt lgkmcnt(4)
    v_mfma_f32_16x16x32_bf16 v[16:19], a[60:63], v[72:75], v[16:19]
    v_mfma_f32_16x16x32_bf16 v[20:23], a[64:67], v[72:75], v[20:23]
    v_mfma_f32_16x16x32_bf16 v[24:27], a[68:71], v[72:75], v[24:27]
    v_mfma_f32_16x16x32_bf16 v[28:31], a[60:63], v[76:79], v[28:31]
    v_mfma_f32_16x16x32_bf16 v[32:35], a[64:67], v[76:79], v[32:35]
    v_mfma_f32_16x16x32_bf16 v[36:39], a[68:71], v[76:79], v[36:39]
    ds_read_b128 v[72:75], v112 offset:512
    ds_read_b128 v[76:79], v112 offset:20992
    s_waitcnt lgkmcnt(4)
    v_mfma_f32_16x16x32_bf16 v[16:19], a[72:75], v[80:83], v[16:19]
    v_mfma_f32_16x16x32_bf16 v[20:23], a[76:79], v[80:83], v[20:23]
    v_mfma_f32_16x16x32_bf16 v[24:27], a[80:83], v[80:83], v[24:27]
    v_mfma_f32_16x16x32_bf16 v[28:31], a[72:75], v[84:87], v[28:31]
    v_mfma_f32_16x16x32_bf16 v[32:35], a[76:79], v[84:87], v[32:35]
    v_mfma_f32_16x16x32_bf16 v[36:39], a[80:83], v[84:87], v[36:39]
    ds_read_b128 v[80:83], v113 offset:512
    ds_read_b128 v[84:87], v113 offset:20992
    s_waitcnt lgkmcnt(4)
    v_mfma_f32_16x16x32_bf16 v[16:19], a[84:87], v[64:67], v[16:19]
    v_mfma_f32_16x16x32_bf16 v[20:23], a[88:91], v[64:67], v[20:23]
    v_mfma_f32_16x16x32_bf16 v[24:27], a[92:95], v[64:67], v[24:27]
    v_mfma_f32_16x16x32_bf16 v[28:31], a[84:87], v[68:71], v[28:31]
    v_mfma_f32_16x16x32_bf16 v[32:35], a[88:91], v[68:71], v[32:35]
    v_mfma_f32_16x16x32_bf16 v[36:39], a[92:95], v[68:71], v[36:39]
    ds_read_b128 v[64:67], v114 offset:512
    ds_read_b128 v[68:71], v114 offset:20992
    s_waitcnt lgkmcnt(4)
    v_mfma_f32_16x16x32_bf16 v[16:19], a[96:99], v[72:75], v[16:19]
    v_mfma_f32_16x16x32_bf16 v[20:23], a[100:103], v[72:75], v[20:23]
    v_mfma_f32_16x16x32_bf16 v[24:27], a[104:107], v[72:75], v[24:27]
    v_mfma_f32_16x16x32_bf16 v[28:31], a[96:99], v[76:79], v[28:31]
    v_mfma_f32_16x16x32_bf16 v[32:35], a[100:103], v[76:79], v[32:35]
    v_mfma_f32_16x16x32_bf16 v[36:39], a[104:107], v[76:79], v[36:39]
    ds_read_b128 v[72:75], v115 offset:512
    ds_read_b128 v[76:79], v115 offset:20992
    s_waitcnt lgkmcnt(4)
    v_mfma_f32_16x16x32_bf16 v[16:19], a[108:111], v[80:83], v[16:19]
    v_mfma_f32_16x16x32_bf16 v[20:23], a[112:115], v[80:83], v[20:23]
    v_mfma_f32_16x16x32_bf16 v[24:27], a[116:119], v[80:83], v[24:27]
    v_mfma_f32_16x16x32_bf16 v[28:31], a[108:111], v[84:87], v[28:31]
    v_mfma_f32_16x16x32_bf16 v[32:35], a[112:115], v[84:87], v[32:35]
    v_mfma_f32_16x16x32_bf16 v[36:39], a[116:119], v[84:87], v[36:39]
    ds_read_b128 v[80:83], v112 offset:768
    ds_read_b128 v[84:87], v112 offset:21248
    s_waitcnt vmcnt(4)
    s_barrier
    s_add_u32 s35, s29, s33
    s_sub_u32 s30, s38, 1
    v_mov_b32 v14, s30
    buffer_store_dword v14, v2, s[16:19], s40 offen sc1
    s_waitcnt lgkmcnt(4)
    v_mfma_f32_16x16x32_bf16 v[16:19], a[120:123], v[64:67], v[16:19]
    v_mfma_f32_16x16x32_bf16 v[20:23], a[124:127], v[64:67], v[20:23]
    s_mov_b32 m0, s35
    s_add_u32 s35, s35, 1024
    buffer_load_dwordx4 v100, s[8:11], s28 offen lds
    v_mfma_f32_16x16x32_bf16 v[24:27], a[128:131], v[64:67], v[24:27]
    v_mfma_f32_16x16x32_bf16 v[28:31], a[120:123], v[68:71], v[28:31]
    v_mfma_f32_16x16x32_bf16 v[32:35], a[124:127], v[68:71], v[32:35]
    v_mfma_f32_16x16x32_bf16 v[36:39], a[128:131], v[68:71], v[36:39]
    ds_read_b128 v[64:67], v113 offset:768
    ds_read_b128 v[68:71], v113 offset:21248
    s_waitcnt lgkmcnt(4)
    v_mfma_f32_16x16x32_bf16 v[16:19], a[132:135], v[72:75], v[16:19]
    v_mfma_f32_16x16x32_bf16 v[20:23], a[136:139], v[72:75], v[20:23]
    s_mov_b32 m0, s35
    s_add_u32 s35, s35, 1024
    buffer_load_dwordx4 v101, s[8:11], s28 offen lds
    v_mfma_f32_16x16x32_bf16 v[24:27], a[140:143], v[72:75], v[24:27]
    v_mfma_f32_16x16x32_bf16 v[28:31], a[132:135], v[76:79], v[28:31]
    v_mfma_f32_16x16x32_bf16 v[32:35], a[136:139], v[76:79], v[32:35]
    v_mfma_f32_16x16x32_bf16 v[36:39], a[140:143], v[76:79], v[36:39]
    ds_read_b128 v[72:75], v114 offset:768
    ds_read_b128 v[76:79], v114 offset:21248
    s_waitcnt lgkmcnt(4)
    v_mfma_f32_16x16x32_bf16 v[16:19], a[144:147], v[80:83], v[16:19]
    v_mfma_f32_16x16x32_bf16 v[20:23], a[148:151], v[80:83], v[20:23]
    s_mov_b32 m0, s35
    s_add_u32 s35, s35, 1024
    buffer_load_dwordx4 v102, s[8:11], s28 offen lds
    v_mfma_f32_16x16x32_bf16 v[24:27], a[152:155], v[80:83], v[24:27]
    v_mfma_f32_16x16x32_bf16 v[28:31], a[144:147], v[84:87], v[28:31]
    v_mfma_f32_16x16x32_bf16 v[32:35], a[148:151], v[84:87], v[32:35]
    v_mfma_f32_16x16x32_bf16 v[36:39], a[152:155], v[84:87], v[36:39]
    ds_read_b128 v[80:83], v115 offset:768
    ds_read_b128 v[84:87], v115 offset:21248
    s_waitcnt lgkmcnt(4)
    v_mfma_f32_16x16x32_bf16 v[16:19], a[156:159], v[64:67], v[16:19]
    v_mfma_f32_16x16x32_bf16 v[20:23], a[160:163], v[64:67], v[20:23]
    s_mov_b32 m0, s35
    s_add_u32 s35, s35, 1024
    buffer_load_dwordx4 v103, s[8:11], s28 offen lds
    v_mfma_f32_16x16x32_bf16 v[24:27], a[164:167], v[64:67], v[24:27]
    v_mfma_f32_16x16x32_bf16 v[28:31], a[156:159], v[68:71], v[28:31]
    v_mfma_f32_16x16x32_bf16 v[32:35], a[160:163], v[68:71], v[32:35]
    v_mfma_f32_16x16x32_bf16 v[36:39], a[164:167], v[68:71], v[36:39]
    ds_read_b128 v[64:67], v112 offset:1024
    ds_read_b128 v[68:71], v112 offset:21504
    s_waitcnt lgkmcnt(4)
    v_mfma_f32_16x16x32_bf16 v[16:19], a[168:171], v[72:75], v[16:19]
    v_mfma_f32_16x16x32_bf16 v[20:23], a[172:175], v[72:75], v[20:23]
    s_mov_b32 m0, s35
    s_add_u32 s35, s35, 1024
    buffer_load_dwordx4 v104, s[8:11], s28 offen lds
    v_mfma_f32_16x16x32_bf16 v[24:27], a[176:179], v[72:75], v[24:27]
    v_mfma_f32_16x16x32_bf16 v[28:31], a[168:171], v[76:79], v[28:31]
    v_mfma_f32_16x16x32_bf16 v[32:35], a[172:175], v[76:79], v[32:35]
    v_mfma_f32_16x16x32_bf16 v[36:39], a[176:179], v[76:79], v[36:39]
    ds_read_b128 v[72:75], v113 offset:1024
    ds_read_b128 v[76:79], v113 offset:21504
    s_waitcnt lgkmcnt(4)
    v_mfma_f32_16x16x32_bf16 v[16:19], a[180:183], v[80:83], v[16:19]
    v_mfma_f32_16x16x32_bf16 v[20:23], a[184:187], v[80:83], v[20:23]
    s_mov_b32 m0, s35
    s_add_u32 s35, s35, 1024
    buffer_load_dwordx4 v105, s[8:11], s28 offen lds
    v_mfma_f32_16x16x32_bf16 v[24:27], a[188:191], v[80:83], v[24:27]
    v_mfma_f32_16x16x32_bf16 v[28:31], a[180:183], v[84:87], v[28:31]
    v_mfma_f32_16x16x32_bf16 v[32:35], a[184:187], v[84:87], v[32:35]
    v_mfma_f32_16x16x32_bf16 v[36:39], a[188:191], v[84:87], v[36:39]
    ds_read_b128 v[80:83], v114 offset:1024
    ds_read_b128 v[84:87], v114 offset:21504
    s_waitcnt lgkmcnt(4)
    v_mfma_f32_16x16x32_bf16 v[16:19], a[192:195], v[64:67], v[16:19]
    v_mfma_f32_16x16x32_bf16 v[20:23], a[196:199], v[64:67], v[20:23]
    s_mov_b32 m0, s35
    s_add_u32 s35, s35, 1024
    buffer_load_dwordx4 v106, s[8:11], s28 offen lds
    v_mfma_f32_16x16x32_bf16 v[24:27], a[200:203], v[64:67], v[24:27]
    v_mfma_f32_16x16x32_bf16 v[28:31], a[192:195], v[68:71], v[28:31]
    v_mfma_f32_16x16x32_bf16 v[32:35], a[196:199], v[68:71], v[32:35]
    v_mfma_f32_16x16x32_bf16 v[36:39], a[200:203], v[68:71], v[36:39]
    ds_read_b128 v[64:67], v115 offset:1024
    ds_read_b128 v[68:71], v115 offset:21504
    s_waitcnt lgkmcnt(4)
    v_mfma_f32_16x16x32_bf16 v[16:19], a[204:207], v[72:75], v[16:19]
    v_mfma_f32_16x16x32_bf16 v[20:23], a[208:211], v[72:75], v[20:23]
    s_mov_b32 m0, s35
    s_add_u32 s35, s35, 1024
    buffer_load_dwordx4 v107, s[8:11], s28 offen lds
    v_mfma_f32_16x16x32_bf16 v[24:27], a[212:215], v[72:75], v[24:27]
    v_mfma_f32_16x16x32_bf16 v[28:31], a[204:207], v[76:79], v[28:31]
    v_mfma_f32_16x16x32_bf16 v[32:35], a[208:211], v[76:79], v[32:35]
    v_mfma_f32_16x16x32_bf16 v[36:39], a[212:215], v[76:79], v[36:39]
    ds_read_b128 v[72:75], v116 offset:0
    ds_read_b128 v[76:79], v116 offset:20480
    s_waitcnt lgkmcnt(4)
    v_mfma_f32_16x16x32_bf16 v[16:19], a[216:219], v[80:83], v[16:19]
    v_mfma_f32_16x16x32_bf16 v[20:23], a[220:223], v[80:83], v[20:23]
    s_mov_b32 m0, s35
    s_add_u32 s35, s35, 1024
    buffer_load_dwordx4 v108, s[8:11], s28 offen lds
    v_mfma_f32_16x16x32_bf16 v[24:27], a[224:227], v[80:83], v[24:27]
    v_mfma_f32_16x16x32_bf16 v[28:31], a[216:219], v[84:87], v[28:31]
    v_mfma_f32_16x16x32_bf16 v[32:35], a[220:223], v[84:87], v[32:35]
    v_mfma_f32_16x16x32_bf16 v[36:39], a[224:227], v[84:87], v[36:39]
    ds_read_b128 v[80:83], v117 offset:0
    ds_read_b128 v[84:87], v117 offset:20480
    s_cmp_gt_u32 s38, 2
    s_cbranch_scc1 PK_ef_50
    s_waitcnt vmcnt(10)
    v_mov_b32 v14, s38
    buffer_store_dword v14, v2, s[16:19], s40 offen sc1
PK_ef_50:
    s_waitcnt lgkmcnt(4)
    v_mfma_f32_16x16x32_bf16 v[16:19], a[228:231], v[64:67], v[16:19]
    v_mfma_f32_16x16x32_bf16 v[20:23], a[232:235], v[64:67], v[20:23]
    s_mov_b32 m0, s35
    s_add_u32 s35, s35, 1024
    buffer_load_dwordx4 v109, s[8:11], s28 offen lds
    v_mfma_f32_16x16x32_bf16 v[24:27], a[236:239], v[64:67], v[24:27]
    v_mfma_f32_16x16x32_bf16 v[28:31], a[228:231], v[68:71], v[28:31]
    v_mfma_f32_16x16x32_bf16 v[32:35], a[232:235], v[68:71], v[32:35]
    v_mfma_f32_16x16x32_bf16 v[36:39], a[236:239], v[68:71], v[36:39]
    s_add_u32 s28, s28, 40960
    s_add_u32 s29, s29, 40960
    s_cmp_eq_u32 s29, 122880
    s_cselect_b32 s29, 0, s29
    v_mov_b32 v112, v116
    v_add_u32 v116, s37, v120
    v_mov_b32 v113, v117
    v_add_u32 v117, s37, v121
    v_mov_b32 v114, v118
    v_add_u32 v118, s37, v122
    v_mov_b32 v115, v119
    v_add_u32 v119, s37, v123
    s_add_u32 s37, s37, 40960
    s_cmp_eq_u32 s37, 122880
    s_cselect_b32 s37, 0, s37
    s_add_u32 s26, s26, 393216
    s_add_u32 s38, s38, 1
    s_cmp_ge_u32 s38, s24
    s_cbranch_scc1 PK_fin0
    ds_read_b128 v[64:67], v114 offset:0
    ds_read_b128 v[68:71], v114 offset:20480
    s_waitcnt lgkmcnt(4)
    v_mfma_f32_16x16x32_bf16 v[40:43], a[0:3], v[72:75], 0
    v_mfma_f32_16x16x32_bf16 v[44:47], a[4:7], v[72:75], 0
    v_mfma_f32_16x16x32_bf16 v[48:51], a[8:11], v[72:75], 0
    v_mfma_f32_16x16x32_bf16 v[52:55], a[0:3], v[76:79], 0
    v_mfma_f32_16x16x32_bf16 v[56:59], a[4:7], v[76:79], 0
    v_mfma_f32_16x16x32_bf16 v[60:63], a[8:11], v[76:79], 0
    ds_read_b128 v[72:75], v115 offset:0
    ds_read_b128 v[76:79], v115 offset:20480
    s_waitcnt lgkmcnt(4)
    v_mfma_f32_16x16x32_bf16 v[40:43], a[12:15], v[80:83], v[40:43]
    v_cvt_pk_bf16_f32 v88, v16, v17
    v_cvt_pk_bf16_f32 v89, v18, v19
    v_mfma_f32_16x16x32_bf16 v[44:47], a[16:19], v[80:83], v[44:47]
    v_mfma_f32_16x16x32_bf16 v[48:51], a[20:23], v[80:83], v[48:51]
    v_cvt_pk_bf16_f32 v90, v20, v21
    v_cvt_pk_bf16_f32 v91, v22, v23
    v_mfma_f32_16x16x32_bf16 v[52:55], a[12:15], v[84:87], v[52:55]
    v_mfma_f32_16x16x32_bf16 v[56:59], a[16:19], v[84:87], v[56:59]
    buffer_store_dwordx4 v[88:91], v9, s[16:19], s26 offen sc1
    v_mfma_f32_16x16x32_bf16 v[60:63], a[20:23], v[84:87], v[60:63]
    ds_read_b128 v[80:83], v112 offset:256
    ds_read_b128 v[84:87], v112 offset:20736
    s_waitcnt lgkmcnt(4)
    v_mfma_f32_16x16x32_bf16 v[40:43], a[24:27], v[64:67], v[40:43]
    v_cvt_pk_bf16_f32 v92, v24, v25
    v_cvt_pk_bf16_f32 v93, v26, v27
    v_mfma_f32_16x16x32_bf16 v[44:47], a[28:31], v[64:67], v[44:47]
    v_mfma_f32_16x16x32_bf16 v[48:51], a[32:35], v[64:67], v[48:51]
    buffer_store_dwordx2 v[92:93], v10, s[16:19], s26 offen sc1
    v_mfma_f32_16x16x32_bf16 v[52:55], a[24:27], v[68:71], v[52:55]
    v_mfma_f32_16x16x32_bf16 v[56:59], a[28:31], v[68:71], v[56:59]
    v_cvt_pk_bf16_f32 v94, v28, v29
    v_cvt_pk_bf16_f32 v95, v30, v31
    v_mfma_f32_16x16x32_bf16 v[60:63], a[32:35], v[68:71], v[60:63]
    ds_read_b128 v[64:67], v113 offset:256
    ds_read_b128 v[68:71], v113 offset:20736
    s_waitcnt lgkmcnt(4)
    v_mfma_f32_16x16x32_bf16 v[40:43], a[36:39], v[72:75], v[40:43]
    v_cvt_pk_bf16_f32 v96, v32, v33
    v_cvt_pk_bf16_f32 v97, v34, v35
    v_mfma_f32_16x16x32_bf16 v[44:47], a[40:43], v[72:75], v[44:47]
    v_mfma_f32_16x16x32_bf16 v[48:51], a[44:47], v[72:75], v[48:51]
    s_add_u32 s39, s26, 6144
    buffer_store_dwordx4 v[94:97], v9, s[16:19], s39 offen sc1
    v_mfma_f32_16x16x32_bf16 v[52:55], a[36:39], v[76:79], v[52:55]
    v_mfma_f32_16x16x32_bf16 v[56:59], a[40:43], v[76:79], v[56:59]
    v_cvt_pk_bf16_f32 v98, v36, v37
    v_cvt_pk_bf16_f32 v99, v38, v39
    v_mfma_f32_16x16x32_bf16 v[60:63], a[44:47], v[76:79], v[60:63]
    ds_read_b128 v[72:75], v114 offset:256
    ds_read_b128 v[76:79], v114 offset:20736
    s_waitcnt lgkmcnt(4)
    v_mfma_f32_16x16x32_bf16 v[40:43], a[48:51], v[80:83], v[40:43]
    buffer_store_dwordx2 v[98:99], v10, s[16:19], s39 offen sc1
    v_mfma_f32_16x16x32_bf16 v[44:47], a[52:55], v[80:83], v[44:47]
    v_mfma_f32_16x16x32_bf16 v[48:51], a[56:59], v[80:83], v[48:51]
    v_mfma_f32_16x16x32_bf16 v[52:55], a[48:51], v[84:87], v[52:55]
    v_mfma_f32_16x16x32_bf16 v[56:59], a[52:55], v[84:87], v[56:59]
    v_mfma_f32_16x16x32_bf16 v[60:63], a[56:59], v[84:87], v[60:63]
    ds_read_b128 v[80:83], v115 offset:256
    ds_read_b128 v[84:87], v115 offset:20736
    s_waitcnt lgkmcnt(4)
    v_mfma_f32_16x16x32_bf16 v[40:43], a[60:63], v[64:67], v[40:43]
    v_mfma_f32_16x16x32_bf16 v[44:47], a[64:67], v[64:67], v[44:47]
    v_mfma_f32_16x16x32_bf16 v[48:51], a[68:71], v[64:67], v[48:51]
    v_mfma_f32_16x16x32_bf16 v[52:55], a[60:63], v[68:71], v[52:55]
    v_mfma_f32_16x16x32_bf16 v[56:59], a[64:67], v[68:71], v[56:59]
    v_mfma_f32_16x16x32_bf16 v[60:63], a[68:71], v[68:71], v[60:63]
    ds_read_b128 v[64:67], v112 offset:512
    ds_read_b128 v[68:71], v112 offset:20992
    s_waitcnt lgkmcnt(4)
    v_mfma_f32_16x16x32_bf16 v[40:43], a[72:75], v[72:75], v[40:43]
    v_mfma_f32_16x16x32_bf16 v[44:47], a[76:79], v[72:75], v[44:47]
    v_mfma_f32_16x16x32_bf16 v[48:51], a[80:83], v[72:75], v[48:51]
    v_mfma_f32_16x16x32_bf16 v[52:55], a[72:75], v[76:79], v[52:55]
    v_mfma_f32_16x16x32_bf16 v[56:59], a[76:79], v[76:79], v[56:59]
    v_mfma_f32_16x16x32_bf16 v[60:63], a[80:83], v[76:79], v[60:63]
    ds_read_b128 v[72:75], v113 offset:512
    ds_read_b128 v[76:79], v113 offset:20992
    s_waitcnt lgkmcnt(4)
    v_mfma_f32_16x16x32_bf16 v[40:43], a[84:87], v[80:83], v[40:43]
    v_mfma_f32_16x16x32_bf16 v[44:47], a[88:91], v[80:83], v[44:47]
    v_mfma_f32_16x16x32_bf16 v[48:51], a[92:95], v[80:83], v[48:51]
    v_mfma_f32_16x16x32_bf16 v[52:55], a[84:87], v[84:87], v[52:55]
    v_mfma_f32_16x16x32_bf16 v[56:59], a[88:91], v[84:87], v[56:59]
    v_mfma_f32_16x16x32_bf16 v[60:63], a[92:95], v[84:87], v[60:63]
    ds_read_b128 v[80:83], v114 offset:512
    ds_read_b128 v[84:87], v114 offset:20992
    s_waitcnt lgkmcnt(4)
    v_mfma_f32_16x16x32_bf16 v[40:43], a[96:99], v[64:67], v[40:43]
    v_mfma_f32_16x16x32_bf16 v[44:47], a[100:103], v[64:67], v[44:47]
    v_mfma_f32_16x16x32_bf16 v[48:51], a[104:107], v[64:67], v[48:51]
    v_mfma_f32_16x16x32_bf16 v[52:55], a[96:99], v[68:71], v[52:55]
    v_mfma_f32_16x16x32_bf16 v[56:59], a[100:103], v[68:71], v[56:59]
    v_mfma_f32_16x16x32_bf16 v[60:63], a[104:107], v[68:71], v[60:63]
    ds_read_b128 v[64:67], v115 offset:512
    ds_read_b128 v[68:71], v115 offset:20992
    s_waitcnt lgkmcnt(4)
    v_mfma_f32_16x16x32_bf16 v[40:43], a[108:111], v[72:75], v[40:43]
    v_mfma_f32_16x16x32_bf16 v[44:47], a[112:115], v[72:75], v[44:47]
    v_mfma_f32_16x16x32_bf16 v[48:51], a[116:119], v[72:75], v[48:51]
    v_mfma_f32_16x16x32_bf16 v[52:55], a[108:111], v[76:79], v[52:55]
    v_mfma_f32_16x16x32_bf16 v[56:59], a[112:115], v[76:79], v[56:59]
    v_mfma_f32_16x16x32_bf16 v[60:63], a[116:119], v[76:79], v[60:63]
    ds_read_b128 v[72:75], v112 offset:768
    ds_read_b128 v[76:79], v112 offset:21248
    s_waitcnt vmcnt(4)
    s_barrier
    s_add_u32 s35, s29, s33
    s_sub_u32 s30, s38, 1
    v_mov_b32 v14, s30
    buffer_store_dword v14, v2, s[16:19], s40 offen sc1
    s_waitcnt lgkmcnt(4)
    v_mfma_f32_16x16x32_bf16 v[40:43], a[120:123], v[80:83], v[40:43]
    v_mfma_f32_16x16x32_bf16 v[44:47], a[124:127], v[80:83], v[44:47]
    s_mov_b32 m0, s35
    s_add_u32 s35, s35, 1024
    buffer_load_dwordx4 v100, s[8:11], s28 offen lds
    v_mfma_f32_16x16x32_bf16 v[48:51], a[128:131], v[80:83], v[48:51]
    v_mfma_f32_16x16x32_bf16 v[52:55], a[120:123], v[84:87], v[52:55]
    v_mfma_f32_16x16x32_bf16 v[56:59], a[124:127], v[84:87], v[56:59]
    v_mfma_f32_16x16x32_bf16 v[60:63], a[128:131], v[84:87], v[60:63]
    ds_read_b128 v[80:83], v113 offset:768
    ds_read_b128 v[84:87], v113 offset:21248
    s_waitcnt lgkmcnt(4)
    v_mfma_f32_16x16x32_bf16 v[40:43], a[132:135], v[64:67], v[40:43]
    v_mfma_f32_16x16x32_bf16 v[44:47], a[136:139], v[64:67], v[44:47]
    s_mov_b32 m0, s35
    s_add_u32 s35, s35, 1024
    buffer_load_dwordx4 v101, s[8:11], s28 offen lds
    v_mfma_f32_16x16x32_bf16 v[48:51], a[140:143], v[64:67], v[48:51]
    v_mfma_f32_16x16x32_bf16 v[52:55], a[132:135], v[68:71], v[52:55]
    v_mfma_f32_16x16x32_bf16 v[56:59], a[136:139], v[68:71], v[56:59]
    v_mfma_f32_16x16x32_bf16 v[60:63], a[140:143], v[68:71], v[60:63]
    ds_read_b128 v[64:67], v114 offset:768
    ds_read_b128 v[68:71], v114 offset:21248
    s_waitcnt lgkmcnt(4)
    v_mfma_f32_16x16x32_bf16 v[40:43], a[144:147], v[72:75], v[40:43]
    v_mfma_f32_16x16x32_bf16 v[44:47], a[148:151], v[72:75], v[44:47]
    s_mov_b32 m0, s35
    s_add_u32 s35, s35, 1024
    buffer_load_dwordx4 v102, s[8:11], s28 offen lds
    v_mfma_f32_16x16x32_bf16 v[48:51], a[152:155], v[72:75], v[48:51]
    v_mfma_f32_16x16x32_bf16 v[52:55], a[144:147], v[76:79], v[52:55]
    v_mfma_f32_16x16x32_bf16 v[56:59], a[148:151], v[76:79], v[56:59]
    v_mfma_f32_16x16x32_bf16 v[60:63], a[152:155], v[76:79], v[60:63]
    ds_read_b128 v[72:75], v115 offset:768
    ds_read_b128 v[76:79], v115 offset:21248
    s_waitcnt lgkmcnt(4)
    v_mfma_f32_16x16x32_bf16 v[40:43], a[156:159], v[80:83], v[40:43]
    v_mfma_f32_16x16x32_bf16 v[44:47], a[160:163], v[80:83], v[44:47]
    s_mov_b32 m0, s35
    s_add_u32 s35, s35, 1024
    buffer_load_dwordx4 v103, s[8:11], s28 offen lds
    v_mfma_f32_16x16x32_bf16 v[48:51], a[164:167], v[80:83], v[48:51]
    v_mfma_f32_16x16x32_bf16 v[52:55], a[156:159], v[84:87], v[52:55]
    v_mfma_f32_16x16x32_bf16 v[56:59], a[160:163], v[84:87], v[56:59]
    v_mfma_f32_16x16x32_bf16 v[60:63], a[164:167], v[84:87], v[60:63]
    ds_read_b128 v[80:83], v112 offset:1024
    ds_read_b128 v[84:87], v112 offset:21504
    s_waitcnt lgkmcnt(4)
    v_mfma_f32_16x16x32_bf16 v[40:43], a[168:171], v[64:67], v[40:43]
    v_mfma_f32_16x16x32_bf16 v[44:47], a[172:175], v[64:67], v[44:47]
    s_mov_b32 m0, s35
    s_add_u32 s35, s35, 1024
    buffer_load_dwordx4 v104, s[8:11], s28 offen lds
    v_mfma_f32_16x16x32_bf16 v[48:51], a[176:179], v[64:67], v[48:51]
    v_mfma_f32_16x16x32_bf16 v[52:55], a[168:171], v[68:71], v[52:55]
    v_mfma_f32_16x16x32_bf16 v[56:59], a[172:175], v[68:71], v[56:59]
    v_mfma_f32_16x16x32_bf16 v[60:63], a[176:179], v[68:71], v[60:63]
    ds_read_b128 v[64:67], v113 offset:1024
    ds_read_b128 v[68:71], v113 offset:21504
    s_waitcnt lgkmcnt(4)
    v_mfma_f32_16x16x32_bf16 v[40:43], a[180:183], v[72:75], v[40:43]
    v_mfma_f32_16x16x32_bf16 v[44:47], a[184:187], v[72:75], v[44:47]
    s_mov_b32 m0, s35
    s_add_u32 s35, s35, 1024
    buffer_load_dwordx4 v105, s[8:11], s28 offen lds
    v_mfma_f32_16x16x32_bf16 v[48:51], a[188:191], v[72:75], v[48:51]
    v_mfma_f32_16x16x32_bf16 v[52:55], a[180:183], v[76:79], v[52:55]
    v_mfma_f32_16x16x32_bf16 v[56:59], a[184:187], v[76:79], v[56:59]
    v_mfma_f32_16x16x32_bf16 v[60:63], a[188:191], v[76:79], v[60:63]
    ds_read_b128 v[72:75], v114 offset:1024
    ds_read_b128 v[76:79], v114 offset:21504
    s_waitcnt lgkmcnt(4)
    v_mfma_f32_16x16x32_bf16 v[40:43], a[192:195], v[80:83], v[40:43]
    v_mfma_f32_16x16x32_bf16 v[44:47], a[196:199], v[80:83], v[44:47]
    s_mov_b32 m0, s35
    s_add_u32 s35, s35, 1024
    buffer_load_dwordx4 v106, s[8:11], s28 offen lds
    v_mfma_f32_16x16x32_bf16 v[48:51], a[200:203], v[80:83], v[48:51]
    v_mfma_f32_16x16x32_bf16 v[52:55], a[192:195], v[84:87], v[52:55]
    v_mfma_f32_16x16x32_bf16 v[56:59], a[196:199], v[84:87], v[56:59]
    v_mfma_f32_16x16x32_bf16 v[60:63], a[200:203], v[84:87], v[60:63]
    ds_read_b128 v[80:83], v115 offset:1024
    ds_read_b128 v[84:87], v115 offset:21504
    s_waitcnt lgkmcnt(4)
    v_mfma_f32_16x16x32_bf16 v[40:43], a[204:207], v[64:67], v[40:43]
    v_mfma_f32_16x16x32_bf16 v[44:47], a[208:211], v[64:67], v[44:47]
    s_mov_b32 m0, s35
    s_add_u32 s35, s35, 1024
    buffer_load_dwordx4 v107, s[8:11], s28 offen lds
    v_mfma_f32_16x16x32_bf16 v[48:51], a[212:215], v[64:67], v[48:51]
    v_mfma_f32_16x16x32_bf16 v[52:55], a[204:207], v[68:71], v[52:55]
    v_mfma_f32_16x16x32_bf16 v[56:59], a[208:211], v[68:71], v[56:59]
    v_mfma_f32_16x16x32_bf16 v[60:63], a[212:215], v[68:71], v[60:63]
    ds_read_b128 v[64:67], v116 offset:0
    ds_read_b128 v[68:71], v116 offset:20480
    s_waitcnt lgkmcnt(4)
    v_mfma_f32_16x16x32_bf16 v[40:43], a[216:219], v[72:75], v[40:43]
    v_mfma_f32_16x16x32_bf16 v[44:47], a[220:223], v[72:75], v[44:47]
    s_mov_b32 m0, s35
    s_add_u32 s35, s35, 1024
    buffer_load_dwordx4 v108, s[8:11], s28 offen lds
    v_mfma_f32_16x16x32_bf16 v[48:51], a[224:227], v[72:75], v[48:51]
    v_mfma_f32_16x16x32_bf16 v[52:55], a[216:219], v[76:79], v[52:55]
    v_mfma_f32_16x16x32_bf16 v[56:59], a[220:223], v[76:79], v[56:59]
    v_mfma_f32_16x16x32_bf16 v[60:63], a[224:227], v[76:79], v[60:63]
    ds_read_b128 v[72:75], v117 offset:0
    ds_read_b128 v[76:79], v117 offset:20480
    s_cmp_gt_u32 s38, 2
    s_cbranch_scc1 PK_ef_51
    s_waitcnt vmcnt(10)
    v_mov_b32 v14, s38
    buffer_store_dword v14, v2, s[16:19], s40 offen sc1
PK_ef_51:
    s_waitcnt lgkmcnt(4)
    v_mfma_f32_16x16x32_bf16 v[40:43], a[228:231], v[80:83], v[40:43]
    v_mfma_f32_16x16x32_bf16 v[44:47], a[232:235], v[80:83], v[44:47]
    s_mov_b32 m0, s35
    s_add_u32 s35, s35, 1024
    buffer_load_dwordx4 v109, s[8:11], s28 offen lds
    v_mfma_f32_16x16x32_bf16 v[48:51], a[236:239], v[80:83], v[48:51]
    v_mfma_f32_16x16x32_bf16 v[52:55], a[228:231], v[84:87], v[52:55]
    v_mfma_f32_16x16x32_bf16 v[56:59], a[232:235], v[84:87], v[56:59]
    v_mfma_f32_16x16x32_bf16 v[60:63], a[236:239], v[84:87], v[60:63]
    s_add_u32 s28, s28, 40960
    s_add_u32 s29, s29, 40960
    s_cmp_eq_u32 s29, 122880
    s_cselect_b32 s29, 0, s29
    v_mov_b32 v112, v116
    v_add_u32 v116, s37, v120
    v_mov_b32 v113, v117
    v_add_u32 v117, s37, v121
    v_mov_b32 v114, v118
    v_add_u32 v118, s37, v122
    v_mov_b32 v115, v119
    v_add_u32 v119, s37, v123
    s_add_u32 s37, s37, 40960
    s_cmp_eq_u32 s37, 122880
    s_cselect_b32 s37, 0, s37
    s_add_u32 s26, s26, 393216
    s_add_u32 s38, s38, 1
    s_cmp_ge_u32 s38, s24
    s_cbranch_scc1 PK_fin1
    ds_read_b128 v[80:83], v114 offset:0
    ds_read_b128 v[84:87], v114 offset:20480
    s_waitcnt lgkmcnt(4)
    v_mfma_f32_16x16x32_bf16 v[16:19], a[0:3], v[64:67], 0
    v_mfma_f32_16x16x32_bf16 v[20:23], a[4:7], v[64:67], 0
    v_mfma_f32_16x16x32_bf16 v[24:27], a[8:11], v[64:67], 0
    v_mfma_f32_16x16x32_bf16 v[28:31], a[0:3], v[68:71], 0
    v_mfma_f32_16x16x32_bf16 v[32:35], a[4:7], v[68:71], 0
    v_mfma_f32_16x16x32_bf16 v[36:39], a[8:11], v[68:71], 0
    ds_read_b128 v[64:67], v115 offset:0
    ds_read_b128 v[68:71], v115 offset:20480
    s_waitcnt lgkmcnt(4)
    v_mfma_f32_16x16x32_bf16 v[16:19], a[12:15], v[72:75], v[16:19]
    v_cvt_pk_bf16_f32 v88, v40, v41
    v_cvt_pk_bf16_f32 v89, v42, v43
    v_mfma_f32_16x16x32_bf16 v[20:23], a[16:19], v[72:75], v[20:23]
    v_mfma_f32_16x16x32_bf16 v[24:27], a[20:23], v[72:75], v[24:27]
    v_cvt_pk_bf16_f32 v90, v44, v45
    v_cvt_pk_bf16_f32 v91, v46, v47
    v_mfma_f32_16x16x32_bf16 v[28:31], a[12:15], v[76:79], v[28:31]
    v_mfma_f32_16x16x32_bf16 v[32:35], a[16:19], v[76:79], v[32:35]
    buffer_store_dwordx4 v[88:91], v9, s[16:19], s26 offen sc1
    v_mfma_f32_16x16x32_bf16 v[36:39], a[20:23], v[76:79], v[36:39]
    ds_read_b128 v[72:75], v112 offset:256
    ds_read_b128 v[76:79], v112 offset:20736
    s_waitcnt lgkmcnt(4)
    v_mfma_f32_16x16x32_bf16 v[16:19], a[24:27], v[80:83], v[16:19]
    v_cvt_pk_bf16_f32 v92, v48, v49
    v_cvt_pk_bf16_f32 v93, v50, v51
    v_mfma_f32_16x16x32_bf16 v[20:23], a[28:31], v[80:83], v[20:23]
    v_mfma_f32_16x16x32_bf16 v[24:27], a[32:35], v[80:83], v[24:27]
    buffer_store_dwordx2 v[92:93], v10, s[16:19], s26 offen sc1
    v_mfma_f32_16x16x32_bf16 v[28:31], a[24:27], v[84:87], v[28:31]
    v_mfma_f32_16x16x32_bf16 v[32:35], a[28:31], v[84:87], v[32:35]
    v_cvt_pk_bf16_f32 v94, v52, v53
    v_cvt_pk_bf16_f32 v95, v54, v55
    v_mfma_f32_16x16x32_bf16 v[36:39], a[32:35], v[84:87], v[36:39]
    ds_read_b128 v[80:83], v113 offset:256
    ds_read_b128 v[84:87], v113 offset:20736
    s_waitcnt lgkmcnt(4)
    v_mfma_f32_16x16x32_bf16 v[16:19], a[36:39], v[64:67], v[16:19]
    v_cvt_pk_bf16_f32 v96, v56, v57
    v_cvt_pk_bf16_f32 v97, v58, v59
    v_mfma_f32_16x16x32_bf16 v[20:23], a[40:43], v[64:67], v[20:23]
    v_mfma_f32_16x16x32_bf16 v[24:27], a[44:47], v[64:67], v[24:27]
    s_add_u32 s39, s26, 6144
    buffer_store_dwordx4 v[94:97], v9, s[16:19], s39 offen sc1
    v_mfma_f32_16x16x32_bf16 v[28:31], a[36:39], v[68:71], v[28:31]
    v_mfma_f32_16x16x32_bf16 v[32:35], a[40:43], v[68:71], v[32:35]
    v_cvt_pk_bf16_f32 v98, v60, v61
    v_cvt_pk_bf16_f32 v99, v62, v63
    v_mfma_f32_16x16x32_bf16 v[36:39], a[44:47], v[68:71], v[36:39]
    ds_read_b128 v[64:67], v114 offset:256
    ds_read_b128 v[68:71], v114 offset:20736
    s_waitcnt lgkmcnt(4)
    v_mfma_f32_16x16x32_bf16 v[16:19], a[48:51], v[72:75], v[16:19]
    buffer_store_dwordx2 v[98:99], v10, s[16:19], s39 offen sc1
    v_mfma_f32_16x16x32_bf16 v[20:23], a[52:55], v[72:75], v[20:23]
    v_mfma_f32_16x16x32_bf16 v[24:27], a[56:59], v[72:75], v[24:27]
    v_mfma_f32_16x16x32_bf16 v[28:31], a[48:51], v[76:79], v[28:31]
    v_mfma_f32_16x16x32_bf16 v[32:35], a[52:55], v[76:79], v[32:35]
    v_mfma_f32_16x16x32_bf16 v[36:39], a[56:59], v[76:79], v[36:39]
    ds_read_b128 v[72:75], v115 offset:256
    ds_read_b128 v[76:79], v115 offset:20736
    s_waitcnt lgkmcnt(4)
    v_mfma_f32_16x16x32_bf16 v[16:19], a[60:63], v[80:83], v[16:19]
    v_mfma_f32_16x16x32_bf16 v[20:23], a[64:67], v[80:83], v[20:23]
    v_mfma_f32_16x16x32_bf16 v[24:27], a[68:71], v[80:83], v[24:27]
    v_mfma_f32_16x16x32_bf16 v[28:31], a[60:63], v[84:87], v[28:31]
    v_mfma_f32_16x16x32_bf16 v[32:35], a[64:67], v[84:87], v[32:35]
    v_mfma_f32_16x16x32_bf16 v[36:39], a[68:71], v[84:87], v[36:39]
    ds_read_b128 v[80:83], v112 offset:512
    ds_read_b128 v[84:87], v112 offset:20992
    s_waitcnt lgkmcnt(4)
    v_mfma_f32_16x16x32_bf16 v[16:19], a[72:75], v[64:67], v[16:19]
    v_mfma_f32_16x16x32_bf16 v[20:23], a[76:79], v[64:67], v[20:23]
    v_mfma_f32_16x16x32_bf16 v[24:27], a[80:83], v[64:67], v[24:27]
    v_mfma_f32_16x16x32_bf16 v[28:31], a[72:75], v[68:71], v[28:31]
    v_mfma_f32_16x16x32_bf16 v[32:35], a[76:79], v[68:71], v[32:35]
    v_mfma_f32_16x16x32_bf16 v[36:39], a[80:83], v[68:71], v[36:39]
    ds_read_b128 v[64:67], v113 offset:512
    ds_read_b128 v[68:71], v113 offset:20992
    s_waitcnt lgkmcnt(4)
    v_mfma_f32_16x16x32_bf16 v[16:19], a[84:87], v[72:75], v[16:19]
    v_mfma_f32_16x16x32_bf16 v[20:23], a[88:91], v[72:75], v[20:23]
    v_mfma_f32_16x16x32_bf16 v[24:27], a[92:95], v[72:75], v[24:27]
    v_mfma_f32_16x16x32_bf16 v[28:31], a[84:87], v[76:79], v[28:31]
    v_mfma_f32_16x16x32_bf16 v[32:35], a[88:91], v[76:79], v[32:35]
    v_mfma_f32_16x16x32_bf16 v[36:39], a[92:95], v[76:79], v[36:39]
    ds_read_b128 v[72:75], v114 offset:512
    ds_read_b128 v[76:79], v114 offset:20992
    s_waitcnt lgkmcnt(4)
    v_mfma_f32_16x16x32_bf16 v[16:19], a[96:99], v[80:83], v[16:19]
    v_mfma_f32_16x16x32_bf16 v[20:23], a[100:103], v[80:83], v[20:23]
    v_mfma_f32_16x16x32_bf16 v[24:27], a[104:107], v[80:83], v[24:27]
    v_mfma_f32_16x16x32_bf16 v[28:31], a[96:99], v[84:87], v[28:31]
    v_mfma_f32_16x16x32_bf16 v[32:35], a[100:103], v[84:87], v[32:35]
    v_mfma_f32_16x16x32_bf16 v[36:39], a[104:107], v[84:87], v[36:39]
    ds_read_b128 v[80:83], v115 offset:512
    ds_read_b128 v[84:87], v115 offset:20992
    s_waitcnt lgkmcnt(4)
    v_mfma_f32_16x16x32_bf16 v[16:19], a[108:111], v[64:67], v[16:19]
    v_mfma_f32_16x16x32_bf16 v[20:23], a[112:115], v[64:67], v[20:23]
    v_mfma_f32_16x16x32_bf16 v[24:27], a[116:119], v[64:67], v[24:27]
    v_mfma_f32_16x16x32_bf16 v[28:31], a[108:111], v[68:71], v[28:31]
    v_mfma_f32_16x16x32_bf16 v[32:35], a[112:115], v[68:71], v[32:35]
    v_mfma_f32_16x16x32_bf16 v[36:39], a[116:119], v[68:71], v[36:39]
    ds_read_b128 v[64:67], v112 offset:768
    ds_read_b128 v[68:71], v112 offset:21248
    s_waitcnt vmcnt(4)
    s_barrier
    s_add_u32 s35, s29, s33
    s_sub_u32 s30, s38, 1
    v_mov_b32 v14, s30
    buffer_store_dword v14, v2, s[16:19], s40 offen sc1
    s_waitcnt lgkmcnt(4)
    v_mfma_f32_16x16x32_bf16 v[16:19], a[120:123], v[72:75], v[16:19]
    v_mfma_f32_16x16x32_bf16 v[20:23], a[124:127], v[72:75], v[20:23]
    s_mov_b32 m0, s35
    s_add_u32 s35, s35, 1024
    buffer_load_dwordx4 v100, s[8:11], s28 offen lds
    v_mfma_f32_16x16x32_bf16 v[24:27], a[128:131], v[72:75], v[24:27]
    v_mfma_f32_16x16x32_bf16 v[28:31], a[120:123], v[76:79], v[28:31]
    v_mfma_f32_16x16x32_bf16 v[32:35], a[124:127], v[76:79], v[32:35]
    v_mfma_f32_16x16x32_bf16 v[36:39], a[128:131], v[76:79], v[36:39]
    ds_read_b128 v[72:75], v113 offset:768
    ds_read_b128 v[76:79], v113 offset:21248
    s_waitcnt lgkmcnt(4)
    v_mfma_f32_16x16x32_bf16 v[16:19], a[132:135], v[80:83], v[16:19]
    v_mfma_f32_16x16x32_bf16 v[20:23], a[136:139], v[80:83], v[20:23]
    s_mov_b32 m0, s35
    s_add_u32 s35, s35, 1024
    buffer_load_dwordx4 v101, s[8:11], s28 offen lds
    v_mfma_f32_16x16x32_bf16 v[24:27], a[140:143], v[80:83], v[24:27]
    v_mfma_f32_16x16x32_bf16 v[28:31], a[132:135], v[84:87], v[28:31]
    v_mfma_f32_16x16x32_bf16 v[32:35], a[136:139], v[84:87], v[32:35]
    v_mfma_f32_16x16x32_bf16 v[36:39], a[140:143], v[84:87], v[36:39]
    ds_read_b128 v[80:83], v114 offset:768
    ds_read_b128 v[84:87], v114 offset:21248
    s_waitcnt lgkmcnt(4)
    v_mfma_f32_16x16x32_bf16 v[16:19], a[144:147], v[64:67], v[16:19]
    v_mfma_f32_16x16x32_bf16 v[20:23], a[148:151], v[64:67], v[20:23]
    s_mov_b32 m0, s35
    s_add_u32 s35, s35, 1024
    buffer_load_dwordx4 v102, s[8:11], s28 offen lds
    v_mfma_f32_16x16x32_bf16 v[24:27], a[152:155], v[64:67], v[24:27]
    v_mfma_f32_16x16x32_bf16 v[28:31], a[144:147], v[68:71], v[28:31]
    v_mfma_f32_16x16x32_bf16 v[32:35], a[148:151], v[68:71], v[32:35]
    v_mfma_f32_16x16x32_bf16 v[36:39], a[152:155], v[68:71], v[36:39]
    ds_read_b128 v[64:67], v115 offset:768
    ds_read_b128 v[68:71], v115 offset:21248
    s_waitcnt lgkmcnt(4)
    v_mfma_f32_16x16x32_bf16 v[16:19], a[156:159], v[72:75], v[16:19]
    v_mfma_f32_16x16x32_bf16 v[20:23], a[160:163], v[72:75], v[20:23]
    s_mov_b32 m0, s35
    s_add_u32 s35, s35, 1024
    buffer_load_dwordx4 v103, s[8:11], s28 offen lds
    v_mfma_f32_16x16x32_bf16 v[24:27], a[164:167], v[72:75], v[24:27]
    v_mfma_f32_16x16x32_bf16 v[28:31], a[156:159], v[76:79], v[28:31]
    v_mfma_f32_16x16x32_bf16 v[32:35], a[160:163], v[76:79], v[32:35]
    v_mfma_f32_16x16x32_bf16 v[36:39], a[164:167], v[76:79], v[36:39]
    ds_read_b128 v[72:75], v112 offset:1024
    ds_read_b128 v[76:79], v112 offset:21504
    s_waitcnt lgkmcnt(4)
    v_mfma_f32_16x16x32_bf16 v[16:19], a[168:171], v[80:83], v[16:19]
    v_mfma_f32_16x16x32_bf16 v[20:23], a[172:175], v[80:83], v[20:23]
    s_mov_b32 m0, s35
    s_add_u32 s35, s35, 1024
    buffer_load_dwordx4 v104, s[8:11], s28 offen lds
    v_mfma_f32_16x16x32_bf16 v[24:27], a[176:179], v[80:83], v[24:27]
    v_mfma_f32_16x16x32_bf16 v[28:31], a[168:171], v[84:87], v[28:31]
    v_mfma_f32_16x16x32_bf16 v[32:35], a[172:175], v[84:87], v[32:35]
    v_mfma_f32_16x16x32_bf16 v[36:39], a[176:179], v[84:87], v[36:39]
    ds_read_b128 v[80:83], v113 offset:1024
    ds_read_b128 v[84:87], v113 offset:21504
    s_waitcnt lgkmcnt(4)
    v_mfma_f32_16x16x32_bf16 v[16:19], a[180:183], v[64:67], v[16:19]
    v_mfma_f32_16x16x32_bf16 v[20:23], a[184:187], v[64:67], v[20:23]
    s_mov_b32 m0, s35
    s_add_u32 s35, s35, 1024
    buffer_load_dwordx4 v105, s[8:11], s28 offen lds
    v_mfma_f32_16x16x32_bf16 v[24:27], a[188:191], v[64:67], v[24:27]
    v_mfma_f32_16x16x32_bf16 v[28:31], a[180:183], v[68:71], v[28:31]
    v_mfma_f32_16x16x32_bf16 v[32:35], a[184:187], v[68:71], v[32:35]
    v_mfma_f32_16x16x32_bf16 v[36:39], a[188:191], v[68:71], v[36:39]
    ds_read_b128 v[64:67], v114 offset:1024
    ds_read_b128 v[68:71], v114 offset:21504
    s_waitcnt lgkmcnt(4)
    v_mfma_f32_16x16x32_bf16 v[16:19], a[192:195], v[72:75], v[16:19]
    v_mfma_f32_16x16x32_bf16 v[20:23], a[196:199], v[72:75], v[20:23]
    s_mov_b32 m0, s35
    s_add_u32 s35, s35, 1024
    buffer_load_dwordx4 v106, s[8:11], s28 offen lds
    v_mfma_f32_16x16x32_bf16 v[24:27], a[200:203], v[72:75], v[24:27]
    v_mfma_f32_16x16x32_bf16 v[28:31], a[192:195], v[76:79], v[28:31]
    v_mfma_f32_16x16x32_bf16 v[32:35], a[196:199], v[76:79], v[32:35]
    v_mfma_f32_16x16x32_bf16 v[36:39], a[200:203], v[76:79], v[36:39]
    ds_read_b128 v[72:75], v115 offset:1024
    ds_read_b128 v[76:79], v115 offset:21504
    s_waitcnt lgkmcnt(4)
    v_mfma_f32_16x16x32_bf16 v[16:19], a[204:207], v[80:83], v[16:19]
    v_mfma_f32_16x16x32_bf16 v[20:23], a[208:211], v[80:83], v[20:23]
    s_mov_b32 m0, s35
    s_add_u32 s35, s35, 1024
    buffer_load_dwordx4 v107, s[8:11], s28 offen lds
    v_mfma_f32_16x16x32_bf16 v[24:27], a[212:215], v[80:83], v[24:27]
    v_mfma_f32_16x16x32_bf16 v[28:31], a[204:207], v[84:87], v[28:31]
    v_mfma_f32_16x16x32_bf16 v[32:35], a[208:211], v[84:87], v[32:35]
    v_mfma_f32_16x16x32_bf16 v[36:39], a[212:215], v[84:87], v[36:39]
    ds_read_b128 v[80:83], v116 offset:0
    ds_read_b128 v[84:87], v116 offset:20480
    s_waitcnt lgkmcnt(4)
    v_mfma_f32_16x16x32_bf16 v[16:19], a[216:219], v[64:67], v[16:19]
    v_mfma_f32_16x16x32_bf16 v[20:23], a[220:223], v[64:67], v[20:23]
    s_mov_b32 m0, s35
    s_add_u32 s35, s35, 1024
    buffer_load_dwordx4 v108, s[8:11], s28 offen lds
    v_mfma_f32_16x16x32_bf16 v[24:27], a[224:227], v[64:67], v[24:27]
    v_mfma_f32_16x16x32_bf16 v[28:31], a[216:219], v[68:71], v[28:31]
    v_mfma_f32_16x16x32_bf16 v[32:35], a[220:223], v[68:71], v[32:35]
    v_mfma_f32_16x16x32_bf16 v[36:39], a[224:227], v[68:71], v[36:39]
    ds_read_b128 v[64:67], v117 offset:0
    ds_read_b128 v[68:71], v117 offset:20480
    s_cmp_gt_u32 s38, 2
    s_cbranch_scc1 PK_ef_52
    s_waitcnt vmcnt(10)
    v_mov_b32 v14, s38
    buffer_store_dword v14, v2, s[16:19], s40 offen sc1
PK_ef_52:
    s_waitcnt lgkmcnt(4)
    v_mfma_f32_16x16x32_bf16 v[16:19], a[228:231], v[72:75], v[16:19]
    v_mfma_f32_16x16x32_bf16 v[20:23], a[232:235], v[72:75], v[20:23]
    s_mov_b32 m0, s35
    s_add_u32 s35, s35, 1024
    buffer_load_dwordx4 v109, s[8:11], s28 offen lds
    v_mfma_f32_16x16x32_bf16 v[24:27], a[236:239], v[72:75], v[24:27]
    v_mfma_f32_16x16x32_bf16 v[28:31], a[228:231], v[76:79], v[28:31]
    v_mfma_f32_16x16x32_bf16 v[32:35], a[232:235], v[76:79], v[32:35]
    v_mfma_f32_16x16x32_bf16 v[36:39], a[236:239], v[76:79], v[36:39]
    s_add_u32 s28, s28, 40960
    s_add_u32 s29, s29, 40960
    s_cmp_eq_u32 s29, 122880
    s_cselect_b32 s29, 0, s29
    v_mov_b32 v112, v116
    v_add_u32 v116, s37, v120
    v_mov_b32 v113, v117
    v_add_u32 v117, s37, v121
    v_mov_b32 v114, v118
    v_add_u32 v118, s37, v122
    v_mov_b32 v115, v119
    v_add_u32 v119, s37, v123
    s_add_u32 s37, s37, 40960
    s_cmp_eq_u32 s37, 122880
    s_cselect_b32 s37, 0, s37
    s_add_u32 s26, s26, 393216
    s_add_u32 s38, s38, 1
    s_branch PK_loop
PK_fin0:
    s_nop 7
    v_cvt_pk_bf16_f32 v88, v16, v17
    v_cvt_pk_bf16_f32 v89, v18, v19
    v_cvt_pk_bf16_f32 v90, v20, v21
    v_cvt_pk_bf16_f32 v91, v22, v23
    buffer_store_dwordx4 v[88:91], v9, s[16:19], s26 offen sc1
    v_cvt_pk_bf16_f32 v92, v24, v25
    v_cvt_pk_bf16_f32 v93, v26, v27
    buffer_store_dwordx2 v[92:93], v10, s[16:19], s26 offen sc1
    v_cvt_pk_bf16_f32 v94, v28, v29
    v_cvt_pk_bf16_f32 v95, v30, v31
    v_cvt_pk_bf16_f32 v96, v32, v33
    v_cvt_pk_bf16_f32 v97, v34, v35
    s_add_u32 s39, s26, 6144
    buffer_store_dwordx4 v[94:97], v9, s[16:19], s39 offen sc1
    v_cvt_pk_bf16_f32 v98, v36, v37
    v_cvt_pk_bf16_f32 v99, v38, v39
    buffer_store_dwordx2 v[98:99], v10, s[16:19], s39 offen sc1
    s_branch PK_done
PK_fin1:
    s_nop 7
    v_cvt_pk_bf16_f32 v88, v40, v41
    v_cvt_pk_bf16_f32 v89, v42, v43
    v_cvt_pk_bf16_f32 v90, v44, v45
    v_cvt_pk_bf16_f32 v91, v46, v47
    buffer_store_dwordx4 v[88:91], v9, s[16:19], s26 offen sc1
    v_cvt_pk_bf16_f32 v92, v48, v49
    v_cvt_pk_bf16_f32 v93, v50, v51
    buffer_store_dwordx2 v[92:93], v10, s[16:19], s26 offen sc1
    v_cvt_pk_bf16_f32 v94, v52, v53
    v_cvt_pk_bf16_f32 v95, v54, v55
    v_cvt_pk_bf16_f32 v96, v56, v57
    v_cvt_pk_bf16_f32 v97, v58, v59
    s_add_u32 s39, s26, 6144
    buffer_store_dwordx4 v[94:97], v9, s[16:19], s39 offen sc1
    v_cvt_pk_bf16_f32 v98, v60, v61
    v_cvt_pk_bf16_f32 v99, v62, v63
    buffer_store_dwordx2 v[98:99], v10, s[16:19], s39 offen sc1
    s_branch PK_done
PK_done:
    s_waitcnt vmcnt(0) lgkmcnt(0)
    v_mov_b32 v14, s38
    v_mov_b32 v15, 0
    s_mov_b64 exec, 1
    buffer_store_dword v14, v15, s[16:19], s40 offen sc1
    s_mov_b64 exec, -1
    s_mov_b32 s12, s80
    s_and_b32 s13, s81, 0xffff
    s_mov_b32 s14, 7864320
    s_mov_b32 s15, 0x20000
    s_mov_b32 s23, 0
    s_mov_b32 s24, 64
    s_mov_b32 s41, 1
    v_and_b32 v1, 63, v0
    v_lshlrev_b32 v11, 4, v1
    v_add_u32 v12, 0, v1
    v_mul_u32_u24 v13, 2731, v12
    v_lshrrev_b32 v13, 16, v13
    v_mul_u32_u24 v14, 24, v13
    v_sub_u32 v14, v12, v14
    v_mul_u32_u24 v3, 12288, v13
    v_lshl_add_u32 v3, v14, 4, v3
    v_add_u32 v12, 64, v1
    v_mul_u32_u24 v13, 2731, v12
    v_lshrrev_b32 v13, 16, v13
    v_mul_u32_u24 v14, 24, v13
    v_sub_u32 v14, v12, v14
    v_mul_u32_u24 v4, 12288, v13
    v_lshl_add_u32 v4, v14, 4, v4
    v_add_u32 v12, 128, v1
    v_mul_u32_u24 v13, 2731, v12
    v_lshrrev_b32 v13, 16, v13
    v_mul_u32_u24 v14, 24, v13
    v_sub_u32 v14, v12, v14
    v_mul_u32_u24 v5, 12288, v13
    v_lshl_add_u32 v5, v14, 4, v5
    v_lshrrev_b32 v12, 4, v1
    v_lshlrev_b32 v12, 3, v12
    v_bfe_u32 v13, v1, 2, 2
    v_add_u32 v12, v12, v13
    v_mul_u32_u24 v8, 384, v12
    v_and_b32 v12, 3, v1
    v_lshl_add_u32 v8, v12, 3, v8
    s_mul_i32 s30, s25, 96
    v_add_u32 v8, s30, v8
    s_mul_i32 s27, s22, 384
    s_waitcnt lgkmcnt(0)
    s_barrier
    s_mul_i32 s30, s25, 393216
    s_add_u32 s30, s30, s27
    s_add_u32 s30, s30, 0
    s_mul_i32 s31, s25, 12288
    s_add_u32 s31, s31, 0
    s_mov_b32 m0, s31
    s_add_u32 s31, s31, 1024
    buffer_load_dwordx4 v3, s[12:15], s30 offen lds
    s_mov_b32 m0, s31
    s_add_u32 s31, s31, 1024
    buffer_load_dwordx4 v4, s[12:15], s30 offen lds
    s_mov_b32 m0, s31
    s_add_u32 s31, s31, 1024
    buffer_load_dwordx4 v5, s[12:15], s30 offen lds
    s_add_u32 s30, s30, 98304
    s_mov_b32 m0, s31
    s_add_u32 s31, s31, 1024
    buffer_load_dwordx4 v3, s[12:15], s30 offen lds
    s_mov_b32 m0, s31
    s_add_u32 s31, s31, 1024
    buffer_load_dwordx4 v4, s[12:15], s30 offen lds
    s_mov_b32 m0, s31
    s_add_u32 s31, s31, 1024
    buffer_load_dwordx4 v5, s[12:15], s30 offen lds
    s_add_u32 s30, s30, 98304
    s_mov_b32 m0, s31
    s_add_u32 s31, s31, 1024
    buffer_load_dwordx4 v3, s[12:15], s30 offen lds
    s_mov_b32 m0, s31
    s_add_u32 s31, s31, 1024
    buffer_load_dwordx4 v4, s[12:15], s30 offen lds
    s_mov_b32 m0, s31
    s_add_u32 s31, s31, 1024
    buffer_load_dwordx4 v5, s[12:15], s30 offen lds
    s_add_u32 s30, s30, 98304
    s_mov_b32 m0, s31
    s_add_u32 s31, s31, 1024
    buffer_load_dwordx4 v3, s[12:15], s30 offen lds
    s_mov_b32 m0, s31
    s_add_u32 s31, s31, 1024
    buffer_load_dwordx4 v4, s[12:15], s30 offen lds
    s_mov_b32 m0, s31
    s_add_u32 s31, s31, 1024
    buffer_load_dwordx4 v5, s[12:15], s30 offen lds
    s_add_u32 s30, s30, 98304
    s_mul_i32 s30, s25, 393216
    s_add_u32 s30, s30, s27
    s_add_u32 s30, s30, 1572864
    s_mul_i32 s31, s25, 12288
    s_add_u32 s31, s31, 49152
    s_mov_b32 m0, s31
    s_add_u32 s31, s31, 1024
    buffer_load_dwordx4 v3, s[12:15], s30 offen lds
    s_mov_b32 m0, s31
    s_add_u32 s31, s31, 1024
    buffer_load_dwordx4 v4, s[12:15], s30 offen lds
    s_mov_b32 m0, s31
    s_add_u32 s31, s31, 1024
    buffer_load_dwordx4 v5, s[12:15], s30 offen lds
    s_add_u32 s30, s30, 98304
    s_mov_b32 m0, s31
    s_add_u32 s31, s31, 1024
    buffer_load_dwordx4 v3, s[12:15], s30 offen lds
    s_mov_b32 m0, s31
    s_add_u32 s31, s31, 1024
    buffer_load_dwordx4 v4, s[12:15], s30 offen lds
    s_mov_b32 m0, s31
    s_add_u32 s31, s31, 1024
    buffer_load_dwordx4 v5, s[12:15], s30 offen lds
    s_add_u32 s30, s30, 98304
    s_mov_b32 m0, s31
    s_add_u32 s31, s31, 1024
    buffer_load_dwordx4 v3, s[12:15], s30 offen lds
    s_mov_b32 m0, s31
    s_add_u32 s31, s31, 1024
    buffer_load_dwordx4 v4, s[12:15], s30 offen lds
    s_mov_b32 m0, s31
    s_add_u32 s31, s31, 1024
    buffer_load_dwordx4 v5, s[12:15], s30 offen lds
    s_add_u32 s30, s30, 98304
    s_mov_b32 m0, s31
    s_add_u32 s31, s31, 1024
    buffer_load_dwordx4 v3, s[12:15], s30 offen lds
    s_mov_b32 m0, s31
    s_add_u32 s31, s31, 1024
    buffer_load_dwordx4 v4, s[12:15], s30 offen lds
    s_mov_b32 m0, s31
    s_add_u32 s31, s31, 1024
    buffer_load_dwordx4 v5, s[12:15], s30 offen lds
    s_add_u32 s30, s30, 98304
    s_mul_i32 s30, s25, 393216
    s_add_u32 s30, s30, s27
    s_add_u32 s30, s30, 3145728
    s_mul_i32 s31, s25, 12288
    s_add_u32 s31, s31, 98304
    s_mov_b32 m0, s31
    s_add_u32 s31, s31, 1024
    buffer_load_dwordx4 v3, s[12:15], s30 offen lds
    s_mov_b32 m0, s31
    s_add_u32 s31, s31, 1024
    buffer_load_dwordx4 v4, s[12:15], s30 offen lds
    s_mov_b32 m0, s31
    s_add_u32 s31, s31, 1024
    buffer_load_dwordx4 v5, s[12:15], s30 offen lds
    s_add_u32 s30, s30, 98304
    s_mov_b32 m0, s31
    s_add_u32 s31, s31, 1024
    buffer_load_dwordx4 v3, s[12:15], s30 offen lds
    s_mov_b32 m0, s31
    s_add_u32 s31, s31, 1024
    buffer_load_dwordx4 v4, s[12:15], s30 offen lds
    s_mov_b32 m0, s31
    s_add_u32 s31, s31, 1024
    buffer_load_dwordx4 v5, s[12:15], s30 offen lds
    s_add_u32 s30, s30, 98304
    s_mov_b32 m0, s31
    s_add_u32 s31, s31, 1024
    buffer_load_dwordx4 v3, s[12:15], s30 offen lds
    s_mov_b32 m0, s31
    s_add_u32 s31, s31, 1024
    buffer_load_dwordx4 v4, s[12:15], s30 offen lds
    s_mov_b32 m0, s31
    s_add_u32 s31, s31, 1024
    buffer_load_dwordx4 v5, s[12:15], s30 offen lds
    s_add_u32 s30, s30, 98304
    s_mov_b32 m0, s31
    s_add_u32 s31, s31, 1024
    buffer_load_dwordx4 v3, s[12:15], s30 offen lds
    s_mov_b32 m0, s31
    s_add_u32 s31, s31, 1024
    buffer_load_dwordx4 v4, s[12:15], s30 offen lds
    s_mov_b32 m0, s31
    s_add_u32 s31, s31, 1024
    buffer_load_dwordx4 v5, s[12:15], s30 offen lds
    s_add_u32 s30, s30, 98304
    s_waitcnt vmcnt(24)
    s_barrier
    v_add_u32 v12, 0, v8
    ds_read_b64_tr_b16 a[0:1], v12 offset:0
    ds_read_b64_tr_b16 a[2:3], v12 offset:1536
    s_waitcnt lgkmcnt(8)
    ds_read_b64_tr_b16 a[4:5], v12 offset:32
    ds_read_b64_tr_b16 a[6:7], v12 offset:1568
    s_waitcnt lgkmcnt(8)
    ds_read_b64_tr_b16 a[8:9], v12 offset:64
    ds_read_b64_tr_b16 a[10:11], v12 offset:1600
    s_waitcnt lgkmcnt(8)
    ds_read_b64_tr_b16 a[12:13], v12 offset:12288
    ds_read_b64_tr_b16 a[14:15], v12 offset:13824
    s_waitcnt lgkmcnt(8)
    ds_read_b64_tr_b16 a[16:17], v12 offset:12320
    ds_read_b64_tr_b16 a[18:19], v12 offset:13856
    s_waitcnt lgkmcnt(8)
    ds_read_b64_tr_b16 a[20:21], v12 offset:12352
    ds_read_b64_tr_b16 a[22:23], v12 offset:13888
    s_waitcnt lgkmcnt(8)
    ds_read_b64_tr_b16 a[24:25], v12 offset:24576
    ds_read_b64_tr_b16 a[26:27], v12 offset:26112
    s_waitcnt lgkmcnt(8)
    ds_read_b64_tr_b16 a[28:29], v12 offset:24608
    ds_read_b64_tr_b16 a[30:31], v12 offset:26144
    s_waitcnt lgkmcnt(8)
    ds_read_b64_tr_b16 a[32:33], v12 offset:24640
    ds_read_b64_tr_b16 a[34:35], v12 offset:26176
    s_waitcnt lgkmcnt(8)
    ds_read_b64_tr_b16 a[36:37], v12 offset:36864
    ds_read_b64_tr_b16 a[38:39], v12 offset:38400
    s_waitcnt lgkmcnt(8)
    ds_read_b64_tr_b16 a[40:41], v12 offset:36896
    ds_read_b64_tr_b16 a[42:43], v12 offset:38432
    s_waitcnt lgkmcnt(8)
    ds_read_b64_tr_b16 a[44:45], v12 offset:36928
    ds_read_b64_tr_b16 a[46:47], v12 offset:38464
    s_waitcnt lgkmcnt(8)
    s_waitcnt lgkmcnt(0)
    s_barrier
    s_mul_i32 s30, s25, 393216
    s_add_u32 s30, s30, s27
    s_add_u32 s30, s30, 4718592
    s_mul_i32 s31, s25, 12288
    s_add_u32 s31, s31, 0
    s_mov_b32 m0, s31
    s_add_u32 s31, s31, 1024
    buffer_load_dwordx4 v3, s[12:15], s30 offen lds
    s_mov_b32 m0, s31
    s_add_u32 s31, s31, 1024
    buffer_load_dwordx4 v4, s[12:15], s30 offen lds
    s_mov_b32 m0, s31
    s_add_u32 s31, s31, 1024
    buffer_load_dwordx4 v5, s[12:15], s30 offen lds
    s_add_u32 s30, s30, 98304
    s_mov_b32 m0, s31
    s_add_u32 s31, s31, 1024
    buffer_load_dwordx4 v3, s[12:15], s30 offen lds
    s_mov_b32 m0, s31
    s_add_u32 s31, s31, 1024
    buffer_load_dwordx4 v4, s[12:15], s30 offen lds
    s_mov_b32 m0, s31
    s_add_u32 s31, s31, 1024
    buffer_load_dwordx4 v5, s[12:15], s30 offen lds
    s_add_u32 s30, s30, 98304
    s_mov_b32 m0, s31
    s_add_u32 s31, s31, 1024
    buffer_load_dwordx4 v3, s[12:15], s30 offen lds
    s_mov_b32 m0, s31
    s_add_u32 s31, s31, 1024
    buffer_load_dwordx4 v4, s[12:15], s30 offen lds
    s_mov_b32 m0, s31
    s_add_u32 s31, s31, 1024
    buffer_load_dwordx4 v5, s[12:15], s30 offen lds
    s_add_u32 s30, s30, 98304
    s_mov_b32 m0, s31
    s_add_u32 s31, s31, 1024
    buffer_load_dwordx4 v3, s[12:15], s30 offen lds
    s_mov_b32 m0, s31
    s_add_u32 s31, s31, 1024
    buffer_load_dwordx4 v4, s[12:15], s30 offen lds
    s_mov_b32 m0, s31
    s_add_u32 s31, s31, 1024
    buffer_load_dwordx4 v5, s[12:15], s30 offen lds
    s_add_u32 s30, s30, 98304
    s_waitcnt vmcnt(24)
    s_barrier
    v_add_u32 v12, 49152, v8
    ds_read_b64_tr_b16 a[48:49], v12 offset:0
    ds_read_b64_tr_b16 a[50:51], v12 offset:1536
    s_waitcnt lgkmcnt(8)
    ds_read_b64_tr_b16 a[52:53], v12 offset:32
    ds_read_b64_tr_b16 a[54:55], v12 offset:1568
    s_waitcnt lgkmcnt(8)
    ds_read_b64_tr_b16 a[56:57], v12 offset:64
    ds_read_b64_tr_b16 a[58:59], v12 offset:1600
    s_waitcnt lgkmcnt(8)
    ds_read_b64_tr_b16 a[60:61], v12 offset:12288
    ds_read_b64_tr_b16 a[62:63], v12 offset:13824
    s_waitcnt lgkmcnt(8)
    ds_read_b64_tr_b16 a[64:65], v12 offset:12320
    ds_read_b64_tr_b16 a[66:67], v12 offset:13856
    s_waitcnt lgkmcnt(8)
    ds_read_b64_tr_b16 a[68:69], v12 offset:12352
    ds_read_b64_tr_b16 a[70:71], v12 offset:13888
    s_waitcnt lgkmcnt(8)
    ds_read_b64_tr_b16 a[72:73], v12 offset:24576
    ds_read_b64_tr_b16 a[74:75], v12 offset:26112
    s_waitcnt lgkmcnt(8)
    ds_read_b64_tr_b16 a[76:77], v12 offset:24608
    ds_read_b64_tr_b16 a[78:79], v12 offset:26144
    s_waitcnt lgkmcnt(8)
    ds_read_b64_tr_b16 a[80:81], v12 offset:24640
    ds_read_b64_tr_b16 a[82:83], v12 offset:26176
    s_waitcnt lgkmcnt(8)
    ds_read_b64_tr_b16 a[84:85], v12 offset:36864
    ds_read_b64_tr_b16 a[86:87], v12 offset:38400
    s_waitcnt lgkmcnt(8)
    ds_read_b64_tr_b16 a[88:89], v12 offset:36896
    ds_read_b64_tr_b16 a[90:91], v12 offset:38432
    s_waitcnt lgkmcnt(8)
    ds_read_b64_tr_b16 a[92:93], v12 offset:36928
    ds_read_b64_tr_b16 a[94:95], v12 offset:38464
    s_waitcnt lgkmcnt(8)
    s_waitcnt lgkmcnt(0)
    s_barrier
    s_mul_i32 s30, s25, 393216
    s_add_u32 s30, s30, s27
    s_add_u32 s30, s30, 6291456
    s_mul_i32 s31, s25, 12288
    s_add_u32 s31, s31, 49152
    s_mov_b32 m0, s31
    s_add_u32 s31, s31, 1024
    buffer_load_dwordx4 v3, s[12:15], s30 offen lds
    s_mov_b32 m0, s31
    s_add_u32 s31, s31, 1024
    buffer_load_dwordx4 v4, s[12:15], s30 offen lds
    s_mov_b32 m0, s31
    s_add_u32 s31, s31, 1024
    buffer_load_dwordx4 v5, s[12:15], s30 offen lds
    s_add_u32 s30, s30, 98304
    s_mov_b32 m0, s31
    s_add_u32 s31, s31, 1024
    buffer_load_dwordx4 v3, s[12:15], s30 offen lds
    s_mov_b32 m0, s31
    s_add_u32 s31, s31, 1024
    buffer_load_dwordx4 v4, s[12:15], s30 offen lds
    s_mov_b32 m0, s31
    s_add_u32 s31, s31, 1024
    buffer_load_dwordx4 v5, s[12:15], s30 offen lds
    s_add_u32 s30, s30, 98304
    s_mov_b32 m0, s31
    s_add_u32 s31, s31, 1024
    buffer_load_dwordx4 v3, s[12:15], s30 offen lds
    s_mov_b32 m0, s31
    s_add_u32 s31, s31, 1024
    buffer_load_dwordx4 v4, s[12:15], s30 offen lds
    s_mov_b32 m0, s31
    s_add_u32 s31, s31, 1024
    buffer_load_dwordx4 v5, s[12:15], s30 offen lds
    s_add_u32 s30, s30, 98304
    s_mov_b32 m0, s31
    s_add_u32 s31, s31, 1024
    buffer_load_dwordx4 v3, s[12:15], s30 offen lds
    s_mov_b32 m0, s31
    s_add_u32 s31, s31, 1024
    buffer_load_dwordx4 v4, s[12:15], s30 offen lds
    s_mov_b32 m0, s31
    s_add_u32 s31, s31, 1024
    buffer_load_dwordx4 v5, s[12:15], s30 offen lds
    s_add_u32 s30, s30, 98304
    s_waitcnt vmcnt(24)
    s_barrier
    v_add_u32 v12, 98304, v8
    ds_read_b64_tr_b16 a[96:97], v12 offset:0
    ds_read_b64_tr_b16 a[98:99], v12 offset:1536
    s_waitcnt lgkmcnt(8)
    ds_read_b64_tr_b16 a[100:101], v12 offset:32
    ds_read_b64_tr_b16 a[102:103], v12 offset:1568
    s_waitcnt lgkmcnt(8)
    ds_read_b64_tr_b16 a[104:105], v12 offset:64
    ds_read_b64_tr_b16 a[106:107], v12 offset:1600
    s_waitcnt lgkmcnt(8)
    ds_read_b64_tr_b16 a[108:109], v12 offset:12288
    ds_read_b64_tr_b16 a[110:111], v12 offset:13824
    s_waitcnt lgkmcnt(8)
    ds_read_b64_tr_b16 a[112:113], v12 offset:12320
    ds_read_b64_tr_b16 a[114:115], v12 offset:13856
    s_waitcnt lgkmcnt(8)
    ds_read_b64_tr_b16 a[116:117], v12 offset:12352
    ds_read_b64_tr_b16 a[118:119], v12 offset:13888
    s_waitcnt lgkmcnt(8)
    ds_read_b64_tr_b16 a[120:121], v12 offset:24576
    ds_read_b64_tr_b16 a[122:123], v12 offset:26112
    s_waitcnt lgkmcnt(8)
    ds_read_b64_tr_b16 a[124:125], v12 offset:24608
    ds_read_b64_tr_b16 a[126:127], v12 offset:26144
    s_waitcnt lgkmcnt(8)
    ds_read_b64_tr_b16 a[128:129], v12 offset:24640
    ds_read_b64_tr_b16 a[130:131], v12 offset:26176
    s_waitcnt lgkmcnt(8)
    ds_read_b64_tr_b16 a[132:133], v12 offset:36864
    ds_read_b64_tr_b16 a[134:135], v12 offset:38400
    s_waitcnt lgkmcnt(8)
    ds_read_b64_tr_b16 a[136:137], v12 offset:36896
    ds_read_b64_tr_b16 a[138:139], v12 offset:38432
    s_waitcnt lgkmcnt(8)
    ds_read_b64_tr_b16 a[140:141], v12 offset:36928
    ds_read_b64_tr_b16 a[142:143], v12 offset:38464
    s_waitcnt lgkmcnt(8)
    s_waitcnt lgkmcnt(0)
    s_barrier
    s_waitcnt vmcnt(12)
    s_barrier
    v_add_u32 v12, 0, v8
    ds_read_b64_tr_b16 a[144:145], v12 offset:0
    ds_read_b64_tr_b16 a[146:147], v12 offset:1536
    s_waitcnt lgkmcnt(8)
    ds_read_b64_tr_b16 a[148:149], v12 offset:32
    ds_read_b64_tr_b16 a[150:151], v12 offset:1568
    s_waitcnt lgkmcnt(8)
    ds_read_b64_tr_b16 a[152:153], v12 offset:64
    ds_read_b64_tr_b16 a[154:155], v12 offset:1600
    s_waitcnt lgkmcnt(8)
    ds_read_b64_tr_b16 a[156:157], v12 offset:12288
    ds_read_b64_tr_b16 a[158:159], v12 offset:13824
    s_waitcnt lgkmcnt(8)
    ds_read_b64_tr_b16 a[160:161], v12 offset:12320
    ds_read_b64_tr_b16 a[162:163], v12 offset:13856
    s_waitcnt lgkmcnt(8)
    ds_read_b64_tr_b16 a[164:165], v12 offset:12352
    ds_read_b64_tr_b16 a[166:167], v12 offset:13888
    s_waitcnt lgkmcnt(8)
    ds_read_b64_tr_b16 a[168:169], v12 offset:24576
    ds_read_b64_tr_b16 a[170:171], v12 offset:26112
    s_waitcnt lgkmcnt(8)
    ds_read_b64_tr_b16 a[172:173], v12 offset:24608
    ds_read_b64_tr_b16 a[174:175], v12 offset:26144
    s_waitcnt lgkmcnt(8)
    ds_read_b64_tr_b16 a[176:177], v12 offset:24640
    ds_read_b64_tr_b16 a[178:179], v12 offset:26176
    s_waitcnt lgkmcnt(8)
    ds_read_b64_tr_b16 a[180:181], v12 offset:36864
    ds_read_b64_tr_b16 a[182:183], v12 offset:38400
    s_waitcnt lgkmcnt(8)
    ds_read_b64_tr_b16 a[184:185], v12 offset:36896
    ds_read_b64_tr_b16 a[186:187], v12 offset:38432
    s_waitcnt lgkmcnt(8)
    ds_read_b64_tr_b16 a[188:189], v12 offset:36928
    ds_read_b64_tr_b16 a[190:191], v12 offset:38464
    s_waitcnt lgkmcnt(8)
    s_waitcnt lgkmcnt(0)
    s_barrier
    s_waitcnt vmcnt(0)
    s_barrier
    v_add_u32 v12, 49152, v8
    ds_read_b64_tr_b16 a[192:193], v12 offset:0
    ds_read_b64_tr_b16 a[194:195], v12 offset:1536
    s_waitcnt lgkmcnt(8)
    ds_read_b64_tr_b16 a[196:197], v12 offset:32
    ds_read_b64_tr_b16 a[198:199], v12 offset:1568
    s_waitcnt lgkmcnt(8)
    ds_read_b64_tr_b16 a[200:201], v12 offset:64
    ds_read_b64_tr_b16 a[202:203], v12 offset:1600
    s_waitcnt lgkmcnt(8)
    ds_read_b64_tr_b16 a[204:205], v12 offset:12288
    ds_read_b64_tr_b16 a[206:207], v12 offset:13824
    s_waitcnt lgkmcnt(8)
    ds_read_b64_tr_b16 a[208:209], v12 offset:12320
    ds_read_b64_tr_b16 a[210:211], v12 offset:13856
    s_waitcnt lgkmcnt(8)
    ds_read_b64_tr_b16 a[212:213], v12 offset:12352
    ds_read_b64_tr_b16 a[214:215], v12 offset:13888
    s_waitcnt lgkmcnt(8)
    ds_read_b64_tr_b16 a[216:217], v12 offset:24576
    ds_read_b64_tr_b16 a[218:219], v12 offset:26112
    s_waitcnt lgkmcnt(8)
    ds_read_b64_tr_b16 a[220:221], v12 offset:24608
    ds_read_b64_tr_b16 a[222:223], v12 offset:26144
    s_waitcnt lgkmcnt(8)
    ds_read_b64_tr_b16 a[224:225], v12 offset:24640
    ds_read_b64_tr_b16 a[226:227], v12 offset:26176
    s_waitcnt lgkmcnt(8)
    ds_read_b64_tr_b16 a[228:229], v12 offset:36864
    ds_read_b64_tr_b16 a[230:231], v12 offset:38400
    s_waitcnt lgkmcnt(8)
    ds_read_b64_tr_b16 a[232:233], v12 offset:36896
    ds_read_b64_tr_b16 a[234:235], v12 offset:38432
    s_waitcnt lgkmcnt(8)
    ds_read_b64_tr_b16 a[236:237], v12 offset:36928
    ds_read_b64_tr_b16 a[238:239], v12 offset:38464
    s_waitcnt lgkmcnt(8)
    s_waitcnt lgkmcnt(0)
    s_barrier
    s_mul_i32 s30, s25, 640
    v_add_u32 v12, s30, v1
    v_add_u32 v12, 0, v12
    v_mul_u32_u24 v13, 3277, v12
    v_lshrrev_b32 v13, 18, v13
    v_mul_u32_u24 v14, 80, v13
    v_sub_u32 v14, v12, v14
    v_and_b32 v15, 15, v13
    v_xor_b32 v14, v14, v15
    v_mul_u32_u24 v100, 1280, v13
    v_lshl_add_u32 v100, v14, 4, v100
    v_add_u32 v12, s30, v1
    v_add_u32 v12, 64, v12
    v_mul_u32_u24 v13, 3277, v12
    v_lshrrev_b32 v13, 18, v13
    v_mul_u32_u24 v14, 80, v13
    v_sub_u32 v14, v12, v14
    v_and_b32 v15, 15, v13
    v_xor_b32 v14, v14, v15
    v_mul_u32_u24 v101, 1280, v13
    v_lshl_add_u32 v101, v14, 4, v101
    v_add_u32 v12, s30, v1
    v_add_u32 v12, 128, v12
    v_mul_u32_u24 v13, 3277, v12
    v_lshrrev_b32 v13, 18, v13
    v_mul_u32_u24 v14, 80, v13
    v_sub_u32 v14, v12, v14
    v_and_b32 v15, 15, v13
    v_xor_b32 v14, v14, v15
    v_mul_u32_u24 v102, 1280, v13
    v_lshl_add_u32 v102, v14, 4, v102
    v_add_u32 v12, s30, v1
    v_add_u32 v12, 192, v12
    v_mul_u32_u24 v13, 3277, v12
    v_lshrrev_b32 v13, 18, v13
    v_mul_u32_u24 v14, 80, v13
    v_sub_u32 v14, v12, v14
    v_and_b32 v15, 15, v13
    v_xor_b32 v14, v14, v15
    v_mul_u32_u24 v103, 1280, v13
    v_lshl_add_u32 v103, v14, 4, v103
    v_add_u32 v12, s30, v1
    v_add_u32 v12, 256, v12
    v_mul_u32_u24 v13, 3277, v12
    v_lshrrev_b32 v13, 18, v13
    v_mul_u32_u24 v14, 80, v13
    v_sub_u32 v14, v12, v14
    v_and_b32 v15, 15, v13
    v_xor_b32 v14, v14, v15
    v_mul_u32_u24 v104, 1280, v13
    v_lshl_add_u32 v104, v14, 4, v104
    v_add_u32 v12, s30, v1
    v_add_u32 v12, 320, v12
    v_mul_u32_u24 v13, 3277, v12
    v_lshrrev_b32 v13, 18, v13
    v_mul_u32_u24 v14, 80, v13
    v_sub_u32 v14, v12, v14
    v_and_b32 v15, 15, v13
    v_xor_b32 v14, v14, v15
    v_mul_u32_u24 v105, 1280, v13
    v_lshl_add_u32 v105, v14, 4, v105
    v_add_u32 v12, s30, v1
    v_add_u32 v12, 384, v12
    v_mul_u32_u24 v13, 3277, v12
    v_lshrrev_b32 v13, 18, v13
    v_mul_u32_u24 v14, 80, v13
    v_sub_u32 v14, v12, v14
    v_and_b32 v15, 15, v13
    v_xor_b32 v14, v14, v15
    v_mul_u32_u24 v106, 1280, v13
    v_lshl_add_u32 v106, v14, 4, v106
    v_add_u32 v12, s30, v1
    v_add_u32 v12, 448, v12
    v_mul_u32_u24 v13, 3277, v12
    v_lshrrev_b32 v13, 18, v13
    v_mul_u32_u24 v14, 80, v13
    v_sub_u32 v14, v12, v14
    v_and_b32 v15, 15, v13
    v_xor_b32 v14, v14, v15
    v_mul_u32_u24 v107, 1280, v13
    v_lshl_add_u32 v107, v14, 4, v107
    v_add_u32 v12, s30, v1
    v_add_u32 v12, 512, v12
    v_mul_u32_u24 v13, 3277, v12
    v_lshrrev_b32 v13, 18, v13
    v_mul_u32_u24 v14, 80, v13
    v_sub_u32 v14, v12, v14
    v_and_b32 v15, 15, v13
    v_xor_b32 v14, v14, v15
    v_mul_u32_u24 v108, 1280, v13
    v_lshl_add_u32 v108, v14, 4, v108
    v_add_u32 v12, s30, v1
    v_add_u32 v12, 576, v12
    v_mul_u32_u24 v13, 3277, v12
    v_lshrrev_b32 v13, 18, v13
    v_mul_u32_u24 v14, 80, v13
    v_sub_u32 v14, v12, v14
    v_and_b32 v15, 15, v13
    v_xor_b32 v14, v14, v15
    v_mul_u32_u24 v109, 1280, v13
    v_lshl_add_u32 v109, v14, 4, v109
    s_mul_i32 s33, s25, 10240
    v_lshrrev_b32 v12, 4, v1
    v_add_u32 v12, 0, v12
    v_and_b32 v13, 15, v1
    v_xor_b32 v12, v12, v13
    v_mul_u32_u24 v120, 1280, v13
    v_lshl_add_u32 v120, v12, 4, v120
    v_lshrrev_b32 v12, 4, v1
    v_add_u32 v12, 4, v12
    v_and_b32 v13, 15, v1
    v_xor_b32 v12, v12, v13
    v_mul_u32_u24 v121, 1280, v13
    v_lshl_add_u32 v121, v12, 4, v121
    v_lshrrev_b32 v12, 4, v1
    v_add_u32 v12, 8, v12
    v_and_b32 v13, 15, v1
    v_xor_b32 v12, v12, v13
    v_mul_u32_u24 v122, 1280, v13
    v_lshl_add_u32 v122, v12, 4, v122
    v_lshrrev_b32 v12, 4, v1
    v_add_u32 v12, 12, v12
    v_and_b32 v13, 15, v1
    v_xor_b32 v12, v12, v13
    v_mul_u32_u24 v123, 1280, v13
    v_lshl_add_u32 v123, v12, 4, v123
    s_lshr_b32 s30, s25, 1
    s_mul_i32 s30, s30, 3
    s_and_b32 s31, s25, 1
    s_add_u32 s36, s30, s31
    s_lshl_b32 s36, s36, 10
    s_add_u32 s36, s36, 81920
    v_add_u32 v9, s36, v11
    s_add_u32 s30, s30, 2
    s_lshl_b32 s30, s30, 10
    s_lshl_b32 s31, s31, 3
    s_add_u32 s30, s30, s31
    s_add_u32 s30, s30, 81920
    v_add_u32 v10, s30, v11
    s_lshr_b32 s42, s25, 1
    s_and_b32 s43, s25, 1
    s_mul_i32 s30, s42, 6144
    s_add_u32 s30, s30, 81920
    v_add_u32 v6, s30, v11
    v_lshlrev_b32 v7, 2, v1
    v_and_b32 v12, 15, v1
    v_lshrrev_b32 v13, 4, v1
    v_lshrrev_b32 v14, 2, v12
    v_lshlrev_b32 v14, 1, v14
    v_and_b32 v15, 1, v12
    v_add_u32 v14, v14, v15
    v_lshl_add_u32 v14, v13, 3, v14
    v_lshlrev_b32 v2, 4, v14
    v_add_u32 v127, 24576, v2
    s_mul_i32 s30, s43, 6144
    s_add_u32 s30, s30, 12288
    v_add_u32 v126, s30, v11
    s_lshl_b32 s30, s43, 11
    s_add_u32 s30, s30, 28672
    v_add_u32 v248, s30, v11
    v_mov_b32 v249, 0xff800000
    v_mov_b32 v250, 0
    v_mov_b32 v15, 2147483632
    v_cmp_eq_u32 vcc, 0, v1
    s_nop 1
    v_cndmask_b32 v250, v15, v250, vcc
    v_min_u32 v88, 7, v1
    v_lshlrev_b32 v88, 2, v88
    v_lshlrev_b32 v13, 2, v13
    v_add_u32 v14, 0, v13
    v_cmp_gt_u32 vcc, v14, v12
    s_cmp_eq_u32 s42, 0
    s_cselect_b64 s[60:61], vcc, 0
    s_cselect_b64 s[68:69], -1, vcc
    v_add_u32 v14, 1, v13
    v_cmp_gt_u32 vcc, v14, v12
    s_cmp_eq_u32 s42, 0
    s_cselect_b64 s[62:63], vcc, 0
    s_cselect_b64 s[70:71], -1, vcc
    v_add_u32 v14, 2, v13
    v_cmp_gt_u32 vcc, v14, v12
    s_cmp_eq_u32 s42, 0
    s_cselect_b64 s[64:65], vcc, 0
    s_cselect_b64 s[72:73], -1, vcc
    v_add_u32 v14, 3, v13
    v_cmp_gt_u32 vcc, v14, v12
    s_cmp_eq_u32 s42, 0
    s_cselect_b64 s[66:67], vcc, 0
    s_cselect_b64 s[74:75], -1, vcc
    v_mov_b32 v233, 0
    v_mov_b32 v234, 0
    s_mul_i32 s30, s20, 2048
    s_add_u32 s30, s30, s22
    s_mul_i32 s31, s23, 32
    s_add_u32 s30, s30, s31
    s_mul_i32 s44, s30, 12288
    s_mul_i32 s45, s30, 3072
    s_add_u32 s45, s45, 150994944
    s_mul_i32 s46, s30, 4096
    s_add_u32 s46, s46, 163577856
    s_mul_i32 s48, s42, 6144
    s_mul_i32 s31, s43, 3072
    s_add_u32 s48, s48, s31
    s_lshl_b32 s30, s20, 5
    s_add_u32 s30, s30, s22
    s_lshl_b32 s30, s30, 7
    s_add_u32 s49, s30, 182468608
    s_add_u32 s50, s30, 182476800
    s_lshl_b32 s31, s25, 2
    s_add_u32 s50, s50, s31
    s_lshl_b32 s30, s20, 6
    s_add_u32 s30, s30, s22
    s_lshl_b32 s30, s30, 7
    s_add_u32 s51, s30, 182452224
    s_add_u32 s52, s51, 4096
    s_mov_b32 s53, 0
    s_mov_b32 s54, 0
    s_mov_b32 s55, 0
    s_mov_b32 s56, 0x3dd53b95
    s_mov_b32 s57, 0xff800000
    s_mul_i32 s28, s23, 40960
    s_mul_i32 s58, s41, 40960
    s_mov_b32 s29, 0
    s_mov_b32 s38, 0
    s_mov_b32 s59, s23
    s_mov_b32 s47, 94208
    s_mov_b32 s76, 1
    s_add_u32 s35, s29, s33
    s_mov_b32 m0, s35
    s_add_u32 s35, s35, 1024
    buffer_load_dwordx4 v100, s[8:11], s28 offen lds
    s_mov_b32 m0, s35
    s_add_u32 s35, s35, 1024
    buffer_load_dwordx4 v101, s[8:11], s28 offen lds
    s_mov_b32 m0, s35
    s_add_u32 s35, s35, 1024
    buffer_load_dwordx4 v102, s[8:11], s28 offen lds
    s_mov_b32 m0, s35
    s_add_u32 s35, s35, 1024
    buffer_load_dwordx4 v103, s[8:11], s28 offen lds
    s_mov_b32 m0, s35
    s_add_u32 s35, s35, 1024
    buffer_load_dwordx4 v104, s[8:11], s28 offen lds
    s_mov_b32 m0, s35
    s_add_u32 s35, s35, 1024
    buffer_load_dwordx4 v105, s[8:11], s28 offen lds
    s_mov_b32 m0, s35
    s_add_u32 s35, s35, 1024
    buffer_load_dwordx4 v106, s[8:11], s28 offen lds
    s_mov_b32 m0, s35
    s_add_u32 s35, s35, 1024
    buffer_load_dwordx4 v107, s[8:11], s28 offen lds
    s_mov_b32 m0, s35
    s_add_u32 s35, s35, 1024
    buffer_load_dwordx4 v108, s[8:11], s28 offen lds
    s_mov_b32 m0, s35
    s_add_u32 s35, s35, 1024
    buffer_load_dwordx4 v109, s[8:11], s28 offen lds
    s_add_u32 s28, s28, s58
    s_xor_b32 s29, s29, 40960
    s_waitcnt vmcnt(0)
    s_waitcnt lgkmcnt(0)
    s_barrier
    v_add_u32 v124, s47, v11
    v_add_u32 v125, s47, v126
    v_add_u32 v2, s47, v127
    v_add_u32 v7, s47, v248
    s_xor_b32 s47, s47, 32768
    s_add_u32 s39, s59, 1
    s_xor_b32 s30, s29, 40960
    v_add_u32 v112, s30, v120
    v_add_u32 v113, s30, v121
    v_add_u32 v114, s30, v122
    v_add_u32 v115, s30, v123
    s_cmp_ge_u32 s53, s39
    s_cbranch_scc1 QA_wf_54
    v_min_u32 v14, 3, v1
    v_lshlrev_b32 v14, 2, v14
QA_wf_53:
    buffer_load_dword v15, v14, s[16:19], s51 offen sc1
    s_sub_u32 s34, s34, 1
    s_cbranch_scc1 G_end
    s_waitcnt vmcnt(0)
    s_nop 1
    v_min_u32_dpp v15, v15, v15 row_shl:1 row_mask:0xf bank_mask:0xf
    s_nop 1
    v_min_u32_dpp v15, v15, v15 row_shl:2 row_mask:0xf bank_mask:0xf
    s_nop 1
    v_readfirstlane_b32 s53, v15
    s_cmp_ge_u32 s53, s39
    s_cbranch_scc1 QA_wf_54
    s_sleep 16
    s_branch QA_wf_53
QA_wf_54:
    s_cmp_ge_u32 s54, s39
    s_cbranch_scc1 QA_wf_56
    v_min_u32 v14, 3, v1
    v_lshlrev_b32 v14, 2, v14
QA_wf_55:
    buffer_load_dword v15, v14, s[16:19], s52 offen sc1
    s_sub_u32 s34, s34, 1
    s_cbranch_scc1 G_end
    s_waitcnt vmcnt(0)
    s_nop 1
    v_min_u32_dpp v15, v15, v15 row_shl:1 row_mask:0xf bank_mask:0xf
    s_nop 1
    v_min_u32_dpp v15, v15, v15 row_shl:2 row_mask:0xf bank_mask:0xf
    s_nop 1
    v_readfirstlane_b32 s54, v15
    s_cmp_ge_u32 s54, s39
    s_cbranch_scc1 QA_wf_56
    s_sleep 16
    s_branch QA_wf_55
QA_wf_56:
    ds_read_b128 v[64:67], v112 offset:0
    ds_read_b128 v[68:71], v112 offset:20480
    ds_read_b128 v[72:75], v113 offset:0
    ds_read_b128 v[76:79], v113 offset:20480
    ds_read_b128 v[80:83], v114 offset:0
    ds_read_b128 v[84:87], v114 offset:20480
    s_waitcnt lgkmcnt(4)
    v_mfma_f32_16x16x32_bf16 v[16:19], a[0:3], v[64:67], 0
    s_mov_b32 s76, 0
    s_cmp_lt_u32 s55, s39
    s_cbranch_scc1 QA_em_57
    s_mov_b32 s76, 1
    s_lshl_b32 s79, s25, 10
    s_add_u32 s37, s79, s47
    s_add_u32 m0, s37, 24576
    s_add_u32 s78, s45, s79
    buffer_load_dwordx4 v11, s[16:19], s78 offen  lds
    s_add_u32 m0, s37, 28672
    s_add_u32 s78, s46, s79
    buffer_load_dwordx4 v11, s[16:19], s78 offen  lds
QA_em_57:
    v_mfma_f32_16x16x32_bf16 v[20:23], a[4:7], v[64:67], 0
    v_mfma_f32_16x16x32_bf16 v[24:27], a[8:11], v[64:67], 0
    s_mul_i32 s77, s25, 3072
    s_add_u32 s30, s44, s77
    s_add_u32 s31, s30, 100663296
    s_add_u32 s30, s30, 50331648
    s_add_u32 s77, s77, s47
    s_add_u32 s78, s77, 12288
    s_add_u32 s35, s29, s33
    v_mfma_f32_16x16x32_bf16 v[28:31], a[0:3], v[68:71], 0
    v_mfma_f32_16x16x32_bf16 v[32:35], a[4:7], v[68:71], 0
    s_mov_b32 m0, s77
    s_nop 0
    buffer_load_dwordx4 v11, s[16:19], s30 offen offset:0  lds
    v_mfma_f32_16x16x32_bf16 v[36:39], a[8:11], v[68:71], 0
    ds_read_b128 v[64:67], v115 offset:0
    ds_read_b128 v[68:71], v115 offset:20480
    s_waitcnt lgkmcnt(4)
    v_mfma_f32_16x16x32_bf16 v[16:19], a[12:15], v[72:75], v[16:19]
    s_mov_b32 m0, s77
    s_nop 0
    buffer_load_dwordx4 v11, s[16:19], s30 offen offset:1024  lds
    v_mfma_f32_16x16x32_bf16 v[20:23], a[16:19], v[72:75], v[20:23]
    v_mfma_f32_16x16x32_bf16 v[24:27], a[20:23], v[72:75], v[24:27]
    s_mov_b32 m0, s77
    s_nop 0
    buffer_load_dwordx4 v11, s[16:19], s30 offen offset:2048  lds
    v_mfma_f32_16x16x32_bf16 v[28:31], a[12:15], v[76:79], v[28:31]
    v_mfma_f32_16x16x32_bf16 v[32:35], a[16:19], v[76:79], v[32:35]
    s_mov_b32 m0, s78
    s_nop 0
    buffer_load_dwordx4 v11, s[16:19], s31 offen offset:0  lds
    v_mfma_f32_16x16x32_bf16 v[36:39], a[20:23], v[76:79], v[36:39]
    ds_read_b128 v[72:75], v112 offset:256
    ds_read_b128 v[76:79], v112 offset:20736
    s_waitcnt lgkmcnt(4)
    v_mfma_f32_16x16x32_bf16 v[16:19], a[24:27], v[80:83], v[16:19]
    s_mov_b32 m0, s78
    s_nop 0
    buffer_load_dwordx4 v11, s[16:19], s31 offen offset:1024  lds
    v_mfma_f32_16x16x32_bf16 v[20:23], a[28:31], v[80:83], v[20:23]
    v_mfma_f32_16x16x32_bf16 v[24:27], a[32:35], v[80:83], v[24:27]
    s_mov_b32 m0, s78
    s_nop 0
    buffer_load_dwordx4 v11, s[16:19], s31 offen offset:2048  lds
    v_mfma_f32_16x16x32_bf16 v[28:31], a[24:27], v[84:87], v[28:31]
    v_mfma_f32_16x16x32_bf16 v[32:35], a[28:31], v[84:87], v[32:35]
    s_mov_b32 m0, s35
    s_add_u32 s35, s35, 1024
    buffer_load_dwordx4 v100, s[8:11], s28 offen lds
    v_mfma_f32_16x16x32_bf16 v[36:39], a[32:35], v[84:87], v[36:39]
    ds_read_b128 v[80:83], v113 offset:256
    ds_read_b128 v[84:87], v113 offset:20736
    s_waitcnt lgkmcnt(4)
    v_mfma_f32_16x16x32_bf16 v[16:19], a[36:39], v[64:67], v[16:19]
    s_mov_b32 m0, s35
    s_add_u32 s35, s35, 1024
    buffer_load_dwordx4 v101, s[8:11], s28 offen lds
    v_mfma_f32_16x16x32_bf16 v[20:23], a[40:43], v[64:67], v[20:23]
    v_mfma_f32_16x16x32_bf16 v[24:27], a[44:47], v[64:67], v[24:27]
    s_mov_b32 m0, s35
    s_add_u32 s35, s35, 1024
    buffer_load_dwordx4 v102, s[8:11], s28 offen lds
    v_mfma_f32_16x16x32_bf16 v[28:31], a[36:39], v[68:71], v[28:31]
    v_mfma_f32_16x16x32_bf16 v[32:35], a[40:43], v[68:71], v[32:35]
    s_mov_b32 m0, s35
    s_add_u32 s35, s35, 1024
    buffer_load_dwordx4 v103, s[8:11], s28 offen lds
    v_mfma_f32_16x16x32_bf16 v[36:39], a[44:47], v[68:71], v[36:39]
    ds_read_b128 v[64:67], v114 offset:256
    ds_read_b128 v[68:71], v114 offset:20736
    s_waitcnt lgkmcnt(4)
    v_mfma_f32_16x16x32_bf16 v[16:19], a[48:51], v[72:75], v[16:19]
    s_mov_b32 m0, s35
    s_add_u32 s35, s35, 1024
    buffer_load_dwordx4 v104, s[8:11], s28 offen lds
    v_mfma_f32_16x16x32_bf16 v[20:23], a[52:55], v[72:75], v[20:23]
    v_mfma_f32_16x16x32_bf16 v[24:27], a[56:59], v[72:75], v[24:27]
    s_mov_b32 m0, s35
    s_add_u32 s35, s35, 1024
    buffer_load_dwordx4 v105, s[8:11], s28 offen lds
    v_mfma_f32_16x16x32_bf16 v[28:31], a[48:51], v[76:79], v[28:31]
    v_mfma_f32_16x16x32_bf16 v[32:35], a[52:55], v[76:79], v[32:35]
    s_mov_b32 m0, s35
    s_add_u32 s35, s35, 1024
    buffer_load_dwordx4 v106, s[8:11], s28 offen lds
    v_mfma_f32_16x16x32_bf16 v[36:39], a[56:59], v[76:79], v[36:39]
    ds_read_b128 v[72:75], v115 offset:256
    ds_read_b128 v[76:79], v115 offset:20736
    s_waitcnt lgkmcnt(4)
    v_mfma_f32_16x16x32_bf16 v[16:19], a[60:63], v[80:83], v[16:19]
    s_mov_b32 m0, s35
    s_add_u32 s35, s35, 1024
    buffer_load_dwordx4 v107, s[8:11], s28 offen lds
    v_mfma_f32_16x16x32_bf16 v[20:23], a[64:67], v[80:83], v[20:23]
    v_mfma_f32_16x16x32_bf16 v[24:27], a[68:71], v[80:83], v[24:27]
    s_mov_b32 m0, s35
    s_add_u32 s35, s35, 1024
    buffer_load_dwordx4 v108, s[8:11], s28 offen lds
    v_mfma_f32_16x16x32_bf16 v[28:31], a[60:63], v[84:87], v[28:31]
    v_mfma_f32_16x16x32_bf16 v[32:35], a[64:67], v[84:87], v[32:35]
    s_mov_b32 m0, s35
    s_add_u32 s35, s35, 1024
    buffer_load_dwordx4 v109, s[8:11], s28 offen lds
    v_mfma_f32_16x16x32_bf16 v[36:39], a[68:71], v[84:87], v[36:39]
    ds_read_b128 v[80:83], v112 offset:512
    ds_read_b128 v[84:87], v112 offset:20992
    s_waitcnt lgkmcnt(4)
    v_mfma_f32_16x16x32_bf16 v[16:19], a[72:75], v[64:67], v[16:19]
    s_add_u32 s28, s28, s58
    s_xor_b32 s29, s29, 40960
    v_mfma_f32_16x16x32_bf16 v[20:23], a[76:79], v[64:67], v[20:23]
    v_mfma_f32_16x16x32_bf16 v[24:27], a[80:83], v[64:67], v[24:27]
    buffer_load_dword v89, v88, s[16:19], s49 offen sc1
    v_mfma_f32_16x16x32_bf16 v[28:31], a[72:75], v[68:71], v[28:31]
    v_mfma_f32_16x16x32_bf16 v[32:35], a[76:79], v[68:71], v[32:35]
    v_mfma_f32_16x16x32_bf16 v[36:39], a[80:83], v[68:71], v[36:39]
    ds_read_b128 v[64:67], v113 offset:512
    ds_read_b128 v[68:71], v113 offset:20992
    s_waitcnt lgkmcnt(4)
    v_mfma_f32_16x16x32_bf16 v[16:19], a[84:87], v[72:75], v[16:19]
    v_mfma_f32_16x16x32_bf16 v[20:23], a[88:91], v[72:75], v[20:23]
    v_mfma_f32_16x16x32_bf16 v[24:27], a[92:95], v[72:75], v[24:27]
    v_mfma_f32_16x16x32_bf16 v[28:31], a[84:87], v[76:79], v[28:31]
    v_mfma_f32_16x16x32_bf16 v[32:35], a[88:91], v[76:79], v[32:35]
    v_mfma_f32_16x16x32_bf16 v[36:39], a[92:95], v[76:79], v[36:39]
    ds_read_b128 v[72:75], v114 offset:512
    ds_read_b128 v[76:79], v114 offset:20992
    s_waitcnt lgkmcnt(4)
    v_mfma_f32_16x16x32_bf16 v[16:19], a[96:99], v[80:83], v[16:19]
    v_mfma_f32_16x16x32_bf16 v[20:23], a[100:103], v[80:83], v[20:23]
    v_mfma_f32_16x16x32_bf16 v[24:27], a[104:107], v[80:83], v[24:27]
    v_mfma_f32_16x16x32_bf16 v[28:31], a[96:99], v[84:87], v[28:31]
    v_mfma_f32_16x16x32_bf16 v[32:35], a[100:103], v[84:87], v[32:35]
    v_mfma_f32_16x16x32_bf16 v[36:39], a[104:107], v[84:87], v[36:39]
    ds_read_b128 v[80:83], v115 offset:512
    ds_read_b128 v[84:87], v115 offset:20992
    s_waitcnt lgkmcnt(4)
    v_mfma_f32_16x16x32_bf16 v[16:19], a[108:111], v[64:67], v[16:19]
    v_mfma_f32_16x16x32_bf16 v[20:23], a[112:115], v[64:67], v[20:23]
    v_mfma_f32_16x16x32_bf16 v[24:27], a[116:119], v[64:67], v[24:27]
    v_mfma_f32_16x16x32_bf16 v[28:31], a[108:111], v[68:71], v[28:31]
    v_mfma_f32_16x16x32_bf16 v[32:35], a[112:115], v[68:71], v[32:35]
    v_mfma_f32_16x16x32_bf16 v[36:39], a[116:119], v[68:71], v[36:39]
    ds_read_b128 v[64:67], v112 offset:768
    ds_read_b128 v[68:71], v112 offset:21248
    s_waitcnt lgkmcnt(4)
    v_mfma_f32_16x16x32_bf16 v[16:19], a[120:123], v[72:75], v[16:19]
    v_mfma_f32_16x16x32_bf16 v[20:23], a[124:127], v[72:75], v[20:23]
    v_mfma_f32_16x16x32_bf16 v[24:27], a[128:131], v[72:75], v[24:27]
    v_mfma_f32_16x16x32_bf16 v[28:31], a[120:123], v[76:79], v[28:31]
    v_mfma_f32_16x16x32_bf16 v[32:35], a[124:127], v[76:79], v[32:35]
    v_mfma_f32_16x16x32_bf16 v[36:39], a[128:131], v[76:79], v[36:39]
    ds_read_b128 v[72:75], v113 offset:768
    ds_read_b128 v[76:79], v113 offset:21248
    s_waitcnt lgkmcnt(4)
    v_mfma_f32_16x16x32_bf16 v[16:19], a[132:135], v[80:83], v[16:19]
    v_mfma_f32_16x16x32_bf16 v[20:23], a[136:139], v[80:83], v[20:23]
    v_mfma_f32_16x16x32_bf16 v[24:27], a[140:143], v[80:83], v[24:27]
    v_mfma_f32_16x16x32_bf16 v[28:31], a[132:135], v[84:87], v[28:31]
    v_mfma_f32_16x16x32_bf16 v[32:35], a[136:139], v[84:87], v[32:35]
    v_mfma_f32_16x16x32_bf16 v[36:39], a[140:143], v[84:87], v[36:39]
    ds_read_b128 v[80:83], v114 offset:768
    ds_read_b128 v[84:87], v114 offset:21248
    s_waitcnt lgkmcnt(4)
    v_mfma_f32_16x16x32_bf16 v[16:19], a[144:147], v[64:67], v[16:19]
    v_mfma_f32_16x16x32_bf16 v[20:23], a[148:151], v[64:67], v[20:23]
    v_mfma_f32_16x16x32_bf16 v[24:27], a[152:155], v[64:67], v[24:27]
    v_mfma_f32_16x16x32_bf16 v[28:31], a[144:147], v[68:71], v[28:31]
    v_mfma_f32_16x16x32_bf16 v[32:35], a[148:151], v[68:71], v[32:35]
    v_mfma_f32_16x16x32_bf16 v[36:39], a[152:155], v[68:71], v[36:39]
    ds_read_b128 v[64:67], v115 offset:768
    ds_read_b128 v[68:71], v115 offset:21248
    s_waitcnt lgkmcnt(4)
    v_mfma_f32_16x16x32_bf16 v[16:19], a[156:159], v[72:75], v[16:19]
    v_mfma_f32_16x16x32_bf16 v[20:23], a[160:163], v[72:75], v[20:23]
    v_mfma_f32_16x16x32_bf16 v[24:27], a[164:167], v[72:75], v[24:27]
    v_mfma_f32_16x16x32_bf16 v[28:31], a[156:159], v[76:79], v[28:31]
    v_mfma_f32_16x16x32_bf16 v[32:35], a[160:163], v[76:79], v[32:35]
    v_mfma_f32_16x16x32_bf16 v[36:39], a[164:167], v[76:79], v[36:39]
    ds_read_b128 v[72:75], v112 offset:1024
    ds_read_b128 v[76:79], v112 offset:21504
    s_waitcnt lgkmcnt(4)
    v_mfma_f32_16x16x32_bf16 v[16:19], a[168:171], v[80:83], v[16:19]
    v_mfma_f32_16x16x32_bf16 v[20:23], a[172:175], v[80:83], v[20:23]
    v_mfma_f32_16x16x32_bf16 v[24:27], a[176:179], v[80:83], v[24:27]
    v_mfma_f32_16x16x32_bf16 v[28:31], a[168:171], v[84:87], v[28:31]
    v_mfma_f32_16x16x32_bf16 v[32:35], a[172:175], v[84:87], v[32:35]
    v_mfma_f32_16x16x32_bf16 v[36:39], a[176:179], v[84:87], v[36:39]
    ds_read_b128 v[80:83], v113 offset:1024
    ds_read_b128 v[84:87], v113 offset:21504
    s_waitcnt lgkmcnt(4)
    v_mfma_f32_16x16x32_bf16 v[16:19], a[180:183], v[64:67], v[16:19]
    v_mfma_f32_16x16x32_bf16 v[20:23], a[184:187], v[64:67], v[20:23]
    v_mfma_f32_16x16x32_bf16 v[24:27], a[188:191], v[64:67], v[24:27]
    v_mfma_f32_16x16x32_bf16 v[28:31], a[180:183], v[68:71], v[28:31]
    v_mfma_f32_16x16x32_bf16 v[32:35], a[184:187], v[68:71], v[32:35]
    v_mfma_f32_16x16x32_bf16 v[36:39], a[188:191], v[68:71], v[36:39]
    ds_read_b128 v[64:67], v114 offset:1024
    ds_read_b128 v[68:71], v114 offset:21504
    s_waitcnt lgkmcnt(4)
    v_mfma_f32_16x16x32_bf16 v[16:19], a[192:195], v[72:75], v[16:19]
    v_mfma_f32_16x16x32_bf16 v[20:23], a[196:199], v[72:75], v[20:23]
    v_mfma_f32_16x16x32_bf16 v[24:27], a[200:203], v[72:75], v[24:27]
    v_mfma_f32_16x16x32_bf16 v[28:31], a[192:195], v[76:79], v[28:31]
    v_mfma_f32_16x16x32_bf16 v[32:35], a[196:199], v[76:79], v[32:35]
    v_mfma_f32_16x16x32_bf16 v[36:39], a[200:203], v[76:79], v[36:39]
    ds_read_b128 v[72:75], v115 offset:1024
    ds_read_b128 v[76:79], v115 offset:21504
    s_waitcnt lgkmcnt(4)
    v_mfma_f32_16x16x32_bf16 v[16:19], a[204:207], v[80:83], v[16:19]
    v_mfma_f32_16x16x32_bf16 v[20:23], a[208:211], v[80:83], v[20:23]
    v_mfma_f32_16x16x32_bf16 v[24:27], a[212:215], v[80:83], v[24:27]
    v_mfma_f32_16x16x32_bf16 v[28:31], a[204:207], v[84:87], v[28:31]
    v_mfma_f32_16x16x32_bf16 v[32:35], a[208:211], v[84:87], v[32:35]
    v_mfma_f32_16x16x32_bf16 v[36:39], a[212:215], v[84:87], v[36:39]
    s_waitcnt lgkmcnt(2)
    v_mfma_f32_16x16x32_bf16 v[16:19], a[216:219], v[64:67], v[16:19]
    v_mfma_f32_16x16x32_bf16 v[20:23], a[220:223], v[64:67], v[20:23]
    v_mfma_f32_16x16x32_bf16 v[24:27], a[224:227], v[64:67], v[24:27]
    v_mfma_f32_16x16x32_bf16 v[28:31], a[216:219], v[68:71], v[28:31]
    v_mfma_f32_16x16x32_bf16 v[32:35], a[220:223], v[68:71], v[32:35]
    v_mfma_f32_16x16x32_bf16 v[36:39], a[224:227], v[68:71], v[36:39]
    s_waitcnt lgkmcnt(0)
    v_mfma_f32_16x16x32_bf16 v[16:19], a[228:231], v[72:75], v[16:19]
    v_mfma_f32_16x16x32_bf16 v[20:23], a[232:235], v[72:75], v[20:23]
    v_mfma_f32_16x16x32_bf16 v[24:27], a[236:239], v[72:75], v[24:27]
    v_mfma_f32_16x16x32_bf16 v[28:31], a[228:231], v[76:79], v[28:31]
    v_mfma_f32_16x16x32_bf16 v[32:35], a[232:235], v[76:79], v[32:35]
    v_mfma_f32_16x16x32_bf16 v[36:39], a[236:239], v[76:79], v[36:39]
    s_nop 7
    v_cvt_pk_bf16_f32 v64, v16, v17
    v_cvt_pk_bf16_f32 v65, v18, v19
    v_cvt_pk_bf16_f32 v66, v20, v21
    v_cvt_pk_bf16_f32 v67, v22, v23
    v_cvt_pk_bf16_f32 v68, v24, v25
    v_cvt_pk_bf16_f32 v69, v26, v27
    ds_write_b128 v9, v[64:67] offset:0
    ds_write_b64 v10, v[68:69] offset:0
    v_cvt_pk_bf16_f32 v70, v28, v29
    v_cvt_pk_bf16_f32 v71, v30, v31
    v_cvt_pk_bf16_f32 v72, v32, v33
    v_cvt_pk_bf16_f32 v73, v34, v35
    v_cvt_pk_bf16_f32 v74, v36, v37
    v_cvt_pk_bf16_f32 v75, v38, v39
    ds_write_b128 v9, v[70:73] offset:6144
    ds_write_b64 v10, v[74:75] offset:6144
    s_add_u32 s40, s44, s48
    s_mov_b32 s26, s45
    s_mov_b32 s27, s46
    s_mul_i32 s30, s41, 393216
    s_add_u32 s44, s44, s30
    s_mul_i32 s30, s41, 98304
    s_add_u32 s45, s45, s30
    s_mul_i32 s30, s41, 131072
    s_add_u32 s46, s46, s30
    s_add_u32 s59, s59, s41
    s_add_u32 s38, s38, 1
QA_loop:
    s_waitcnt vmcnt(0)
    s_sub_u32 s23, s39, s41
    s_cmp_eq_u32 s76, 1
    s_cbranch_scc1 QA_lm_58
    v_mov_b32 v14, s23
    buffer_store_dword v14, v250, s[16:19], s50 offen sc1
    s_cmp_ge_u32 s55, s39
    s_cbranch_scc1 QA_wf_60
    v_min_u32 v14, 7, v1
    v_lshlrev_b32 v14, 2, v14
QA_wf_59:
    buffer_load_dword v15, v14, s[16:19], s49 offen sc1
    s_sub_u32 s34, s34, 1
    s_cbranch_scc1 G_end
    s_waitcnt vmcnt(0)
    s_nop 1
    v_min_u32_dpp v15, v15, v15 row_shl:1 row_mask:0xf bank_mask:0xf
    s_nop 1
    v_min_u32_dpp v15, v15, v15 row_shl:2 row_mask:0xf bank_mask:0xf
    s_nop 1
    v_min_u32_dpp v15, v15, v15 row_shl:4 row_mask:0xf bank_mask:0xf
    s_nop 1
    v_readfirstlane_b32 s55, v15
    s_cmp_ge_u32 s55, s39
    s_cbranch_scc1 QA_wf_60
    s_sleep 16
    s_branch QA_wf_59
QA_wf_60:
    s_lshl_b32 s79, s25, 10
    s_add_u32 s37, s79, s47
    s_add_u32 m0, s37, 24576
    s_add_u32 s78, s26, s79
    buffer_load_dwordx4 v11, s[16:19], s78 offen  lds
    s_add_u32 m0, s37, 28672
    s_add_u32 s78, s27, s79
    buffer_load_dwordx4 v11, s[16:19], s78 offen  lds
    s_waitcnt vmcnt(0)
QA_lm_58:
    s_waitcnt lgkmcnt(0)
    s_barrier
    v_add_u32 v124, s47, v11
    v_add_u32 v125, s47, v126
    v_add_u32 v2, s47, v127
    v_add_u32 v7, s47, v248
    s_xor_b32 s47, s47, 32768
    s_add_u32 s39, s59, 1
    s_xor_b32 s30, s29, 40960
    v_add_u32 v112, s30, v120
    v_add_u32 v113, s30, v121
    v_add_u32 v114, s30, v122
    v_add_u32 v115, s30, v123
    s_cmp_ge_u32 s53, s39
    s_cbranch_scc1 QA_wf_62
    v_min_u32 v14, 3, v1
    v_lshlrev_b32 v14, 2, v14
QA_wf_61:
    buffer_load_dword v15, v14, s[16:19], s51 offen sc1
    s_sub_u32 s34, s34, 1
    s_cbranch_scc1 G_end
    s_waitcnt vmcnt(0)
    s_nop 1
    v_min_u32_dpp v15, v15, v15 row_shl:1 row_mask:0xf bank_mask:0xf
    s_nop 1
    v_min_u32_dpp v15, v15, v15 row_shl:2 row_mask:0xf bank_mask:0xf
    s_nop 1
    v_readfirstlane_b32 s53, v15
    s_cmp_ge_u32 s53, s39
    s_cbranch_scc1 QA_wf_62
    s_sleep 16
    s_branch QA_wf_61
QA_wf_62:
    s_cmp_ge_u32 s54, s39
    s_cbranch_scc1 QA_wf_64
    v_min_u32 v14, 3, v1
    v_lshlrev_b32 v14, 2, v14
QA_wf_63:
    buffer_load_dword v15, v14, s[16:19], s52 offen sc1
    s_sub_u32 s34, s34, 1
    s_cbranch_scc1 G_end
    s_waitcnt vmcnt(0)
    s_nop 1
    v_min_u32_dpp v15, v15, v15 row_shl:1 row_mask:0xf bank_mask:0xf
    s_nop 1
    v_min_u32_dpp v15, v15, v15 row_shl:2 row_mask:0xf bank_mask:0xf
    s_nop 1
    v_readfirstlane_b32 s54, v15
    s_cmp_ge_u32 s54, s39
    s_cbranch_scc1 QA_wf_64
    s_sleep 16
    s_branch QA_wf_63
QA_wf_64:
    ds_read_b128 v[64:67], v112 offset:0
    ds_read_b128 v[68:71], v112 offset:20480
    ds_read_b128 v[72:75], v113 offset:0
    ds_read_b128 v[76:79], v113 offset:20480
    ds_read_b128 v[80:83], v114 offset:0
    ds_read_b128 v[84:87], v114 offset:20480
    s_waitcnt lgkmcnt(4)
    v_mfma_f32_16x16x32_bf16 v[16:19], a[0:3], v[64:67], 0
    v_mov_b32 v14, s23
    buffer_store_dword v14, v250, s[16:19], s50 offen sc1
    v_min_u32_dpp v89, v89, v89 row_shl:1 row_mask:0xf bank_mask:0xf
    v_mfma_f32_16x16x32_bf16 v[20:23], a[4:7], v[64:67], 0
    ds_read_b128 v[40:43], v6 offset:0
    ds_read_b128 v[128:131], v124 offset:0
    ds_read_b128 v[152:155], v124 offset:6144
    v_mfma_f32_16x16x32_bf16 v[24:27], a[8:11], v[64:67], 0
    v_min_u32_dpp v89, v89, v89 row_shl:2 row_mask:0xf bank_mask:0xf
    v_mfma_f32_16x16x32_bf16 v[28:31], a[0:3], v[68:71], 0
    ds_read_b128 v[176:179], v2 offset:0
    ds_read_b128 v[44:47], v6 offset:1024
    ds_read_b128 v[132:135], v124 offset:1024
    v_mfma_f32_16x16x32_bf16 v[32:35], a[4:7], v[68:71], 0
    v_min_u32_dpp v89, v89, v89 row_shl:4 row_mask:0xf bank_mask:0xf
    v_mfma_f32_16x16x32_bf16 v[36:39], a[8:11], v[68:71], 0
    ds_read_b128 v[156:159], v124 offset:7168
    ds_read_b128 v[180:183], v2 offset:512
    ds_read_b128 v[48:51], v6 offset:2048
    ds_read_b128 v[64:67], v115 offset:0
    ds_read_b128 v[68:71], v115 offset:20480
    s_waitcnt lgkmcnt(13)
    v_mfma_f32_16x16x32_bf16 v[16:19], a[12:15], v[72:75], v[16:19]
    v_readfirstlane_b32 s37, v89
    s_max_u32 s55, s55, s37
    v_mfma_f32_16x16x32_bf16 v[20:23], a[16:19], v[72:75], v[20:23]
    ds_read_b128 v[136:139], v124 offset:2048
    ds_read_b128 v[160:163], v124 offset:8192
    ds_read_b128 v[184:187], v2 offset:1024
    v_mfma_f32_16x16x32_bf16 v[24:27], a[20:23], v[72:75], v[24:27]
    s_mov_b32 s76, 0
    s_cmp_lt_u32 s55, s39
    s_cbranch_scc1 QA_em_65
    s_mov_b32 s76, 1
    s_lshl_b32 s79, s25, 10
    s_add_u32 s37, s79, s47
    s_add_u32 m0, s37, 24576
    s_add_u32 s78, s45, s79
    buffer_load_dwordx4 v11, s[16:19], s78 offen  lds
    s_add_u32 m0, s37, 28672
    s_add_u32 s78, s46, s79
    buffer_load_dwordx4 v11, s[16:19], s78 offen  lds
QA_em_65:
    v_mfma_f32_16x16x32_bf16 v[28:31], a[12:15], v[76:79], v[28:31]
    s_waitcnt lgkmcnt(10)
    v_mfma_f32_16x16x32_bf16 v[240:243], v[128:131], v[40:43], 0
    v_mfma_f32_16x16x32_bf16 v[244:247], v[152:155], v[40:43], 0
    v_mfma_f32_16x16x32_bf16 v[236:239], v[176:179], v[40:43], 0
    v_mfma_f32_16x16x32_bf16 v[32:35], a[16:19], v[76:79], v[32:35]
    s_mul_i32 s77, s25, 3072
    s_add_u32 s30, s44, s77
    s_add_u32 s31, s30, 100663296
    s_add_u32 s30, s30, 50331648
    s_add_u32 s77, s77, s47
    s_add_u32 s78, s77, 12288
    s_add_u32 s35, s29, s33
    v_mfma_f32_16x16x32_bf16 v[36:39], a[20:23], v[76:79], v[36:39]
    ds_read_b128 v[52:55], v6 offset:3072
    ds_read_b128 v[140:143], v124 offset:3072
    ds_read_b128 v[164:167], v124 offset:9216
    ds_read_b128 v[72:75], v112 offset:256
    ds_read_b128 v[76:79], v112 offset:20736
    v_mfma_f32_16x16x32_bf16 v[16:19], a[24:27], v[80:83], v[16:19]
    s_mov_b32 m0, s77
    s_nop 0
    buffer_load_dwordx4 v11, s[16:19], s30 offen offset:0  lds
    v_mfma_f32_16x16x32_bf16 v[20:23], a[28:31], v[80:83], v[20:23]
    ds_read_b128 v[188:191], v2 offset:1536
    s_waitcnt lgkmcnt(12)
    v_mfma_f32_16x16x32_bf16 v[240:243], v[132:135], v[44:47], v[240:243]
    v_mfma_f32_16x16x32_bf16 v[244:247], v[156:159], v[44:47], v[244:247]
    v_mfma_f32_16x16x32_bf16 v[24:27], a[32:35], v[80:83], v[24:27]
    s_mov_b32 m0, s77
    s_nop 0
    buffer_load_dwordx4 v11, s[16:19], s30 offen offset:1024  lds
    v_mfma_f32_16x16x32_bf16 v[28:31], a[24:27], v[84:87], v[28:31]
    v_mfma_f32_16x16x32_bf16 v[236:239], v[180:183], v[44:47], v[236:239]
    ds_read_b128 v[56:59], v6 offset:4096
    ds_read_b128 v[144:147], v124 offset:4096
    v_mfma_f32_16x16x32_bf16 v[32:35], a[28:31], v[84:87], v[32:35]
    s_mov_b32 m0, s77
    s_nop 0
    buffer_load_dwordx4 v11, s[16:19], s30 offen offset:2048  lds
    v_mfma_f32_16x16x32_bf16 v[36:39], a[32:35], v[84:87], v[36:39]
    ds_read_b128 v[168:171], v124 offset:10240
    ds_read_b128 v[192:195], v2 offset:2048
    s_waitcnt lgkmcnt(10)
    v_mfma_f32_16x16x32_bf16 v[240:243], v[136:139], v[48:51], v[240:243]
    ds_read_b128 v[80:83], v113 offset:256
    ds_read_b128 v[84:87], v113 offset:20736
    v_mfma_f32_16x16x32_bf16 v[16:19], a[36:39], v[64:67], v[16:19]
    s_mov_b32 m0, s78
    s_nop 0
    buffer_load_dwordx4 v11, s[16:19], s31 offen offset:0  lds
    v_mfma_f32_16x16x32_bf16 v[20:23], a[40:43], v[64:67], v[20:23]
    v_mfma_f32_16x16x32_bf16 v[244:247], v[160:163], v[48:51], v[244:247]
    v_mfma_f32_16x16x32_bf16 v[236:239], v[184:187], v[48:51], v[236:239]
    ds_read_b128 v[60:63], v6 offset:5120
    v_mfma_f32_16x16x32_bf16 v[24:27], a[44:47], v[64:67], v[24:27]
    s_mov_b32 m0, s78
    s_nop 0
    buffer_load_dwordx4 v11, s[16:19], s31 offen offset:1024  lds
    v_mfma_f32_16x16x32_bf16 v[28:31], a[36:39], v[68:71], v[28:31]
    ds_read_b128 v[148:151], v124 offset:5120
    ds_read_b128 v[172:175], v124 offset:11264
    ds_read_b128 v[196:199], v2 offset:2560
    v_mfma_f32_16x16x32_bf16 v[32:35], a[40:43], v[68:71], v[32:35]
    s_mov_b32 m0, s78
    s_nop 0
    buffer_load_dwordx4 v11, s[16:19], s31 offen offset:2048  lds
    v_mfma_f32_16x16x32_bf16 v[36:39], a[44:47], v[68:71], v[36:39]
    s_waitcnt lgkmcnt(10)
    v_mfma_f32_16x16x32_bf16 v[240:243], v[140:143], v[52:55], v[240:243]
    v_mfma_f32_16x16x32_bf16 v[244:247], v[164:167], v[52:55], v[244:247]
    v_mfma_f32_16x16x32_bf16 v[236:239], v[188:191], v[52:55], v[236:239]
    ds_read_b128 v[64:67], v114 offset:256
    ds_read_b128 v[68:71], v114 offset:20736
    v_mfma_f32_16x16x32_bf16 v[16:19], a[48:51], v[72:75], v[16:19]
    s_mov_b32 m0, s35
    s_add_u32 s35, s35, 1024
    buffer_load_dwordx4 v100, s[8:11], s28 offen lds
    v_mfma_f32_16x16x32_bf16 v[20:23], a[52:55], v[72:75], v[20:23]
    s_waitcnt lgkmcnt(8)
    v_mfma_f32_16x16x32_bf16 v[240:243], v[144:147], v[56:59], v[240:243]
    v_mfma_f32_16x16x32_bf16 v[244:247], v[168:171], v[56:59], v[244:247]
    v_mfma_f32_16x16x32_bf16 v[236:239], v[192:195], v[56:59], v[236:239]
    v_mfma_f32_16x16x32_bf16 v[24:27], a[56:59], v[72:75], v[24:27]
    s_mov_b32 m0, s35
    s_add_u32 s35, s35, 1024
    buffer_load_dwordx4 v101, s[8:11], s28 offen lds
    v_mfma_f32_16x16x32_bf16 v[28:31], a[48:51], v[76:79], v[28:31]
    s_waitcnt lgkmcnt(2)
    v_mfma_f32_16x16x32_bf16 v[240:243], v[148:151], v[60:63], v[240:243]
    v_mfma_f32_16x16x32_bf16 v[244:247], v[172:175], v[60:63], v[244:247]
    v_mfma_f32_16x16x32_bf16 v[236:239], v[196:199], v[60:63], v[236:239]
    v_mfma_f32_16x16x32_bf16 v[32:35], a[52:55], v[76:79], v[32:35]
    s_mov_b32 m0, s35
    s_add_u32 s35, s35, 1024
    buffer_load_dwordx4 v102, s[8:11], s28 offen lds
    v_mfma_f32_16x16x32_bf16 v[36:39], a[56:59], v[76:79], v[36:39]
    ds_read_b128 v[200:203], v125 offset:0
    ds_read_b128 v[204:207], v125 offset:1024
    ds_read_b128 v[208:211], v125 offset:2048
    ds_read_b128 v[72:75], v115 offset:256
    ds_read_b128 v[76:79], v115 offset:20736
    v_mfma_f32_16x16x32_bf16 v[16:19], a[60:63], v[80:83], v[16:19]
    s_mov_b32 m0, s35
    s_add_u32 s35, s35, 1024
    buffer_load_dwordx4 v103, s[8:11], s28 offen lds
    v_mfma_f32_16x16x32_bf16 v[20:23], a[64:67], v[80:83], v[20:23]
    ds_read_b128 v[212:215], v125 offset:3072
    ds_read_b128 v[216:219], v125 offset:4096
    ds_read_b128 v[220:223], v125 offset:5120
    v_mfma_f32_16x16x32_bf16 v[24:27], a[68:71], v[80:83], v[24:27]
    s_mov_b32 m0, s35
    s_add_u32 s35, s35, 1024
    buffer_load_dwordx4 v104, s[8:11], s28 offen lds
    v_mfma_f32_16x16x32_bf16 v[28:31], a[60:63], v[84:87], v[28:31]
    ds_read_b128 v[224:227], v7 offset:0
    ds_read_b128 v[228:231], v7 offset:1024
    s_waitcnt lgkmcnt(0)
    s_barrier
    v_mfma_f32_16x16x32_bf16 v[32:35], a[64:67], v[84:87], v[32:35]
    s_mov_b32 m0, s35
    s_add_u32 s35, s35, 1024
    buffer_load_dwordx4 v105, s[8:11], s28 offen lds
    v_mfma_f32_16x16x32_bf16 v[36:39], a[68:71], v[84:87], v[36:39]
    v_cndmask_b32 v240, v240, v249, s[60:61]
    v_cndmask_b32 v244, v244, v249, s[68:69]
    v_cndmask_b32 v241, v241, v249, s[62:63]
    ds_read_b128 v[80:83], v112 offset:512
    ds_read_b128 v[84:87], v112 offset:20992
    v_mfma_f32_16x16x32_bf16 v[16:19], a[72:75], v[64:67], v[16:19]
    s_mov_b32 m0, s35
    s_add_u32 s35, s35, 1024
    buffer_load_dwordx4 v106, s[8:11], s28 offen lds
    v_mfma_f32_16x16x32_bf16 v[20:23], a[76:79], v[64:67], v[20:23]
    v_cndmask_b32 v245, v245, v249, s[70:71]
    v_cndmask_b32 v242, v242, v249, s[64:65]
    v_cndmask_b32 v246, v246, v249, s[72:73]
    v_mfma_f32_16x16x32_bf16 v[24:27], a[80:83], v[64:67], v[24:27]
    s_mov_b32 m0, s35
    s_add_u32 s35, s35, 1024
    buffer_load_dwordx4 v107, s[8:11], s28 offen lds
    v_mfma_f32_16x16x32_bf16 v[28:31], a[72:75], v[68:71], v[28:31]
    v_cndmask_b32 v243, v243, v249, s[66:67]
    v_cndmask_b32 v247, v247, v249, s[74:75]
    v_max3_f32 v40, v240, v241, v242
    v_mfma_f32_16x16x32_bf16 v[32:35], a[76:79], v[68:71], v[32:35]
    s_mov_b32 m0, s35
    s_add_u32 s35, s35, 1024
    buffer_load_dwordx4 v108, s[8:11], s28 offen lds
    v_mfma_f32_16x16x32_bf16 v[36:39], a[80:83], v[68:71], v[36:39]
    v_max3_f32 v41, v243, v244, v245
    v_max3_f32 v40, v40, v246, v247
    v_max3_f32 v41, v41, v236, v237
    ds_read_b128 v[64:67], v113 offset:512
    ds_read_b128 v[68:71], v113 offset:20992
    v_mfma_f32_16x16x32_bf16 v[16:19], a[84:87], v[72:75], v[16:19]
    s_mov_b32 m0, s35
    s_add_u32 s35, s35, 1024
    buffer_load_dwordx4 v109, s[8:11], s28 offen lds
    v_mfma_f32_16x16x32_bf16 v[20:23], a[88:91], v[72:75], v[20:23]
    v_max_f32 v40, v40, v41
    v_mov_b32 v41, v40
    v_mfma_f32_16x16x32_bf16 v[24:27], a[92:95], v[72:75], v[24:27]
    s_add_u32 s28, s28, s58
    s_xor_b32 s29, s29, 40960
    v_mfma_f32_16x16x32_bf16 v[28:31], a[84:87], v[76:79], v[28:31]
    v_permlane32_swap_b32 v40, v41
    v_max_f32 v40, v40, v41
    v_mov_b32 v41, v40
    v_mfma_f32_16x16x32_bf16 v[32:35], a[88:91], v[76:79], v[32:35]
    buffer_load_dword v89, v88, s[16:19], s49 offen sc1
    v_mfma_f32_16x16x32_bf16 v[36:39], a[92:95], v[76:79], v[36:39]
    ds_read_b128 v[72:75], v114 offset:512
    ds_read_b128 v[76:79], v114 offset:20992
    s_waitcnt lgkmcnt(4)
    v_mfma_f32_16x16x32_bf16 v[16:19], a[96:99], v[80:83], v[16:19]
    v_mfma_f32_16x16x32_bf16 v[20:23], a[100:103], v[80:83], v[20:23]
    v_permlane16_swap_b32 v40, v41
    v_max_f32 v40, v40, v41
    v_mul_f32 v42, s56, v40
    v_mfma_f32_16x16x32_bf16 v[24:27], a[104:107], v[80:83], v[24:27]
    v_fma_f32 v240, v240, s56, -v42
    v_fma_f32 v241, v241, s56, -v42
    v_fma_f32 v242, v242, s56, -v42
    v_mfma_f32_16x16x32_bf16 v[28:31], a[96:99], v[84:87], v[28:31]
    v_fma_f32 v243, v243, s56, -v42
    v_fma_f32 v244, v244, s56, -v42
    v_fma_f32 v245, v245, s56, -v42
    v_mfma_f32_16x16x32_bf16 v[32:35], a[100:103], v[84:87], v[32:35]
    v_fma_f32 v246, v246, s56, -v42
    v_fma_f32 v247, v247, s56, -v42
    v_fma_f32 v236, v236, s56, -v42
    v_mfma_f32_16x16x32_bf16 v[36:39], a[104:107], v[84:87], v[36:39]
    v_fma_f32 v237, v237, s56, -v42
    v_exp_f32 v240, v240
    v_exp_f32 v241, v241
    ds_read_b128 v[80:83], v115 offset:512
    ds_read_b128 v[84:87], v115 offset:20992
    s_waitcnt lgkmcnt(4)
    v_mfma_f32_16x16x32_bf16 v[16:19], a[108:111], v[64:67], v[16:19]
    v_exp_f32 v242, v242
    v_exp_f32 v243, v243
    v_exp_f32 v244, v244
    v_mfma_f32_16x16x32_bf16 v[20:23], a[112:115], v[64:67], v[20:23]
    v_exp_f32 v245, v245
    v_exp_f32 v246, v246
    v_exp_f32 v247, v247
    v_mfma_f32_16x16x32_bf16 v[24:27], a[116:119], v[64:67], v[24:27]
    v_exp_f32 v236, v236
    v_exp_f32 v237, v237
    v_cvt_pk_bf16_f32 v48, v240, v241
    v_mfma_f32_16x16x32_bf16 v[28:31], a[108:111], v[68:71], v[28:31]
    v_cvt_pk_bf16_f32 v49, v242, v243
    v_cvt_pk_bf16_f32 v50, v244, v245
    v_cvt_pk_bf16_f32 v51, v246, v247
    v_mfma_f32_16x16x32_bf16 v[32:35], a[112:115], v[68:71], v[32:35]
    v_cvt_pk_bf16_f32 v52, v236, v237
    v_cvt_pk_bf16_f32 v53, v236, v237
    v_cvt_pk_bf16_f32 v232, v236, v237
    v_mfma_f32_16x16x32_bf16 v[36:39], a[116:119], v[68:71], v[36:39]
    v_cvt_pk_bf16_f32 v235, v236, v237
    ds_read_b128 v[64:67], v112 offset:768
    ds_read_b128 v[68:71], v112 offset:21248
    s_waitcnt lgkmcnt(4)
    v_mfma_f32_16x16x32_bf16 v[16:19], a[120:123], v[72:75], v[16:19]
    v_mfma_f32_16x16x32_bf16 v[20:23], a[124:127], v[72:75], v[20:23]
    v_mfma_f32_16x16x32_bf16 v[128:131], v[200:203], v[48:51], 0
    v_mfma_f32_16x16x32_bf16 v[132:135], v[204:207], v[48:51], 0
    v_mfma_f32_16x16x32_bf16 v[136:139], v[208:211], v[48:51], 0
    v_mfma_f32_16x16x32_bf16 v[24:27], a[128:131], v[72:75], v[24:27]
    v_mfma_f32_16x16x32_bf16 v[140:143], v[212:215], v[48:51], 0
    v_mfma_f32_16x16x32_bf16 v[144:147], v[216:219], v[48:51], 0
    v_mfma_f32_16x16x32_bf16 v[148:151], v[220:223], v[48:51], 0
    v_mfma_f32_16x16x32_bf16 v[28:31], a[120:123], v[76:79], v[28:31]
    v_mfma_f32_16x16x16_bf16 v[128:131], v[224:225], v[232:233], v[128:131]
    v_mfma_f32_16x16x16_bf16 v[132:135], v[224:225], v[234:235], v[132:135]
    v_mfma_f32_16x16x16_bf16 v[136:139], v[226:227], v[52:53], v[136:139]
    v_mfma_f32_16x16x32_bf16 v[32:35], a[124:127], v[76:79], v[32:35]
    v_mfma_f32_16x16x16_bf16 v[140:143], v[228:229], v[232:233], v[140:143]
    v_mfma_f32_16x16x16_bf16 v[144:147], v[228:229], v[234:235], v[144:147]
    v_mfma_f32_16x16x16_bf16 v[148:151], v[230:231], v[52:53], v[148:151]
    v_mfma_f32_16x16x32_bf16 v[36:39], a[128:131], v[76:79], v[36:39]
    v_add_f32 v44, v236, v237
    v_add_f32 v41, v240, v241
    v_add_f32 v44, v44, v242
    ds_read_b128 v[72:75], v113 offset:768
    ds_read_b128 v[76:79], v113 offset:21248
    s_waitcnt lgkmcnt(4)
    v_mfma_f32_16x16x32_bf16 v[16:19], a[132:135], v[80:83], v[16:19]
    v_add_f32 v41, v41, v243
    v_add_f32 v44, v44, v244
    v_add_f32 v41, v41, v245
    v_mfma_f32_16x16x32_bf16 v[20:23], a[136:139], v[80:83], v[20:23]
    v_add_f32 v44, v44, v246
    v_add_f32 v41, v41, v247
    v_add_f32 v44, v44, v41
    v_mfma_f32_16x16x32_bf16 v[24:27], a[140:143], v[80:83], v[24:27]
    v_mov_b32 v41, v44
    v_mfma_f32_16x16x32_bf16 v[28:31], a[132:135], v[84:87], v[28:31]
    v_mfma_f32_16x16x32_bf16 v[32:35], a[136:139], v[84:87], v[32:35]
    v_permlane32_swap_b32 v44, v41
    v_add_f32 v44, v44, v41
    v_mov_b32 v41, v44
    v_mfma_f32_16x16x32_bf16 v[36:39], a[140:143], v[84:87], v[36:39]
    ds_read_b128 v[80:83], v114 offset:768
    ds_read_b128 v[84:87], v114 offset:21248
    s_waitcnt lgkmcnt(4)
    v_mfma_f32_16x16x32_bf16 v[16:19], a[144:147], v[64:67], v[16:19]
    v_mfma_f32_16x16x32_bf16 v[20:23], a[148:151], v[64:67], v[20:23]
    v_permlane16_swap_b32 v44, v41
    v_add_f32 v44, v44, v41
    v_rcp_f32 v44, v44
    v_mfma_f32_16x16x32_bf16 v[24:27], a[152:155], v[64:67], v[24:27]
    v_mfma_f32_16x16x32_bf16 v[28:31], a[144:147], v[68:71], v[28:31]
    v_mul_f32 v128, v128, v44
    v_mul_f32 v129, v129, v44
    v_mul_f32 v130, v130, v44
    v_mfma_f32_16x16x32_bf16 v[32:35], a[148:151], v[68:71], v[32:35]
    v_mul_f32 v131, v131, v44
    v_cvt_pk_bf16_f32 v176, v128, v129
    v_cvt_pk_bf16_f32 v177, v130, v131
    v_mfma_f32_16x16x32_bf16 v[36:39], a[152:155], v[68:71], v[36:39]
    v_mul_f32 v132, v132, v44
    v_mul_f32 v133, v133, v44
    v_mul_f32 v134, v134, v44
    ds_read_b128 v[64:67], v115 offset:768
    ds_read_b128 v[68:71], v115 offset:21248
    s_waitcnt lgkmcnt(4)
    v_mfma_f32_16x16x32_bf16 v[16:19], a[156:159], v[72:75], v[16:19]
    v_mul_f32 v135, v135, v44
    v_cvt_pk_bf16_f32 v178, v132, v133
    v_cvt_pk_bf16_f32 v179, v134, v135
    v_mfma_f32_16x16x32_bf16 v[20:23], a[160:163], v[72:75], v[20:23]
    buffer_store_dwordx4 v[176:179], v11, s[16:19], s40 offen offset:0 sc1
    v_mul_f32 v140, v140, v44
    v_mul_f32 v141, v141, v44
    v_mfma_f32_16x16x32_bf16 v[24:27], a[164:167], v[72:75], v[24:27]
    v_mul_f32 v142, v142, v44
    v_mul_f32 v143, v143, v44
    v_cvt_pk_bf16_f32 v180, v140, v141
    v_mfma_f32_16x16x32_bf16 v[28:31], a[156:159], v[76:79], v[28:31]
    v_cvt_pk_bf16_f32 v181, v142, v143
    v_mul_f32 v144, v144, v44
    v_mul_f32 v145, v145, v44
    v_mfma_f32_16x16x32_bf16 v[32:35], a[160:163], v[76:79], v[32:35]
    v_mul_f32 v146, v146, v44
    v_mul_f32 v147, v147, v44
    v_cvt_pk_bf16_f32 v182, v144, v145
    v_mfma_f32_16x16x32_bf16 v[36:39], a[164:167], v[76:79], v[36:39]
    v_cvt_pk_bf16_f32 v183, v146, v147
    buffer_store_dwordx4 v[180:183], v11, s[16:19], s40 offen offset:1024 sc1
    v_mul_f32 v136, v136, v44
    ds_read_b128 v[72:75], v112 offset:1024
    ds_read_b128 v[76:79], v112 offset:21504
    s_waitcnt lgkmcnt(4)
    v_mfma_f32_16x16x32_bf16 v[16:19], a[168:171], v[80:83], v[16:19]
    v_mul_f32 v137, v137, v44
    v_mul_f32 v138, v138, v44
    v_mul_f32 v139, v139, v44
    v_mfma_f32_16x16x32_bf16 v[20:23], a[172:175], v[80:83], v[20:23]
    v_cvt_pk_bf16_f32 v184, v136, v137
    v_cvt_pk_bf16_f32 v185, v138, v139
    v_mul_f32 v148, v148, v44
    v_mfma_f32_16x16x32_bf16 v[24:27], a[176:179], v[80:83], v[24:27]
    v_mul_f32 v149, v149, v44
    v_mul_f32 v150, v150, v44
    v_mul_f32 v151, v151, v44
    v_mfma_f32_16x16x32_bf16 v[28:31], a[168:171], v[84:87], v[28:31]
    v_cvt_pk_bf16_f32 v186, v148, v149
    v_cvt_pk_bf16_f32 v187, v150, v151
    buffer_store_dwordx4 v[184:187], v11, s[16:19], s40 offen offset:2048 sc1
    v_mfma_f32_16x16x32_bf16 v[32:35], a[172:175], v[84:87], v[32:35]
    v_mfma_f32_16x16x32_bf16 v[36:39], a[176:179], v[84:87], v[36:39]
    ds_read_b128 v[80:83], v113 offset:1024
    ds_read_b128 v[84:87], v113 offset:21504
    s_waitcnt lgkmcnt(4)
    v_mfma_f32_16x16x32_bf16 v[16:19], a[180:183], v[64:67], v[16:19]
    v_mfma_f32_16x16x32_bf16 v[20:23], a[184:187], v[64:67], v[20:23]
    v_mfma_f32_16x16x32_bf16 v[24:27], a[188:191], v[64:67], v[24:27]
    v_mfma_f32_16x16x32_bf16 v[28:31], a[180:183], v[68:71], v[28:31]
    v_mfma_f32_16x16x32_bf16 v[32:35], a[184:187], v[68:71], v[32:35]
    v_mfma_f32_16x16x32_bf16 v[36:39], a[188:191], v[68:71], v[36:39]
    ds_read_b128 v[64:67], v114 offset:1024
    ds_read_b128 v[68:71], v114 offset:21504
    s_waitcnt lgkmcnt(4)
    v_mfma_f32_16x16x32_bf16 v[16:19], a[192:195], v[72:75], v[16:19]
    v_mfma_f32_16x16x32_bf16 v[20:23], a[196:199], v[72:75], v[20:23]
    v_mfma_f32_16x16x32_bf16 v[24:27], a[200:203], v[72:75], v[24:27]
    v_mfma_f32_16x16x32_bf16 v[28:31], a[192:195], v[76:79], v[28:31]
    v_mfma_f32_16x16x32_bf16 v[32:35], a[196:199], v[76:79], v[32:35]
    v_mfma_f32_16x16x32_bf16 v[36:39], a[200:203], v[76:79], v[36:39]
    ds_read_b128 v[72:75], v115 offset:1024
    ds_read_b128 v[76:79], v115 offset:21504
    s_waitcnt lgkmcnt(4)
    v_mfma_f32_16x16x32_bf16 v[16:19], a[204:207], v[80:83], v[16:19]
    v_mfma_f32_16x16x32_bf16 v[20:23], a[208:211], v[80:83], v[20:23]
    v_mfma_f32_16x16x32_bf16 v[24:27], a[212:215], v[80:83], v[24:27]
    v_mfma_f32_16x16x32_bf16 v[28:31], a[204:207], v[84:87], v[28:31]
    v_mfma_f32_16x16x32_bf16 v[32:35], a[208:211], v[84:87], v[32:35]
    v_mfma_f32_16x16x32_bf16 v[36:39], a[212:215], v[84:87], v[36:39]
    s_waitcnt lgkmcnt(2)
    v_mfma_f32_16x16x32_bf16 v[16:19], a[216:219], v[64:67], v[16:19]
    v_mfma_f32_16x16x32_bf16 v[20:23], a[220:223], v[64:67], v[20:23]
    v_mfma_f32_16x16x32_bf16 v[24:27], a[224:227], v[64:67], v[24:27]
    v_mfma_f32_16x16x32_bf16 v[28:31], a[216:219], v[68:71], v[28:31]
    v_mfma_f32_16x16x32_bf16 v[32:35], a[220:223], v[68:71], v[32:35]
    v_mfma_f32_16x16x32_bf16 v[36:39], a[224:227], v[68:71], v[36:39]
    s_waitcnt lgkmcnt(0)
    v_mfma_f32_16x16x32_bf16 v[16:19], a[228:231], v[72:75], v[16:19]
    v_mfma_f32_16x16x32_bf16 v[20:23], a[232:235], v[72:75], v[20:23]
    v_mfma_f32_16x16x32_bf16 v[24:27], a[236:239], v[72:75], v[24:27]
    v_mfma_f32_16x16x32_bf16 v[28:31], a[228:231], v[76:79], v[28:31]
    v_mfma_f32_16x16x32_bf16 v[32:35], a[232:235], v[76:79], v[32:35]
    v_mfma_f32_16x16x32_bf16 v[36:39], a[236:239], v[76:79], v[36:39]
    s_nop 7
    v_cvt_pk_bf16_f32 v64, v16, v17
    v_cvt_pk_bf16_f32 v65, v18, v19
    v_cvt_pk_bf16_f32 v66, v20, v21
    v_cvt_pk_bf16_f32 v67, v22, v23
    v_cvt_pk_bf16_f32 v68, v24, v25
    v_cvt_pk_bf16_f32 v69, v26, v27
    ds_write_b128 v9, v[64:67] offset:0
    ds_write_b64 v10, v[68:69] offset:0
    v_cvt_pk_bf16_f32 v70, v28, v29
    v_cvt_pk_bf16_f32 v71, v30, v31
    v_cvt_pk_bf16_f32 v72, v32, v33
    v_cvt_pk_bf16_f32 v73, v34, v35
    v_cvt_pk_bf16_f32 v74, v36, v37
    v_cvt_pk_bf16_f32 v75, v38, v39
    ds_write_b128 v9, v[70:73] offset:6144
    ds_write_b64 v10, v[74:75] offset:6144
    s_add_u32 s40, s44, s48
    s_mov_b32 s26, s45
    s_mov_b32 s27, s46
    s_mul_i32 s30, s41, 393216
    s_add_u32 s44, s44, s30
    s_mul_i32 s30, s41, 98304
    s_add_u32 s45, s45, s30
    s_mul_i32 s30, s41, 131072
    s_add_u32 s46, s46, s30
    s_add_u32 s59, s59, s41
    s_add_u32 s38, s38, 1
    s_cmp_lt_u32 s38, s24
    s_cbranch_scc1 QA_loop
    s_waitcnt vmcnt(0)
    s_sub_u32 s23, s39, s41
    v_mov_b32 v14, s23
    buffer_store_dword v14, v250, s[16:19], s50 offen sc1
    s_cmp_eq_u32 s76, 1
    s_cbranch_scc1 QA_lm_66
    s_cmp_ge_u32 s55, s39
    s_cbranch_scc1 QA_wf_68
    v_min_u32 v14, 7, v1
    v_lshlrev_b32 v14, 2, v14
QA_wf_67:
    buffer_load_dword v15, v14, s[16:19], s49 offen sc1
    s_sub_u32 s34, s34, 1
    s_cbranch_scc1 G_end
    s_waitcnt vmcnt(0)
    s_nop 1
    v_min_u32_dpp v15, v15, v15 row_shl:1 row_mask:0xf bank_mask:0xf
    s_nop 1
    v_min_u32_dpp v15, v15, v15 row_shl:2 row_mask:0xf bank_mask:0xf
    s_nop 1
    v_min_u32_dpp v15, v15, v15 row_shl:4 row_mask:0xf bank_mask:0xf
    s_nop 1
    v_readfirstlane_b32 s55, v15
    s_cmp_ge_u32 s55, s39
    s_cbranch_scc1 QA_wf_68
    s_sleep 2
    s_branch QA_wf_67
QA_wf_68:
    s_lshl_b32 s79, s25, 10
    s_add_u32 s37, s79, s47
    s_add_u32 m0, s37, 24576
    s_add_u32 s78, s26, s79
    buffer_load_dwordx4 v11, s[16:19], s78 offen  lds
    s_add_u32 m0, s37, 28672
    s_add_u32 s78, s27, s79
    buffer_load_dwordx4 v11, s[16:19], s78 offen  lds
    s_waitcnt vmcnt(0)
QA_lm_66:
    s_waitcnt lgkmcnt(0)
    s_barrier
    v_add_u32 v124, s47, v11
    v_add_u32 v125, s47, v126
    v_add_u32 v2, s47, v127
    v_add_u32 v7, s47, v248
    s_xor_b32 s47, s47, 32768
    s_add_u32 s39, s59, 1
    s_xor_b32 s30, s29, 40960
    v_add_u32 v112, s30, v120
    v_add_u32 v113, s30, v121
    v_add_u32 v114, s30, v122
    v_add_u32 v115, s30, v123
    ds_read_b128 v[40:43], v6 offset:0
    ds_read_b128 v[128:131], v124 offset:0
    ds_read_b128 v[152:155], v124 offset:6144
    ds_read_b128 v[176:179], v2 offset:0
    ds_read_b128 v[44:47], v6 offset:1024
    ds_read_b128 v[132:135], v124 offset:1024
    ds_read_b128 v[156:159], v124 offset:7168
    ds_read_b128 v[180:183], v2 offset:512
    ds_read_b128 v[48:51], v6 offset:2048
    ds_read_b128 v[136:139], v124 offset:2048
    ds_read_b128 v[160:163], v124 offset:8192
    ds_read_b128 v[184:187], v2 offset:1024
    s_waitcnt lgkmcnt(8)
    v_mfma_f32_16x16x32_bf16 v[240:243], v[128:131], v[40:43], 0
    v_mfma_f32_16x16x32_bf16 v[244:247], v[152:155], v[40:43], 0
    v_mfma_f32_16x16x32_bf16 v[236:239], v[176:179], v[40:43], 0
    ds_read_b128 v[52:55], v6 offset:3072
    ds_read_b128 v[140:143], v124 offset:3072
    ds_read_b128 v[164:167], v124 offset:9216
    ds_read_b128 v[188:191], v2 offset:1536
    s_waitcnt lgkmcnt(8)
    v_mfma_f32_16x16x32_bf16 v[240:243], v[132:135], v[44:47], v[240:243]
    v_mfma_f32_16x16x32_bf16 v[244:247], v[156:159], v[44:47], v[244:247]
    v_mfma_f32_16x16x32_bf16 v[236:239], v[180:183], v[44:47], v[236:239]
    ds_read_b128 v[56:59], v6 offset:4096
    ds_read_b128 v[144:147], v124 offset:4096
    ds_read_b128 v[168:171], v124 offset:10240
    ds_read_b128 v[192:195], v2 offset:2048
    s_waitcnt lgkmcnt(8)
    v_mfma_f32_16x16x32_bf16 v[240:243], v[136:139], v[48:51], v[240:243]
    v_mfma_f32_16x16x32_bf16 v[244:247], v[160:163], v[48:51], v[244:247]
    v_mfma_f32_16x16x32_bf16 v[236:239], v[184:187], v[48:51], v[236:239]
    ds_read_b128 v[60:63], v6 offset:5120
    ds_read_b128 v[148:151], v124 offset:5120
    ds_read_b128 v[172:175], v124 offset:11264
    ds_read_b128 v[196:199], v2 offset:2560
    s_waitcnt lgkmcnt(8)
    v_mfma_f32_16x16x32_bf16 v[240:243], v[140:143], v[52:55], v[240:243]
    v_mfma_f32_16x16x32_bf16 v[244:247], v[164:167], v[52:55], v[244:247]
    v_mfma_f32_16x16x32_bf16 v[236:239], v[188:191], v[52:55], v[236:239]
    s_waitcnt lgkmcnt(4)
    v_mfma_f32_16x16x32_bf16 v[240:243], v[144:147], v[56:59], v[240:243]
    v_mfma_f32_16x16x32_bf16 v[244:247], v[168:171], v[56:59], v[244:247]
    v_mfma_f32_16x16x32_bf16 v[236:239], v[192:195], v[56:59], v[236:239]
    s_waitcnt lgkmcnt(0)
    v_mfma_f32_16x16x32_bf16 v[240:243], v[148:151], v[60:63], v[240:243]
    v_mfma_f32_16x16x32_bf16 v[244:247], v[172:175], v[60:63], v[244:247]
    v_mfma_f32_16x16x32_bf16 v[236:239], v[196:199], v[60:63], v[236:239]
    ds_read_b128 v[200:203], v125 offset:0
    ds_read_b128 v[204:207], v125 offset:1024
    ds_read_b128 v[208:211], v125 offset:2048
    ds_read_b128 v[212:215], v125 offset:3072
    ds_read_b128 v[216:219], v125 offset:4096
    ds_read_b128 v[220:223], v125 offset:5120
    ds_read_b128 v[224:227], v7 offset:0
    ds_read_b128 v[228:231], v7 offset:1024
    v_cndmask_b32 v240, v240, v249, s[60:61]
    v_cndmask_b32 v244, v244, v249, s[68:69]
    v_cndmask_b32 v241, v241, v249, s[62:63]
    v_cndmask_b32 v245, v245, v249, s[70:71]
    v_cndmask_b32 v242, v242, v249, s[64:65]
    v_cndmask_b32 v246, v246, v249, s[72:73]
    v_cndmask_b32 v243, v243, v249, s[66:67]
    v_cndmask_b32 v247, v247, v249, s[74:75]
    v_max3_f32 v40, v240, v241, v242
    v_max3_f32 v41, v243, v244, v245
    v_max3_f32 v40, v40, v246, v247
    v_max3_f32 v41, v41, v236, v237
    v_max_f32 v40, v40, v41
    v_mov_b32 v41, v40
    s_nop 1
    v_permlane32_swap_b32 v40, v41
    v_max_f32 v40, v40, v41
    v_mov_b32 v41, v40
    s_nop 1
    v_permlane16_swap_b32 v40, v41
    v_max_f32 v40, v40, v41
    v_mul_f32 v42, s56, v40
    v_fma_f32 v240, v240, s56, -v42
    v_fma_f32 v241, v241, s56, -v42
    v_fma_f32 v242, v242, s56, -v42
    v_fma_f32 v243, v243, s56, -v42
    v_fma_f32 v244, v244, s56, -v42
    v_fma_f32 v245, v245, s56, -v42
    v_fma_f32 v246, v246, s56, -v42
    v_fma_f32 v247, v247, s56, -v42
    v_fma_f32 v236, v236, s56, -v42
    v_fma_f32 v237, v237, s56, -v42
    v_exp_f32 v240, v240
    v_exp_f32 v241, v241
    v_exp_f32 v242, v242
    v_exp_f32 v243, v243
    v_exp_f32 v244, v244
    v_exp_f32 v245, v245
    v_exp_f32 v246, v246
    v_exp_f32 v247, v247
    v_exp_f32 v236, v236
    v_exp_f32 v237, v237
    v_cvt_pk_bf16_f32 v48, v240, v241
    v_cvt_pk_bf16_f32 v49, v242, v243
    v_cvt_pk_bf16_f32 v50, v244, v245
    v_cvt_pk_bf16_f32 v51, v246, v247
    v_cvt_pk_bf16_f32 v52, v236, v237
    v_cvt_pk_bf16_f32 v53, v236, v237
    v_cvt_pk_bf16_f32 v232, v236, v237
    v_cvt_pk_bf16_f32 v235, v236, v237
    s_nop 1
    s_waitcnt lgkmcnt(0)
    v_mfma_f32_16x16x32_bf16 v[128:131], v[200:203], v[48:51], 0
    v_mfma_f32_16x16x32_bf16 v[132:135], v[204:207], v[48:51], 0
    v_mfma_f32_16x16x32_bf16 v[136:139], v[208:211], v[48:51], 0
    v_mfma_f32_16x16x32_bf16 v[140:143], v[212:215], v[48:51], 0
    v_mfma_f32_16x16x32_bf16 v[144:147], v[216:219], v[48:51], 0
    v_mfma_f32_16x16x32_bf16 v[148:151], v[220:223], v[48:51], 0
    v_mfma_f32_16x16x16_bf16 v[128:131], v[224:225], v[232:233], v[128:131]
    v_mfma_f32_16x16x16_bf16 v[132:135], v[224:225], v[234:235], v[132:135]
    v_mfma_f32_16x16x16_bf16 v[136:139], v[226:227], v[52:53], v[136:139]
    v_mfma_f32_16x16x16_bf16 v[140:143], v[228:229], v[232:233], v[140:143]
    v_mfma_f32_16x16x16_bf16 v[144:147], v[228:229], v[234:235], v[144:147]
    v_mfma_f32_16x16x16_bf16 v[148:151], v[230:231], v[52:53], v[148:151]
    v_add_f32 v44, v236, v237
    v_add_f32 v41, v240, v241
    v_add_f32 v44, v44, v242
    v_add_f32 v41, v41, v243
    v_add_f32 v44, v44, v244
    v_add_f32 v41, v41, v245
    v_add_f32 v44, v44, v246
    v_add_f32 v41, v41, v247
    v_add_f32 v44, v44, v41
    v_mov_b32 v41, v44
    s_nop 1
    v_permlane32_swap_b32 v44, v41
    v_add_f32 v44, v44, v41
    v_mov_b32 v41, v44
    s_nop 1
    v_permlane16_swap_b32 v44, v41
    v_add_f32 v44, v44, v41
    v_rcp_f32 v44, v44
    s_nop 0
    v_mul_f32 v128, v128, v44
    v_mul_f32 v129, v129, v44
    v_mul_f32 v130, v130, v44
    v_mul_f32 v131, v131, v44
    v_cvt_pk_bf16_f32 v176, v128, v129
    v_cvt_pk_bf16_f32 v177, v130, v131
    v_mul_f32 v132, v132, v44
    v_mul_f32 v133, v133, v44
    v_mul_f32 v134, v134, v44
    v_mul_f32 v135, v135, v44
    v_cvt_pk_bf16_f32 v178, v132, v133
    v_cvt_pk_bf16_f32 v179, v134, v135
    buffer_store_dwordx4 v[176:179], v11, s[16:19], s40 offen offset:0 sc1
    v_mul_f32 v140, v140, v44
    v_mul_f32 v141, v141, v44
    v_mul_f32 v142, v142, v44
    v_mul_f32 v143, v143, v44
    v_cvt_pk_bf16_f32 v180, v140, v141
    v_cvt_pk_bf16_f32 v181, v142, v143
    v_mul_f32 v144, v144, v44
    v_mul_f32 v145, v145, v44
    v_mul_f32 v146, v146, v44
    v_mul_f32 v147, v147, v44
    v_cvt_pk_bf16_f32 v182, v144, v145
    v_cvt_pk_bf16_f32 v183, v146, v147
    buffer_store_dwordx4 v[180:183], v11, s[16:19], s40 offen offset:1024 sc1
    v_mul_f32 v136, v136, v44
    v_mul_f32 v137, v137, v44
    v_mul_f32 v138, v138, v44
    v_mul_f32 v139, v139, v44
    v_cvt_pk_bf16_f32 v184, v136, v137
    v_cvt_pk_bf16_f32 v185, v138, v139
    v_mul_f32 v148, v148, v44
    v_mul_f32 v149, v149, v44
    v_mul_f32 v150, v150, v44
    v_mul_f32 v151, v151, v44
    v_cvt_pk_bf16_f32 v186, v148, v149
    v_cvt_pk_bf16_f32 v187, v150, v151
    buffer_store_dwordx4 v[184:187], v11, s[16:19], s40 offen offset:2048 sc1
    s_waitcnt vmcnt(0)
    s_mov_b32 s30, s59
    v_mov_b32 v14, s30
    v_mov_b32 v15, 0
    s_mov_b64 exec, 1
    buffer_store_dword v14, v15, s[16:19], s50 offen sc1
    s_mov_b64 exec, -1
    s_branch G_end
M_V:
    v_and_b32 v1, 63, v0
    v_lshlrev_b32 v11, 4, v1
    v_add_u32 v12, 0, v1
    v_mul_u32_u24 v13, 2731, v12
    v_lshrrev_b32 v13, 16, v13
    v_mul_u32_u24 v14, 24, v13
    v_sub_u32 v14, v12, v14
    v_mul_u32_u24 v3, 12288, v13
    v_lshl_add_u32 v3, v14, 4, v3
    v_add_u32 v12, 64, v1
    v_mul_u32_u24 v13, 2731, v12
    v_lshrrev_b32 v13, 16, v13
    v_mul_u32_u24 v14, 24, v13
    v_sub_u32 v14, v12, v14
    v_mul_u32_u24 v4, 12288, v13
    v_lshl_add_u32 v4, v14, 4, v4
    v_add_u32 v12, 128, v1
    v_mul_u32_u24 v13, 2731, v12
    v_lshrrev_b32 v13, 16, v13
    v_mul_u32_u24 v14, 24, v13
    v_sub_u32 v14, v12, v14
    v_mul_u32_u24 v5, 12288, v13
    v_lshl_add_u32 v5, v14, 4, v5
    v_lshrrev_b32 v12, 4, v1
    v_lshlrev_b32 v12, 3, v12
    v_bfe_u32 v13, v1, 2, 2
    v_add_u32 v12, v12, v13
    v_mul_u32_u24 v8, 384, v12
    v_and_b32 v12, 3, v1
    v_lshl_add_u32 v8, v12, 3, v8
    s_mul_i32 s30, s25, 96
    v_add_u32 v8, s30, v8
    s_mul_i32 s27, s22, 384
    s_waitcnt lgkmcnt(0)
    s_barrier
    s_mul_i32 s30, s25, 393216
    s_add_u32 s30, s30, s27
    s_add_u32 s30, s30, 0
    s_mul_i32 s31, s25, 12288
    s_add_u32 s31, s31, 0
    s_mov_b32 m0, s31
    s_add_u32 s31, s31, 1024
    buffer_load_dwordx4 v3, s[12:15], s30 offen lds
    s_mov_b32 m0, s31
    s_add_u32 s31, s31, 1024
    buffer_load_dwordx4 v4, s[12:15], s30 offen lds
    s_mov_b32 m0, s31
    s_add_u32 s31, s31, 1024
    buffer_load_dwordx4 v5, s[12:15], s30 offen lds
    s_add_u32 s30, s30, 98304
    s_mov_b32 m0, s31
    s_add_u32 s31, s31, 1024
    buffer_load_dwordx4 v3, s[12:15], s30 offen lds
    s_mov_b32 m0, s31
    s_add_u32 s31, s31, 1024
    buffer_load_dwordx4 v4, s[12:15], s30 offen lds
    s_mov_b32 m0, s31
    s_add_u32 s31, s31, 1024
    buffer_load_dwordx4 v5, s[12:15], s30 offen lds
    s_add_u32 s30, s30, 98304
    s_mov_b32 m0, s31
    s_add_u32 s31, s31, 1024
    buffer_load_dwordx4 v3, s[12:15], s30 offen lds
    s_mov_b32 m0, s31
    s_add_u32 s31, s31, 1024
    buffer_load_dwordx4 v4, s[12:15], s30 offen lds
    s_mov_b32 m0, s31
    s_add_u32 s31, s31, 1024
    buffer_load_dwordx4 v5, s[12:15], s30 offen lds
    s_add_u32 s30, s30, 98304
    s_mov_b32 m0, s31
    s_add_u32 s31, s31, 1024
    buffer_load_dwordx4 v3, s[12:15], s30 offen lds
    s_mov_b32 m0, s31
    s_add_u32 s31, s31, 1024
    buffer_load_dwordx4 v4, s[12:15], s30 offen lds
    s_mov_b32 m0, s31
    s_add_u32 s31, s31, 1024
    buffer_load_dwordx4 v5, s[12:15], s30 offen lds
    s_add_u32 s30, s30, 98304
    s_mul_i32 s30, s25, 393216
    s_add_u32 s30, s30, s27
    s_add_u32 s30, s30, 1572864
    s_mul_i32 s31, s25, 12288
    s_add_u32 s31, s31, 49152
    s_mov_b32 m0, s31
    s_add_u32 s31, s31, 1024
    buffer_load_dwordx4 v3, s[12:15], s30 offen lds
    s_mov_b32 m0, s31
    s_add_u32 s31, s31, 1024
    buffer_load_dwordx4 v4, s[12:15], s30 offen lds
    s_mov_b32 m0, s31
    s_add_u32 s31, s31, 1024
    buffer_load_dwordx4 v5, s[12:15], s30 offen lds
    s_add_u32 s30, s30, 98304
    s_mov_b32 m0, s31
    s_add_u32 s31, s31, 1024
    buffer_load_dwordx4 v3, s[12:15], s30 offen lds
    s_mov_b32 m0, s31
    s_add_u32 s31, s31, 1024
    buffer_load_dwordx4 v4, s[12:15], s30 offen lds
    s_mov_b32 m0, s31
    s_add_u32 s31, s31, 1024
    buffer_load_dwordx4 v5, s[12:15], s30 offen lds
    s_add_u32 s30, s30, 98304
    s_mov_b32 m0, s31
    s_add_u32 s31, s31, 1024
    buffer_load_dwordx4 v3, s[12:15], s30 offen lds
    s_mov_b32 m0, s31
    s_add_u32 s31, s31, 1024
    buffer_load_dwordx4 v4, s[12:15], s30 offen lds
    s_mov_b32 m0, s31
    s_add_u32 s31, s31, 1024
    buffer_load_dwordx4 v5, s[12:15], s30 offen lds
    s_add_u32 s30, s30, 98304
    s_mov_b32 m0, s31
    s_add_u32 s31, s31, 1024
    buffer_load_dwordx4 v3, s[12:15], s30 offen lds
    s_mov_b32 m0, s31
    s_add_u32 s31, s31, 1024
    buffer_load_dwordx4 v4, s[12:15], s30 offen lds
    s_mov_b32 m0, s31
    s_add_u32 s31, s31, 1024
    buffer_load_dwordx4 v5, s[12:15], s30 offen lds
    s_add_u32 s30, s30, 98304
    s_mul_i32 s30, s25, 393216
    s_add_u32 s30, s30, s27
    s_add_u32 s30, s30, 3145728
    s_mul_i32 s31, s25, 12288
    s_add_u32 s31, s31, 98304
    s_mov_b32 m0, s31
    s_add_u32 s31, s31, 1024
    buffer_load_dwordx4 v3, s[12:15], s30 offen lds
    s_mov_b32 m0, s31
    s_add_u32 s31, s31, 1024
    buffer_load_dwordx4 v4, s[12:15], s30 offen lds
    s_mov_b32 m0, s31
    s_add_u32 s31, s31, 1024
    buffer_load_dwordx4 v5, s[12:15], s30 offen lds
    s_add_u32 s30, s30, 98304
    s_mov_b32 m0, s31
    s_add_u32 s31, s31, 1024
    buffer_load_dwordx4 v3, s[12:15], s30 offen lds
    s_mov_b32 m0, s31
    s_add_u32 s31, s31, 1024
    buffer_load_dwordx4 v4, s[12:15], s30 offen lds
    s_mov_b32 m0, s31
    s_add_u32 s31, s31, 1024
    buffer_load_dwordx4 v5, s[12:15], s30 offen lds
    s_add_u32 s30, s30, 98304
    s_mov_b32 m0, s31
    s_add_u32 s31, s31, 1024
    buffer_load_dwordx4 v3, s[12:15], s30 offen lds
    s_mov_b32 m0, s31
    s_add_u32 s31, s31, 1024
    buffer_load_dwordx4 v4, s[12:15], s30 offen lds
    s_mov_b32 m0, s31
    s_add_u32 s31, s31, 1024
    buffer_load_dwordx4 v5, s[12:15], s30 offen lds
    s_add_u32 s30, s30, 98304
    s_mov_b32 m0, s31
    s_add_u32 s31, s31, 1024
    buffer_load_dwordx4 v3, s[12:15], s30 offen lds
    s_mov_b32 m0, s31
    s_add_u32 s31, s31, 1024
    buffer_load_dwordx4 v4, s[12:15], s30 offen lds
    s_mov_b32 m0, s31
    s_add_u32 s31, s31, 1024
    buffer_load_dwordx4 v5, s[12:15], s30 offen lds
    s_add_u32 s30, s30, 98304
    s_waitcnt vmcnt(24)
    s_barrier
    s_mov_b32 s4, s78
    s_and_b32 s5, s79, 0xffff
    s_mov_b32 s6, 256
    s_mov_b32 s7, 0x20000
    s_cmp_lg_u32 s25, 0
    s_cbranch_scc1 M_ch_69
    v_mov_b32 v26, 1
    v_mov_b32 v27, 32
    s_mov_b64 exec, 1
    buffer_atomic_add v26, v27, s[4:7], 0 offen
    s_mov_b64 exec, -1
M_ch_69:
    v_add_u32 v12, 0, v8
    ds_read_b64_tr_b16 a[0:1], v12 offset:0
    ds_read_b64_tr_b16 a[2:3], v12 offset:1536
    s_waitcnt lgkmcnt(8)
    ds_read_b64_tr_b16 a[4:5], v12 offset:32
    ds_read_b64_tr_b16 a[6:7], v12 offset:1568
    s_waitcnt lgkmcnt(8)
    ds_read_b64_tr_b16 a[8:9], v12 offset:64
    ds_read_b64_tr_b16 a[10:11], v12 offset:1600
    s_waitcnt lgkmcnt(8)
    ds_read_b64_tr_b16 a[12:13], v12 offset:12288
    ds_read_b64_tr_b16 a[14:15], v12 offset:13824
    s_waitcnt lgkmcnt(8)
    ds_read_b64_tr_b16 a[16:17], v12 offset:12320
    ds_read_b64_tr_b16 a[18:19], v12 offset:13856
    s_waitcnt lgkmcnt(8)
    ds_read_b64_tr_b16 a[20:21], v12 offset:12352
    ds_read_b64_tr_b16 a[22:23], v12 offset:13888
    s_waitcnt lgkmcnt(8)
    ds_read_b64_tr_b16 a[24:25], v12 offset:24576
    ds_read_b64_tr_b16 a[26:27], v12 offset:26112
    s_waitcnt lgkmcnt(8)
    ds_read_b64_tr_b16 a[28:29], v12 offset:24608
    ds_read_b64_tr_b16 a[30:31], v12 offset:26144
    s_waitcnt lgkmcnt(8)
    ds_read_b64_tr_b16 a[32:33], v12 offset:24640
    ds_read_b64_tr_b16 a[34:35], v12 offset:26176
    s_waitcnt lgkmcnt(8)
    ds_read_b64_tr_b16 a[36:37], v12 offset:36864
    ds_read_b64_tr_b16 a[38:39], v12 offset:38400
    s_waitcnt lgkmcnt(8)
    ds_read_b64_tr_b16 a[40:41], v12 offset:36896
    ds_read_b64_tr_b16 a[42:43], v12 offset:38432
    s_waitcnt lgkmcnt(8)
    ds_read_b64_tr_b16 a[44:45], v12 offset:36928
    ds_read_b64_tr_b16 a[46:47], v12 offset:38464
    s_waitcnt lgkmcnt(8)
    s_waitcnt lgkmcnt(0)
    s_barrier
    s_mul_i32 s30, s25, 393216
    s_add_u32 s30, s30, s27
    s_add_u32 s30, s30, 4718592
    s_mul_i32 s31, s25, 12288
    s_add_u32 s31, s31, 0
    s_mov_b32 m0, s31
    s_add_u32 s31, s31, 1024
    buffer_load_dwordx4 v3, s[12:15], s30 offen lds
    s_mov_b32 m0, s31
    s_add_u32 s31, s31, 1024
    buffer_load_dwordx4 v4, s[12:15], s30 offen lds
    s_mov_b32 m0, s31
    s_add_u32 s31, s31, 1024
    buffer_load_dwordx4 v5, s[12:15], s30 offen lds
    s_add_u32 s30, s30, 98304
    s_mov_b32 m0, s31
    s_add_u32 s31, s31, 1024
    buffer_load_dwordx4 v3, s[12:15], s30 offen lds
    s_mov_b32 m0, s31
    s_add_u32 s31, s31, 1024
    buffer_load_dwordx4 v4, s[12:15], s30 offen lds
    s_mov_b32 m0, s31
    s_add_u32 s31, s31, 1024
    buffer_load_dwordx4 v5, s[12:15], s30 offen lds
    s_add_u32 s30, s30, 98304
    s_mov_b32 m0, s31
    s_add_u32 s31, s31, 1024
    buffer_load_dwordx4 v3, s[12:15], s30 offen lds
    s_mov_b32 m0, s31
    s_add_u32 s31, s31, 1024
    buffer_load_dwordx4 v4, s[12:15], s30 offen lds
    s_mov_b32 m0, s31
    s_add_u32 s31, s31, 1024
    buffer_load_dwordx4 v5, s[12:15], s30 offen lds
    s_add_u32 s30, s30, 98304
    s_mov_b32 m0, s31
    s_add_u32 s31, s31, 1024
    buffer_load_dwordx4 v3, s[12:15], s30 offen lds
    s_mov_b32 m0, s31
    s_add_u32 s31, s31, 1024
    buffer_load_dwordx4 v4, s[12:15], s30 offen lds
    s_mov_b32 m0, s31
    s_add_u32 s31, s31, 1024
    buffer_load_dwordx4 v5, s[12:15], s30 offen lds
    s_add_u32 s30, s30, 98304
    s_waitcnt vmcnt(24)
    s_barrier
    v_add_u32 v12, 49152, v8
    ds_read_b64_tr_b16 a[48:49], v12 offset:0
    ds_read_b64_tr_b16 a[50:51], v12 offset:1536
    s_waitcnt lgkmcnt(8)
    ds_read_b64_tr_b16 a[52:53], v12 offset:32
    ds_read_b64_tr_b16 a[54:55], v12 offset:1568
    s_waitcnt lgkmcnt(8)
    ds_read_b64_tr_b16 a[56:57], v12 offset:64
    ds_read_b64_tr_b16 a[58:59], v12 offset:1600
    s_waitcnt lgkmcnt(8)
    ds_read_b64_tr_b16 a[60:61], v12 offset:12288
    ds_read_b64_tr_b16 a[62:63], v12 offset:13824
    s_waitcnt lgkmcnt(8)
    ds_read_b64_tr_b16 a[64:65], v12 offset:12320
    ds_read_b64_tr_b16 a[66:67], v12 offset:13856
    s_waitcnt lgkmcnt(8)
    ds_read_b64_tr_b16 a[68:69], v12 offset:12352
    ds_read_b64_tr_b16 a[70:71], v12 offset:13888
    s_waitcnt lgkmcnt(8)
    ds_read_b64_tr_b16 a[72:73], v12 offset:24576
    ds_read_b64_tr_b16 a[74:75], v12 offset:26112
    s_waitcnt lgkmcnt(8)
    ds_read_b64_tr_b16 a[76:77], v12 offset:24608
    ds_read_b64_tr_b16 a[78:79], v12 offset:26144
    s_waitcnt lgkmcnt(8)
    ds_read_b64_tr_b16 a[80:81], v12 offset:24640
    ds_read_b64_tr_b16 a[82:83], v12 offset:26176
    s_waitcnt lgkmcnt(8)
    ds_read_b64_tr_b16 a[84:85], v12 offset:36864
    ds_read_b64_tr_b16 a[86:87], v12 offset:38400
    s_waitcnt lgkmcnt(8)
    ds_read_b64_tr_b16 a[88:89], v12 offset:36896
    ds_read_b64_tr_b16 a[90:91], v12 offset:38432
    s_waitcnt lgkmcnt(8)
    ds_read_b64_tr_b16 a[92:93], v12 offset:36928
    ds_read_b64_tr_b16 a[94:95], v12 offset:38464
    s_waitcnt lgkmcnt(8)
    s_waitcnt lgkmcnt(0)
    s_barrier
    s_mul_i32 s30, s25, 393216
    s_add_u32 s30, s30, s27
    s_add_u32 s30, s30, 6291456
    s_mul_i32 s31, s25, 12288
    s_add_u32 s31, s31, 49152
    s_mov_b32 m0, s31
    s_add_u32 s31, s31, 1024
    buffer_load_dwordx4 v3, s[12:15], s30 offen lds
    s_mov_b32 m0, s31
    s_add_u32 s31, s31, 1024
    buffer_load_dwordx4 v4, s[12:15], s30 offen lds
    s_mov_b32 m0, s31
    s_add_u32 s31, s31, 1024
    buffer_load_dwordx4 v5, s[12:15], s30 offen lds
    s_add_u32 s30, s30, 98304
    s_mov_b32 m0, s31
    s_add_u32 s31, s31, 1024
    buffer_load_dwordx4 v3, s[12:15], s30 offen lds
    s_mov_b32 m0, s31
    s_add_u32 s31, s31, 1024
    buffer_load_dwordx4 v4, s[12:15], s30 offen lds
    s_mov_b32 m0, s31
    s_add_u32 s31, s31, 1024
    buffer_load_dwordx4 v5, s[12:15], s30 offen lds
    s_add_u32 s30, s30, 98304
    s_mov_b32 m0, s31
    s_add_u32 s31, s31, 1024
    buffer_load_dwordx4 v3, s[12:15], s30 offen lds
    s_mov_b32 m0, s31
    s_add_u32 s31, s31, 1024
    buffer_load_dwordx4 v4, s[12:15], s30 offen lds
    s_mov_b32 m0, s31
    s_add_u32 s31, s31, 1024
    buffer_load_dwordx4 v5, s[12:15], s30 offen lds
    s_add_u32 s30, s30, 98304
    s_mov_b32 m0, s31
    s_add_u32 s31, s31, 1024
    buffer_load_dwordx4 v3, s[12:15], s30 offen lds
    s_mov_b32 m0, s31
    s_add_u32 s31, s31, 1024
    buffer_load_dwordx4 v4, s[12:15], s30 offen lds
    s_mov_b32 m0, s31
    s_add_u32 s31, s31, 1024
    buffer_load_dwordx4 v5, s[12:15], s30 offen lds
    s_add_u32 s30, s30, 98304
    s_waitcnt vmcnt(24)
    s_barrier
    v_add_u32 v12, 98304, v8
    ds_read_b64_tr_b16 a[96:97], v12 offset:0
    ds_read_b64_tr_b16 a[98:99], v12 offset:1536
    s_waitcnt lgkmcnt(8)
    ds_read_b64_tr_b16 a[100:101], v12 offset:32
    ds_read_b64_tr_b16 a[102:103], v12 offset:1568
    s_waitcnt lgkmcnt(8)
    ds_read_b64_tr_b16 a[104:105], v12 offset:64
    ds_read_b64_tr_b16 a[106:107], v12 offset:1600
    s_waitcnt lgkmcnt(8)
    ds_read_b64_tr_b16 a[108:109], v12 offset:12288
    ds_read_b64_tr_b16 a[110:111], v12 offset:13824
    s_waitcnt lgkmcnt(8)
    ds_read_b64_tr_b16 a[112:113], v12 offset:12320
    ds_read_b64_tr_b16 a[114:115], v12 offset:13856
    s_waitcnt lgkmcnt(8)
    ds_read_b64_tr_b16 a[116:117], v12 offset:12352
    ds_read_b64_tr_b16 a[118:119], v12 offset:13888
    s_waitcnt lgkmcnt(8)
    ds_read_b64_tr_b16 a[120:121], v12 offset:24576
    ds_read_b64_tr_b16 a[122:123], v12 offset:26112
    s_waitcnt lgkmcnt(8)
    ds_read_b64_tr_b16 a[124:125], v12 offset:24608
    ds_read_b64_tr_b16 a[126:127], v12 offset:26144
    s_waitcnt lgkmcnt(8)
    ds_read_b64_tr_b16 a[128:129], v12 offset:24640
    ds_read_b64_tr_b16 a[130:131], v12 offset:26176
    s_waitcnt lgkmcnt(8)
    ds_read_b64_tr_b16 a[132:133], v12 offset:36864
    ds_read_b64_tr_b16 a[134:135], v12 offset:38400
    s_waitcnt lgkmcnt(8)
    ds_read_b64_tr_b16 a[136:137], v12 offset:36896
    ds_read_b64_tr_b16 a[138:139], v12 offset:38432
    s_waitcnt lgkmcnt(8)
    ds_read_b64_tr_b16 a[140:141], v12 offset:36928
    ds_read_b64_tr_b16 a[142:143], v12 offset:38464
    s_waitcnt lgkmcnt(8)
    s_waitcnt lgkmcnt(0)
    s_barrier
    s_waitcnt vmcnt(12)
    s_barrier
    v_add_u32 v12, 0, v8
    ds_read_b64_tr_b16 a[144:145], v12 offset:0
    ds_read_b64_tr_b16 a[146:147], v12 offset:1536
    s_waitcnt lgkmcnt(8)
    ds_read_b64_tr_b16 a[148:149], v12 offset:32
    ds_read_b64_tr_b16 a[150:151], v12 offset:1568
    s_waitcnt lgkmcnt(8)
    ds_read_b64_tr_b16 a[152:153], v12 offset:64
    ds_read_b64_tr_b16 a[154:155], v12 offset:1600
    s_waitcnt lgkmcnt(8)
    ds_read_b64_tr_b16 a[156:157], v12 offset:12288
    ds_read_b64_tr_b16 a[158:159], v12 offset:13824
    s_waitcnt lgkmcnt(8)
    ds_read_b64_tr_b16 a[160:161], v12 offset:12320
    ds_read_b64_tr_b16 a[162:163], v12 offset:13856
    s_waitcnt lgkmcnt(8)
    ds_read_b64_tr_b16 a[164:165], v12 offset:12352
    ds_read_b64_tr_b16 a[166:167], v12 offset:13888
    s_waitcnt lgkmcnt(8)
    ds_read_b64_tr_b16 a[168:169], v12 offset:24576
    ds_read_b64_tr_b16 a[170:171], v12 offset:26112
    s_waitcnt lgkmcnt(8)
    ds_read_b64_tr_b16 a[172:173], v12 offset:24608
    ds_read_b64_tr_b16 a[174:175], v12 offset:26144
    s_waitcnt lgkmcnt(8)
    ds_read_b64_tr_b16 a[176:177], v12 offset:24640
    ds_read_b64_tr_b16 a[178:179], v12 offset:26176
    s_waitcnt lgkmcnt(8)
    ds_read_b64_tr_b16 a[180:181], v12 offset:36864
    ds_read_b64_tr_b16 a[182:183], v12 offset:38400
    s_waitcnt lgkmcnt(8)
    ds_read_b64_tr_b16 a[184:185], v12 offset:36896
    ds_read_b64_tr_b16 a[186:187], v12 offset:38432
    s_waitcnt lgkmcnt(8)
    ds_read_b64_tr_b16 a[188:189], v12 offset:36928
    ds_read_b64_tr_b16 a[190:191], v12 offset:38464
    s_waitcnt lgkmcnt(8)
    s_waitcnt lgkmcnt(0)
    s_barrier
    s_waitcnt vmcnt(0)
    s_barrier
    v_add_u32 v12, 49152, v8
    ds_read_b64_tr_b16 a[192:193], v12 offset:0
    ds_read_b64_tr_b16 a[194:195], v12 offset:1536
    s_waitcnt lgkmcnt(8)
    ds_read_b64_tr_b16 a[196:197], v12 offset:32
    ds_read_b64_tr_b16 a[198:199], v12 offset:1568
    s_waitcnt lgkmcnt(8)
    ds_read_b64_tr_b16 a[200:201], v12 offset:64
    ds_read_b64_tr_b16 a[202:203], v12 offset:1600
    s_waitcnt lgkmcnt(8)
    ds_read_b64_tr_b16 a[204:205], v12 offset:12288
    ds_read_b64_tr_b16 a[206:207], v12 offset:13824
    s_waitcnt lgkmcnt(8)
    ds_read_b64_tr_b16 a[208:209], v12 offset:12320
    ds_read_b64_tr_b16 a[210:211], v12 offset:13856
    s_waitcnt lgkmcnt(8)
    ds_read_b64_tr_b16 a[212:213], v12 offset:12352
    ds_read_b64_tr_b16 a[214:215], v12 offset:13888
    s_waitcnt lgkmcnt(8)
    ds_read_b64_tr_b16 a[216:217], v12 offset:24576
    ds_read_b64_tr_b16 a[218:219], v12 offset:26112
    s_waitcnt lgkmcnt(8)
    ds_read_b64_tr_b16 a[220:221], v12 offset:24608
    ds_read_b64_tr_b16 a[222:223], v12 offset:26144
    s_waitcnt lgkmcnt(8)
    ds_read_b64_tr_b16 a[224:225], v12 offset:24640
    ds_read_b64_tr_b16 a[226:227], v12 offset:26176
    s_waitcnt lgkmcnt(8)
    ds_read_b64_tr_b16 a[228:229], v12 offset:36864
    ds_read_b64_tr_b16 a[230:231], v12 offset:38400
    s_waitcnt lgkmcnt(8)
    ds_read_b64_tr_b16 a[232:233], v12 offset:36896
    ds_read_b64_tr_b16 a[234:235], v12 offset:38432
    s_waitcnt lgkmcnt(8)
    ds_read_b64_tr_b16 a[236:237], v12 offset:36928
    ds_read_b64_tr_b16 a[238:239], v12 offset:38464
    s_waitcnt lgkmcnt(8)
    s_waitcnt lgkmcnt(0)
    s_barrier
    s_mul_i32 s30, s25, 640
    v_add_u32 v12, s30, v1
    v_add_u32 v12, 0, v12
    v_mul_u32_u24 v13, 3277, v12
    v_lshrrev_b32 v13, 18, v13
    v_mul_u32_u24 v14, 80, v13
    v_sub_u32 v14, v12, v14
    v_and_b32 v15, 15, v13
    v_xor_b32 v14, v14, v15
    v_mul_u32_u24 v100, 1280, v13
    v_lshl_add_u32 v100, v14, 4, v100
    v_add_u32 v12, s30, v1
    v_add_u32 v12, 64, v12
    v_mul_u32_u24 v13, 3277, v12
    v_lshrrev_b32 v13, 18, v13
    v_mul_u32_u24 v14, 80, v13
    v_sub_u32 v14, v12, v14
    v_and_b32 v15, 15, v13
    v_xor_b32 v14, v14, v15
    v_mul_u32_u24 v101, 1280, v13
    v_lshl_add_u32 v101, v14, 4, v101
    v_add_u32 v12, s30, v1
    v_add_u32 v12, 128, v12
    v_mul_u32_u24 v13, 3277, v12
    v_lshrrev_b32 v13, 18, v13
    v_mul_u32_u24 v14, 80, v13
    v_sub_u32 v14, v12, v14
    v_and_b32 v15, 15, v13
    v_xor_b32 v14, v14, v15
    v_mul_u32_u24 v102, 1280, v13
    v_lshl_add_u32 v102, v14, 4, v102
    v_add_u32 v12, s30, v1
    v_add_u32 v12, 192, v12
    v_mul_u32_u24 v13, 3277, v12
    v_lshrrev_b32 v13, 18, v13
    v_mul_u32_u24 v14, 80, v13
    v_sub_u32 v14, v12, v14
    v_and_b32 v15, 15, v13
    v_xor_b32 v14, v14, v15
    v_mul_u32_u24 v103, 1280, v13
    v_lshl_add_u32 v103, v14, 4, v103
    v_add_u32 v12, s30, v1
    v_add_u32 v12, 256, v12
    v_mul_u32_u24 v13, 3277, v12
    v_lshrrev_b32 v13, 18, v13
    v_mul_u32_u24 v14, 80, v13
    v_sub_u32 v14, v12, v14
    v_and_b32 v15, 15, v13
    v_xor_b32 v14, v14, v15
    v_mul_u32_u24 v104, 1280, v13
    v_lshl_add_u32 v104, v14, 4, v104
    v_add_u32 v12, s30, v1
    v_add_u32 v12, 320, v12
    v_mul_u32_u24 v13, 3277, v12
    v_lshrrev_b32 v13, 18, v13
    v_mul_u32_u24 v14, 80, v13
    v_sub_u32 v14, v12, v14
    v_and_b32 v15, 15, v13
    v_xor_b32 v14, v14, v15
    v_mul_u32_u24 v105, 1280, v13
    v_lshl_add_u32 v105, v14, 4, v105
    v_add_u32 v12, s30, v1
    v_add_u32 v12, 384, v12
    v_mul_u32_u24 v13, 3277, v12
    v_lshrrev_b32 v13, 18, v13
    v_mul_u32_u24 v14, 80, v13
    v_sub_u32 v14, v12, v14
    v_and_b32 v15, 15, v13
    v_xor_b32 v14, v14, v15
    v_mul_u32_u24 v106, 1280, v13
    v_lshl_add_u32 v106, v14, 4, v106
    v_add_u32 v12, s30, v1
    v_add_u32 v12, 448, v12
    v_mul_u32_u24 v13, 3277, v12
    v_lshrrev_b32 v13, 18, v13
    v_mul_u32_u24 v14, 80, v13
    v_sub_u32 v14, v12, v14
    v_and_b32 v15, 15, v13
    v_xor_b32 v14, v14, v15
    v_mul_u32_u24 v107, 1280, v13
    v_lshl_add_u32 v107, v14, 4, v107
    v_add_u32 v12, s30, v1
    v_add_u32 v12, 512, v12
    v_mul_u32_u24 v13, 3277, v12
    v_lshrrev_b32 v13, 18, v13
    v_mul_u32_u24 v14, 80, v13
    v_sub_u32 v14, v12, v14
    v_and_b32 v15, 15, v13
    v_xor_b32 v14, v14, v15
    v_mul_u32_u24 v108, 1280, v13
    v_lshl_add_u32 v108, v14, 4, v108
    v_add_u32 v12, s30, v1
    v_add_u32 v12, 576, v12
    v_mul_u32_u24 v13, 3277, v12
    v_lshrrev_b32 v13, 18, v13
    v_mul_u32_u24 v14, 80, v13
    v_sub_u32 v14, v12, v14
    v_and_b32 v15, 15, v13
    v_xor_b32 v14, v14, v15
    v_mul_u32_u24 v109, 1280, v13
    v_lshl_add_u32 v109, v14, 4, v109
    s_mul_i32 s33, s25, 10240
    v_lshrrev_b32 v12, 4, v1
    v_add_u32 v12, 0, v12
    v_and_b32 v13, 15, v1
    v_xor_b32 v12, v12, v13
    v_mul_u32_u24 v120, 1280, v13
    v_lshl_add_u32 v120, v12, 4, v120
    v_lshrrev_b32 v12, 4, v1
    v_add_u32 v12, 4, v12
    v_and_b32 v13, 15, v1
    v_xor_b32 v12, v12, v13
    v_mul_u32_u24 v121, 1280, v13
    v_lshl_add_u32 v121, v12, 4, v121
    v_lshrrev_b32 v12, 4, v1
    v_add_u32 v12, 8, v12
    v_and_b32 v13, 15, v1
    v_xor_b32 v12, v12, v13
    v_mul_u32_u24 v122, 1280, v13
    v_lshl_add_u32 v122, v12, 4, v122
    v_lshrrev_b32 v12, 4, v1
    v_add_u32 v12, 12, v12
    v_and_b32 v13, 15, v1
    v_xor_b32 v12, v12, v13
    v_mul_u32_u24 v123, 1280, v13
    v_lshl_add_u32 v123, v12, 4, v123
    s_mov_b32 s4, s78
    s_and_b32 s5, s79, 0xffff
    s_mov_b32 s6, 256
    s_mov_b32 s7, 0x20000
    v_mov_b32 v126, 32
M_wc_70:
    buffer_load_dword v127, v126, s[4:7], 0 offen sc1
    s_sub_u32 s34, s34, 1
    s_cbranch_scc1 G_end
    s_waitcnt vmcnt(0)
    v_readfirstlane_b32 s30, v127
    s_cmp_eq_u32 s30, 256
    s_cbranch_scc1 M_wc_71
    s_sleep 4
    s_branch M_wc_70
M_wc_71:
    v_mov_b32 v2, 0
    v_mov_b32 v14, 2147483632
    v_cmp_eq_u32 vcc, 0, v1
    s_nop 1
    v_cndmask_b32 v2, v14, v2, vcc
    s_mul_i32 s28, s23, 40960
    s_mov_b32 s29, 0
    s_add_u32 s35, s29, s33
    s_mov_b32 m0, s35
    s_add_u32 s35, s35, 1024
    buffer_load_dwordx4 v100, s[8:11], s28 offen lds
    s_mov_b32 m0, s35
    s_add_u32 s35, s35, 1024
    buffer_load_dwordx4 v101, s[8:11], s28 offen lds
    s_mov_b32 m0, s35
    s_add_u32 s35, s35, 1024
    buffer_load_dwordx4 v102, s[8:11], s28 offen lds
    s_mov_b32 m0, s35
    s_add_u32 s35, s35, 1024
    buffer_load_dwordx4 v103, s[8:11], s28 offen lds
    s_mov_b32 m0, s35
    s_add_u32 s35, s35, 1024
    buffer_load_dwordx4 v104, s[8:11], s28 offen lds
    s_mov_b32 m0, s35
    s_add_u32 s35, s35, 1024
    buffer_load_dwordx4 v105, s[8:11], s28 offen lds
    s_mov_b32 m0, s35
    s_add_u32 s35, s35, 1024
    buffer_load_dwordx4 v106, s[8:11], s28 offen lds
    s_mov_b32 m0, s35
    s_add_u32 s35, s35, 1024
    buffer_load_dwordx4 v107, s[8:11], s28 offen lds
    s_mov_b32 m0, s35
    s_add_u32 s35, s35, 1024
    buffer_load_dwordx4 v108, s[8:11], s28 offen lds
    s_mov_b32 m0, s35
    s_add_u32 s35, s35, 1024
    buffer_load_dwordx4 v109, s[8:11], s28 offen lds
    s_add_u32 s28, s28, 40960
    s_add_u32 s29, s29, 40960
    s_cmp_eq_u32 s29, 122880
    s_cselect_b32 s29, 0, s29
    s_add_u32 s35, s29, s33
    s_mov_b32 m0, s35
    s_add_u32 s35, s35, 1024
    buffer_load_dwordx4 v100, s[8:11], s28 offen lds
    s_mov_b32 m0, s35
    s_add_u32 s35, s35, 1024
    buffer_load_dwordx4 v101, s[8:11], s28 offen lds
    s_mov_b32 m0, s35
    s_add_u32 s35, s35, 1024
    buffer_load_dwordx4 v102, s[8:11], s28 offen lds
    s_mov_b32 m0, s35
    s_add_u32 s35, s35, 1024
    buffer_load_dwordx4 v103, s[8:11], s28 offen lds
    s_mov_b32 m0, s35
    s_add_u32 s35, s35, 1024
    buffer_load_dwordx4 v104, s[8:11], s28 offen lds
    s_mov_b32 m0, s35
    s_add_u32 s35, s35, 1024
    buffer_load_dwordx4 v105, s[8:11], s28 offen lds
    s_mov_b32 m0, s35
    s_add_u32 s35, s35, 1024
    buffer_load_dwordx4 v106, s[8:11], s28 offen lds
    s_mov_b32 m0, s35
    s_add_u32 s35, s35, 1024
    buffer_load_dwordx4 v107, s[8:11], s28 offen lds
    s_mov_b32 m0, s35
    s_add_u32 s35, s35, 1024
    buffer_load_dwordx4 v108, s[8:11], s28 offen lds
    s_mov_b32 m0, s35
    s_add_u32 s35, s35, 1024
    buffer_load_dwordx4 v109, s[8:11], s28 offen lds
    s_add_u32 s28, s28, 40960
    s_add_u32 s29, s29, 40960
    s_cmp_eq_u32 s29, 122880
    s_cselect_b32 s29, 0, s29
    s_mul_i32 s30, s25, 3072
    v_add_u32 v9, s30, v11
    v_mov_b32 v112, v120
    v_add_u32 v116, 40960, v120
    v_mov_b32 v113, v121
    v_add_u32 v117, 40960, v121
    v_mov_b32 v114, v122
    v_add_u32 v118, 40960, v122
    v_mov_b32 v115, v123
    v_add_u32 v119, 40960, v123
    s_mov_b32 s37, 81920
    s_mov_b32 s38, 0
    s_sub_u32 s26, s26, 393216
    s_waitcnt vmcnt(10)
    s_barrier
    ds_read_b128 v[64:67], v112 offset:0
    ds_read_b128 v[68:71], v112 offset:20480
    ds_read_b128 v[72:75], v113 offset:0
    ds_read_b128 v[76:79], v113 offset:20480
    ds_read_b128 v[80:83], v114 offset:0
    ds_read_b128 v[84:87], v114 offset:20480
    s_waitcnt lgkmcnt(4)
    v_mfma_f32_16x16x32_bf16 v[16:19], v[64:67], a[0:3], 0
    v_mfma_f32_16x16x32_bf16 v[20:23], v[64:67], a[4:7], 0
    v_mfma_f32_16x16x32_bf16 v[24:27], v[64:67], a[8:11], 0
    v_mfma_f32_16x16x32_bf16 v[28:31], v[68:71], a[0:3], 0
    v_mfma_f32_16x16x32_bf16 v[32:35], v[68:71], a[4:7], 0
    v_mfma_f32_16x16x32_bf16 v[36:39], v[68:71], a[8:11], 0
    ds_read_b128 v[64:67], v115 offset:0
    ds_read_b128 v[68:71], v115 offset:20480
    s_waitcnt lgkmcnt(4)
    v_mfma_f32_16x16x32_bf16 v[16:19], v[72:75], a[12:15], v[16:19]
    v_mfma_f32_16x16x32_bf16 v[20:23], v[72:75], a[16:19], v[20:23]
    v_mfma_f32_16x16x32_bf16 v[24:27], v[72:75], a[20:23], v[24:27]
    v_mfma_f32_16x16x32_bf16 v[28:31], v[76:79], a[12:15], v[28:31]
    v_mfma_f32_16x16x32_bf16 v[32:35], v[76:79], a[16:19], v[32:35]
    v_mfma_f32_16x16x32_bf16 v[36:39], v[76:79], a[20:23], v[36:39]
    ds_read_b128 v[72:75], v112 offset:256
    ds_read_b128 v[76:79], v112 offset:20736
    s_waitcnt lgkmcnt(4)
    v_mfma_f32_16x16x32_bf16 v[16:19], v[80:83], a[24:27], v[16:19]
    v_mfma_f32_16x16x32_bf16 v[20:23], v[80:83], a[28:31], v[20:23]
    v_mfma_f32_16x16x32_bf16 v[24:27], v[80:83], a[32:35], v[24:27]
    v_mfma_f32_16x16x32_bf16 v[28:31], v[84:87], a[24:27], v[28:31]
    v_mfma_f32_16x16x32_bf16 v[32:35], v[84:87], a[28:31], v[32:35]
    v_mfma_f32_16x16x32_bf16 v[36:39], v[84:87], a[32:35], v[36:39]
    ds_read_b128 v[80:83], v113 offset:256
    ds_read_b128 v[84:87], v113 offset:20736
    s_waitcnt lgkmcnt(4)
    v_mfma_f32_16x16x32_bf16 v[16:19], v[64:67], a[36:39], v[16:19]
    v_mfma_f32_16x16x32_bf16 v[20:23], v[64:67], a[40:43], v[20:23]
    v_mfma_f32_16x16x32_bf16 v[24:27], v[64:67], a[44:47], v[24:27]
    v_mfma_f32_16x16x32_bf16 v[28:31], v[68:71], a[36:39], v[28:31]
    v_mfma_f32_16x16x32_bf16 v[32:35], v[68:71], a[40:43], v[32:35]
    v_mfma_f32_16x16x32_bf16 v[36:39], v[68:71], a[44:47], v[36:39]
    ds_read_b128 v[64:67], v114 offset:256
    ds_read_b128 v[68:71], v114 offset:20736
    s_waitcnt lgkmcnt(4)
    v_mfma_f32_16x16x32_bf16 v[16:19], v[72:75], a[48:51], v[16:19]
    v_mfma_f32_16x16x32_bf16 v[20:23], v[72:75], a[52:55], v[20:23]
    v_mfma_f32_16x16x32_bf16 v[24:27], v[72:75], a[56:59], v[24:27]
    v_mfma_f32_16x16x32_bf16 v[28:31], v[76:79], a[48:51], v[28:31]
    v_mfma_f32_16x16x32_bf16 v[32:35], v[76:79], a[52:55], v[32:35]
    v_mfma_f32_16x16x32_bf16 v[36:39], v[76:79], a[56:59], v[36:39]
    ds_read_b128 v[72:75], v115 offset:256
    ds_read_b128 v[76:79], v115 offset:20736
    s_waitcnt lgkmcnt(4)
    v_mfma_f32_16x16x32_bf16 v[16:19], v[80:83], a[60:63], v[16:19]
    v_mfma_f32_16x16x32_bf16 v[20:23], v[80:83], a[64:67], v[20:23]
    v_mfma_f32_16x16x32_bf16 v[24:27], v[80:83], a[68:71], v[24:27]
    v_mfma_f32_16x16x32_bf16 v[28:31], v[84:87], a[60:63], v[28:31]
    v_mfma_f32_16x16x32_bf16 v[32:35], v[84:87], a[64:67], v[32:35]
    v_mfma_f32_16x16x32_bf16 v[36:39], v[84:87], a[68:71], v[36:39]
    ds_read_b128 v[80:83], v112 offset:512
    ds_read_b128 v[84:87], v112 offset:20992
    s_waitcnt lgkmcnt(4)
    v_mfma_f32_16x16x32_bf16 v[16:19], v[64:67], a[72:75], v[16:19]
    v_mfma_f32_16x16x32_bf16 v[20:23], v[64:67], a[76:79], v[20:23]
    v_mfma_f32_16x16x32_bf16 v[24:27], v[64:67], a[80:83], v[24:27]
    v_mfma_f32_16x16x32_bf16 v[28:31], v[68:71], a[72:75], v[28:31]
    v_mfma_f32_16x16x32_bf16 v[32:35], v[68:71], a[76:79], v[32:35]
    v_mfma_f32_16x16x32_bf16 v[36:39], v[68:71], a[80:83], v[36:39]
    ds_read_b128 v[64:67], v113 offset:512
    ds_read_b128 v[68:71], v113 offset:20992
    s_waitcnt lgkmcnt(4)
    v_mfma_f32_16x16x32_bf16 v[16:19], v[72:75], a[84:87], v[16:19]
    v_mfma_f32_16x16x32_bf16 v[20:23], v[72:75], a[88:91], v[20:23]
    v_mfma_f32_16x16x32_bf16 v[24:27], v[72:75], a[92:95], v[24:27]
    v_mfma_f32_16x16x32_bf16 v[28:31], v[76:79], a[84:87], v[28:31]
    v_mfma_f32_16x16x32_bf16 v[32:35], v[76:79], a[88:91], v[32:35]
    v_mfma_f32_16x16x32_bf16 v[36:39], v[76:79], a[92:95], v[36:39]
    ds_read_b128 v[72:75], v114 offset:512
    ds_read_b128 v[76:79], v114 offset:20992
    s_waitcnt lgkmcnt(4)
    v_mfma_f32_16x16x32_bf16 v[16:19], v[80:83], a[96:99], v[16:19]
    v_mfma_f32_16x16x32_bf16 v[20:23], v[80:83], a[100:103], v[20:23]
    v_mfma_f32_16x16x32_bf16 v[24:27], v[80:83], a[104:107], v[24:27]
    v_mfma_f32_16x16x32_bf16 v[28:31], v[84:87], a[96:99], v[28:31]
    v_mfma_f32_16x16x32_bf16 v[32:35], v[84:87], a[100:103], v[32:35]
    v_mfma_f32_16x16x32_bf16 v[36:39], v[84:87], a[104:107], v[36:39]
    ds_read_b128 v[80:83], v115 offset:512
    ds_read_b128 v[84:87], v115 offset:20992
    s_waitcnt lgkmcnt(4)
    v_mfma_f32_16x16x32_bf16 v[16:19], v[64:67], a[108:111], v[16:19]
    v_mfma_f32_16x16x32_bf16 v[20:23], v[64:67], a[112:115], v[20:23]
    v_mfma_f32_16x16x32_bf16 v[24:27], v[64:67], a[116:119], v[24:27]
    v_mfma_f32_16x16x32_bf16 v[28:31], v[68:71], a[108:111], v[28:31]
    v_mfma_f32_16x16x32_bf16 v[32:35], v[68:71], a[112:115], v[32:35]
    v_mfma_f32_16x16x32_bf16 v[36:39], v[68:71], a[116:119], v[36:39]
    ds_read_b128 v[64:67], v112 offset:768
    ds_read_b128 v[68:71], v112 offset:21248
    s_waitcnt vmcnt(0)
    s_barrier
    s_add_u32 s35, s29, s33
    s_waitcnt lgkmcnt(4)
    v_mfma_f32_16x16x32_bf16 v[16:19], v[72:75], a[120:123], v[16:19]
    v_mfma_f32_16x16x32_bf16 v[20:23], v[72:75], a[124:127], v[20:23]
    s_mov_b32 m0, s35
    s_add_u32 s35, s35, 1024
    buffer_load_dwordx4 v100, s[8:11], s28 offen lds
    v_mfma_f32_16x16x32_bf16 v[24:27], v[72:75], a[128:131], v[24:27]
    v_mfma_f32_16x16x32_bf16 v[28:31], v[76:79], a[120:123], v[28:31]
    v_mfma_f32_16x16x32_bf16 v[32:35], v[76:79], a[124:127], v[32:35]
    v_mfma_f32_16x16x32_bf16 v[36:39], v[76:79], a[128:131], v[36:39]
    ds_read_b128 v[72:75], v113 offset:768
    ds_read_b128 v[76:79], v113 offset:21248
    s_waitcnt lgkmcnt(4)
    v_mfma_f32_16x16x32_bf16 v[16:19], v[80:83], a[132:135], v[16:19]
    v_mfma_f32_16x16x32_bf16 v[20:23], v[80:83], a[136:139], v[20:23]
    s_mov_b32 m0, s35
    s_add_u32 s35, s35, 1024
    buffer_load_dwordx4 v101, s[8:11], s28 offen lds
    v_mfma_f32_16x16x32_bf16 v[24:27], v[80:83], a[140:143], v[24:27]
    v_mfma_f32_16x16x32_bf16 v[28:31], v[84:87], a[132:135], v[28:31]
    v_mfma_f32_16x16x32_bf16 v[32:35], v[84:87], a[136:139], v[32:35]
    v_mfma_f32_16x16x32_bf16 v[36:39], v[84:87], a[140:143], v[36:39]
    ds_read_b128 v[80:83], v114 offset:768
    ds_read_b128 v[84:87], v114 offset:21248
    s_waitcnt lgkmcnt(4)
    v_mfma_f32_16x16x32_bf16 v[16:19], v[64:67], a[144:147], v[16:19]
    v_mfma_f32_16x16x32_bf16 v[20:23], v[64:67], a[148:151], v[20:23]
    s_mov_b32 m0, s35
    s_add_u32 s35, s35, 1024
    buffer_load_dwordx4 v102, s[8:11], s28 offen lds
    v_mfma_f32_16x16x32_bf16 v[24:27], v[64:67], a[152:155], v[24:27]
    v_mfma_f32_16x16x32_bf16 v[28:31], v[68:71], a[144:147], v[28:31]
    v_mfma_f32_16x16x32_bf16 v[32:35], v[68:71], a[148:151], v[32:35]
    v_mfma_f32_16x16x32_bf16 v[36:39], v[68:71], a[152:155], v[36:39]
    ds_read_b128 v[64:67], v115 offset:768
    ds_read_b128 v[68:71], v115 offset:21248
    s_waitcnt lgkmcnt(4)
    v_mfma_f32_16x16x32_bf16 v[16:19], v[72:75], a[156:159], v[16:19]
    v_mfma_f32_16x16x32_bf16 v[20:23], v[72:75], a[160:163], v[20:23]
    s_mov_b32 m0, s35
    s_add_u32 s35, s35, 1024
    buffer_load_dwordx4 v103, s[8:11], s28 offen lds
    v_mfma_f32_16x16x32_bf16 v[24:27], v[72:75], a[164:167], v[24:27]
    v_mfma_f32_16x16x32_bf16 v[28:31], v[76:79], a[156:159], v[28:31]
    v_mfma_f32_16x16x32_bf16 v[32:35], v[76:79], a[160:163], v[32:35]
    v_mfma_f32_16x16x32_bf16 v[36:39], v[76:79], a[164:167], v[36:39]
    ds_read_b128 v[72:75], v112 offset:1024
    ds_read_b128 v[76:79], v112 offset:21504
    s_waitcnt lgkmcnt(4)
    v_mfma_f32_16x16x32_bf16 v[16:19], v[80:83], a[168:171], v[16:19]
    v_mfma_f32_16x16x32_bf16 v[20:23], v[80:83], a[172:175], v[20:23]
    s_mov_b32 m0, s35
    s_add_u32 s35, s35, 1024
    buffer_load_dwordx4 v104, s[8:11], s28 offen lds
    v_mfma_f32_16x16x32_bf16 v[24:27], v[80:83], a[176:179], v[24:27]
    v_mfma_f32_16x16x32_bf16 v[28:31], v[84:87], a[168:171], v[28:31]
    v_mfma_f32_16x16x32_bf16 v[32:35], v[84:87], a[172:175], v[32:35]
    v_mfma_f32_16x16x32_bf16 v[36:39], v[84:87], a[176:179], v[36:39]
    ds_read_b128 v[80:83], v113 offset:1024
    ds_read_b128 v[84:87], v113 offset:21504
    s_waitcnt lgkmcnt(4)
    v_mfma_f32_16x16x32_bf16 v[16:19], v[64:67], a[180:183], v[16:19]
    v_mfma_f32_16x16x32_bf16 v[20:23], v[64:67], a[184:187], v[20:23]
    s_mov_b32 m0, s35
    s_add_u32 s35, s35, 1024
    buffer_load_dwordx4 v105, s[8:11], s28 offen lds
    v_mfma_f32_16x16x32_bf16 v[24:27], v[64:67], a[188:191], v[24:27]
    v_mfma_f32_16x16x32_bf16 v[28:31], v[68:71], a[180:183], v[28:31]
    v_mfma_f32_16x16x32_bf16 v[32:35], v[68:71], a[184:187], v[32:35]
    v_mfma_f32_16x16x32_bf16 v[36:39], v[68:71], a[188:191], v[36:39]
    ds_read_b128 v[64:67], v114 offset:1024
    ds_read_b128 v[68:71], v114 offset:21504
    s_waitcnt lgkmcnt(4)
    v_mfma_f32_16x16x32_bf16 v[16:19], v[72:75], a[192:195], v[16:19]
    v_mfma_f32_16x16x32_bf16 v[20:23], v[72:75], a[196:199], v[20:23]
    s_mov_b32 m0, s35
    s_add_u32 s35, s35, 1024
    buffer_load_dwordx4 v106, s[8:11], s28 offen lds
    v_mfma_f32_16x16x32_bf16 v[24:27], v[72:75], a[200:203], v[24:27]
    v_mfma_f32_16x16x32_bf16 v[28:31], v[76:79], a[192:195], v[28:31]
    v_mfma_f32_16x16x32_bf16 v[32:35], v[76:79], a[196:199], v[32:35]
    v_mfma_f32_16x16x32_bf16 v[36:39], v[76:79], a[200:203], v[36:39]
    ds_read_b128 v[72:75], v115 offset:1024
    ds_read_b128 v[76:79], v115 offset:21504
    s_waitcnt lgkmcnt(4)
    v_mfma_f32_16x16x32_bf16 v[16:19], v[80:83], a[204:207], v[16:19]
    v_mfma_f32_16x16x32_bf16 v[20:23], v[80:83], a[208:211], v[20:23]
    s_mov_b32 m0, s35
    s_add_u32 s35, s35, 1024
    buffer_load_dwordx4 v107, s[8:11], s28 offen lds
    v_mfma_f32_16x16x32_bf16 v[24:27], v[80:83], a[212:215], v[24:27]
    v_mfma_f32_16x16x32_bf16 v[28:31], v[84:87], a[204:207], v[28:31]
    v_mfma_f32_16x16x32_bf16 v[32:35], v[84:87], a[208:211], v[32:35]
    v_mfma_f32_16x16x32_bf16 v[36:39], v[84:87], a[212:215], v[36:39]
    ds_read_b128 v[80:83], v116 offset:0
    ds_read_b128 v[84:87], v116 offset:20480
    s_waitcnt lgkmcnt(4)
    v_mfma_f32_16x16x32_bf16 v[16:19], v[64:67], a[216:219], v[16:19]
    v_mfma_f32_16x16x32_bf16 v[20:23], v[64:67], a[220:223], v[20:23]
    s_mov_b32 m0, s35
    s_add_u32 s35, s35, 1024
    buffer_load_dwordx4 v108, s[8:11], s28 offen lds
    v_mfma_f32_16x16x32_bf16 v[24:27], v[64:67], a[224:227], v[24:27]
    v_mfma_f32_16x16x32_bf16 v[28:31], v[68:71], a[216:219], v[28:31]
    v_mfma_f32_16x16x32_bf16 v[32:35], v[68:71], a[220:223], v[32:35]
    v_mfma_f32_16x16x32_bf16 v[36:39], v[68:71], a[224:227], v[36:39]
    ds_read_b128 v[64:67], v117 offset:0
    ds_read_b128 v[68:71], v117 offset:20480
    s_waitcnt lgkmcnt(4)
    v_mfma_f32_16x16x32_bf16 v[16:19], v[72:75], a[228:231], v[16:19]
    v_mfma_f32_16x16x32_bf16 v[20:23], v[72:75], a[232:235], v[20:23]
    s_mov_b32 m0, s35
    s_add_u32 s35, s35, 1024
    buffer_load_dwordx4 v109, s[8:11], s28 offen lds
    v_mfma_f32_16x16x32_bf16 v[24:27], v[72:75], a[236:239], v[24:27]
    v_mfma_f32_16x16x32_bf16 v[28:31], v[76:79], a[228:231], v[28:31]
    v_mfma_f32_16x16x32_bf16 v[32:35], v[76:79], a[232:235], v[32:35]
    v_mfma_f32_16x16x32_bf16 v[36:39], v[76:79], a[236:239], v[36:39]
    s_add_u32 s28, s28, 40960
    s_add_u32 s29, s29, 40960
    s_cmp_eq_u32 s29, 122880
    s_cselect_b32 s29, 0, s29
    v_mov_b32 v112, v116
    v_add_u32 v116, s37, v120
    v_mov_b32 v113, v117
    v_add_u32 v117, s37, v121
    v_mov_b32 v114, v118
    v_add_u32 v118, s37, v122
    v_mov_b32 v115, v119
    v_add_u32 v119, s37, v123
    s_add_u32 s37, s37, 40960
    s_cmp_eq_u32 s37, 122880
    s_cselect_b32 s37, 0, s37
    s_add_u32 s26, s26, 393216
    s_add_u32 s38, s38, 1
PV_loop:
    s_cmp_ge_u32 s38, s24
    s_cbranch_scc1 PV_fin0
    ds_read_b128 v[72:75], v114 offset:0
    ds_read_b128 v[76:79], v114 offset:20480
    s_waitcnt lgkmcnt(4)
    v_mfma_f32_16x16x32_bf16 v[40:43], v[80:83], a[0:3], 0
    v_mfma_f32_16x16x32_bf16 v[44:47], v[80:83], a[4:7], 0
    v_mfma_f32_16x16x32_bf16 v[48:51], v[80:83], a[8:11], 0
    v_mfma_f32_16x16x32_bf16 v[52:55], v[84:87], a[0:3], 0
    v_mfma_f32_16x16x32_bf16 v[56:59], v[84:87], a[4:7], 0
    v_mfma_f32_16x16x32_bf16 v[60:63], v[84:87], a[8:11], 0
    ds_read_b128 v[80:83], v115 offset:0
    ds_read_b128 v[84:87], v115 offset:20480
    s_waitcnt lgkmcnt(4)
    v_mfma_f32_16x16x32_bf16 v[40:43], v[64:67], a[12:15], v[40:43]
    v_cvt_pk_bf16_f32 v88, v16, v17
    v_cvt_pk_bf16_f32 v89, v18, v19
    v_mfma_f32_16x16x32_bf16 v[44:47], v[64:67], a[16:19], v[44:47]
    v_mfma_f32_16x16x32_bf16 v[48:51], v[64:67], a[20:23], v[48:51]
    v_cvt_pk_bf16_f32 v90, v28, v29
    v_cvt_pk_bf16_f32 v91, v30, v31
    v_mfma_f32_16x16x32_bf16 v[52:55], v[68:71], a[12:15], v[52:55]
    v_mfma_f32_16x16x32_bf16 v[56:59], v[68:71], a[16:19], v[56:59]
    buffer_store_dwordx4 v[88:91], v9, s[16:19], s26 offen offset:0 sc1
    v_mfma_f32_16x16x32_bf16 v[60:63], v[68:71], a[20:23], v[60:63]
    ds_read_b128 v[64:67], v112 offset:256
    ds_read_b128 v[68:71], v112 offset:20736
    s_waitcnt lgkmcnt(4)
    v_mfma_f32_16x16x32_bf16 v[40:43], v[72:75], a[24:27], v[40:43]
    v_cvt_pk_bf16_f32 v92, v20, v21
    v_cvt_pk_bf16_f32 v93, v22, v23
    v_mfma_f32_16x16x32_bf16 v[44:47], v[72:75], a[28:31], v[44:47]
    v_mfma_f32_16x16x32_bf16 v[48:51], v[72:75], a[32:35], v[48:51]
    v_cvt_pk_bf16_f32 v94, v32, v33
    v_cvt_pk_bf16_f32 v95, v34, v35
    v_mfma_f32_16x16x32_bf16 v[52:55], v[76:79], a[24:27], v[52:55]
    v_mfma_f32_16x16x32_bf16 v[56:59], v[76:79], a[28:31], v[56:59]
    buffer_store_dwordx4 v[92:95], v9, s[16:19], s26 offen offset:1024 sc1
    v_mfma_f32_16x16x32_bf16 v[60:63], v[76:79], a[32:35], v[60:63]
    ds_read_b128 v[72:75], v113 offset:256
    ds_read_b128 v[76:79], v113 offset:20736
    s_waitcnt lgkmcnt(4)
    v_mfma_f32_16x16x32_bf16 v[40:43], v[80:83], a[36:39], v[40:43]
    v_cvt_pk_bf16_f32 v96, v24, v25
    v_cvt_pk_bf16_f32 v97, v26, v27
    v_mfma_f32_16x16x32_bf16 v[44:47], v[80:83], a[40:43], v[44:47]
    v_mfma_f32_16x16x32_bf16 v[48:51], v[80:83], a[44:47], v[48:51]
    v_cvt_pk_bf16_f32 v98, v36, v37
    v_cvt_pk_bf16_f32 v99, v38, v39
    v_mfma_f32_16x16x32_bf16 v[52:55], v[84:87], a[36:39], v[52:55]
    v_mfma_f32_16x16x32_bf16 v[56:59], v[84:87], a[40:43], v[56:59]
    buffer_store_dwordx4 v[96:99], v9, s[16:19], s26 offen offset:2048 sc1
    v_mfma_f32_16x16x32_bf16 v[60:63], v[84:87], a[44:47], v[60:63]
    ds_read_b128 v[80:83], v114 offset:256
    ds_read_b128 v[84:87], v114 offset:20736
    s_waitcnt lgkmcnt(4)
    v_mfma_f32_16x16x32_bf16 v[40:43], v[64:67], a[48:51], v[40:43]
    v_mfma_f32_16x16x32_bf16 v[44:47], v[64:67], a[52:55], v[44:47]
    v_mfma_f32_16x16x32_bf16 v[48:51], v[64:67], a[56:59], v[48:51]
    v_mfma_f32_16x16x32_bf16 v[52:55], v[68:71], a[48:51], v[52:55]
    v_mfma_f32_16x16x32_bf16 v[56:59], v[68:71], a[52:55], v[56:59]
    v_mfma_f32_16x16x32_bf16 v[60:63], v[68:71], a[56:59], v[60:63]
    ds_read_b128 v[64:67], v115 offset:256
    ds_read_b128 v[68:71], v115 offset:20736
    s_waitcnt lgkmcnt(4)
    v_mfma_f32_16x16x32_bf16 v[40:43], v[72:75], a[60:63], v[40:43]
    v_mfma_f32_16x16x32_bf16 v[44:47], v[72:75], a[64:67], v[44:47]
    v_mfma_f32_16x16x32_bf16 v[48:51], v[72:75], a[68:71], v[48:51]
    v_mfma_f32_16x16x32_bf16 v[52:55], v[76:79], a[60:63], v[52:55]
    v_mfma_f32_16x16x32_bf16 v[56:59], v[76:79], a[64:67], v[56:59]
    v_mfma_f32_16x16x32_bf16 v[60:63], v[76:79], a[68:71], v[60:63]
    ds_read_b128 v[72:75], v112 offset:512
    ds_read_b128 v[76:79], v112 offset:20992
    s_waitcnt lgkmcnt(4)
    v_mfma_f32_16x16x32_bf16 v[40:43], v[80:83], a[72:75], v[40:43]
    v_mfma_f32_16x16x32_bf16 v[44:47], v[80:83], a[76:79], v[44:47]
    v_mfma_f32_16x16x32_bf16 v[48:51], v[80:83], a[80:83], v[48:51]
    v_mfma_f32_16x16x32_bf16 v[52:55], v[84:87], a[72:75], v[52:55]
    v_mfma_f32_16x16x32_bf16 v[56:59], v[84:87], a[76:79], v[56:59]
    v_mfma_f32_16x16x32_bf16 v[60:63], v[84:87], a[80:83], v[60:63]
    ds_read_b128 v[80:83], v113 offset:512
    ds_read_b128 v[84:87], v113 offset:20992
    s_waitcnt lgkmcnt(4)
    v_mfma_f32_16x16x32_bf16 v[40:43], v[64:67], a[84:87], v[40:43]
    v_mfma_f32_16x16x32_bf16 v[44:47], v[64:67], a[88:91], v[44:47]
    v_mfma_f32_16x16x32_bf16 v[48:51], v[64:67], a[92:95], v[48:51]
    v_mfma_f32_16x16x32_bf16 v[52:55], v[68:71], a[84:87], v[52:55]
    v_mfma_f32_16x16x32_bf16 v[56:59], v[68:71], a[88:91], v[56:59]
    v_mfma_f32_16x16x32_bf16 v[60:63], v[68:71], a[92:95], v[60:63]
    ds_read_b128 v[64:67], v114 offset:512
    ds_read_b128 v[68:71], v114 offset:20992
    s_waitcnt lgkmcnt(4)
    v_mfma_f32_16x16x32_bf16 v[40:43], v[72:75], a[96:99], v[40:43]
    v_mfma_f32_16x16x32_bf16 v[44:47], v[72:75], a[100:103], v[44:47]
    v_mfma_f32_16x16x32_bf16 v[48:51], v[72:75], a[104:107], v[48:51]
    v_mfma_f32_16x16x32_bf16 v[52:55], v[76:79], a[96:99], v[52:55]
    v_mfma_f32_16x16x32_bf16 v[56:59], v[76:79], a[100:103], v[56:59]
    v_mfma_f32_16x16x32_bf16 v[60:63], v[76:79], a[104:107], v[60:63]
    ds_read_b128 v[72:75], v115 offset:512
    ds_read_b128 v[76:79], v115 offset:20992
    s_waitcnt lgkmcnt(4)
    v_mfma_f32_16x16x32_bf16 v[40:43], v[80:83], a[108:111], v[40:43]
    v_mfma_f32_16x16x32_bf16 v[44:47], v[80:83], a[112:115], v[44:47]
    v_mfma_f32_16x16x32_bf16 v[48:51], v[80:83], a[116:119], v[48:51]
    v_mfma_f32_16x16x32_bf16 v[52:55], v[84:87], a[108:111], v[52:55]
    v_mfma_f32_16x16x32_bf16 v[56:59], v[84:87], a[112:115], v[56:59]
    v_mfma_f32_16x16x32_bf16 v[60:63], v[84:87], a[116:119], v[60:63]
    ds_read_b128 v[80:83], v112 offset:768
    ds_read_b128 v[84:87], v112 offset:21248
    s_waitcnt vmcnt(3)
    s_barrier
    s_add_u32 s35, s29, s33
    s_sub_u32 s30, s38, 1
    v_mov_b32 v14, s30
    buffer_store_dword v14, v2, s[16:19], s40 offen sc1
    s_waitcnt lgkmcnt(4)
    v_mfma_f32_16x16x32_bf16 v[40:43], v[64:67], a[120:123], v[40:43]
    v_mfma_f32_16x16x32_bf16 v[44:47], v[64:67], a[124:127], v[44:47]
    s_mov_b32 m0, s35
    s_add_u32 s35, s35, 1024
    buffer_load_dwordx4 v100, s[8:11], s28 offen lds
    v_mfma_f32_16x16x32_bf16 v[48:51], v[64:67], a[128:131], v[48:51]
    v_mfma_f32_16x16x32_bf16 v[52:55], v[68:71], a[120:123], v[52:55]
    v_mfma_f32_16x16x32_bf16 v[56:59], v[68:71], a[124:127], v[56:59]
    v_mfma_f32_16x16x32_bf16 v[60:63], v[68:71], a[128:131], v[60:63]
    ds_read_b128 v[64:67], v113 offset:768
    ds_read_b128 v[68:71], v113 offset:21248
    s_waitcnt lgkmcnt(4)
    v_mfma_f32_16x16x32_bf16 v[40:43], v[72:75], a[132:135], v[40:43]
    v_mfma_f32_16x16x32_bf16 v[44:47], v[72:75], a[136:139], v[44:47]
    s_mov_b32 m0, s35
    s_add_u32 s35, s35, 1024
    buffer_load_dwordx4 v101, s[8:11], s28 offen lds
    v_mfma_f32_16x16x32_bf16 v[48:51], v[72:75], a[140:143], v[48:51]
    v_mfma_f32_16x16x32_bf16 v[52:55], v[76:79], a[132:135], v[52:55]
    v_mfma_f32_16x16x32_bf16 v[56:59], v[76:79], a[136:139], v[56:59]
    v_mfma_f32_16x16x32_bf16 v[60:63], v[76:79], a[140:143], v[60:63]
    ds_read_b128 v[72:75], v114 offset:768
    ds_read_b128 v[76:79], v114 offset:21248
    s_waitcnt lgkmcnt(4)
    v_mfma_f32_16x16x32_bf16 v[40:43], v[80:83], a[144:147], v[40:43]
    v_mfma_f32_16x16x32_bf16 v[44:47], v[80:83], a[148:151], v[44:47]
    s_mov_b32 m0, s35
    s_add_u32 s35, s35, 1024
    buffer_load_dwordx4 v102, s[8:11], s28 offen lds
    v_mfma_f32_16x16x32_bf16 v[48:51], v[80:83], a[152:155], v[48:51]
    v_mfma_f32_16x16x32_bf16 v[52:55], v[84:87], a[144:147], v[52:55]
    v_mfma_f32_16x16x32_bf16 v[56:59], v[84:87], a[148:151], v[56:59]
    v_mfma_f32_16x16x32_bf16 v[60:63], v[84:87], a[152:155], v[60:63]
    ds_read_b128 v[80:83], v115 offset:768
    ds_read_b128 v[84:87], v115 offset:21248
    s_waitcnt lgkmcnt(4)
    v_mfma_f32_16x16x32_bf16 v[40:43], v[64:67], a[156:159], v[40:43]
    v_mfma_f32_16x16x32_bf16 v[44:47], v[64:67], a[160:163], v[44:47]
    s_mov_b32 m0, s35
    s_add_u32 s35, s35, 1024
    buffer_load_dwordx4 v103, s[8:11], s28 offen lds
    v_mfma_f32_16x16x32_bf16 v[48:51], v[64:67], a[164:167], v[48:51]
    v_mfma_f32_16x16x32_bf16 v[52:55], v[68:71], a[156:159], v[52:55]
    v_mfma_f32_16x16x32_bf16 v[56:59], v[68:71], a[160:163], v[56:59]
    v_mfma_f32_16x16x32_bf16 v[60:63], v[68:71], a[164:167], v[60:63]
    ds_read_b128 v[64:67], v112 offset:1024
    ds_read_b128 v[68:71], v112 offset:21504
    s_waitcnt lgkmcnt(4)
    v_mfma_f32_16x16x32_bf16 v[40:43], v[72:75], a[168:171], v[40:43]
    v_mfma_f32_16x16x32_bf16 v[44:47], v[72:75], a[172:175], v[44:47]
    s_mov_b32 m0, s35
    s_add_u32 s35, s35, 1024
    buffer_load_dwordx4 v104, s[8:11], s28 offen lds
    v_mfma_f32_16x16x32_bf16 v[48:51], v[72:75], a[176:179], v[48:51]
    v_mfma_f32_16x16x32_bf16 v[52:55], v[76:79], a[168:171], v[52:55]
    v_mfma_f32_16x16x32_bf16 v[56:59], v[76:79], a[172:175], v[56:59]
    v_mfma_f32_16x16x32_bf16 v[60:63], v[76:79], a[176:179], v[60:63]
    ds_read_b128 v[72:75], v113 offset:1024
    ds_read_b128 v[76:79], v113 offset:21504
    s_waitcnt lgkmcnt(4)
    v_mfma_f32_16x16x32_bf16 v[40:43], v[80:83], a[180:183], v[40:43]
    v_mfma_f32_16x16x32_bf16 v[44:47], v[80:83], a[184:187], v[44:47]
    s_mov_b32 m0, s35
    s_add_u32 s35, s35, 1024
    buffer_load_dwordx4 v105, s[8:11], s28 offen lds
    v_mfma_f32_16x16x32_bf16 v[48:51], v[80:83], a[188:191], v[48:51]
    v_mfma_f32_16x16x32_bf16 v[52:55], v[84:87], a[180:183], v[52:55]
    v_mfma_f32_16x16x32_bf16 v[56:59], v[84:87], a[184:187], v[56:59]
    v_mfma_f32_16x16x32_bf16 v[60:63], v[84:87], a[188:191], v[60:63]
    ds_read_b128 v[80:83], v114 offset:1024
    ds_read_b128 v[84:87], v114 offset:21504
    s_waitcnt lgkmcnt(4)
    v_mfma_f32_16x16x32_bf16 v[40:43], v[64:67], a[192:195], v[40:43]
    v_mfma_f32_16x16x32_bf16 v[44:47], v[64:67], a[196:199], v[44:47]
    s_mov_b32 m0, s35
    s_add_u32 s35, s35, 1024
    buffer_load_dwordx4 v106, s[8:11], s28 offen lds
    v_mfma_f32_16x16x32_bf16 v[48:51], v[64:67], a[200:203], v[48:51]
    v_mfma_f32_16x16x32_bf16 v[52:55], v[68:71], a[192:195], v[52:55]
    v_mfma_f32_16x16x32_bf16 v[56:59], v[68:71], a[196:199], v[56:59]
    v_mfma_f32_16x16x32_bf16 v[60:63], v[68:71], a[200:203], v[60:63]
    ds_read_b128 v[64:67], v115 offset:1024
    ds_read_b128 v[68:71], v115 offset:21504
    s_waitcnt lgkmcnt(4)
    v_mfma_f32_16x16x32_bf16 v[40:43], v[72:75], a[204:207], v[40:43]
    v_mfma_f32_16x16x32_bf16 v[44:47], v[72:75], a[208:211], v[44:47]
    s_mov_b32 m0, s35
    s_add_u32 s35, s35, 1024
    buffer_load_dwordx4 v107, s[8:11], s28 offen lds
    v_mfma_f32_16x16x32_bf16 v[48:51], v[72:75], a[212:215], v[48:51]
    v_mfma_f32_16x16x32_bf16 v[52:55], v[76:79], a[204:207], v[52:55]
    v_mfma_f32_16x16x32_bf16 v[56:59], v[76:79], a[208:211], v[56:59]
    v_mfma_f32_16x16x32_bf16 v[60:63], v[76:79], a[212:215], v[60:63]
    ds_read_b128 v[72:75], v116 offset:0
    ds_read_b128 v[76:79], v116 offset:20480
    s_waitcnt lgkmcnt(4)
    v_mfma_f32_16x16x32_bf16 v[40:43], v[80:83], a[216:219], v[40:43]
    v_mfma_f32_16x16x32_bf16 v[44:47], v[80:83], a[220:223], v[44:47]
    s_mov_b32 m0, s35
    s_add_u32 s35, s35, 1024
    buffer_load_dwordx4 v108, s[8:11], s28 offen lds
    v_mfma_f32_16x16x32_bf16 v[48:51], v[80:83], a[224:227], v[48:51]
    v_mfma_f32_16x16x32_bf16 v[52:55], v[84:87], a[216:219], v[52:55]
    v_mfma_f32_16x16x32_bf16 v[56:59], v[84:87], a[220:223], v[56:59]
    v_mfma_f32_16x16x32_bf16 v[60:63], v[84:87], a[224:227], v[60:63]
    ds_read_b128 v[80:83], v117 offset:0
    ds_read_b128 v[84:87], v117 offset:20480
    s_cmp_gt_u32 s38, 2
    s_cbranch_scc1 PV_ef_72
    s_waitcnt vmcnt(10)
    v_mov_b32 v14, s38
    buffer_store_dword v14, v2, s[16:19], s40 offen sc1
PV_ef_72:
    s_waitcnt lgkmcnt(4)
    v_mfma_f32_16x16x32_bf16 v[40:43], v[64:67], a[228:231], v[40:43]
    v_mfma_f32_16x16x32_bf16 v[44:47], v[64:67], a[232:235], v[44:47]
    s_mov_b32 m0, s35
    s_add_u32 s35, s35, 1024
    buffer_load_dwordx4 v109, s[8:11], s28 offen lds
    v_mfma_f32_16x16x32_bf16 v[48:51], v[64:67], a[236:239], v[48:51]
    v_mfma_f32_16x16x32_bf16 v[52:55], v[68:71], a[228:231], v[52:55]
    v_mfma_f32_16x16x32_bf16 v[56:59], v[68:71], a[232:235], v[56:59]
    v_mfma_f32_16x16x32_bf16 v[60:63], v[68:71], a[236:239], v[60:63]
    s_add_u32 s28, s28, 40960
    s_add_u32 s29, s29, 40960
    s_cmp_eq_u32 s29, 122880
    s_cselect_b32 s29, 0, s29
    v_mov_b32 v112, v116
    v_add_u32 v116, s37, v120
    v_mov_b32 v113, v117
    v_add_u32 v117, s37, v121
    v_mov_b32 v114, v118
    v_add_u32 v118, s37, v122
    v_mov_b32 v115, v119
    v_add_u32 v119, s37, v123
    s_add_u32 s37, s37, 40960
    s_cmp_eq_u32 s37, 122880
    s_cselect_b32 s37, 0, s37
    s_add_u32 s26, s26, 393216
    s_add_u32 s38, s38, 1
    s_cmp_ge_u32 s38, s24
    s_cbranch_scc1 PV_fin1
    ds_read_b128 v[64:67], v114 offset:0
    ds_read_b128 v[68:71], v114 offset:20480
    s_waitcnt lgkmcnt(4)
    v_mfma_f32_16x16x32_bf16 v[16:19], v[72:75], a[0:3], 0
    v_mfma_f32_16x16x32_bf16 v[20:23], v[72:75], a[4:7], 0
    v_mfma_f32_16x16x32_bf16 v[24:27], v[72:75], a[8:11], 0
    v_mfma_f32_16x16x32_bf16 v[28:31], v[76:79], a[0:3], 0
    v_mfma_f32_16x16x32_bf16 v[32:35], v[76:79], a[4:7], 0
    v_mfma_f32_16x16x32_bf16 v[36:39], v[76:79], a[8:11], 0
    ds_read_b128 v[72:75], v115 offset:0
    ds_read_b128 v[76:79], v115 offset:20480
    s_waitcnt lgkmcnt(4)
    v_mfma_f32_16x16x32_bf16 v[16:19], v[80:83], a[12:15], v[16:19]
    v_cvt_pk_bf16_f32 v88, v40, v41
    v_cvt_pk_bf16_f32 v89, v42, v43
    v_mfma_f32_16x16x32_bf16 v[20:23], v[80:83], a[16:19], v[20:23]
    v_mfma_f32_16x16x32_bf16 v[24:27], v[80:83], a[20:23], v[24:27]
    v_cvt_pk_bf16_f32 v90, v52, v53
    v_cvt_pk_bf16_f32 v91, v54, v55
    v_mfma_f32_16x16x32_bf16 v[28:31], v[84:87], a[12:15], v[28:31]
    v_mfma_f32_16x16x32_bf16 v[32:35], v[84:87], a[16:19], v[32:35]
    buffer_store_dwordx4 v[88:91], v9, s[16:19], s26 offen offset:0 sc1
    v_mfma_f32_16x16x32_bf16 v[36:39], v[84:87], a[20:23], v[36:39]
    ds_read_b128 v[80:83], v112 offset:256
    ds_read_b128 v[84:87], v112 offset:20736
    s_waitcnt lgkmcnt(4)
    v_mfma_f32_16x16x32_bf16 v[16:19], v[64:67], a[24:27], v[16:19]
    v_cvt_pk_bf16_f32 v92, v44, v45
    v_cvt_pk_bf16_f32 v93, v46, v47
    v_mfma_f32_16x16x32_bf16 v[20:23], v[64:67], a[28:31], v[20:23]
    v_mfma_f32_16x16x32_bf16 v[24:27], v[64:67], a[32:35], v[24:27]
    v_cvt_pk_bf16_f32 v94, v56, v57
    v_cvt_pk_bf16_f32 v95, v58, v59
    v_mfma_f32_16x16x32_bf16 v[28:31], v[68:71], a[24:27], v[28:31]
    v_mfma_f32_16x16x32_bf16 v[32:35], v[68:71], a[28:31], v[32:35]
    buffer_store_dwordx4 v[92:95], v9, s[16:19], s26 offen offset:1024 sc1
    v_mfma_f32_16x16x32_bf16 v[36:39], v[68:71], a[32:35], v[36:39]
    ds_read_b128 v[64:67], v113 offset:256
    ds_read_b128 v[68:71], v113 offset:20736
    s_waitcnt lgkmcnt(4)
    v_mfma_f32_16x16x32_bf16 v[16:19], v[72:75], a[36:39], v[16:19]
    v_cvt_pk_bf16_f32 v96, v48, v49
    v_cvt_pk_bf16_f32 v97, v50, v51
    v_mfma_f32_16x16x32_bf16 v[20:23], v[72:75], a[40:43], v[20:23]
    v_mfma_f32_16x16x32_bf16 v[24:27], v[72:75], a[44:47], v[24:27]
    v_cvt_pk_bf16_f32 v98, v60, v61
    v_cvt_pk_bf16_f32 v99, v62, v63
    v_mfma_f32_16x16x32_bf16 v[28:31], v[76:79], a[36:39], v[28:31]
    v_mfma_f32_16x16x32_bf16 v[32:35], v[76:79], a[40:43], v[32:35]
    buffer_store_dwordx4 v[96:99], v9, s[16:19], s26 offen offset:2048 sc1
    v_mfma_f32_16x16x32_bf16 v[36:39], v[76:79], a[44:47], v[36:39]
    ds_read_b128 v[72:75], v114 offset:256
    ds_read_b128 v[76:79], v114 offset:20736
    s_waitcnt lgkmcnt(4)
    v_mfma_f32_16x16x32_bf16 v[16:19], v[80:83], a[48:51], v[16:19]
    v_mfma_f32_16x16x32_bf16 v[20:23], v[80:83], a[52:55], v[20:23]
    v_mfma_f32_16x16x32_bf16 v[24:27], v[80:83], a[56:59], v[24:27]
    v_mfma_f32_16x16x32_bf16 v[28:31], v[84:87], a[48:51], v[28:31]
    v_mfma_f32_16x16x32_bf16 v[32:35], v[84:87], a[52:55], v[32:35]
    v_mfma_f32_16x16x32_bf16 v[36:39], v[84:87], a[56:59], v[36:39]
    ds_read_b128 v[80:83], v115 offset:256
    ds_read_b128 v[84:87], v115 offset:20736
    s_waitcnt lgkmcnt(4)
    v_mfma_f32_16x16x32_bf16 v[16:19], v[64:67], a[60:63], v[16:19]
    v_mfma_f32_16x16x32_bf16 v[20:23], v[64:67], a[64:67], v[20:23]
    v_mfma_f32_16x16x32_bf16 v[24:27], v[64:67], a[68:71], v[24:27]
    v_mfma_f32_16x16x32_bf16 v[28:31], v[68:71], a[60:63], v[28:31]
    v_mfma_f32_16x16x32_bf16 v[32:35], v[68:71], a[64:67], v[32:35]
    v_mfma_f32_16x16x32_bf16 v[36:39], v[68:71], a[68:71], v[36:39]
    ds_read_b128 v[64:67], v112 offset:512
    ds_read_b128 v[68:71], v112 offset:20992
    s_waitcnt lgkmcnt(4)
    v_mfma_f32_16x16x32_bf16 v[16:19], v[72:75], a[72:75], v[16:19]
    v_mfma_f32_16x16x32_bf16 v[20:23], v[72:75], a[76:79], v[20:23]
    v_mfma_f32_16x16x32_bf16 v[24:27], v[72:75], a[80:83], v[24:27]
    v_mfma_f32_16x16x32_bf16 v[28:31], v[76:79], a[72:75], v[28:31]
    v_mfma_f32_16x16x32_bf16 v[32:35], v[76:79], a[76:79], v[32:35]
    v_mfma_f32_16x16x32_bf16 v[36:39], v[76:79], a[80:83], v[36:39]
    ds_read_b128 v[72:75], v113 offset:512
    ds_read_b128 v[76:79], v113 offset:20992
    s_waitcnt lgkmcnt(4)
    v_mfma_f32_16x16x32_bf16 v[16:19], v[80:83], a[84:87], v[16:19]
    v_mfma_f32_16x16x32_bf16 v[20:23], v[80:83], a[88:91], v[20:23]
    v_mfma_f32_16x16x32_bf16 v[24:27], v[80:83], a[92:95], v[24:27]
    v_mfma_f32_16x16x32_bf16 v[28:31], v[84:87], a[84:87], v[28:31]
    v_mfma_f32_16x16x32_bf16 v[32:35], v[84:87], a[88:91], v[32:35]
    v_mfma_f32_16x16x32_bf16 v[36:39], v[84:87], a[92:95], v[36:39]
    ds_read_b128 v[80:83], v114 offset:512
    ds_read_b128 v[84:87], v114 offset:20992
    s_waitcnt lgkmcnt(4)
    v_mfma_f32_16x16x32_bf16 v[16:19], v[64:67], a[96:99], v[16:19]
    v_mfma_f32_16x16x32_bf16 v[20:23], v[64:67], a[100:103], v[20:23]
    v_mfma_f32_16x16x32_bf16 v[24:27], v[64:67], a[104:107], v[24:27]
    v_mfma_f32_16x16x32_bf16 v[28:31], v[68:71], a[96:99], v[28:31]
    v_mfma_f32_16x16x32_bf16 v[32:35], v[68:71], a[100:103], v[32:35]
    v_mfma_f32_16x16x32_bf16 v[36:39], v[68:71], a[104:107], v[36:39]
    ds_read_b128 v[64:67], v115 offset:512
    ds_read_b128 v[68:71], v115 offset:20992
    s_waitcnt lgkmcnt(4)
    v_mfma_f32_16x16x32_bf16 v[16:19], v[72:75], a[108:111], v[16:19]
    v_mfma_f32_16x16x32_bf16 v[20:23], v[72:75], a[112:115], v[20:23]
    v_mfma_f32_16x16x32_bf16 v[24:27], v[72:75], a[116:119], v[24:27]
    v_mfma_f32_16x16x32_bf16 v[28:31], v[76:79], a[108:111], v[28:31]
    v_mfma_f32_16x16x32_bf16 v[32:35], v[76:79], a[112:115], v[32:35]
    v_mfma_f32_16x16x32_bf16 v[36:39], v[76:79], a[116:119], v[36:39]
    ds_read_b128 v[72:75], v112 offset:768
    ds_read_b128 v[76:79], v112 offset:21248
    s_waitcnt vmcnt(3)
    s_barrier
    s_add_u32 s35, s29, s33
    s_sub_u32 s30, s38, 1
    v_mov_b32 v14, s30
    buffer_store_dword v14, v2, s[16:19], s40 offen sc1
    s_waitcnt lgkmcnt(4)
    v_mfma_f32_16x16x32_bf16 v[16:19], v[80:83], a[120:123], v[16:19]
    v_mfma_f32_16x16x32_bf16 v[20:23], v[80:83], a[124:127], v[20:23]
    s_mov_b32 m0, s35
    s_add_u32 s35, s35, 1024
    buffer_load_dwordx4 v100, s[8:11], s28 offen lds
    v_mfma_f32_16x16x32_bf16 v[24:27], v[80:83], a[128:131], v[24:27]
    v_mfma_f32_16x16x32_bf16 v[28:31], v[84:87], a[120:123], v[28:31]
    v_mfma_f32_16x16x32_bf16 v[32:35], v[84:87], a[124:127], v[32:35]
    v_mfma_f32_16x16x32_bf16 v[36:39], v[84:87], a[128:131], v[36:39]
    ds_read_b128 v[80:83], v113 offset:768
    ds_read_b128 v[84:87], v113 offset:21248
    s_waitcnt lgkmcnt(4)
    v_mfma_f32_16x16x32_bf16 v[16:19], v[64:67], a[132:135], v[16:19]
    v_mfma_f32_16x16x32_bf16 v[20:23], v[64:67], a[136:139], v[20:23]
    s_mov_b32 m0, s35
    s_add_u32 s35, s35, 1024
    buffer_load_dwordx4 v101, s[8:11], s28 offen lds
    v_mfma_f32_16x16x32_bf16 v[24:27], v[64:67], a[140:143], v[24:27]
    v_mfma_f32_16x16x32_bf16 v[28:31], v[68:71], a[132:135], v[28:31]
    v_mfma_f32_16x16x32_bf16 v[32:35], v[68:71], a[136:139], v[32:35]
    v_mfma_f32_16x16x32_bf16 v[36:39], v[68:71], a[140:143], v[36:39]
    ds_read_b128 v[64:67], v114 offset:768
    ds_read_b128 v[68:71], v114 offset:21248
    s_waitcnt lgkmcnt(4)
    v_mfma_f32_16x16x32_bf16 v[16:19], v[72:75], a[144:147], v[16:19]
    v_mfma_f32_16x16x32_bf16 v[20:23], v[72:75], a[148:151], v[20:23]
    s_mov_b32 m0, s35
    s_add_u32 s35, s35, 1024
    buffer_load_dwordx4 v102, s[8:11], s28 offen lds
    v_mfma_f32_16x16x32_bf16 v[24:27], v[72:75], a[152:155], v[24:27]
    v_mfma_f32_16x16x32_bf16 v[28:31], v[76:79], a[144:147], v[28:31]
    v_mfma_f32_16x16x32_bf16 v[32:35], v[76:79], a[148:151], v[32:35]
    v_mfma_f32_16x16x32_bf16 v[36:39], v[76:79], a[152:155], v[36:39]
    ds_read_b128 v[72:75], v115 offset:768
    ds_read_b128 v[76:79], v115 offset:21248
    s_waitcnt lgkmcnt(4)
    v_mfma_f32_16x16x32_bf16 v[16:19], v[80:83], a[156:159], v[16:19]
    v_mfma_f32_16x16x32_bf16 v[20:23], v[80:83], a[160:163], v[20:23]
    s_mov_b32 m0, s35
    s_add_u32 s35, s35, 1024
    buffer_load_dwordx4 v103, s[8:11], s28 offen lds
    v_mfma_f32_16x16x32_bf16 v[24:27], v[80:83], a[164:167], v[24:27]
    v_mfma_f32_16x16x32_bf16 v[28:31], v[84:87], a[156:159], v[28:31]
    v_mfma_f32_16x16x32_bf16 v[32:35], v[84:87], a[160:163], v[32:35]
    v_mfma_f32_16x16x32_bf16 v[36:39], v[84:87], a[164:167], v[36:39]
    ds_read_b128 v[80:83], v112 offset:1024
    ds_read_b128 v[84:87], v112 offset:21504
    s_waitcnt lgkmcnt(4)
    v_mfma_f32_16x16x32_bf16 v[16:19], v[64:67], a[168:171], v[16:19]
    v_mfma_f32_16x16x32_bf16 v[20:23], v[64:67], a[172:175], v[20:23]
    s_mov_b32 m0, s35
    s_add_u32 s35, s35, 1024
    buffer_load_dwordx4 v104, s[8:11], s28 offen lds
    v_mfma_f32_16x16x32_bf16 v[24:27], v[64:67], a[176:179], v[24:27]
    v_mfma_f32_16x16x32_bf16 v[28:31], v[68:71], a[168:171], v[28:31]
    v_mfma_f32_16x16x32_bf16 v[32:35], v[68:71], a[172:175], v[32:35]
    v_mfma_f32_16x16x32_bf16 v[36:39], v[68:71], a[176:179], v[36:39]
    ds_read_b128 v[64:67], v113 offset:1024
    ds_read_b128 v[68:71], v113 offset:21504
    s_waitcnt lgkmcnt(4)
    v_mfma_f32_16x16x32_bf16 v[16:19], v[72:75], a[180:183], v[16:19]
    v_mfma_f32_16x16x32_bf16 v[20:23], v[72:75], a[184:187], v[20:23]
    s_mov_b32 m0, s35
    s_add_u32 s35, s35, 1024
    buffer_load_dwordx4 v105, s[8:11], s28 offen lds
    v_mfma_f32_16x16x32_bf16 v[24:27], v[72:75], a[188:191], v[24:27]
    v_mfma_f32_16x16x32_bf16 v[28:31], v[76:79], a[180:183], v[28:31]
    v_mfma_f32_16x16x32_bf16 v[32:35], v[76:79], a[184:187], v[32:35]
    v_mfma_f32_16x16x32_bf16 v[36:39], v[76:79], a[188:191], v[36:39]
    ds_read_b128 v[72:75], v114 offset:1024
    ds_read_b128 v[76:79], v114 offset:21504
    s_waitcnt lgkmcnt(4)
    v_mfma_f32_16x16x32_bf16 v[16:19], v[80:83], a[192:195], v[16:19]
    v_mfma_f32_16x16x32_bf16 v[20:23], v[80:83], a[196:199], v[20:23]
    s_mov_b32 m0, s35
    s_add_u32 s35, s35, 1024
    buffer_load_dwordx4 v106, s[8:11], s28 offen lds
    v_mfma_f32_16x16x32_bf16 v[24:27], v[80:83], a[200:203], v[24:27]
    v_mfma_f32_16x16x32_bf16 v[28:31], v[84:87], a[192:195], v[28:31]
    v_mfma_f32_16x16x32_bf16 v[32:35], v[84:87], a[196:199], v[32:35]
    v_mfma_f32_16x16x32_bf16 v[36:39], v[84:87], a[200:203], v[36:39]
    ds_read_b128 v[80:83], v115 offset:1024
    ds_read_b128 v[84:87], v115 offset:21504
    s_waitcnt lgkmcnt(4)
    v_mfma_f32_16x16x32_bf16 v[16:19], v[64:67], a[204:207], v[16:19]
    v_mfma_f32_16x16x32_bf16 v[20:23], v[64:67], a[208:211], v[20:23]
    s_mov_b32 m0, s35
    s_add_u32 s35, s35, 1024
    buffer_load_dwordx4 v107, s[8:11], s28 offen lds
    v_mfma_f32_16x16x32_bf16 v[24:27], v[64:67], a[212:215], v[24:27]
    v_mfma_f32_16x16x32_bf16 v[28:31], v[68:71], a[204:207], v[28:31]
    v_mfma_f32_16x16x32_bf16 v[32:35], v[68:71], a[208:211], v[32:35]
    v_mfma_f32_16x16x32_bf16 v[36:39], v[68:71], a[212:215], v[36:39]
    ds_read_b128 v[64:67], v116 offset:0
    ds_read_b128 v[68:71], v116 offset:20480
    s_waitcnt lgkmcnt(4)
    v_mfma_f32_16x16x32_bf16 v[16:19], v[72:75], a[216:219], v[16:19]
    v_mfma_f32_16x16x32_bf16 v[20:23], v[72:75], a[220:223], v[20:23]
    s_mov_b32 m0, s35
    s_add_u32 s35, s35, 1024
    buffer_load_dwordx4 v108, s[8:11], s28 offen lds
    v_mfma_f32_16x16x32_bf16 v[24:27], v[72:75], a[224:227], v[24:27]
    v_mfma_f32_16x16x32_bf16 v[28:31], v[76:79], a[216:219], v[28:31]
    v_mfma_f32_16x16x32_bf16 v[32:35], v[76:79], a[220:223], v[32:35]
    v_mfma_f32_16x16x32_bf16 v[36:39], v[76:79], a[224:227], v[36:39]
    ds_read_b128 v[72:75], v117 offset:0
    ds_read_b128 v[76:79], v117 offset:20480
    s_cmp_gt_u32 s38, 2
    s_cbranch_scc1 PV_ef_73
    s_waitcnt vmcnt(10)
    v_mov_b32 v14, s38
    buffer_store_dword v14, v2, s[16:19], s40 offen sc1
PV_ef_73:
    s_waitcnt lgkmcnt(4)
    v_mfma_f32_16x16x32_bf16 v[16:19], v[80:83], a[228:231], v[16:19]
    v_mfma_f32_16x16x32_bf16 v[20:23], v[80:83], a[232:235], v[20:23]
    s_mov_b32 m0, s35
    s_add_u32 s35, s35, 1024
    buffer_load_dwordx4 v109, s[8:11], s28 offen lds
    v_mfma_f32_16x16x32_bf16 v[24:27], v[80:83], a[236:239], v[24:27]
    v_mfma_f32_16x16x32_bf16 v[28:31], v[84:87], a[228:231], v[28:31]
    v_mfma_f32_16x16x32_bf16 v[32:35], v[84:87], a[232:235], v[32:35]
    v_mfma_f32_16x16x32_bf16 v[36:39], v[84:87], a[236:239], v[36:39]
    s_add_u32 s28, s28, 40960
    s_add_u32 s29, s29, 40960
    s_cmp_eq_u32 s29, 122880
    s_cselect_b32 s29, 0, s29
    v_mov_b32 v112, v116
    v_add_u32 v116, s37, v120
    v_mov_b32 v113, v117
    v_add_u32 v117, s37, v121
    v_mov_b32 v114, v118
    v_add_u32 v118, s37, v122
    v_mov_b32 v115, v119
    v_add_u32 v119, s37, v123
    s_add_u32 s37, s37, 40960
    s_cmp_eq_u32 s37, 122880
    s_cselect_b32 s37, 0, s37
    s_add_u32 s26, s26, 393216
    s_add_u32 s38, s38, 1
    s_cmp_ge_u32 s38, s24
    s_cbranch_scc1 PV_fin0
    ds_read_b128 v[80:83], v114 offset:0
    ds_read_b128 v[84:87], v114 offset:20480
    s_waitcnt lgkmcnt(4)
    v_mfma_f32_16x16x32_bf16 v[40:43], v[64:67], a[0:3], 0
    v_mfma_f32_16x16x32_bf16 v[44:47], v[64:67], a[4:7], 0
    v_mfma_f32_16x16x32_bf16 v[48:51], v[64:67], a[8:11], 0
    v_mfma_f32_16x16x32_bf16 v[52:55], v[68:71], a[0:3], 0
    v_mfma_f32_16x16x32_bf16 v[56:59], v[68:71], a[4:7], 0
    v_mfma_f32_16x16x32_bf16 v[60:63], v[68:71], a[8:11], 0
    ds_read_b128 v[64:67], v115 offset:0
    ds_read_b128 v[68:71], v115 offset:20480
    s_waitcnt lgkmcnt(4)
    v_mfma_f32_16x16x32_bf16 v[40:43], v[72:75], a[12:15], v[40:43]
    v_cvt_pk_bf16_f32 v88, v16, v17
    v_cvt_pk_bf16_f32 v89, v18, v19
    v_mfma_f32_16x16x32_bf16 v[44:47], v[72:75], a[16:19], v[44:47]
    v_mfma_f32_16x16x32_bf16 v[48:51], v[72:75], a[20:23], v[48:51]
    v_cvt_pk_bf16_f32 v90, v28, v29
    v_cvt_pk_bf16_f32 v91, v30, v31
    v_mfma_f32_16x16x32_bf16 v[52:55], v[76:79], a[12:15], v[52:55]
    v_mfma_f32_16x16x32_bf16 v[56:59], v[76:79], a[16:19], v[56:59]
    buffer_store_dwordx4 v[88:91], v9, s[16:19], s26 offen offset:0 sc1
    v_mfma_f32_16x16x32_bf16 v[60:63], v[76:79], a[20:23], v[60:63]
    ds_read_b128 v[72:75], v112 offset:256
    ds_read_b128 v[76:79], v112 offset:20736
    s_waitcnt lgkmcnt(4)
    v_mfma_f32_16x16x32_bf16 v[40:43], v[80:83], a[24:27], v[40:43]
    v_cvt_pk_bf16_f32 v92, v20, v21
    v_cvt_pk_bf16_f32 v93, v22, v23
    v_mfma_f32_16x16x32_bf16 v[44:47], v[80:83], a[28:31], v[44:47]
    v_mfma_f32_16x16x32_bf16 v[48:51], v[80:83], a[32:35], v[48:51]
    v_cvt_pk_bf16_f32 v94, v32, v33
    v_cvt_pk_bf16_f32 v95, v34, v35
    v_mfma_f32_16x16x32_bf16 v[52:55], v[84:87], a[24:27], v[52:55]
    v_mfma_f32_16x16x32_bf16 v[56:59], v[84:87], a[28:31], v[56:59]
    buffer_store_dwordx4 v[92:95], v9, s[16:19], s26 offen offset:1024 sc1
    v_mfma_f32_16x16x32_bf16 v[60:63], v[84:87], a[32:35], v[60:63]
    ds_read_b128 v[80:83], v113 offset:256
    ds_read_b128 v[84:87], v113 offset:20736
    s_waitcnt lgkmcnt(4)
    v_mfma_f32_16x16x32_bf16 v[40:43], v[64:67], a[36:39], v[40:43]
    v_cvt_pk_bf16_f32 v96, v24, v25
    v_cvt_pk_bf16_f32 v97, v26, v27
    v_mfma_f32_16x16x32_bf16 v[44:47], v[64:67], a[40:43], v[44:47]
    v_mfma_f32_16x16x32_bf16 v[48:51], v[64:67], a[44:47], v[48:51]
    v_cvt_pk_bf16_f32 v98, v36, v37
    v_cvt_pk_bf16_f32 v99, v38, v39
    v_mfma_f32_16x16x32_bf16 v[52:55], v[68:71], a[36:39], v[52:55]
    v_mfma_f32_16x16x32_bf16 v[56:59], v[68:71], a[40:43], v[56:59]
    buffer_store_dwordx4 v[96:99], v9, s[16:19], s26 offen offset:2048 sc1
    v_mfma_f32_16x16x32_bf16 v[60:63], v[68:71], a[44:47], v[60:63]
    ds_read_b128 v[64:67], v114 offset:256
    ds_read_b128 v[68:71], v114 offset:20736
    s_waitcnt lgkmcnt(4)
    v_mfma_f32_16x16x32_bf16 v[40:43], v[72:75], a[48:51], v[40:43]
    v_mfma_f32_16x16x32_bf16 v[44:47], v[72:75], a[52:55], v[44:47]
    v_mfma_f32_16x16x32_bf16 v[48:51], v[72:75], a[56:59], v[48:51]
    v_mfma_f32_16x16x32_bf16 v[52:55], v[76:79], a[48:51], v[52:55]
    v_mfma_f32_16x16x32_bf16 v[56:59], v[76:79], a[52:55], v[56:59]
    v_mfma_f32_16x16x32_bf16 v[60:63], v[76:79], a[56:59], v[60:63]
    ds_read_b128 v[72:75], v115 offset:256
    ds_read_b128 v[76:79], v115 offset:20736
    s_waitcnt lgkmcnt(4)
    v_mfma_f32_16x16x32_bf16 v[40:43], v[80:83], a[60:63], v[40:43]
    v_mfma_f32_16x16x32_bf16 v[44:47], v[80:83], a[64:67], v[44:47]
    v_mfma_f32_16x16x32_bf16 v[48:51], v[80:83], a[68:71], v[48:51]
    v_mfma_f32_16x16x32_bf16 v[52:55], v[84:87], a[60:63], v[52:55]
    v_mfma_f32_16x16x32_bf16 v[56:59], v[84:87], a[64:67], v[56:59]
    v_mfma_f32_16x16x32_bf16 v[60:63], v[84:87], a[68:71], v[60:63]
    ds_read_b128 v[80:83], v112 offset:512
    ds_read_b128 v[84:87], v112 offset:20992
    s_waitcnt lgkmcnt(4)
    v_mfma_f32_16x16x32_bf16 v[40:43], v[64:67], a[72:75], v[40:43]
    v_mfma_f32_16x16x32_bf16 v[44:47], v[64:67], a[76:79], v[44:47]
    v_mfma_f32_16x16x32_bf16 v[48:51], v[64:67], a[80:83], v[48:51]
    v_mfma_f32_16x16x32_bf16 v[52:55], v[68:71], a[72:75], v[52:55]
    v_mfma_f32_16x16x32_bf16 v[56:59], v[68:71], a[76:79], v[56:59]
    v_mfma_f32_16x16x32_bf16 v[60:63], v[68:71], a[80:83], v[60:63]
    ds_read_b128 v[64:67], v113 offset:512
    ds_read_b128 v[68:71], v113 offset:20992
    s_waitcnt lgkmcnt(4)
    v_mfma_f32_16x16x32_bf16 v[40:43], v[72:75], a[84:87], v[40:43]
    v_mfma_f32_16x16x32_bf16 v[44:47], v[72:75], a[88:91], v[44:47]
    v_mfma_f32_16x16x32_bf16 v[48:51], v[72:75], a[92:95], v[48:51]
    v_mfma_f32_16x16x32_bf16 v[52:55], v[76:79], a[84:87], v[52:55]
    v_mfma_f32_16x16x32_bf16 v[56:59], v[76:79], a[88:91], v[56:59]
    v_mfma_f32_16x16x32_bf16 v[60:63], v[76:79], a[92:95], v[60:63]
    ds_read_b128 v[72:75], v114 offset:512
    ds_read_b128 v[76:79], v114 offset:20992
    s_waitcnt lgkmcnt(4)
    v_mfma_f32_16x16x32_bf16 v[40:43], v[80:83], a[96:99], v[40:43]
    v_mfma_f32_16x16x32_bf16 v[44:47], v[80:83], a[100:103], v[44:47]
    v_mfma_f32_16x16x32_bf16 v[48:51], v[80:83], a[104:107], v[48:51]
    v_mfma_f32_16x16x32_bf16 v[52:55], v[84:87], a[96:99], v[52:55]
    v_mfma_f32_16x16x32_bf16 v[56:59], v[84:87], a[100:103], v[56:59]
    v_mfma_f32_16x16x32_bf16 v[60:63], v[84:87], a[104:107], v[60:63]
    ds_read_b128 v[80:83], v115 offset:512
    ds_read_b128 v[84:87], v115 offset:20992
    s_waitcnt lgkmcnt(4)
    v_mfma_f32_16x16x32_bf16 v[40:43], v[64:67], a[108:111], v[40:43]
    v_mfma_f32_16x16x32_bf16 v[44:47], v[64:67], a[112:115], v[44:47]
    v_mfma_f32_16x16x32_bf16 v[48:51], v[64:67], a[116:119], v[48:51]
    v_mfma_f32_16x16x32_bf16 v[52:55], v[68:71], a[108:111], v[52:55]
    v_mfma_f32_16x16x32_bf16 v[56:59], v[68:71], a[112:115], v[56:59]
    v_mfma_f32_16x16x32_bf16 v[60:63], v[68:71], a[116:119], v[60:63]
    ds_read_b128 v[64:67], v112 offset:768
    ds_read_b128 v[68:71], v112 offset:21248
    s_waitcnt vmcnt(3)
    s_barrier
    s_add_u32 s35, s29, s33
    s_sub_u32 s30, s38, 1
    v_mov_b32 v14, s30
    buffer_store_dword v14, v2, s[16:19], s40 offen sc1
    s_waitcnt lgkmcnt(4)
    v_mfma_f32_16x16x32_bf16 v[40:43], v[72:75], a[120:123], v[40:43]
    v_mfma_f32_16x16x32_bf16 v[44:47], v[72:75], a[124:127], v[44:47]
    s_mov_b32 m0, s35
    s_add_u32 s35, s35, 1024
    buffer_load_dwordx4 v100, s[8:11], s28 offen lds
    v_mfma_f32_16x16x32_bf16 v[48:51], v[72:75], a[128:131], v[48:51]
    v_mfma_f32_16x16x32_bf16 v[52:55], v[76:79], a[120:123], v[52:55]
    v_mfma_f32_16x16x32_bf16 v[56:59], v[76:79], a[124:127], v[56:59]
    v_mfma_f32_16x16x32_bf16 v[60:63], v[76:79], a[128:131], v[60:63]
    ds_read_b128 v[72:75], v113 offset:768
    ds_read_b128 v[76:79], v113 offset:21248
    s_waitcnt lgkmcnt(4)
    v_mfma_f32_16x16x32_bf16 v[40:43], v[80:83], a[132:135], v[40:43]
    v_mfma_f32_16x16x32_bf16 v[44:47], v[80:83], a[136:139], v[44:47]
    s_mov_b32 m0, s35
    s_add_u32 s35, s35, 1024
    buffer_load_dwordx4 v101, s[8:11], s28 offen lds
    v_mfma_f32_16x16x32_bf16 v[48:51], v[80:83], a[140:143], v[48:51]
    v_mfma_f32_16x16x32_bf16 v[52:55], v[84:87], a[132:135], v[52:55]
    v_mfma_f32_16x16x32_bf16 v[56:59], v[84:87], a[136:139], v[56:59]
    v_mfma_f32_16x16x32_bf16 v[60:63], v[84:87], a[140:143], v[60:63]
    ds_read_b128 v[80:83], v114 offset:768
    ds_read_b128 v[84:87], v114 offset:21248
    s_waitcnt lgkmcnt(4)
    v_mfma_f32_16x16x32_bf16 v[40:43], v[64:67], a[144:147], v[40:43]
    v_mfma_f32_16x16x32_bf16 v[44:47], v[64:67], a[148:151], v[44:47]
    s_mov_b32 m0, s35
    s_add_u32 s35, s35, 1024
    buffer_load_dwordx4 v102, s[8:11], s28 offen lds
    v_mfma_f32_16x16x32_bf16 v[48:51], v[64:67], a[152:155], v[48:51]
    v_mfma_f32_16x16x32_bf16 v[52:55], v[68:71], a[144:147], v[52:55]
    v_mfma_f32_16x16x32_bf16 v[56:59], v[68:71], a[148:151], v[56:59]
    v_mfma_f32_16x16x32_bf16 v[60:63], v[68:71], a[152:155], v[60:63]
    ds_read_b128 v[64:67], v115 offset:768
    ds_read_b128 v[68:71], v115 offset:21248
    s_waitcnt lgkmcnt(4)
    v_mfma_f32_16x16x32_bf16 v[40:43], v[72:75], a[156:159], v[40:43]
    v_mfma_f32_16x16x32_bf16 v[44:47], v[72:75], a[160:163], v[44:47]
    s_mov_b32 m0, s35
    s_add_u32 s35, s35, 1024
    buffer_load_dwordx4 v103, s[8:11], s28 offen lds
    v_mfma_f32_16x16x32_bf16 v[48:51], v[72:75], a[164:167], v[48:51]
    v_mfma_f32_16x16x32_bf16 v[52:55], v[76:79], a[156:159], v[52:55]
    v_mfma_f32_16x16x32_bf16 v[56:59], v[76:79], a[160:163], v[56:59]
    v_mfma_f32_16x16x32_bf16 v[60:63], v[76:79], a[164:167], v[60:63]
    ds_read_b128 v[72:75], v112 offset:1024
    ds_read_b128 v[76:79], v112 offset:21504
    s_waitcnt lgkmcnt(4)
    v_mfma_f32_16x16x32_bf16 v[40:43], v[80:83], a[168:171], v[40:43]
    v_mfma_f32_16x16x32_bf16 v[44:47], v[80:83], a[172:175], v[44:47]
    s_mov_b32 m0, s35
    s_add_u32 s35, s35, 1024
    buffer_load_dwordx4 v104, s[8:11], s28 offen lds
    v_mfma_f32_16x16x32_bf16 v[48:51], v[80:83], a[176:179], v[48:51]
    v_mfma_f32_16x16x32_bf16 v[52:55], v[84:87], a[168:171], v[52:55]
    v_mfma_f32_16x16x32_bf16 v[56:59], v[84:87], a[172:175], v[56:59]
    v_mfma_f32_16x16x32_bf16 v[60:63], v[84:87], a[176:179], v[60:63]
    ds_read_b128 v[80:83], v113 offset:1024
    ds_read_b128 v[84:87], v113 offset:21504
    s_waitcnt lgkmcnt(4)
    v_mfma_f32_16x16x32_bf16 v[40:43], v[64:67], a[180:183], v[40:43]
    v_mfma_f32_16x16x32_bf16 v[44:47], v[64:67], a[184:187], v[44:47]
    s_mov_b32 m0, s35
    s_add_u32 s35, s35, 1024
    buffer_load_dwordx4 v105, s[8:11], s28 offen lds
    v_mfma_f32_16x16x32_bf16 v[48:51], v[64:67], a[188:191], v[48:51]
    v_mfma_f32_16x16x32_bf16 v[52:55], v[68:71], a[180:183], v[52:55]
    v_mfma_f32_16x16x32_bf16 v[56:59], v[68:71], a[184:187], v[56:59]
    v_mfma_f32_16x16x32_bf16 v[60:63], v[68:71], a[188:191], v[60:63]
    ds_read_b128 v[64:67], v114 offset:1024
    ds_read_b128 v[68:71], v114 offset:21504
    s_waitcnt lgkmcnt(4)
    v_mfma_f32_16x16x32_bf16 v[40:43], v[72:75], a[192:195], v[40:43]
    v_mfma_f32_16x16x32_bf16 v[44:47], v[72:75], a[196:199], v[44:47]
    s_mov_b32 m0, s35
    s_add_u32 s35, s35, 1024
    buffer_load_dwordx4 v106, s[8:11], s28 offen lds
    v_mfma_f32_16x16x32_bf16 v[48:51], v[72:75], a[200:203], v[48:51]
    v_mfma_f32_16x16x32_bf16 v[52:55], v[76:79], a[192:195], v[52:55]
    v_mfma_f32_16x16x32_bf16 v[56:59], v[76:79], a[196:199], v[56:59]
    v_mfma_f32_16x16x32_bf16 v[60:63], v[76:79], a[200:203], v[60:63]
    ds_read_b128 v[72:75], v115 offset:1024
    ds_read_b128 v[76:79], v115 offset:21504
    s_waitcnt lgkmcnt(4)
    v_mfma_f32_16x16x32_bf16 v[40:43], v[80:83], a[204:207], v[40:43]
    v_mfma_f32_16x16x32_bf16 v[44:47], v[80:83], a[208:211], v[44:47]
    s_mov_b32 m0, s35
    s_add_u32 s35, s35, 1024
    buffer_load_dwordx4 v107, s[8:11], s28 offen lds
    v_mfma_f32_16x16x32_bf16 v[48:51], v[80:83], a[212:215], v[48:51]
    v_mfma_f32_16x16x32_bf16 v[52:55], v[84:87], a[204:207], v[52:55]
    v_mfma_f32_16x16x32_bf16 v[56:59], v[84:87], a[208:211], v[56:59]
    v_mfma_f32_16x16x32_bf16 v[60:63], v[84:87], a[212:215], v[60:63]
    ds_read_b128 v[80:83], v116 offset:0
    ds_read_b128 v[84:87], v116 offset:20480
    s_waitcnt lgkmcnt(4)
    v_mfma_f32_16x16x32_bf16 v[40:43], v[64:67], a[216:219], v[40:43]
    v_mfma_f32_16x16x32_bf16 v[44:47], v[64:67], a[220:223], v[44:47]
    s_mov_b32 m0, s35
    s_add_u32 s35, s35, 1024
    buffer_load_dwordx4 v108, s[8:11], s28 offen lds
    v_mfma_f32_16x16x32_bf16 v[48:51], v[64:67], a[224:227], v[48:51]
    v_mfma_f32_16x16x32_bf16 v[52:55], v[68:71], a[216:219], v[52:55]
    v_mfma_f32_16x16x32_bf16 v[56:59], v[68:71], a[220:223], v[56:59]
    v_mfma_f32_16x16x32_bf16 v[60:63], v[68:71], a[224:227], v[60:63]
    ds_read_b128 v[64:67], v117 offset:0
    ds_read_b128 v[68:71], v117 offset:20480
    s_cmp_gt_u32 s38, 2
    s_cbranch_scc1 PV_ef_74
    s_waitcnt vmcnt(10)
    v_mov_b32 v14, s38
    buffer_store_dword v14, v2, s[16:19], s40 offen sc1
PV_ef_74:
    s_waitcnt lgkmcnt(4)
    v_mfma_f32_16x16x32_bf16 v[40:43], v[72:75], a[228:231], v[40:43]
    v_mfma_f32_16x16x32_bf16 v[44:47], v[72:75], a[232:235], v[44:47]
    s_mov_b32 m0, s35
    s_add_u32 s35, s35, 1024
    buffer_load_dwordx4 v109, s[8:11], s28 offen lds
    v_mfma_f32_16x16x32_bf16 v[48:51], v[72:75], a[236:239], v[48:51]
    v_mfma_f32_16x16x32_bf16 v[52:55], v[76:79], a[228:231], v[52:55]
    v_mfma_f32_16x16x32_bf16 v[56:59], v[76:79], a[232:235], v[56:59]
    v_mfma_f32_16x16x32_bf16 v[60:63], v[76:79], a[236:239], v[60:63]
    s_add_u32 s28, s28, 40960
    s_add_u32 s29, s29, 40960
    s_cmp_eq_u32 s29, 122880
    s_cselect_b32 s29, 0, s29
    v_mov_b32 v112, v116
    v_add_u32 v116, s37, v120
    v_mov_b32 v113, v117
    v_add_u32 v117, s37, v121
    v_mov_b32 v114, v118
    v_add_u32 v118, s37, v122
    v_mov_b32 v115, v119
    v_add_u32 v119, s37, v123
    s_add_u32 s37, s37, 40960
    s_cmp_eq_u32 s37, 122880
    s_cselect_b32 s37, 0, s37
    s_add_u32 s26, s26, 393216
    s_add_u32 s38, s38, 1
    s_cmp_ge_u32 s38, s24
    s_cbranch_scc1 PV_fin1
    ds_read_b128 v[72:75], v114 offset:0
    ds_read_b128 v[76:79], v114 offset:20480
    s_waitcnt lgkmcnt(4)
    v_mfma_f32_16x16x32_bf16 v[16:19], v[80:83], a[0:3], 0
    v_mfma_f32_16x16x32_bf16 v[20:23], v[80:83], a[4:7], 0
    v_mfma_f32_16x16x32_bf16 v[24:27], v[80:83], a[8:11], 0
    v_mfma_f32_16x16x32_bf16 v[28:31], v[84:87], a[0:3], 0
    v_mfma_f32_16x16x32_bf16 v[32:35], v[84:87], a[4:7], 0
    v_mfma_f32_16x16x32_bf16 v[36:39], v[84:87], a[8:11], 0
    ds_read_b128 v[80:83], v115 offset:0
    ds_read_b128 v[84:87], v115 offset:20480
    s_waitcnt lgkmcnt(4)
    v_mfma_f32_16x16x32_bf16 v[16:19], v[64:67], a[12:15], v[16:19]
    v_cvt_pk_bf16_f32 v88, v40, v41
    v_cvt_pk_bf16_f32 v89, v42, v43
    v_mfma_f32_16x16x32_bf16 v[20:23], v[64:67], a[16:19], v[20:23]
    v_mfma_f32_16x16x32_bf16 v[24:27], v[64:67], a[20:23], v[24:27]
    v_cvt_pk_bf16_f32 v90, v52, v53
    v_cvt_pk_bf16_f32 v91, v54, v55
    v_mfma_f32_16x16x32_bf16 v[28:31], v[68:71], a[12:15], v[28:31]
    v_mfma_f32_16x16x32_bf16 v[32:35], v[68:71], a[16:19], v[32:35]
    buffer_store_dwordx4 v[88:91], v9, s[16:19], s26 offen offset:0 sc1
    v_mfma_f32_16x16x32_bf16 v[36:39], v[68:71], a[20:23], v[36:39]
    ds_read_b128 v[64:67], v112 offset:256
    ds_read_b128 v[68:71], v112 offset:20736
    s_waitcnt lgkmcnt(4)
    v_mfma_f32_16x16x32_bf16 v[16:19], v[72:75], a[24:27], v[16:19]
    v_cvt_pk_bf16_f32 v92, v44, v45
    v_cvt_pk_bf16_f32 v93, v46, v47
    v_mfma_f32_16x16x32_bf16 v[20:23], v[72:75], a[28:31], v[20:23]
    v_mfma_f32_16x16x32_bf16 v[24:27], v[72:75], a[32:35], v[24:27]
    v_cvt_pk_bf16_f32 v94, v56, v57
    v_cvt_pk_bf16_f32 v95, v58, v59
    v_mfma_f32_16x16x32_bf16 v[28:31], v[76:79], a[24:27], v[28:31]
    v_mfma_f32_16x16x32_bf16 v[32:35], v[76:79], a[28:31], v[32:35]
    buffer_store_dwordx4 v[92:95], v9, s[16:19], s26 offen offset:1024 sc1
    v_mfma_f32_16x16x32_bf16 v[36:39], v[76:79], a[32:35], v[36:39]
    ds_read_b128 v[72:75], v113 offset:256
    ds_read_b128 v[76:79], v113 offset:20736
    s_waitcnt lgkmcnt(4)
    v_mfma_f32_16x16x32_bf16 v[16:19], v[80:83], a[36:39], v[16:19]
    v_cvt_pk_bf16_f32 v96, v48, v49
    v_cvt_pk_bf16_f32 v97, v50, v51
    v_mfma_f32_16x16x32_bf16 v[20:23], v[80:83], a[40:43], v[20:23]
    v_mfma_f32_16x16x32_bf16 v[24:27], v[80:83], a[44:47], v[24:27]
    v_cvt_pk_bf16_f32 v98, v60, v61
    v_cvt_pk_bf16_f32 v99, v62, v63
    v_mfma_f32_16x16x32_bf16 v[28:31], v[84:87], a[36:39], v[28:31]
    v_mfma_f32_16x16x32_bf16 v[32:35], v[84:87], a[40:43], v[32:35]
    buffer_store_dwordx4 v[96:99], v9, s[16:19], s26 offen offset:2048 sc1
    v_mfma_f32_16x16x32_bf16 v[36:39], v[84:87], a[44:47], v[36:39]
    ds_read_b128 v[80:83], v114 offset:256
    ds_read_b128 v[84:87], v114 offset:20736
    s_waitcnt lgkmcnt(4)
    v_mfma_f32_16x16x32_bf16 v[16:19], v[64:67], a[48:51], v[16:19]
    v_mfma_f32_16x16x32_bf16 v[20:23], v[64:67], a[52:55], v[20:23]
    v_mfma_f32_16x16x32_bf16 v[24:27], v[64:67], a[56:59], v[24:27]
    v_mfma_f32_16x16x32_bf16 v[28:31], v[68:71], a[48:51], v[28:31]
    v_mfma_f32_16x16x32_bf16 v[32:35], v[68:71], a[52:55], v[32:35]
    v_mfma_f32_16x16x32_bf16 v[36:39], v[68:71], a[56:59], v[36:39]
    ds_read_b128 v[64:67], v115 offset:256
    ds_read_b128 v[68:71], v115 offset:20736
    s_waitcnt lgkmcnt(4)
    v_mfma_f32_16x16x32_bf16 v[16:19], v[72:75], a[60:63], v[16:19]
    v_mfma_f32_16x16x32_bf16 v[20:23], v[72:75], a[64:67], v[20:23]
    v_mfma_f32_16x16x32_bf16 v[24:27], v[72:75], a[68:71], v[24:27]
    v_mfma_f32_16x16x32_bf16 v[28:31], v[76:79], a[60:63], v[28:31]
    v_mfma_f32_16x16x32_bf16 v[32:35], v[76:79], a[64:67], v[32:35]
    v_mfma_f32_16x16x32_bf16 v[36:39], v[76:79], a[68:71], v[36:39]
    ds_read_b128 v[72:75], v112 offset:512
    ds_read_b128 v[76:79], v112 offset:20992
    s_waitcnt lgkmcnt(4)
    v_mfma_f32_16x16x32_bf16 v[16:19], v[80:83], a[72:75], v[16:19]
    v_mfma_f32_16x16x32_bf16 v[20:23], v[80:83], a[76:79], v[20:23]
    v_mfma_f32_16x16x32_bf16 v[24:27], v[80:83], a[80:83], v[24:27]
    v_mfma_f32_16x16x32_bf16 v[28:31], v[84:87], a[72:75], v[28:31]
    v_mfma_f32_16x16x32_bf16 v[32:35], v[84:87], a[76:79], v[32:35]
    v_mfma_f32_16x16x32_bf16 v[36:39], v[84:87], a[80:83], v[36:39]
    ds_read_b128 v[80:83], v113 offset:512
    ds_read_b128 v[84:87], v113 offset:20992
    s_waitcnt lgkmcnt(4)
    v_mfma_f32_16x16x32_bf16 v[16:19], v[64:67], a[84:87], v[16:19]
    v_mfma_f32_16x16x32_bf16 v[20:23], v[64:67], a[88:91], v[20:23]
    v_mfma_f32_16x16x32_bf16 v[24:27], v[64:67], a[92:95], v[24:27]
    v_mfma_f32_16x16x32_bf16 v[28:31], v[68:71], a[84:87], v[28:31]
    v_mfma_f32_16x16x32_bf16 v[32:35], v[68:71], a[88:91], v[32:35]
    v_mfma_f32_16x16x32_bf16 v[36:39], v[68:71], a[92:95], v[36:39]
    ds_read_b128 v[64:67], v114 offset:512
    ds_read_b128 v[68:71], v114 offset:20992
    s_waitcnt lgkmcnt(4)
    v_mfma_f32_16x16x32_bf16 v[16:19], v[72:75], a[96:99], v[16:19]
    v_mfma_f32_16x16x32_bf16 v[20:23], v[72:75], a[100:103], v[20:23]
    v_mfma_f32_16x16x32_bf16 v[24:27], v[72:75], a[104:107], v[24:27]
    v_mfma_f32_16x16x32_bf16 v[28:31], v[76:79], a[96:99], v[28:31]
    v_mfma_f32_16x16x32_bf16 v[32:35], v[76:79], a[100:103], v[32:35]
    v_mfma_f32_16x16x32_bf16 v[36:39], v[76:79], a[104:107], v[36:39]
    ds_read_b128 v[72:75], v115 offset:512
    ds_read_b128 v[76:79], v115 offset:20992
    s_waitcnt lgkmcnt(4)
    v_mfma_f32_16x16x32_bf16 v[16:19], v[80:83], a[108:111], v[16:19]
    v_mfma_f32_16x16x32_bf16 v[20:23], v[80:83], a[112:115], v[20:23]
    v_mfma_f32_16x16x32_bf16 v[24:27], v[80:83], a[116:119], v[24:27]
    v_mfma_f32_16x16x32_bf16 v[28:31], v[84:87], a[108:111], v[28:31]
    v_mfma_f32_16x16x32_bf16 v[32:35], v[84:87], a[112:115], v[32:35]
    v_mfma_f32_16x16x32_bf16 v[36:39], v[84:87], a[116:119], v[36:39]
    ds_read_b128 v[80:83], v112 offset:768
    ds_read_b128 v[84:87], v112 offset:21248
    s_waitcnt vmcnt(3)
    s_barrier
    s_add_u32 s35, s29, s33
    s_sub_u32 s30, s38, 1
    v_mov_b32 v14, s30
    buffer_store_dword v14, v2, s[16:19], s40 offen sc1
    s_waitcnt lgkmcnt(4)
    v_mfma_f32_16x16x32_bf16 v[16:19], v[64:67], a[120:123], v[16:19]
    v_mfma_f32_16x16x32_bf16 v[20:23], v[64:67], a[124:127], v[20:23]
    s_mov_b32 m0, s35
    s_add_u32 s35, s35, 1024
    buffer_load_dwordx4 v100, s[8:11], s28 offen lds
    v_mfma_f32_16x16x32_bf16 v[24:27], v[64:67], a[128:131], v[24:27]
    v_mfma_f32_16x16x32_bf16 v[28:31], v[68:71], a[120:123], v[28:31]
    v_mfma_f32_16x16x32_bf16 v[32:35], v[68:71], a[124:127], v[32:35]
    v_mfma_f32_16x16x32_bf16 v[36:39], v[68:71], a[128:131], v[36:39]
    ds_read_b128 v[64:67], v113 offset:768
    ds_read_b128 v[68:71], v113 offset:21248
    s_waitcnt lgkmcnt(4)
    v_mfma_f32_16x16x32_bf16 v[16:19], v[72:75], a[132:135], v[16:19]
    v_mfma_f32_16x16x32_bf16 v[20:23], v[72:75], a[136:139], v[20:23]
    s_mov_b32 m0, s35
    s_add_u32 s35, s35, 1024
    buffer_load_dwordx4 v101, s[8:11], s28 offen lds
    v_mfma_f32_16x16x32_bf16 v[24:27], v[72:75], a[140:143], v[24:27]
    v_mfma_f32_16x16x32_bf16 v[28:31], v[76:79], a[132:135], v[28:31]
    v_mfma_f32_16x16x32_bf16 v[32:35], v[76:79], a[136:139], v[32:35]
    v_mfma_f32_16x16x32_bf16 v[36:39], v[76:79], a[140:143], v[36:39]
    ds_read_b128 v[72:75], v114 offset:768
    ds_read_b128 v[76:79], v114 offset:21248
    s_waitcnt lgkmcnt(4)
    v_mfma_f32_16x16x32_bf16 v[16:19], v[80:83], a[144:147], v[16:19]
    v_mfma_f32_16x16x32_bf16 v[20:23], v[80:83], a[148:151], v[20:23]
    s_mov_b32 m0, s35
    s_add_u32 s35, s35, 1024
    buffer_load_dwordx4 v102, s[8:11], s28 offen lds
    v_mfma_f32_16x16x32_bf16 v[24:27], v[80:83], a[152:155], v[24:27]
    v_mfma_f32_16x16x32_bf16 v[28:31], v[84:87], a[144:147], v[28:31]
    v_mfma_f32_16x16x32_bf16 v[32:35], v[84:87], a[148:151], v[32:35]
    v_mfma_f32_16x16x32_bf16 v[36:39], v[84:87], a[152:155], v[36:39]
    ds_read_b128 v[80:83], v115 offset:768
    ds_read_b128 v[84:87], v115 offset:21248
    s_waitcnt lgkmcnt(4)
    v_mfma_f32_16x16x32_bf16 v[16:19], v[64:67], a[156:159], v[16:19]
    v_mfma_f32_16x16x32_bf16 v[20:23], v[64:67], a[160:163], v[20:23]
    s_mov_b32 m0, s35
    s_add_u32 s35, s35, 1024
    buffer_load_dwordx4 v103, s[8:11], s28 offen lds
    v_mfma_f32_16x16x32_bf16 v[24:27], v[64:67], a[164:167], v[24:27]
    v_mfma_f32_16x16x32_bf16 v[28:31], v[68:71], a[156:159], v[28:31]
    v_mfma_f32_16x16x32_bf16 v[32:35], v[68:71], a[160:163], v[32:35]
    v_mfma_f32_16x16x32_bf16 v[36:39], v[68:71], a[164:167], v[36:39]
    ds_read_b128 v[64:67], v112 offset:1024
    ds_read_b128 v[68:71], v112 offset:21504
    s_waitcnt lgkmcnt(4)
    v_mfma_f32_16x16x32_bf16 v[16:19], v[72:75], a[168:171], v[16:19]
    v_mfma_f32_16x16x32_bf16 v[20:23], v[72:75], a[172:175], v[20:23]
    s_mov_b32 m0, s35
    s_add_u32 s35, s35, 1024
    buffer_load_dwordx4 v104, s[8:11], s28 offen lds
    v_mfma_f32_16x16x32_bf16 v[24:27], v[72:75], a[176:179], v[24:27]
    v_mfma_f32_16x16x32_bf16 v[28:31], v[76:79], a[168:171], v[28:31]
    v_mfma_f32_16x16x32_bf16 v[32:35], v[76:79], a[172:175], v[32:35]
    v_mfma_f32_16x16x32_bf16 v[36:39], v[76:79], a[176:179], v[36:39]
    ds_read_b128 v[72:75], v113 offset:1024
    ds_read_b128 v[76:79], v113 offset:21504
    s_waitcnt lgkmcnt(4)
    v_mfma_f32_16x16x32_bf16 v[16:19], v[80:83], a[180:183], v[16:19]
    v_mfma_f32_16x16x32_bf16 v[20:23], v[80:83], a[184:187], v[20:23]
    s_mov_b32 m0, s35
    s_add_u32 s35, s35, 1024
    buffer_load_dwordx4 v105, s[8:11], s28 offen lds
    v_mfma_f32_16x16x32_bf16 v[24:27], v[80:83], a[188:191], v[24:27]
    v_mfma_f32_16x16x32_bf16 v[28:31], v[84:87], a[180:183], v[28:31]
    v_mfma_f32_16x16x32_bf16 v[32:35], v[84:87], a[184:187], v[32:35]
    v_mfma_f32_16x16x32_bf16 v[36:39], v[84:87], a[188:191], v[36:39]
    ds_read_b128 v[80:83], v114 offset:1024
    ds_read_b128 v[84:87], v114 offset:21504
    s_waitcnt lgkmcnt(4)
    v_mfma_f32_16x16x32_bf16 v[16:19], v[64:67], a[192:195], v[16:19]
    v_mfma_f32_16x16x32_bf16 v[20:23], v[64:67], a[196:199], v[20:23]
    s_mov_b32 m0, s35
    s_add_u32 s35, s35, 1024
    buffer_load_dwordx4 v106, s[8:11], s28 offen lds
    v_mfma_f32_16x16x32_bf16 v[24:27], v[64:67], a[200:203], v[24:27]
    v_mfma_f32_16x16x32_bf16 v[28:31], v[68:71], a[192:195], v[28:31]
    v_mfma_f32_16x16x32_bf16 v[32:35], v[68:71], a[196:199], v[32:35]
    v_mfma_f32_16x16x32_bf16 v[36:39], v[68:71], a[200:203], v[36:39]
    ds_read_b128 v[64:67], v115 offset:1024
    ds_read_b128 v[68:71], v115 offset:21504
    s_waitcnt lgkmcnt(4)
    v_mfma_f32_16x16x32_bf16 v[16:19], v[72:75], a[204:207], v[16:19]
    v_mfma_f32_16x16x32_bf16 v[20:23], v[72:75], a[208:211], v[20:23]
    s_mov_b32 m0, s35
    s_add_u32 s35, s35, 1024
    buffer_load_dwordx4 v107, s[8:11], s28 offen lds
    v_mfma_f32_16x16x32_bf16 v[24:27], v[72:75], a[212:215], v[24:27]
    v_mfma_f32_16x16x32_bf16 v[28:31], v[76:79], a[204:207], v[28:31]
    v_mfma_f32_16x16x32_bf16 v[32:35], v[76:79], a[208:211], v[32:35]
    v_mfma_f32_16x16x32_bf16 v[36:39], v[76:79], a[212:215], v[36:39]
    ds_read_b128 v[72:75], v116 offset:0
    ds_read_b128 v[76:79], v116 offset:20480
    s_waitcnt lgkmcnt(4)
    v_mfma_f32_16x16x32_bf16 v[16:19], v[80:83], a[216:219], v[16:19]
    v_mfma_f32_16x16x32_bf16 v[20:23], v[80:83], a[220:223], v[20:23]
    s_mov_b32 m0, s35
    s_add_u32 s35, s35, 1024
    buffer_load_dwordx4 v108, s[8:11], s28 offen lds
    v_mfma_f32_16x16x32_bf16 v[24:27], v[80:83], a[224:227], v[24:27]
    v_mfma_f32_16x16x32_bf16 v[28:31], v[84:87], a[216:219], v[28:31]
    v_mfma_f32_16x16x32_bf16 v[32:35], v[84:87], a[220:223], v[32:35]
    v_mfma_f32_16x16x32_bf16 v[36:39], v[84:87], a[224:227], v[36:39]
    ds_read_b128 v[80:83], v117 offset:0
    ds_read_b128 v[84:87], v117 offset:20480
    s_cmp_gt_u32 s38, 2
    s_cbranch_scc1 PV_ef_75
    s_waitcnt vmcnt(10)
    v_mov_b32 v14, s38
    buffer_store_dword v14, v2, s[16:19], s40 offen sc1
PV_ef_75:
    s_waitcnt lgkmcnt(4)
    v_mfma_f32_16x16x32_bf16 v[16:19], v[64:67], a[228:231], v[16:19]
    v_mfma_f32_16x16x32_bf16 v[20:23], v[64:67], a[232:235], v[20:23]
    s_mov_b32 m0, s35
    s_add_u32 s35, s35, 1024
    buffer_load_dwordx4 v109, s[8:11], s28 offen lds
    v_mfma_f32_16x16x32_bf16 v[24:27], v[64:67], a[236:239], v[24:27]
    v_mfma_f32_16x16x32_bf16 v[28:31], v[68:71], a[228:231], v[28:31]
    v_mfma_f32_16x16x32_bf16 v[32:35], v[68:71], a[232:235], v[32:35]
    v_mfma_f32_16x16x32_bf16 v[36:39], v[68:71], a[236:239], v[36:39]
    s_add_u32 s28, s28, 40960
    s_add_u32 s29, s29, 40960
    s_cmp_eq_u32 s29, 122880
    s_cselect_b32 s29, 0, s29
    v_mov_b32 v112, v116
    v_add_u32 v116, s37, v120
    v_mov_b32 v113, v117
    v_add_u32 v117, s37, v121
    v_mov_b32 v114, v118
    v_add_u32 v118, s37, v122
    v_mov_b32 v115, v119
    v_add_u32 v119, s37, v123
    s_add_u32 s37, s37, 40960
    s_cmp_eq_u32 s37, 122880
    s_cselect_b32 s37, 0, s37
    s_add_u32 s26, s26, 393216
    s_add_u32 s38, s38, 1
    s_cmp_ge_u32 s38, s24
    s_cbranch_scc1 PV_fin0
    ds_read_b128 v[64:67], v114 offset:0
    ds_read_b128 v[68:71], v114 offset:20480
    s_waitcnt lgkmcnt(4)
    v_mfma_f32_16x16x32_bf16 v[40:43], v[72:75], a[0:3], 0
    v_mfma_f32_16x16x32_bf16 v[44:47], v[72:75], a[4:7], 0
    v_mfma_f32_16x16x32_bf16 v[48:51], v[72:75], a[8:11], 0
    v_mfma_f32_16x16x32_bf16 v[52:55], v[76:79], a[0:3], 0
    v_mfma_f32_16x16x32_bf16 v[56:59], v[76:79], a[4:7], 0
    v_mfma_f32_16x16x32_bf16 v[60:63], v[76:79], a[8:11], 0
    ds_read_b128 v[72:75], v115 offset:0
    ds_read_b128 v[76:79], v115 offset:20480
    s_waitcnt lgkmcnt(4)
    v_mfma_f32_16x16x32_bf16 v[40:43], v[80:83], a[12:15], v[40:43]
    v_cvt_pk_bf16_f32 v88, v16, v17
    v_cvt_pk_bf16_f32 v89, v18, v19
    v_mfma_f32_16x16x32_bf16 v[44:47], v[80:83], a[16:19], v[44:47]
    v_mfma_f32_16x16x32_bf16 v[48:51], v[80:83], a[20:23], v[48:51]
    v_cvt_pk_bf16_f32 v90, v28, v29
    v_cvt_pk_bf16_f32 v91, v30, v31
    v_mfma_f32_16x16x32_bf16 v[52:55], v[84:87], a[12:15], v[52:55]
    v_mfma_f32_16x16x32_bf16 v[56:59], v[84:87], a[16:19], v[56:59]
    buffer_store_dwordx4 v[88:91], v9, s[16:19], s26 offen offset:0 sc1
    v_mfma_f32_16x16x32_bf16 v[60:63], v[84:87], a[20:23], v[60:63]
    ds_read_b128 v[80:83], v112 offset:256
    ds_read_b128 v[84:87], v112 offset:20736
    s_waitcnt lgkmcnt(4)
    v_mfma_f32_16x16x32_bf16 v[40:43], v[64:67], a[24:27], v[40:43]
    v_cvt_pk_bf16_f32 v92, v20, v21
    v_cvt_pk_bf16_f32 v93, v22, v23
    v_mfma_f32_16x16x32_bf16 v[44:47], v[64:67], a[28:31], v[44:47]
    v_mfma_f32_16x16x32_bf16 v[48:51], v[64:67], a[32:35], v[48:51]
    v_cvt_pk_bf16_f32 v94, v32, v33
    v_cvt_pk_bf16_f32 v95, v34, v35
    v_mfma_f32_16x16x32_bf16 v[52:55], v[68:71], a[24:27], v[52:55]
    v_mfma_f32_16x16x32_bf16 v[56:59], v[68:71], a[28:31], v[56:59]
    buffer_store_dwordx4 v[92:95], v9, s[16:19], s26 offen offset:1024 sc1
    v_mfma_f32_16x16x32_bf16 v[60:63], v[68:71], a[32:35], v[60:63]
    ds_read_b128 v[64:67], v113 offset:256
    ds_read_b128 v[68:71], v113 offset:20736
    s_waitcnt lgkmcnt(4)
    v_mfma_f32_16x16x32_bf16 v[40:43], v[72:75], a[36:39], v[40:43]
    v_cvt_pk_bf16_f32 v96, v24, v25
    v_cvt_pk_bf16_f32 v97, v26, v27
    v_mfma_f32_16x16x32_bf16 v[44:47], v[72:75], a[40:43], v[44:47]
    v_mfma_f32_16x16x32_bf16 v[48:51], v[72:75], a[44:47], v[48:51]
    v_cvt_pk_bf16_f32 v98, v36, v37
    v_cvt_pk_bf16_f32 v99, v38, v39
    v_mfma_f32_16x16x32_bf16 v[52:55], v[76:79], a[36:39], v[52:55]
    v_mfma_f32_16x16x32_bf16 v[56:59], v[76:79], a[40:43], v[56:59]
    buffer_store_dwordx4 v[96:99], v9, s[16:19], s26 offen offset:2048 sc1
    v_mfma_f32_16x16x32_bf16 v[60:63], v[76:79], a[44:47], v[60:63]
    ds_read_b128 v[72:75], v114 offset:256
    ds_read_b128 v[76:79], v114 offset:20736
    s_waitcnt lgkmcnt(4)
    v_mfma_f32_16x16x32_bf16 v[40:43], v[80:83], a[48:51], v[40:43]
    v_mfma_f32_16x16x32_bf16 v[44:47], v[80:83], a[52:55], v[44:47]
    v_mfma_f32_16x16x32_bf16 v[48:51], v[80:83], a[56:59], v[48:51]
    v_mfma_f32_16x16x32_bf16 v[52:55], v[84:87], a[48:51], v[52:55]
    v_mfma_f32_16x16x32_bf16 v[56:59], v[84:87], a[52:55], v[56:59]
    v_mfma_f32_16x16x32_bf16 v[60:63], v[84:87], a[56:59], v[60:63]
    ds_read_b128 v[80:83], v115 offset:256
    ds_read_b128 v[84:87], v115 offset:20736
    s_waitcnt lgkmcnt(4)
    v_mfma_f32_16x16x32_bf16 v[40:43], v[64:67], a[60:63], v[40:43]
    v_mfma_f32_16x16x32_bf16 v[44:47], v[64:67], a[64:67], v[44:47]
    v_mfma_f32_16x16x32_bf16 v[48:51], v[64:67], a[68:71], v[48:51]
    v_mfma_f32_16x16x32_bf16 v[52:55], v[68:71], a[60:63], v[52:55]
    v_mfma_f32_16x16x32_bf16 v[56:59], v[68:71], a[64:67], v[56:59]
    v_mfma_f32_16x16x32_bf16 v[60:63], v[68:71], a[68:71], v[60:63]
    ds_read_b128 v[64:67], v112 offset:512
    ds_read_b128 v[68:71], v112 offset:20992
    s_waitcnt lgkmcnt(4)
    v_mfma_f32_16x16x32_bf16 v[40:43], v[72:75], a[72:75], v[40:43]
    v_mfma_f32_16x16x32_bf16 v[44:47], v[72:75], a[76:79], v[44:47]
    v_mfma_f32_16x16x32_bf16 v[48:51], v[72:75], a[80:83], v[48:51]
    v_mfma_f32_16x16x32_bf16 v[52:55], v[76:79], a[72:75], v[52:55]
    v_mfma_f32_16x16x32_bf16 v[56:59], v[76:79], a[76:79], v[56:59]
    v_mfma_f32_16x16x32_bf16 v[60:63], v[76:79], a[80:83], v[60:63]
    ds_read_b128 v[72:75], v113 offset:512
    ds_read_b128 v[76:79], v113 offset:20992
    s_waitcnt lgkmcnt(4)
    v_mfma_f32_16x16x32_bf16 v[40:43], v[80:83], a[84:87], v[40:43]
    v_mfma_f32_16x16x32_bf16 v[44:47], v[80:83], a[88:91], v[44:47]
    v_mfma_f32_16x16x32_bf16 v[48:51], v[80:83], a[92:95], v[48:51]
    v_mfma_f32_16x16x32_bf16 v[52:55], v[84:87], a[84:87], v[52:55]
    v_mfma_f32_16x16x32_bf16 v[56:59], v[84:87], a[88:91], v[56:59]
    v_mfma_f32_16x16x32_bf16 v[60:63], v[84:87], a[92:95], v[60:63]
    ds_read_b128 v[80:83], v114 offset:512
    ds_read_b128 v[84:87], v114 offset:20992
    s_waitcnt lgkmcnt(4)
    v_mfma_f32_16x16x32_bf16 v[40:43], v[64:67], a[96:99], v[40:43]
    v_mfma_f32_16x16x32_bf16 v[44:47], v[64:67], a[100:103], v[44:47]
    v_mfma_f32_16x16x32_bf16 v[48:51], v[64:67], a[104:107], v[48:51]
    v_mfma_f32_16x16x32_bf16 v[52:55], v[68:71], a[96:99], v[52:55]
    v_mfma_f32_16x16x32_bf16 v[56:59], v[68:71], a[100:103], v[56:59]
    v_mfma_f32_16x16x32_bf16 v[60:63], v[68:71], a[104:107], v[60:63]
    ds_read_b128 v[64:67], v115 offset:512
    ds_read_b128 v[68:71], v115 offset:20992
    s_waitcnt lgkmcnt(4)
    v_mfma_f32_16x16x32_bf16 v[40:43], v[72:75], a[108:111], v[40:43]
    v_mfma_f32_16x16x32_bf16 v[44:47], v[72:75], a[112:115], v[44:47]
    v_mfma_f32_16x16x32_bf16 v[48:51], v[72:75], a[116:119], v[48:51]
    v_mfma_f32_16x16x32_bf16 v[52:55], v[76:79], a[108:111], v[52:55]
    v_mfma_f32_16x16x32_bf16 v[56:59], v[76:79], a[112:115], v[56:59]
    v_mfma_f32_16x16x32_bf16 v[60:63], v[76:79], a[116:119], v[60:63]
    ds_read_b128 v[72:75], v112 offset:768
    ds_read_b128 v[76:79], v112 offset:21248
    s_waitcnt vmcnt(3)
    s_barrier
    s_add_u32 s35, s29, s33
    s_sub_u32 s30, s38, 1
    v_mov_b32 v14, s30
    buffer_store_dword v14, v2, s[16:19], s40 offen sc1
    s_waitcnt lgkmcnt(4)
    v_mfma_f32_16x16x32_bf16 v[40:43], v[80:83], a[120:123], v[40:43]
    v_mfma_f32_16x16x32_bf16 v[44:47], v[80:83], a[124:127], v[44:47]
    s_mov_b32 m0, s35
    s_add_u32 s35, s35, 1024
    buffer_load_dwordx4 v100, s[8:11], s28 offen lds
    v_mfma_f32_16x16x32_bf16 v[48:51], v[80:83], a[128:131], v[48:51]
    v_mfma_f32_16x16x32_bf16 v[52:55], v[84:87], a[120:123], v[52:55]
    v_mfma_f32_16x16x32_bf16 v[56:59], v[84:87], a[124:127], v[56:59]
    v_mfma_f32_16x16x32_bf16 v[60:63], v[84:87], a[128:131], v[60:63]
    ds_read_b128 v[80:83], v113 offset:768
    ds_read_b128 v[84:87], v113 offset:21248
    s_waitcnt lgkmcnt(4)
    v_mfma_f32_16x16x32_bf16 v[40:43], v[64:67], a[132:135], v[40:43]
    v_mfma_f32_16x16x32_bf16 v[44:47], v[64:67], a[136:139], v[44:47]
    s_mov_b32 m0, s35
    s_add_u32 s35, s35, 1024
    buffer_load_dwordx4 v101, s[8:11], s28 offen lds
    v_mfma_f32_16x16x32_bf16 v[48:51], v[64:67], a[140:143], v[48:51]
    v_mfma_f32_16x16x32_bf16 v[52:55], v[68:71], a[132:135], v[52:55]
    v_mfma_f32_16x16x32_bf16 v[56:59], v[68:71], a[136:139], v[56:59]
    v_mfma_f32_16x16x32_bf16 v[60:63], v[68:71], a[140:143], v[60:63]
    ds_read_b128 v[64:67], v114 offset:768
    ds_read_b128 v[68:71], v114 offset:21248
    s_waitcnt lgkmcnt(4)
    v_mfma_f32_16x16x32_bf16 v[40:43], v[72:75], a[144:147], v[40:43]
    v_mfma_f32_16x16x32_bf16 v[44:47], v[72:75], a[148:151], v[44:47]
    s_mov_b32 m0, s35
    s_add_u32 s35, s35, 1024
    buffer_load_dwordx4 v102, s[8:11], s28 offen lds
    v_mfma_f32_16x16x32_bf16 v[48:51], v[72:75], a[152:155], v[48:51]
    v_mfma_f32_16x16x32_bf16 v[52:55], v[76:79], a[144:147], v[52:55]
    v_mfma_f32_16x16x32_bf16 v[56:59], v[76:79], a[148:151], v[56:59]
    v_mfma_f32_16x16x32_bf16 v[60:63], v[76:79], a[152:155], v[60:63]
    ds_read_b128 v[72:75], v115 offset:768
    ds_read_b128 v[76:79], v115 offset:21248
    s_waitcnt lgkmcnt(4)
    v_mfma_f32_16x16x32_bf16 v[40:43], v[80:83], a[156:159], v[40:43]
    v_mfma_f32_16x16x32_bf16 v[44:47], v[80:83], a[160:163], v[44:47]
    s_mov_b32 m0, s35
    s_add_u32 s35, s35, 1024
    buffer_load_dwordx4 v103, s[8:11], s28 offen lds
    v_mfma_f32_16x16x32_bf16 v[48:51], v[80:83], a[164:167], v[48:51]
    v_mfma_f32_16x16x32_bf16 v[52:55], v[84:87], a[156:159], v[52:55]
    v_mfma_f32_16x16x32_bf16 v[56:59], v[84:87], a[160:163], v[56:59]
    v_mfma_f32_16x16x32_bf16 v[60:63], v[84:87], a[164:167], v[60:63]
    ds_read_b128 v[80:83], v112 offset:1024
    ds_read_b128 v[84:87], v112 offset:21504
    s_waitcnt lgkmcnt(4)
    v_mfma_f32_16x16x32_bf16 v[40:43], v[64:67], a[168:171], v[40:43]
    v_mfma_f32_16x16x32_bf16 v[44:47], v[64:67], a[172:175], v[44:47]
    s_mov_b32 m0, s35
    s_add_u32 s35, s35, 1024
    buffer_load_dwordx4 v104, s[8:11], s28 offen lds
    v_mfma_f32_16x16x32_bf16 v[48:51], v[64:67], a[176:179], v[48:51]
    v_mfma_f32_16x16x32_bf16 v[52:55], v[68:71], a[168:171], v[52:55]
    v_mfma_f32_16x16x32_bf16 v[56:59], v[68:71], a[172:175], v[56:59]
    v_mfma_f32_16x16x32_bf16 v[60:63], v[68:71], a[176:179], v[60:63]
    ds_read_b128 v[64:67], v113 offset:1024
    ds_read_b128 v[68:71], v113 offset:21504
    s_waitcnt lgkmcnt(4)
    v_mfma_f32_16x16x32_bf16 v[40:43], v[72:75], a[180:183], v[40:43]
    v_mfma_f32_16x16x32_bf16 v[44:47], v[72:75], a[184:187], v[44:47]
    s_mov_b32 m0, s35
    s_add_u32 s35, s35, 1024
    buffer_load_dwordx4 v105, s[8:11], s28 offen lds
    v_mfma_f32_16x16x32_bf16 v[48:51], v[72:75], a[188:191], v[48:51]
    v_mfma_f32_16x16x32_bf16 v[52:55], v[76:79], a[180:183], v[52:55]
    v_mfma_f32_16x16x32_bf16 v[56:59], v[76:79], a[184:187], v[56:59]
    v_mfma_f32_16x16x32_bf16 v[60:63], v[76:79], a[188:191], v[60:63]
    ds_read_b128 v[72:75], v114 offset:1024
    ds_read_b128 v[76:79], v114 offset:21504
    s_waitcnt lgkmcnt(4)
    v_mfma_f32_16x16x32_bf16 v[40:43], v[80:83], a[192:195], v[40:43]
    v_mfma_f32_16x16x32_bf16 v[44:47], v[80:83], a[196:199], v[44:47]
    s_mov_b32 m0, s35
    s_add_u32 s35, s35, 1024
    buffer_load_dwordx4 v106, s[8:11], s28 offen lds
    v_mfma_f32_16x16x32_bf16 v[48:51], v[80:83], a[200:203], v[48:51]
    v_mfma_f32_16x16x32_bf16 v[52:55], v[84:87], a[192:195], v[52:55]
    v_mfma_f32_16x16x32_bf16 v[56:59], v[84:87], a[196:199], v[56:59]
    v_mfma_f32_16x16x32_bf16 v[60:63], v[84:87], a[200:203], v[60:63]
    ds_read_b128 v[80:83], v115 offset:1024
    ds_read_b128 v[84:87], v115 offset:21504
    s_waitcnt lgkmcnt(4)
    v_mfma_f32_16x16x32_bf16 v[40:43], v[64:67], a[204:207], v[40:43]
    v_mfma_f32_16x16x32_bf16 v[44:47], v[64:67], a[208:211], v[44:47]
    s_mov_b32 m0, s35
    s_add_u32 s35, s35, 1024
    buffer_load_dwordx4 v107, s[8:11], s28 offen lds
    v_mfma_f32_16x16x32_bf16 v[48:51], v[64:67], a[212:215], v[48:51]
    v_mfma_f32_16x16x32_bf16 v[52:55], v[68:71], a[204:207], v[52:55]
    v_mfma_f32_16x16x32_bf16 v[56:59], v[68:71], a[208:211], v[56:59]
    v_mfma_f32_16x16x32_bf16 v[60:63], v[68:71], a[212:215], v[60:63]
    ds_read_b128 v[64:67], v116 offset:0
    ds_read_b128 v[68:71], v116 offset:20480
    s_waitcnt lgkmcnt(4)
    v_mfma_f32_16x16x32_bf16 v[40:43], v[72:75], a[216:219], v[40:43]
    v_mfma_f32_16x16x32_bf16 v[44:47], v[72:75], a[220:223], v[44:47]
    s_mov_b32 m0, s35
    s_add_u32 s35, s35, 1024
    buffer_load_dwordx4 v108, s[8:11], s28 offen lds
    v_mfma_f32_16x16x32_bf16 v[48:51], v[72:75], a[224:227], v[48:51]
    v_mfma_f32_16x16x32_bf16 v[52:55], v[76:79], a[216:219], v[52:55]
    v_mfma_f32_16x16x32_bf16 v[56:59], v[76:79], a[220:223], v[56:59]
    v_mfma_f32_16x16x32_bf16 v[60:63], v[76:79], a[224:227], v[60:63]
    ds_read_b128 v[72:75], v117 offset:0
    ds_read_b128 v[76:79], v117 offset:20480
    s_cmp_gt_u32 s38, 2
    s_cbranch_scc1 PV_ef_76
    s_waitcnt vmcnt(10)
    v_mov_b32 v14, s38
    buffer_store_dword v14, v2, s[16:19], s40 offen sc1
PV_ef_76:
    s_waitcnt lgkmcnt(4)
    v_mfma_f32_16x16x32_bf16 v[40:43], v[80:83], a[228:231], v[40:43]
    v_mfma_f32_16x16x32_bf16 v[44:47], v[80:83], a[232:235], v[44:47]
    s_mov_b32 m0, s35
    s_add_u32 s35, s35, 1024
    buffer_load_dwordx4 v109, s[8:11], s28 offen lds
    v_mfma_f32_16x16x32_bf16 v[48:51], v[80:83], a[236:239], v[48:51]
    v_mfma_f32_16x16x32_bf16 v[52:55], v[84:87], a[228:231], v[52:55]
    v_mfma_f32_16x16x32_bf16 v[56:59], v[84:87], a[232:235], v[56:59]
    v_mfma_f32_16x16x32_bf16 v[60:63], v[84:87], a[236:239], v[60:63]
    s_add_u32 s28, s28, 40960
    s_add_u32 s29, s29, 40960
    s_cmp_eq_u32 s29, 122880
    s_cselect_b32 s29, 0, s29
    v_mov_b32 v112, v116
    v_add_u32 v116, s37, v120
    v_mov_b32 v113, v117
    v_add_u32 v117, s37, v121
    v_mov_b32 v114, v118
    v_add_u32 v118, s37, v122
    v_mov_b32 v115, v119
    v_add_u32 v119, s37, v123
    s_add_u32 s37, s37, 40960
    s_cmp_eq_u32 s37, 122880
    s_cselect_b32 s37, 0, s37
    s_add_u32 s26, s26, 393216
    s_add_u32 s38, s38, 1
    s_cmp_ge_u32 s38, s24
    s_cbranch_scc1 PV_fin1
    ds_read_b128 v[80:83], v114 offset:0
    ds_read_b128 v[84:87], v114 offset:20480
    s_waitcnt lgkmcnt(4)
    v_mfma_f32_16x16x32_bf16 v[16:19], v[64:67], a[0:3], 0
    v_mfma_f32_16x16x32_bf16 v[20:23], v[64:67], a[4:7], 0
    v_mfma_f32_16x16x32_bf16 v[24:27], v[64:67], a[8:11], 0
    v_mfma_f32_16x16x32_bf16 v[28:31], v[68:71], a[0:3], 0
    v_mfma_f32_16x16x32_bf16 v[32:35], v[68:71], a[4:7], 0
    v_mfma_f32_16x16x32_bf16 v[36:39], v[68:71], a[8:11], 0
    ds_read_b128 v[64:67], v115 offset:0
    ds_read_b128 v[68:71], v115 offset:20480
    s_waitcnt lgkmcnt(4)
    v_mfma_f32_16x16x32_bf16 v[16:19], v[72:75], a[12:15], v[16:19]
    v_cvt_pk_bf16_f32 v88, v40, v41
    v_cvt_pk_bf16_f32 v89, v42, v43
    v_mfma_f32_16x16x32_bf16 v[20:23], v[72:75], a[16:19], v[20:23]
    v_mfma_f32_16x16x32_bf16 v[24:27], v[72:75], a[20:23], v[24:27]
    v_cvt_pk_bf16_f32 v90, v52, v53
    v_cvt_pk_bf16_f32 v91, v54, v55
    v_mfma_f32_16x16x32_bf16 v[28:31], v[76:79], a[12:15], v[28:31]
    v_mfma_f32_16x16x32_bf16 v[32:35], v[76:79], a[16:19], v[32:35]
    buffer_store_dwordx4 v[88:91], v9, s[16:19], s26 offen offset:0 sc1
    v_mfma_f32_16x16x32_bf16 v[36:39], v[76:79], a[20:23], v[36:39]
    ds_read_b128 v[72:75], v112 offset:256
    ds_read_b128 v[76:79], v112 offset:20736
    s_waitcnt lgkmcnt(4)
    v_mfma_f32_16x16x32_bf16 v[16:19], v[80:83], a[24:27], v[16:19]
    v_cvt_pk_bf16_f32 v92, v44, v45
    v_cvt_pk_bf16_f32 v93, v46, v47
    v_mfma_f32_16x16x32_bf16 v[20:23], v[80:83], a[28:31], v[20:23]
    v_mfma_f32_16x16x32_bf16 v[24:27], v[80:83], a[32:35], v[24:27]
    v_cvt_pk_bf16_f32 v94, v56, v57
    v_cvt_pk_bf16_f32 v95, v58, v59
    v_mfma_f32_16x16x32_bf16 v[28:31], v[84:87], a[24:27], v[28:31]
    v_mfma_f32_16x16x32_bf16 v[32:35], v[84:87], a[28:31], v[32:35]
    buffer_store_dwordx4 v[92:95], v9, s[16:19], s26 offen offset:1024 sc1
    v_mfma_f32_16x16x32_bf16 v[36:39], v[84:87], a[32:35], v[36:39]
    ds_read_b128 v[80:83], v113 offset:256
    ds_read_b128 v[84:87], v113 offset:20736
    s_waitcnt lgkmcnt(4)
    v_mfma_f32_16x16x32_bf16 v[16:19], v[64:67], a[36:39], v[16:19]
    v_cvt_pk_bf16_f32 v96, v48, v49
    v_cvt_pk_bf16_f32 v97, v50, v51
    v_mfma_f32_16x16x32_bf16 v[20:23], v[64:67], a[40:43], v[20:23]
    v_mfma_f32_16x16x32_bf16 v[24:27], v[64:67], a[44:47], v[24:27]
    v_cvt_pk_bf16_f32 v98, v60, v61
    v_cvt_pk_bf16_f32 v99, v62, v63
    v_mfma_f32_16x16x32_bf16 v[28:31], v[68:71], a[36:39], v[28:31]
    v_mfma_f32_16x16x32_bf16 v[32:35], v[68:71], a[40:43], v[32:35]
    buffer_store_dwordx4 v[96:99], v9, s[16:19], s26 offen offset:2048 sc1
    v_mfma_f32_16x16x32_bf16 v[36:39], v[68:71], a[44:47], v[36:39]
    ds_read_b128 v[64:67], v114 offset:256
    ds_read_b128 v[68:71], v114 offset:20736
    s_waitcnt lgkmcnt(4)
    v_mfma_f32_16x16x32_bf16 v[16:19], v[72:75], a[48:51], v[16:19]
    v_mfma_f32_16x16x32_bf16 v[20:23], v[72:75], a[52:55], v[20:23]
    v_mfma_f32_16x16x32_bf16 v[24:27], v[72:75], a[56:59], v[24:27]
    v_mfma_f32_16x16x32_bf16 v[28:31], v[76:79], a[48:51], v[28:31]
    v_mfma_f32_16x16x32_bf16 v[32:35], v[76:79], a[52:55], v[32:35]
    v_mfma_f32_16x16x32_bf16 v[36:39], v[76:79], a[56:59], v[36:39]
    ds_read_b128 v[72:75], v115 offset:256
    ds_read_b128 v[76:79], v115 offset:20736
    s_waitcnt lgkmcnt(4)
    v_mfma_f32_16x16x32_bf16 v[16:19], v[80:83], a[60:63], v[16:19]
    v_mfma_f32_16x16x32_bf16 v[20:23], v[80:83], a[64:67], v[20:23]
    v_mfma_f32_16x16x32_bf16 v[24:27], v[80:83], a[68:71], v[24:27]
    v_mfma_f32_16x16x32_bf16 v[28:31], v[84:87], a[60:63], v[28:31]
    v_mfma_f32_16x16x32_bf16 v[32:35], v[84:87], a[64:67], v[32:35]
    v_mfma_f32_16x16x32_bf16 v[36:39], v[84:87], a[68:71], v[36:39]
    ds_read_b128 v[80:83], v112 offset:512
    ds_read_b128 v[84:87], v112 offset:20992
    s_waitcnt lgkmcnt(4)
    v_mfma_f32_16x16x32_bf16 v[16:19], v[64:67], a[72:75], v[16:19]
    v_mfma_f32_16x16x32_bf16 v[20:23], v[64:67], a[76:79], v[20:23]
    v_mfma_f32_16x16x32_bf16 v[24:27], v[64:67], a[80:83], v[24:27]
    v_mfma_f32_16x16x32_bf16 v[28:31], v[68:71], a[72:75], v[28:31]
    v_mfma_f32_16x16x32_bf16 v[32:35], v[68:71], a[76:79], v[32:35]
    v_mfma_f32_16x16x32_bf16 v[36:39], v[68:71], a[80:83], v[36:39]
    ds_read_b128 v[64:67], v113 offset:512
    ds_read_b128 v[68:71], v113 offset:20992
    s_waitcnt lgkmcnt(4)
    v_mfma_f32_16x16x32_bf16 v[16:19], v[72:75], a[84:87], v[16:19]
    v_mfma_f32_16x16x32_bf16 v[20:23], v[72:75], a[88:91], v[20:23]
    v_mfma_f32_16x16x32_bf16 v[24:27], v[72:75], a[92:95], v[24:27]
    v_mfma_f32_16x16x32_bf16 v[28:31], v[76:79], a[84:87], v[28:31]
    v_mfma_f32_16x16x32_bf16 v[32:35], v[76:79], a[88:91], v[32:35]
    v_mfma_f32_16x16x32_bf16 v[36:39], v[76:79], a[92:95], v[36:39]
    ds_read_b128 v[72:75], v114 offset:512
    ds_read_b128 v[76:79], v114 offset:20992
    s_waitcnt lgkmcnt(4)
    v_mfma_f32_16x16x32_bf16 v[16:19], v[80:83], a[96:99], v[16:19]
    v_mfma_f32_16x16x32_bf16 v[20:23], v[80:83], a[100:103], v[20:23]
    v_mfma_f32_16x16x32_bf16 v[24:27], v[80:83], a[104:107], v[24:27]
    v_mfma_f32_16x16x32_bf16 v[28:31], v[84:87], a[96:99], v[28:31]
    v_mfma_f32_16x16x32_bf16 v[32:35], v[84:87], a[100:103], v[32:35]
    v_mfma_f32_16x16x32_bf16 v[36:39], v[84:87], a[104:107], v[36:39]
    ds_read_b128 v[80:83], v115 offset:512
    ds_read_b128 v[84:87], v115 offset:20992
    s_waitcnt lgkmcnt(4)
    v_mfma_f32_16x16x32_bf16 v[16:19], v[64:67], a[108:111], v[16:19]
    v_mfma_f32_16x16x32_bf16 v[20:23], v[64:67], a[112:115], v[20:23]
    v_mfma_f32_16x16x32_bf16 v[24:27], v[64:67], a[116:119], v[24:27]
    v_mfma_f32_16x16x32_bf16 v[28:31], v[68:71], a[108:111], v[28:31]
    v_mfma_f32_16x16x32_bf16 v[32:35], v[68:71], a[112:115], v[32:35]
    v_mfma_f32_16x16x32_bf16 v[36:39], v[68:71], a[116:119], v[36:39]
    ds_read_b128 v[64:67], v112 offset:768
    ds_read_b128 v[68:71], v112 offset:21248
    s_waitcnt vmcnt(3)
    s_barrier
    s_add_u32 s35, s29, s33
    s_sub_u32 s30, s38, 1
    v_mov_b32 v14, s30
    buffer_store_dword v14, v2, s[16:19], s40 offen sc1
    s_waitcnt lgkmcnt(4)
    v_mfma_f32_16x16x32_bf16 v[16:19], v[72:75], a[120:123], v[16:19]
    v_mfma_f32_16x16x32_bf16 v[20:23], v[72:75], a[124:127], v[20:23]
    s_mov_b32 m0, s35
    s_add_u32 s35, s35, 1024
    buffer_load_dwordx4 v100, s[8:11], s28 offen lds
    v_mfma_f32_16x16x32_bf16 v[24:27], v[72:75], a[128:131], v[24:27]
    v_mfma_f32_16x16x32_bf16 v[28:31], v[76:79], a[120:123], v[28:31]
    v_mfma_f32_16x16x32_bf16 v[32:35], v[76:79], a[124:127], v[32:35]
    v_mfma_f32_16x16x32_bf16 v[36:39], v[76:79], a[128:131], v[36:39]
    ds_read_b128 v[72:75], v113 offset:768
    ds_read_b128 v[76:79], v113 offset:21248
    s_waitcnt lgkmcnt(4)
    v_mfma_f32_16x16x32_bf16 v[16:19], v[80:83], a[132:135], v[16:19]
    v_mfma_f32_16x16x32_bf16 v[20:23], v[80:83], a[136:139], v[20:23]
    s_mov_b32 m0, s35
    s_add_u32 s35, s35, 1024
    buffer_load_dwordx4 v101, s[8:11], s28 offen lds
    v_mfma_f32_16x16x32_bf16 v[24:27], v[80:83], a[140:143], v[24:27]
    v_mfma_f32_16x16x32_bf16 v[28:31], v[84:87], a[132:135], v[28:31]
    v_mfma_f32_16x16x32_bf16 v[32:35], v[84:87], a[136:139], v[32:35]
    v_mfma_f32_16x16x32_bf16 v[36:39], v[84:87], a[140:143], v[36:39]
    ds_read_b128 v[80:83], v114 offset:768
    ds_read_b128 v[84:87], v114 offset:21248
    s_waitcnt lgkmcnt(4)
    v_mfma_f32_16x16x32_bf16 v[16:19], v[64:67], a[144:147], v[16:19]
    v_mfma_f32_16x16x32_bf16 v[20:23], v[64:67], a[148:151], v[20:23]
    s_mov_b32 m0, s35
    s_add_u32 s35, s35, 1024
    buffer_load_dwordx4 v102, s[8:11], s28 offen lds
    v_mfma_f32_16x16x32_bf16 v[24:27], v[64:67], a[152:155], v[24:27]
    v_mfma_f32_16x16x32_bf16 v[28:31], v[68:71], a[144:147], v[28:31]
    v_mfma_f32_16x16x32_bf16 v[32:35], v[68:71], a[148:151], v[32:35]
    v_mfma_f32_16x16x32_bf16 v[36:39], v[68:71], a[152:155], v[36:39]
    ds_read_b128 v[64:67], v115 offset:768
    ds_read_b128 v[68:71], v115 offset:21248
    s_waitcnt lgkmcnt(4)
    v_mfma_f32_16x16x32_bf16 v[16:19], v[72:75], a[156:159], v[16:19]
    v_mfma_f32_16x16x32_bf16 v[20:23], v[72:75], a[160:163], v[20:23]
    s_mov_b32 m0, s35
    s_add_u32 s35, s35, 1024
    buffer_load_dwordx4 v103, s[8:11], s28 offen lds
    v_mfma_f32_16x16x32_bf16 v[24:27], v[72:75], a[164:167], v[24:27]
    v_mfma_f32_16x16x32_bf16 v[28:31], v[76:79], a[156:159], v[28:31]
    v_mfma_f32_16x16x32_bf16 v[32:35], v[76:79], a[160:163], v[32:35]
    v_mfma_f32_16x16x32_bf16 v[36:39], v[76:79], a[164:167], v[36:39]
    ds_read_b128 v[72:75], v112 offset:1024
    ds_read_b128 v[76:79], v112 offset:21504
    s_waitcnt lgkmcnt(4)
    v_mfma_f32_16x16x32_bf16 v[16:19], v[80:83], a[168:171], v[16:19]
    v_mfma_f32_16x16x32_bf16 v[20:23], v[80:83], a[172:175], v[20:23]
    s_mov_b32 m0, s35
    s_add_u32 s35, s35, 1024
    buffer_load_dwordx4 v104, s[8:11], s28 offen lds
    v_mfma_f32_16x16x32_bf16 v[24:27], v[80:83], a[176:179], v[24:27]
    v_mfma_f32_16x16x32_bf16 v[28:31], v[84:87], a[168:171], v[28:31]
    v_mfma_f32_16x16x32_bf16 v[32:35], v[84:87], a[172:175], v[32:35]
    v_mfma_f32_16x16x32_bf16 v[36:39], v[84:87], a[176:179], v[36:39]
    ds_read_b128 v[80:83], v113 offset:1024
    ds_read_b128 v[84:87], v113 offset:21504
    s_waitcnt lgkmcnt(4)
    v_mfma_f32_16x16x32_bf16 v[16:19], v[64:67], a[180:183], v[16:19]
    v_mfma_f32_16x16x32_bf16 v[20:23], v[64:67], a[184:187], v[20:23]
    s_mov_b32 m0, s35
    s_add_u32 s35, s35, 1024
    buffer_load_dwordx4 v105, s[8:11], s28 offen lds
    v_mfma_f32_16x16x32_bf16 v[24:27], v[64:67], a[188:191], v[24:27]
    v_mfma_f32_16x16x32_bf16 v[28:31], v[68:71], a[180:183], v[28:31]
    v_mfma_f32_16x16x32_bf16 v[32:35], v[68:71], a[184:187], v[32:35]
    v_mfma_f32_16x16x32_bf16 v[36:39], v[68:71], a[188:191], v[36:39]
    ds_read_b128 v[64:67], v114 offset:1024
    ds_read_b128 v[68:71], v114 offset:21504
    s_waitcnt lgkmcnt(4)
    v_mfma_f32_16x16x32_bf16 v[16:19], v[72:75], a[192:195], v[16:19]
    v_mfma_f32_16x16x32_bf16 v[20:23], v[72:75], a[196:199], v[20:23]
    s_mov_b32 m0, s35
    s_add_u32 s35, s35, 1024
    buffer_load_dwordx4 v106, s[8:11], s28 offen lds
    v_mfma_f32_16x16x32_bf16 v[24:27], v[72:75], a[200:203], v[24:27]
    v_mfma_f32_16x16x32_bf16 v[28:31], v[76:79], a[192:195], v[28:31]
    v_mfma_f32_16x16x32_bf16 v[32:35], v[76:79], a[196:199], v[32:35]
    v_mfma_f32_16x16x32_bf16 v[36:39], v[76:79], a[200:203], v[36:39]
    ds_read_b128 v[72:75], v115 offset:1024
    ds_read_b128 v[76:79], v115 offset:21504
    s_waitcnt lgkmcnt(4)
    v_mfma_f32_16x16x32_bf16 v[16:19], v[80:83], a[204:207], v[16:19]
    v_mfma_f32_16x16x32_bf16 v[20:23], v[80:83], a[208:211], v[20:23]
    s_mov_b32 m0, s35
    s_add_u32 s35, s35, 1024
    buffer_load_dwordx4 v107, s[8:11], s28 offen lds
    v_mfma_f32_16x16x32_bf16 v[24:27], v[80:83], a[212:215], v[24:27]
    v_mfma_f32_16x16x32_bf16 v[28:31], v[84:87], a[204:207], v[28:31]
    v_mfma_f32_16x16x32_bf16 v[32:35], v[84:87], a[208:211], v[32:35]
    v_mfma_f32_16x16x32_bf16 v[36:39], v[84:87], a[212:215], v[36:39]
    ds_read_b128 v[80:83], v116 offset:0
    ds_read_b128 v[84:87], v116 offset:20480
    s_waitcnt lgkmcnt(4)
    v_mfma_f32_16x16x32_bf16 v[16:19], v[64:67], a[216:219], v[16:19]
    v_mfma_f32_16x16x32_bf16 v[20:23], v[64:67], a[220:223], v[20:23]
    s_mov_b32 m0, s35
    s_add_u32 s35, s35, 1024
    buffer_load_dwordx4 v108, s[8:11], s28 offen lds
    v_mfma_f32_16x16x32_bf16 v[24:27], v[64:67], a[224:227], v[24:27]
    v_mfma_f32_16x16x32_bf16 v[28:31], v[68:71], a[216:219], v[28:31]
    v_mfma_f32_16x16x32_bf16 v[32:35], v[68:71], a[220:223], v[32:35]
    v_mfma_f32_16x16x32_bf16 v[36:39], v[68:71], a[224:227], v[36:39]
    ds_read_b128 v[64:67], v117 offset:0
    ds_read_b128 v[68:71], v117 offset:20480
    s_cmp_gt_u32 s38, 2
    s_cbranch_scc1 PV_ef_77
    s_waitcnt vmcnt(10)
    v_mov_b32 v14, s38
    buffer_store_dword v14, v2, s[16:19], s40 offen sc1
PV_ef_77:
    s_waitcnt lgkmcnt(4)
    v_mfma_f32_16x16x32_bf16 v[16:19], v[72:75], a[228:231], v[16:19]
    v_mfma_f32_16x16x32_bf16 v[20:23], v[72:75], a[232:235], v[20:23]
    s_mov_b32 m0, s35
    s_add_u32 s35, s35, 1024
    buffer_load_dwordx4 v109, s[8:11], s28 offen lds
    v_mfma_f32_16x16x32_bf16 v[24:27], v[72:75], a[236:239], v[24:27]
    v_mfma_f32_16x16x32_bf16 v[28:31], v[76:79], a[228:231], v[28:31]
    v_mfma_f32_16x16x32_bf16 v[32:35], v[76:79], a[232:235], v[32:35]
    v_mfma_f32_16x16x32_bf16 v[36:39], v[76:79], a[236:239], v[36:39]
    s_add_u32 s28, s28, 40960
    s_add_u32 s29, s29, 40960
    s_cmp_eq_u32 s29, 122880
    s_cselect_b32 s29, 0, s29
    v_mov_b32 v112, v116
    v_add_u32 v116, s37, v120
    v_mov_b32 v113, v117
    v_add_u32 v117, s37, v121
    v_mov_b32 v114, v118
    v_add_u32 v118, s37, v122
    v_mov_b32 v115, v119
    v_add_u32 v119, s37, v123
    s_add_u32 s37, s37, 40960
    s_cmp_eq_u32 s37, 122880
    s_cselect_b32 s37, 0, s37
    s_add_u32 s26, s26, 393216
    s_add_u32 s38, s38, 1
    s_branch PV_loop
PV_fin0:
    s_nop 7
    v_cvt_pk_bf16_f32 v88, v16, v17
    v_cvt_pk_bf16_f32 v89, v18, v19
    v_cvt_pk_bf16_f32 v90, v28, v29
    v_cvt_pk_bf16_f32 v91, v30, v31
    buffer_store_dwordx4 v[88:91], v9, s[16:19], s26 offen offset:0 sc1
    v_cvt_pk_bf16_f32 v92, v20, v21
    v_cvt_pk_bf16_f32 v93, v22, v23
    v_cvt_pk_bf16_f32 v94, v32, v33
    v_cvt_pk_bf16_f32 v95, v34, v35
    buffer_store_dwordx4 v[92:95], v9, s[16:19], s26 offen offset:1024 sc1
    v_cvt_pk_bf16_f32 v96, v24, v25
    v_cvt_pk_bf16_f32 v97, v26, v27
    v_cvt_pk_bf16_f32 v98, v36, v37
    v_cvt_pk_bf16_f32 v99, v38, v39
    buffer_store_dwordx4 v[96:99], v9, s[16:19], s26 offen offset:2048 sc1
    s_branch PV_done
PV_fin1:
    s_nop 7
    v_cvt_pk_bf16_f32 v88, v40, v41
    v_cvt_pk_bf16_f32 v89, v42, v43
    v_cvt_pk_bf16_f32 v90, v52, v53
    v_cvt_pk_bf16_f32 v91, v54, v55
    buffer_store_dwordx4 v[88:91], v9, s[16:19], s26 offen offset:0 sc1
    v_cvt_pk_bf16_f32 v92, v44, v45
    v_cvt_pk_bf16_f32 v93, v46, v47
    v_cvt_pk_bf16_f32 v94, v56, v57
    v_cvt_pk_bf16_f32 v95, v58, v59
    buffer_store_dwordx4 v[92:95], v9, s[16:19], s26 offen offset:1024 sc1
    v_cvt_pk_bf16_f32 v96, v48, v49
    v_cvt_pk_bf16_f32 v97, v50, v51
    v_cvt_pk_bf16_f32 v98, v60, v61
    v_cvt_pk_bf16_f32 v99, v62, v63
    buffer_store_dwordx4 v[96:99], v9, s[16:19], s26 offen offset:2048 sc1
    s_branch PV_done
PV_done:
    s_waitcnt vmcnt(0) lgkmcnt(0)
    v_mov_b32 v14, s38
    v_mov_b32 v15, 0
    s_mov_b64 exec, 1
    buffer_store_dword v14, v15, s[16:19], s40 offen sc1
    s_mov_b64 exec, -1
    s_mov_b32 s8, s76
    s_and_b32 s9, s77, 0xffff
    s_mov_b32 s10, 5242880
    s_mov_b32 s11, 0x20000
    s_mov_b32 s12, s86
    s_and_b32 s13, s87, 0xffff
    s_mov_b32 s14, 7864320
    s_mov_b32 s15, 0x20000
    s_lshr_b32 s21, s22, 3
    s_and_b32 s22, s22, 7
    s_mov_b32 s23, 0
    s_mov_b32 s24, 64
    v_and_b32 v1, 63, v0
    v_lshlrev_b32 v11, 4, v1
    s_waitcnt vmcnt(0) lgkmcnt(0)
    s_barrier
    v_add_u32 v12, 0, v1
    v_mul_u32_u24 v13, 6554, v12
    v_lshrrev_b32 v13, 16, v13
    v_mul_u32_u24 v14, 10, v13
    v_sub_u32 v14, v12, v14
    v_mul_u32_u24 v116, 1280, v13
    v_lshl_add_u32 v116, v14, 4, v116
    v_add_u32 v12, 64, v1
    v_mul_u32_u24 v13, 6554, v12
    v_lshrrev_b32 v13, 16, v13
    v_mul_u32_u24 v14, 10, v13
    v_sub_u32 v14, v12, v14
    v_mul_u32_u24 v117, 1280, v13
    v_lshl_add_u32 v117, v14, 4, v117
    v_add_u32 v12, 128, v1
    v_mul_u32_u24 v13, 6554, v12
    v_lshrrev_b32 v13, 16, v13
    v_mul_u32_u24 v14, 10, v13
    v_sub_u32 v14, v12, v14
    v_mul_u32_u24 v118, 1280, v13
    v_lshl_add_u32 v118, v14, 4, v118
    v_add_u32 v12, 192, v1
    v_mul_u32_u24 v13, 6554, v12
    v_lshrrev_b32 v13, 16, v13
    v_mul_u32_u24 v14, 10, v13
    v_sub_u32 v14, v12, v14
    v_mul_u32_u24 v119, 1280, v13
    v_lshl_add_u32 v119, v14, 4, v119
    v_add_u32 v12, 256, v1
    v_mul_u32_u24 v13, 6554, v12
    v_lshrrev_b32 v13, 16, v13
    v_mul_u32_u24 v14, 10, v13
    v_sub_u32 v14, v12, v14
    v_mul_u32_u24 v120, 1280, v13
    v_lshl_add_u32 v120, v14, 4, v120
    v_lshrrev_b32 v12, 4, v1
    v_lshlrev_b32 v12, 2, v12
    v_bfe_u32 v13, v1, 2, 2
    v_add_u32 v12, v12, v13
    v_mul_u32_u24 v2, 160, v12
    v_and_b32 v12, 3, v1
    v_lshl_add_u32 v2, v12, 3, v2
    s_mul_i32 s27, s25, 30720
    v_add_u32 v2, s27, v2
    s_lshl_b32 s26, s21, 3
    s_lshl_b32 s30, s25, 1
    s_add_u32 s26, s26, s30
    s_add_u32 s30, s26, 0
    s_mul_i32 s30, s30, 245760
    s_mul_i32 s31, s22, 160
    s_add_u32 s30, s30, s31
    s_mov_b32 s31, s27
    s_mov_b32 m0, s31
    s_add_u32 s31, s31, 1024
    buffer_load_dwordx4 v116, s[12:15], s30 offen lds
    s_mov_b32 m0, s31
    s_add_u32 s31, s31, 1024
    buffer_load_dwordx4 v117, s[12:15], s30 offen lds
    s_mov_b32 m0, s31
    s_add_u32 s31, s31, 1024
    buffer_load_dwordx4 v118, s[12:15], s30 offen lds
    s_mov_b32 m0, s31
    s_add_u32 s31, s31, 1024
    buffer_load_dwordx4 v119, s[12:15], s30 offen lds
    s_mov_b32 m0, s31
    s_add_u32 s31, s31, 1024
    buffer_load_dwordx4 v120, s[12:15], s30 offen lds
    s_add_u32 s30, s30, 40960
    s_mov_b32 m0, s31
    s_add_u32 s31, s31, 1024
    buffer_load_dwordx4 v116, s[12:15], s30 offen lds
    s_mov_b32 m0, s31
    s_add_u32 s31, s31, 1024
    buffer_load_dwordx4 v117, s[12:15], s30 offen lds
    s_mov_b32 m0, s31
    s_add_u32 s31, s31, 1024
    buffer_load_dwordx4 v118, s[12:15], s30 offen lds
    s_mov_b32 m0, s31
    s_add_u32 s31, s31, 1024
    buffer_load_dwordx4 v119, s[12:15], s30 offen lds
    s_mov_b32 m0, s31
    s_add_u32 s31, s31, 1024
    buffer_load_dwordx4 v120, s[12:15], s30 offen lds
    s_add_u32 s30, s30, 40960
    s_mov_b32 m0, s31
    s_add_u32 s31, s31, 1024
    buffer_load_dwordx4 v116, s[12:15], s30 offen lds
    s_mov_b32 m0, s31
    s_add_u32 s31, s31, 1024
    buffer_load_dwordx4 v117, s[12:15], s30 offen lds
    s_mov_b32 m0, s31
    s_add_u32 s31, s31, 1024
    buffer_load_dwordx4 v118, s[12:15], s30 offen lds
    s_mov_b32 m0, s31
    s_add_u32 s31, s31, 1024
    buffer_load_dwordx4 v119, s[12:15], s30 offen lds
    s_mov_b32 m0, s31
    s_add_u32 s31, s31, 1024
    buffer_load_dwordx4 v120, s[12:15], s30 offen lds
    s_add_u32 s30, s30, 40960
    s_mov_b32 m0, s31
    s_add_u32 s31, s31, 1024
    buffer_load_dwordx4 v116, s[12:15], s30 offen lds
    s_mov_b32 m0, s31
    s_add_u32 s31, s31, 1024
    buffer_load_dwordx4 v117, s[12:15], s30 offen lds
    s_mov_b32 m0, s31
    s_add_u32 s31, s31, 1024
    buffer_load_dwordx4 v118, s[12:15], s30 offen lds
    s_mov_b32 m0, s31
    s_add_u32 s31, s31, 1024
    buffer_load_dwordx4 v119, s[12:15], s30 offen lds
    s_mov_b32 m0, s31
    s_add_u32 s31, s31, 1024
    buffer_load_dwordx4 v120, s[12:15], s30 offen lds
    s_add_u32 s30, s30, 40960
    s_mov_b32 m0, s31
    s_add_u32 s31, s31, 1024
    buffer_load_dwordx4 v116, s[12:15], s30 offen lds
    s_mov_b32 m0, s31
    s_add_u32 s31, s31, 1024
    buffer_load_dwordx4 v117, s[12:15], s30 offen lds
    s_mov_b32 m0, s31
    s_add_u32 s31, s31, 1024
    buffer_load_dwordx4 v118, s[12:15], s30 offen lds
    s_mov_b32 m0, s31
    s_add_u32 s31, s31, 1024
    buffer_load_dwordx4 v119, s[12:15], s30 offen lds
    s_mov_b32 m0, s31
    s_add_u32 s31, s31, 1024
    buffer_load_dwordx4 v120, s[12:15], s30 offen lds
    s_add_u32 s30, s30, 40960
    s_mov_b32 m0, s31
    s_add_u32 s31, s31, 1024
    buffer_load_dwordx4 v116, s[12:15], s30 offen lds
    s_mov_b32 m0, s31
    s_add_u32 s31, s31, 1024
    buffer_load_dwordx4 v117, s[12:15], s30 offen lds
    s_mov_b32 m0, s31
    s_add_u32 s31, s31, 1024
    buffer_load_dwordx4 v118, s[12:15], s30 offen lds
    s_mov_b32 m0, s31
    s_add_u32 s31, s31, 1024
    buffer_load_dwordx4 v119, s[12:15], s30 offen lds
    s_mov_b32 m0, s31
    s_add_u32 s31, s31, 1024
    buffer_load_dwordx4 v120, s[12:15], s30 offen lds
    s_add_u32 s30, s30, 40960
    s_waitcnt vmcnt(0)
    ds_read_b64_tr_b16 a[0:1], v2 offset:0
    ds_read_b64_tr_b16 a[2:3], v2 offset:2560
    s_waitcnt lgkmcnt(8)
    ds_read_b64_tr_b16 a[4:5], v2 offset:32
    ds_read_b64_tr_b16 a[6:7], v2 offset:2592
    s_waitcnt lgkmcnt(8)
    ds_read_b64_tr_b16 a[8:9], v2 offset:64
    ds_read_b64_tr_b16 a[10:11], v2 offset:2624
    s_waitcnt lgkmcnt(8)
    ds_read_b64_tr_b16 a[12:13], v2 offset:96
    ds_read_b64_tr_b16 a[14:15], v2 offset:2656
    s_waitcnt lgkmcnt(8)
    ds_read_b64_tr_b16 a[16:17], v2 offset:128
    ds_read_b64_tr_b16 a[18:19], v2 offset:2688
    s_waitcnt lgkmcnt(8)
    ds_read_b64_tr_b16 a[20:21], v2 offset:7680
    ds_read_b64_tr_b16 a[22:23], v2 offset:10240
    s_waitcnt lgkmcnt(8)
    ds_read_b64_tr_b16 a[24:25], v2 offset:7712
    ds_read_b64_tr_b16 a[26:27], v2 offset:10272
    s_waitcnt lgkmcnt(8)
    ds_read_b64_tr_b16 a[28:29], v2 offset:7744
    ds_read_b64_tr_b16 a[30:31], v2 offset:10304
    s_waitcnt lgkmcnt(8)
    ds_read_b64_tr_b16 a[32:33], v2 offset:7776
    ds_read_b64_tr_b16 a[34:35], v2 offset:10336
    s_waitcnt lgkmcnt(8)
    ds_read_b64_tr_b16 a[36:37], v2 offset:7808
    ds_read_b64_tr_b16 a[38:39], v2 offset:10368
    s_waitcnt lgkmcnt(8)
    ds_read_b64_tr_b16 a[40:41], v2 offset:5120
    ds_read_b64_tr_b16 a[42:43], v2 offset:12800
    s_waitcnt lgkmcnt(8)
    ds_read_b64_tr_b16 a[44:45], v2 offset:5152
    ds_read_b64_tr_b16 a[46:47], v2 offset:12832
    s_waitcnt lgkmcnt(8)
    ds_read_b64_tr_b16 a[48:49], v2 offset:5184
    ds_read_b64_tr_b16 a[50:51], v2 offset:12864
    s_waitcnt lgkmcnt(8)
    ds_read_b64_tr_b16 a[52:53], v2 offset:5216
    ds_read_b64_tr_b16 a[54:55], v2 offset:12896
    s_waitcnt lgkmcnt(8)
    ds_read_b64_tr_b16 a[56:57], v2 offset:5248
    ds_read_b64_tr_b16 a[58:59], v2 offset:12928
    s_waitcnt lgkmcnt(8)
    ds_read_b64_tr_b16 a[60:61], v2 offset:15360
    ds_read_b64_tr_b16 a[62:63], v2 offset:17920
    s_waitcnt lgkmcnt(8)
    ds_read_b64_tr_b16 a[64:65], v2 offset:15392
    ds_read_b64_tr_b16 a[66:67], v2 offset:17952
    s_waitcnt lgkmcnt(8)
    ds_read_b64_tr_b16 a[68:69], v2 offset:15424
    ds_read_b64_tr_b16 a[70:71], v2 offset:17984
    s_waitcnt lgkmcnt(8)
    ds_read_b64_tr_b16 a[72:73], v2 offset:15456
    ds_read_b64_tr_b16 a[74:75], v2 offset:18016
    s_waitcnt lgkmcnt(8)
    ds_read_b64_tr_b16 a[76:77], v2 offset:15488
    ds_read_b64_tr_b16 a[78:79], v2 offset:18048
    s_waitcnt lgkmcnt(8)
    ds_read_b64_tr_b16 a[80:81], v2 offset:23040
    ds_read_b64_tr_b16 a[82:83], v2 offset:25600
    s_waitcnt lgkmcnt(8)
    ds_read_b64_tr_b16 a[84:85], v2 offset:23072
    ds_read_b64_tr_b16 a[86:87], v2 offset:25632
    s_waitcnt lgkmcnt(8)
    ds_read_b64_tr_b16 a[88:89], v2 offset:23104
    ds_read_b64_tr_b16 a[90:91], v2 offset:25664
    s_waitcnt lgkmcnt(8)
    ds_read_b64_tr_b16 a[92:93], v2 offset:23136
    ds_read_b64_tr_b16 a[94:95], v2 offset:25696
    s_waitcnt lgkmcnt(8)
    ds_read_b64_tr_b16 a[96:97], v2 offset:23168
    ds_read_b64_tr_b16 a[98:99], v2 offset:25728
    s_waitcnt lgkmcnt(8)
    ds_read_b64_tr_b16 a[100:101], v2 offset:20480
    ds_read_b64_tr_b16 a[102:103], v2 offset:28160
    s_waitcnt lgkmcnt(8)
    ds_read_b64_tr_b16 a[104:105], v2 offset:20512
    ds_read_b64_tr_b16 a[106:107], v2 offset:28192
    s_waitcnt lgkmcnt(8)
    ds_read_b64_tr_b16 a[108:109], v2 offset:20544
    ds_read_b64_tr_b16 a[110:111], v2 offset:28224
    s_waitcnt lgkmcnt(8)
    ds_read_b64_tr_b16 a[112:113], v2 offset:20576
    ds_read_b64_tr_b16 a[114:115], v2 offset:28256
    s_waitcnt lgkmcnt(8)
    ds_read_b64_tr_b16 a[116:117], v2 offset:20608
    ds_read_b64_tr_b16 a[118:119], v2 offset:28288
    s_waitcnt lgkmcnt(8)
    s_waitcnt lgkmcnt(0)
    s_add_u32 s30, s26, 1
    s_mul_i32 s30, s30, 245760
    s_mul_i32 s31, s22, 160
    s_add_u32 s30, s30, s31
    s_mov_b32 s31, s27
    s_mov_b32 m0, s31
    s_add_u32 s31, s31, 1024
    buffer_load_dwordx4 v116, s[12:15], s30 offen lds
    s_mov_b32 m0, s31
    s_add_u32 s31, s31, 1024
    buffer_load_dwordx4 v117, s[12:15], s30 offen lds
    s_mov_b32 m0, s31
    s_add_u32 s31, s31, 1024
    buffer_load_dwordx4 v118, s[12:15], s30 offen lds
    s_mov_b32 m0, s31
    s_add_u32 s31, s31, 1024
    buffer_load_dwordx4 v119, s[12:15], s30 offen lds
    s_mov_b32 m0, s31
    s_add_u32 s31, s31, 1024
    buffer_load_dwordx4 v120, s[12:15], s30 offen lds
    s_add_u32 s30, s30, 40960
    s_mov_b32 m0, s31
    s_add_u32 s31, s31, 1024
    buffer_load_dwordx4 v116, s[12:15], s30 offen lds
    s_mov_b32 m0, s31
    s_add_u32 s31, s31, 1024
    buffer_load_dwordx4 v117, s[12:15], s30 offen lds
    s_mov_b32 m0, s31
    s_add_u32 s31, s31, 1024
    buffer_load_dwordx4 v118, s[12:15], s30 offen lds
    s_mov_b32 m0, s31
    s_add_u32 s31, s31, 1024
    buffer_load_dwordx4 v119, s[12:15], s30 offen lds
    s_mov_b32 m0, s31
    s_add_u32 s31, s31, 1024
    buffer_load_dwordx4 v120, s[12:15], s30 offen lds
    s_add_u32 s30, s30, 40960
    s_mov_b32 m0, s31
    s_add_u32 s31, s31, 1024
    buffer_load_dwordx4 v116, s[12:15], s30 offen lds
    s_mov_b32 m0, s31
    s_add_u32 s31, s31, 1024
    buffer_load_dwordx4 v117, s[12:15], s30 offen lds
    s_mov_b32 m0, s31
    s_add_u32 s31, s31, 1024
    buffer_load_dwordx4 v118, s[12:15], s30 offen lds
    s_mov_b32 m0, s31
    s_add_u32 s31, s31, 1024
    buffer_load_dwordx4 v119, s[12:15], s30 offen lds
    s_mov_b32 m0, s31
    s_add_u32 s31, s31, 1024
    buffer_load_dwordx4 v120, s[12:15], s30 offen lds
    s_add_u32 s30, s30, 40960
    s_mov_b32 m0, s31
    s_add_u32 s31, s31, 1024
    buffer_load_dwordx4 v116, s[12:15], s30 offen lds
    s_mov_b32 m0, s31
    s_add_u32 s31, s31, 1024
    buffer_load_dwordx4 v117, s[12:15], s30 offen lds
    s_mov_b32 m0, s31
    s_add_u32 s31, s31, 1024
    buffer_load_dwordx4 v118, s[12:15], s30 offen lds
    s_mov_b32 m0, s31
    s_add_u32 s31, s31, 1024
    buffer_load_dwordx4 v119, s[12:15], s30 offen lds
    s_mov_b32 m0, s31
    s_add_u32 s31, s31, 1024
    buffer_load_dwordx4 v120, s[12:15], s30 offen lds
    s_add_u32 s30, s30, 40960
    s_mov_b32 m0, s31
    s_add_u32 s31, s31, 1024
    buffer_load_dwordx4 v116, s[12:15], s30 offen lds
    s_mov_b32 m0, s31
    s_add_u32 s31, s31, 1024
    buffer_load_dwordx4 v117, s[12:15], s30 offen lds
    s_mov_b32 m0, s31
    s_add_u32 s31, s31, 1024
    buffer_load_dwordx4 v118, s[12:15], s30 offen lds
    s_mov_b32 m0, s31
    s_add_u32 s31, s31, 1024
    buffer_load_dwordx4 v119, s[12:15], s30 offen lds
    s_mov_b32 m0, s31
    s_add_u32 s31, s31, 1024
    buffer_load_dwordx4 v120, s[12:15], s30 offen lds
    s_add_u32 s30, s30, 40960
    s_mov_b32 m0, s31
    s_add_u32 s31, s31, 1024
    buffer_load_dwordx4 v116, s[12:15], s30 offen lds
    s_mov_b32 m0, s31
    s_add_u32 s31, s31, 1024
    buffer_load_dwordx4 v117, s[12:15], s30 offen lds
    s_mov_b32 m0, s31
    s_add_u32 s31, s31, 1024
    buffer_load_dwordx4 v118, s[12:15], s30 offen lds
    s_mov_b32 m0, s31
    s_add_u32 s31, s31, 1024
    buffer_load_dwordx4 v119, s[12:15], s30 offen lds
    s_mov_b32 m0, s31
    s_add_u32 s31, s31, 1024
    buffer_load_dwordx4 v120, s[12:15], s30 offen lds
    s_add_u32 s30, s30, 40960
    s_waitcnt vmcnt(0)
    ds_read_b64_tr_b16 a[120:121], v2 offset:0
    ds_read_b64_tr_b16 a[122:123], v2 offset:2560
    s_waitcnt lgkmcnt(8)
    ds_read_b64_tr_b16 a[124:125], v2 offset:32
    ds_read_b64_tr_b16 a[126:127], v2 offset:2592
    s_waitcnt lgkmcnt(8)
    ds_read_b64_tr_b16 a[128:129], v2 offset:64
    ds_read_b64_tr_b16 a[130:131], v2 offset:2624
    s_waitcnt lgkmcnt(8)
    ds_read_b64_tr_b16 a[132:133], v2 offset:96
    ds_read_b64_tr_b16 a[134:135], v2 offset:2656
    s_waitcnt lgkmcnt(8)
    ds_read_b64_tr_b16 a[136:137], v2 offset:128
    ds_read_b64_tr_b16 a[138:139], v2 offset:2688
    s_waitcnt lgkmcnt(8)
    ds_read_b64_tr_b16 a[140:141], v2 offset:7680
    ds_read_b64_tr_b16 a[142:143], v2 offset:10240
    s_waitcnt lgkmcnt(8)
    ds_read_b64_tr_b16 a[144:145], v2 offset:7712
    ds_read_b64_tr_b16 a[146:147], v2 offset:10272
    s_waitcnt lgkmcnt(8)
    ds_read_b64_tr_b16 a[148:149], v2 offset:7744
    ds_read_b64_tr_b16 a[150:151], v2 offset:10304
    s_waitcnt lgkmcnt(8)
    ds_read_b64_tr_b16 a[152:153], v2 offset:7776
    ds_read_b64_tr_b16 a[154:155], v2 offset:10336
    s_waitcnt lgkmcnt(8)
    ds_read_b64_tr_b16 a[156:157], v2 offset:7808
    ds_read_b64_tr_b16 a[158:159], v2 offset:10368
    s_waitcnt lgkmcnt(8)
    ds_read_b64_tr_b16 a[160:161], v2 offset:5120
    ds_read_b64_tr_b16 a[162:163], v2 offset:12800
    s_waitcnt lgkmcnt(8)
    ds_read_b64_tr_b16 a[164:165], v2 offset:5152
    ds_read_b64_tr_b16 a[166:167], v2 offset:12832
    s_waitcnt lgkmcnt(8)
    ds_read_b64_tr_b16 a[168:169], v2 offset:5184
    ds_read_b64_tr_b16 a[170:171], v2 offset:12864
    s_waitcnt lgkmcnt(8)
    ds_read_b64_tr_b16 a[172:173], v2 offset:5216
    ds_read_b64_tr_b16 a[174:175], v2 offset:12896
    s_waitcnt lgkmcnt(8)
    ds_read_b64_tr_b16 a[176:177], v2 offset:5248
    ds_read_b64_tr_b16 a[178:179], v2 offset:12928
    s_waitcnt lgkmcnt(8)
    ds_read_b64_tr_b16 a[180:181], v2 offset:15360
    ds_read_b64_tr_b16 a[182:183], v2 offset:17920
    s_waitcnt lgkmcnt(8)
    ds_read_b64_tr_b16 a[184:185], v2 offset:15392
    ds_read_b64_tr_b16 a[186:187], v2 offset:17952
    s_waitcnt lgkmcnt(8)
    ds_read_b64_tr_b16 a[188:189], v2 offset:15424
    ds_read_b64_tr_b16 a[190:191], v2 offset:17984
    s_waitcnt lgkmcnt(8)
    ds_read_b64_tr_b16 a[192:193], v2 offset:15456
    ds_read_b64_tr_b16 a[194:195], v2 offset:18016
    s_waitcnt lgkmcnt(8)
    ds_read_b64_tr_b16 a[196:197], v2 offset:15488
    ds_read_b64_tr_b16 a[198:199], v2 offset:18048
    s_waitcnt lgkmcnt(8)
    ds_read_b64_tr_b16 a[200:201], v2 offset:23040
    ds_read_b64_tr_b16 a[202:203], v2 offset:25600
    s_waitcnt lgkmcnt(8)
    ds_read_b64_tr_b16 a[204:205], v2 offset:23072
    ds_read_b64_tr_b16 a[206:207], v2 offset:25632
    s_waitcnt lgkmcnt(8)
    ds_read_b64_tr_b16 a[208:209], v2 offset:23104
    ds_read_b64_tr_b16 a[210:211], v2 offset:25664
    s_waitcnt lgkmcnt(8)
    ds_read_b64_tr_b16 a[212:213], v2 offset:23136
    ds_read_b64_tr_b16 a[214:215], v2 offset:25696
    s_waitcnt lgkmcnt(8)
    ds_read_b64_tr_b16 a[216:217], v2 offset:23168
    ds_read_b64_tr_b16 a[218:219], v2 offset:25728
    s_waitcnt lgkmcnt(8)
    ds_read_b64_tr_b16 a[220:221], v2 offset:20480
    ds_read_b64_tr_b16 a[222:223], v2 offset:28160
    s_waitcnt lgkmcnt(8)
    ds_read_b64_tr_b16 a[224:225], v2 offset:20512
    ds_read_b64_tr_b16 a[226:227], v2 offset:28192
    s_waitcnt lgkmcnt(8)
    ds_read_b64_tr_b16 a[228:229], v2 offset:20544
    ds_read_b64_tr_b16 a[230:231], v2 offset:28224
    s_waitcnt lgkmcnt(8)
    ds_read_b64_tr_b16 a[232:233], v2 offset:20576
    ds_read_b64_tr_b16 a[234:235], v2 offset:28256
    s_waitcnt lgkmcnt(8)
    ds_read_b64_tr_b16 a[236:237], v2 offset:20608
    ds_read_b64_tr_b16 a[238:239], v2 offset:28288
    s_waitcnt lgkmcnt(8)
    s_waitcnt lgkmcnt(0)
    s_mul_i32 s30, s25, 160
    v_add_u32 v12, s30, v1
    v_add_u32 v12, 0, v12
    v_lshrrev_b32 v13, 6, v12
    v_cmp_le_u32 vcc, 5, v13
    v_subrev_u32 v14, 5, v13
    v_and_b32 v15, 15, v12
    v_cndmask_b32 v13, v13, v14, vcc
    v_add_u32 v14, 16, v15
    v_cndmask_b32 v15, v15, v14, vcc
    v_mul_u32_u24 v4, 2560, v15
    v_lshl_add_u32 v4, v13, 5, v4
    v_bfe_u32 v13, v12, 4, 2
    v_lshl_add_u32 v4, v13, 3, v4
    v_add_u32 v12, s30, v1
    v_add_u32 v12, 64, v12
    v_lshrrev_b32 v13, 6, v12
    v_cmp_le_u32 vcc, 5, v13
    v_subrev_u32 v14, 5, v13
    v_and_b32 v15, 15, v12
    v_cndmask_b32 v13, v13, v14, vcc
    v_add_u32 v14, 16, v15
    v_cndmask_b32 v15, v15, v14, vcc
    v_mul_u32_u24 v5, 2560, v15
    v_lshl_add_u32 v5, v13, 5, v5
    v_bfe_u32 v13, v12, 4, 2
    v_lshl_add_u32 v5, v13, 3, v5
    v_add_u32 v12, s30, v1
    v_add_u32 v12, 128, v12
    v_lshrrev_b32 v13, 6, v12
    v_cmp_le_u32 vcc, 5, v13
    v_subrev_u32 v14, 5, v13
    v_and_b32 v15, 15, v12
    v_cndmask_b32 v13, v13, v14, vcc
    v_add_u32 v14, 16, v15
    v_cndmask_b32 v15, v15, v14, vcc
    v_mul_u32_u24 v6, 2560, v15
    v_lshl_add_u32 v6, v13, 5, v6
    v_bfe_u32 v13, v12, 4, 2
    v_lshl_add_u32 v6, v13, 3, v6
    v_mov_b32 v12, 2147483632
    v_cmp_gt_u32 vcc, 32, v1
    s_mul_i32 s30, s20, 1280
    s_mul_i32 s31, s22, 160
    v_cndmask_b32 v6, v12, v6, vcc
    v_cndmask_b32 v13, v12, v11, vcc
    v_mov_b32 v9, v13
    s_add_u32 s47, s30, s31
    s_mul_i32 s30, s25, 2560
    v_add_u32 v3, s30, v11
    s_mul_i32 s30, s25, 10240
    v_add_u32 v2, s30, v11
    s_mul_i32 s30, s20, 2048
    s_mul_i32 s31, s23, 32
    s_add_u32 s30, s30, s31
    s_add_u32 s30, s30, s26
    s_mul_i32 s44, s30, 12288
    s_lshl_b32 s30, s20, 6
    s_add_u32 s30, s30, s23
    s_lshl_b32 s30, s30, 3
    s_add_u32 s30, s30, s22
    s_mul_i32 s45, s30, 40960
    s_add_u32 s45, s45, 185286656
    s_mul_i32 s31, s25, 2560
    s_add_u32 s45, s45, s31
    s_lshl_b32 s30, s20, 3
    s_add_u32 s30, s30, s22
    s_lshl_b32 s30, s30, 9
    s_add_u32 s48, s30, 182484992
    s_lshl_b32 s31, s25, 2
    s_add_u32 s48, s48, s31
    s_lshl_b32 s31, s21, 7
    s_add_u32 s49, s48, s31
    s_lshl_b32 s30, s20, 5
    s_add_u32 s30, s30, s26
    s_lshl_b32 s30, s30, 7
    s_add_u32 s50, s30, 182476800
    v_and_b32 v12, 3, v1
    v_lshlrev_b32 v7, 2, v12
    v_bfe_u32 v12, v1, 2, 1
    v_lshl_add_u32 v7, v12, 7, v7
    v_min_u32 v8, 2, v1
    s_add_u32 s30, s21, 1
    v_add_u32 v8, s30, v8
    v_and_b32 v8, 3, v8
    v_lshlrev_b32 v8, 7, v8
    v_min_u32 v250, 23, v1
    v_lshlrev_b32 v250, 7, v250
    s_mul_i32 s30, s22, 3072
    v_add_u32 v250, s30, v250
    s_mov_b32 s53, 0
    s_mov_b32 s54, 0
    s_mov_b32 s59, s23
    s_mov_b32 s29, 0
    s_barrier
    s_mov_b32 s58, -1
    s_mov_b32 s56, s23
    s_mov_b32 s57, 0
OU_cold:
    s_add_u32 s39, s59, 1
    s_cmp_ge_u32 s53, s39
    s_cbranch_scc1 OU_cw_78
    buffer_load_dword v15, v7, s[16:19], s50 offen sc1
    s_waitcnt vmcnt(0)
    s_nop 1
    v_min_u32_dpp v15, v15, v15 row_shl:1 row_mask:0xf bank_mask:0xf
    s_nop 1
    v_min_u32_dpp v15, v15, v15 row_shl:2 row_mask:0xf bank_mask:0xf
    s_nop 1
    v_min_u32_dpp v15, v15, v15 row_shl:4 row_mask:0xf bank_mask:0xf
    s_nop 1
    v_readfirstlane_b32 s53, v15
    v_mov_b32 v14, s56
    v_mov_b32 v15, 0
    s_mov_b64 exec, 1
    buffer_store_dword v14, v15, s[16:19], s49 offen sc1
    s_mov_b64 exec, -1
OU_cw_78:
    s_add_u32 s39, s59, 1
    s_cmp_ge_u32 s53, s39
    s_cbranch_scc1 OU_wf_80
    v_min_u32 v14, 7, v1
    v_lshlrev_b32 v14, 2, v14
    v_mov_b32 v14, v7
OU_wf_79:
    buffer_load_dword v15, v14, s[16:19], s50 offen sc1
    s_sub_u32 s34, s34, 1
    s_cbranch_scc1 G_end
    s_waitcnt vmcnt(0)
    s_nop 1
    v_min_u32_dpp v15, v15, v15 row_shl:1 row_mask:0xf bank_mask:0xf
    s_nop 1
    v_min_u32_dpp v15, v15, v15 row_shl:2 row_mask:0xf bank_mask:0xf
    s_nop 1
    v_min_u32_dpp v15, v15, v15 row_shl:4 row_mask:0xf bank_mask:0xf
    s_nop 1
    v_readfirstlane_b32 s53, v15
    s_cmp_ge_u32 s53, s39
    s_cbranch_scc1 OU_wf_80
    s_sleep 4
    s_branch OU_wf_79
OU_wf_80:
    s_mov_b32 s30, s44
    buffer_load_dwordx4 v[128:131], v11, s[16:19], s30 offen offset:0
    buffer_load_dwordx4 v[132:135], v11, s[16:19], s30 offen offset:1024
    buffer_load_dwordx4 v[136:139], v11, s[16:19], s30 offen offset:2048
    buffer_load_dwordx4 v[140:143], v11, s[16:19], s30 offen offset:3072
    s_add_u32 s30, s30, 4096
    buffer_load_dwordx4 v[144:147], v11, s[16:19], s30 offen offset:0
    buffer_load_dwordx4 v[148:151], v11, s[16:19], s30 offen offset:1024
    buffer_load_dwordx4 v[152:155], v11, s[16:19], s30 offen offset:2048
    buffer_load_dwordx4 v[156:159], v11, s[16:19], s30 offen offset:3072
    s_add_u32 s30, s30, 4096
    buffer_load_dwordx4 v[160:163], v11, s[16:19], s30 offen offset:0
    buffer_load_dwordx4 v[164:167], v11, s[16:19], s30 offen offset:1024
    buffer_load_dwordx4 v[168:171], v11, s[16:19], s30 offen offset:2048
    buffer_load_dwordx4 v[172:175], v11, s[16:19], s30 offen offset:3072
    s_add_u32 s30, s30, 4096
    buffer_load_dwordx4 v[176:179], v11, s[16:19], s30 offen offset:0
    buffer_load_dwordx4 v[180:183], v11, s[16:19], s30 offen offset:1024
    buffer_load_dwordx4 v[184:187], v11, s[16:19], s30 offen offset:2048
    buffer_load_dwordx4 v[188:191], v11, s[16:19], s30 offen offset:3072
    s_add_u32 s30, s30, 4096
    buffer_load_dwordx4 v[192:195], v11, s[16:19], s30 offen offset:0
    buffer_load_dwordx4 v[196:199], v11, s[16:19], s30 offen offset:1024
    buffer_load_dwordx4 v[200:203], v11, s[16:19], s30 offen offset:2048
    buffer_load_dwordx4 v[204:207], v11, s[16:19], s30 offen offset:3072
    s_add_u32 s30, s30, 4096
    buffer_load_dwordx4 v[208:211], v11, s[16:19], s30 offen offset:0
    buffer_load_dwordx4 v[212:215], v11, s[16:19], s30 offen offset:1024
    buffer_load_dwordx4 v[216:219], v11, s[16:19], s30 offen offset:2048
    buffer_load_dwordx4 v[220:223], v11, s[16:19], s30 offen offset:3072
    s_waitcnt vmcnt(24)
    v_mov_b32 v14, s56
    v_mov_b32 v15, 0
    s_mov_b64 exec, 1
    buffer_store_dword v14, v15, s[16:19], s49 offen sc1
    s_mov_b64 exec, -1
    s_add_u32 s39, s59, 2
    s_cmp_gt_u32 s39, s24
    s_cbranch_scc1 OU_c0
    s_cmp_ge_u32 s53, s39
    s_cbranch_scc0 OU_c0
    s_add_u32 s30, s44, 393216
    s_waitcnt vmcnt(24)
    v_mfma_f32_16x16x32_bf16 v[16:19], a[0:3], v[128:131], 0
    v_mfma_f32_16x16x32_bf16 v[20:23], a[4:7], v[128:131], 0
    v_mfma_f32_16x16x32_bf16 v[24:27], a[8:11], v[128:131], 0
    v_mfma_f32_16x16x32_bf16 v[28:31], a[12:15], v[128:131], 0
    v_mfma_f32_16x16x32_bf16 v[32:35], a[16:19], v[128:131], 0
    buffer_load_dwordx4 v[128:131], v11, s[16:19], s30 offen offset:0
    s_waitcnt vmcnt(24)
    v_mfma_f32_16x16x32_bf16 v[16:19], a[20:23], v[132:135], v[16:19]
    v_mfma_f32_16x16x32_bf16 v[20:23], a[24:27], v[132:135], v[20:23]
    v_mfma_f32_16x16x32_bf16 v[24:27], a[28:31], v[132:135], v[24:27]
    v_mfma_f32_16x16x32_bf16 v[28:31], a[32:35], v[132:135], v[28:31]
    v_mfma_f32_16x16x32_bf16 v[32:35], a[36:39], v[132:135], v[32:35]
    buffer_load_dwordx4 v[132:135], v11, s[16:19], s30 offen offset:1024
    s_waitcnt vmcnt(24)
    v_mfma_f32_16x16x32_bf16 v[16:19], a[40:43], v[136:139], v[16:19]
    v_mfma_f32_16x16x32_bf16 v[20:23], a[44:47], v[136:139], v[20:23]
    v_mfma_f32_16x16x32_bf16 v[24:27], a[48:51], v[136:139], v[24:27]
    v_mfma_f32_16x16x32_bf16 v[28:31], a[52:55], v[136:139], v[28:31]
    v_mfma_f32_16x16x32_bf16 v[32:35], a[56:59], v[136:139], v[32:35]
    buffer_load_dwordx4 v[136:139], v11, s[16:19], s30 offen offset:2048
    s_waitcnt vmcnt(24)
    v_mfma_f32_16x16x32_bf16 v[16:19], a[60:63], v[140:143], v[16:19]
    v_mfma_f32_16x16x32_bf16 v[20:23], a[64:67], v[140:143], v[20:23]
    v_mfma_f32_16x16x32_bf16 v[24:27], a[68:71], v[140:143], v[24:27]
    v_mfma_f32_16x16x32_bf16 v[28:31], a[72:75], v[140:143], v[28:31]
    v_mfma_f32_16x16x32_bf16 v[32:35], a[76:79], v[140:143], v[32:35]
    buffer_load_dwordx4 v[140:143], v11, s[16:19], s30 offen offset:3072
    s_waitcnt vmcnt(24)
    v_mfma_f32_16x16x32_bf16 v[16:19], a[80:83], v[144:147], v[16:19]
    v_mfma_f32_16x16x32_bf16 v[20:23], a[84:87], v[144:147], v[20:23]
    v_mfma_f32_16x16x32_bf16 v[24:27], a[88:91], v[144:147], v[24:27]
    v_mfma_f32_16x16x32_bf16 v[28:31], a[92:95], v[144:147], v[28:31]
    v_mfma_f32_16x16x32_bf16 v[32:35], a[96:99], v[144:147], v[32:35]
    s_add_u32 s30, s30, 4096
    buffer_load_dwordx4 v[144:147], v11, s[16:19], s30 offen offset:0
    s_waitcnt vmcnt(24)
    v_mfma_f32_16x16x32_bf16 v[16:19], a[100:103], v[148:151], v[16:19]
    v_mfma_f32_16x16x32_bf16 v[20:23], a[104:107], v[148:151], v[20:23]
    v_mfma_f32_16x16x32_bf16 v[24:27], a[108:111], v[148:151], v[24:27]
    v_mfma_f32_16x16x32_bf16 v[28:31], a[112:115], v[148:151], v[28:31]
    v_mfma_f32_16x16x32_bf16 v[32:35], a[116:119], v[148:151], v[32:35]
    buffer_load_dwordx4 v[148:151], v11, s[16:19], s30 offen offset:1024
    s_waitcnt vmcnt(24)
    v_mfma_f32_16x16x32_bf16 v[36:39], a[0:3], v[152:155], 0
    v_mfma_f32_16x16x32_bf16 v[40:43], a[4:7], v[152:155], 0
    v_mfma_f32_16x16x32_bf16 v[44:47], a[8:11], v[152:155], 0
    v_mfma_f32_16x16x32_bf16 v[48:51], a[12:15], v[152:155], 0
    v_mfma_f32_16x16x32_bf16 v[52:55], a[16:19], v[152:155], 0
    buffer_load_dwordx4 v[152:155], v11, s[16:19], s30 offen offset:2048
    s_waitcnt vmcnt(24)
    v_mfma_f32_16x16x32_bf16 v[36:39], a[20:23], v[156:159], v[36:39]
    v_mfma_f32_16x16x32_bf16 v[40:43], a[24:27], v[156:159], v[40:43]
    v_mfma_f32_16x16x32_bf16 v[44:47], a[28:31], v[156:159], v[44:47]
    v_mfma_f32_16x16x32_bf16 v[48:51], a[32:35], v[156:159], v[48:51]
    v_mfma_f32_16x16x32_bf16 v[52:55], a[36:39], v[156:159], v[52:55]
    buffer_load_dwordx4 v[156:159], v11, s[16:19], s30 offen offset:3072
    s_waitcnt vmcnt(24)
    v_mfma_f32_16x16x32_bf16 v[36:39], a[40:43], v[160:163], v[36:39]
    v_mfma_f32_16x16x32_bf16 v[40:43], a[44:47], v[160:163], v[40:43]
    v_mfma_f32_16x16x32_bf16 v[44:47], a[48:51], v[160:163], v[44:47]
    v_mfma_f32_16x16x32_bf16 v[48:51], a[52:55], v[160:163], v[48:51]
    v_mfma_f32_16x16x32_bf16 v[52:55], a[56:59], v[160:163], v[52:55]
    s_add_u32 s30, s30, 4096
    buffer_load_dwordx4 v[160:163], v11, s[16:19], s30 offen offset:0
    s_waitcnt vmcnt(24)
    v_mfma_f32_16x16x32_bf16 v[36:39], a[60:63], v[164:167], v[36:39]
    v_mfma_f32_16x16x32_bf16 v[40:43], a[64:67], v[164:167], v[40:43]
    v_mfma_f32_16x16x32_bf16 v[44:47], a[68:71], v[164:167], v[44:47]
    v_mfma_f32_16x16x32_bf16 v[48:51], a[72:75], v[164:167], v[48:51]
    v_mfma_f32_16x16x32_bf16 v[52:55], a[76:79], v[164:167], v[52:55]
    buffer_load_dwordx4 v[164:167], v11, s[16:19], s30 offen offset:1024
    s_waitcnt vmcnt(24)
    v_mfma_f32_16x16x32_bf16 v[36:39], a[80:83], v[168:171], v[36:39]
    v_mfma_f32_16x16x32_bf16 v[40:43], a[84:87], v[168:171], v[40:43]
    v_mfma_f32_16x16x32_bf16 v[44:47], a[88:91], v[168:171], v[44:47]
    v_mfma_f32_16x16x32_bf16 v[48:51], a[92:95], v[168:171], v[48:51]
    v_mfma_f32_16x16x32_bf16 v[52:55], a[96:99], v[168:171], v[52:55]
    buffer_load_dwordx4 v[168:171], v11, s[16:19], s30 offen offset:2048
    s_waitcnt vmcnt(24)
    v_mfma_f32_16x16x32_bf16 v[36:39], a[100:103], v[172:175], v[36:39]
    v_mfma_f32_16x16x32_bf16 v[40:43], a[104:107], v[172:175], v[40:43]
    v_mfma_f32_16x16x32_bf16 v[44:47], a[108:111], v[172:175], v[44:47]
    v_mfma_f32_16x16x32_bf16 v[48:51], a[112:115], v[172:175], v[48:51]
    v_mfma_f32_16x16x32_bf16 v[52:55], a[116:119], v[172:175], v[52:55]
    buffer_load_dwordx4 v[172:175], v11, s[16:19], s30 offen offset:3072
    s_waitcnt vmcnt(24)
    v_mfma_f32_16x16x32_bf16 v[16:19], a[120:123], v[176:179], v[16:19]
    v_mfma_f32_16x16x32_bf16 v[20:23], a[124:127], v[176:179], v[20:23]
    v_mfma_f32_16x16x32_bf16 v[24:27], a[128:131], v[176:179], v[24:27]
    v_mfma_f32_16x16x32_bf16 v[28:31], a[132:135], v[176:179], v[28:31]
    v_mfma_f32_16x16x32_bf16 v[32:35], a[136:139], v[176:179], v[32:35]
    s_add_u32 s30, s30, 4096
    buffer_load_dwordx4 v[176:179], v11, s[16:19], s30 offen offset:0
    s_waitcnt vmcnt(24)
    v_mfma_f32_16x16x32_bf16 v[16:19], a[140:143], v[180:183], v[16:19]
    v_mfma_f32_16x16x32_bf16 v[20:23], a[144:147], v[180:183], v[20:23]
    v_mfma_f32_16x16x32_bf16 v[24:27], a[148:151], v[180:183], v[24:27]
    v_mfma_f32_16x16x32_bf16 v[28:31], a[152:155], v[180:183], v[28:31]
    v_mfma_f32_16x16x32_bf16 v[32:35], a[156:159], v[180:183], v[32:35]
    buffer_load_dwordx4 v[180:183], v11, s[16:19], s30 offen offset:1024
    s_waitcnt vmcnt(24)
    v_mfma_f32_16x16x32_bf16 v[16:19], a[160:163], v[184:187], v[16:19]
    v_mfma_f32_16x16x32_bf16 v[20:23], a[164:167], v[184:187], v[20:23]
    v_mfma_f32_16x16x32_bf16 v[24:27], a[168:171], v[184:187], v[24:27]
    v_mfma_f32_16x16x32_bf16 v[28:31], a[172:175], v[184:187], v[28:31]
    v_mfma_f32_16x16x32_bf16 v[32:35], a[176:179], v[184:187], v[32:35]
    buffer_load_dwordx4 v[184:187], v11, s[16:19], s30 offen offset:2048
    s_waitcnt vmcnt(24)
    v_mfma_f32_16x16x32_bf16 v[16:19], a[180:183], v[188:191], v[16:19]
    v_mfma_f32_16x16x32_bf16 v[20:23], a[184:187], v[188:191], v[20:23]
    v_mfma_f32_16x16x32_bf16 v[24:27], a[188:191], v[188:191], v[24:27]
    v_mfma_f32_16x16x32_bf16 v[28:31], a[192:195], v[188:191], v[28:31]
    v_mfma_f32_16x16x32_bf16 v[32:35], a[196:199], v[188:191], v[32:35]
    buffer_load_dwordx4 v[188:191], v11, s[16:19], s30 offen offset:3072
    s_waitcnt vmcnt(24)
    v_mfma_f32_16x16x32_bf16 v[16:19], a[200:203], v[192:195], v[16:19]
    v_mfma_f32_16x16x32_bf16 v[20:23], a[204:207], v[192:195], v[20:23]
    v_mfma_f32_16x16x32_bf16 v[24:27], a[208:211], v[192:195], v[24:27]
    v_mfma_f32_16x16x32_bf16 v[28:31], a[212:215], v[192:195], v[28:31]
    v_mfma_f32_16x16x32_bf16 v[32:35], a[216:219], v[192:195], v[32:35]
    s_add_u32 s30, s30, 4096
    buffer_load_dwordx4 v[192:195], v11, s[16:19], s30 offen offset:0
    s_waitcnt vmcnt(24)
    v_mfma_f32_16x16x32_bf16 v[16:19], a[220:223], v[196:199], v[16:19]
    v_mfma_f32_16x16x32_bf16 v[20:23], a[224:227], v[196:199], v[20:23]
    v_mfma_f32_16x16x32_bf16 v[24:27], a[228:231], v[196:199], v[24:27]
    v_mfma_f32_16x16x32_bf16 v[28:31], a[232:235], v[196:199], v[28:31]
    v_mfma_f32_16x16x32_bf16 v[32:35], a[236:239], v[196:199], v[32:35]
    buffer_load_dwordx4 v[196:199], v11, s[16:19], s30 offen offset:1024
    s_waitcnt vmcnt(24)
    v_mfma_f32_16x16x32_bf16 v[36:39], a[120:123], v[200:203], v[36:39]
    v_mfma_f32_16x16x32_bf16 v[40:43], a[124:127], v[200:203], v[40:43]
    v_mfma_f32_16x16x32_bf16 v[44:47], a[128:131], v[200:203], v[44:47]
    v_mfma_f32_16x16x32_bf16 v[48:51], a[132:135], v[200:203], v[48:51]
    v_mfma_f32_16x16x32_bf16 v[52:55], a[136:139], v[200:203], v[52:55]
    buffer_load_dwordx4 v[200:203], v11, s[16:19], s30 offen offset:2048
    s_waitcnt vmcnt(24)
    v_mfma_f32_16x16x32_bf16 v[36:39], a[140:143], v[204:207], v[36:39]
    v_mfma_f32_16x16x32_bf16 v[40:43], a[144:147], v[204:207], v[40:43]
    v_mfma_f32_16x16x32_bf16 v[44:47], a[148:151], v[204:207], v[44:47]
    v_mfma_f32_16x16x32_bf16 v[48:51], a[152:155], v[204:207], v[48:51]
    v_mfma_f32_16x16x32_bf16 v[52:55], a[156:159], v[204:207], v[52:55]
    buffer_load_dwordx4 v[204:207], v11, s[16:19], s30 offen offset:3072
    s_waitcnt vmcnt(24)
    v_mfma_f32_16x16x32_bf16 v[36:39], a[160:163], v[208:211], v[36:39]
    v_mfma_f32_16x16x32_bf16 v[40:43], a[164:167], v[208:211], v[40:43]
    v_mfma_f32_16x16x32_bf16 v[44:47], a[168:171], v[208:211], v[44:47]
    v_mfma_f32_16x16x32_bf16 v[48:51], a[172:175], v[208:211], v[48:51]
    v_mfma_f32_16x16x32_bf16 v[52:55], a[176:179], v[208:211], v[52:55]
    s_add_u32 s30, s30, 4096
    buffer_load_dwordx4 v[208:211], v11, s[16:19], s30 offen offset:0
    s_waitcnt vmcnt(24)
    v_mfma_f32_16x16x32_bf16 v[36:39], a[180:183], v[212:215], v[36:39]
    v_mfma_f32_16x16x32_bf16 v[40:43], a[184:187], v[212:215], v[40:43]
    v_mfma_f32_16x16x32_bf16 v[44:47], a[188:191], v[212:215], v[44:47]
    v_mfma_f32_16x16x32_bf16 v[48:51], a[192:195], v[212:215], v[48:51]
    v_mfma_f32_16x16x32_bf16 v[52:55], a[196:199], v[212:215], v[52:55]
    buffer_load_dwordx4 v[212:215], v11, s[16:19], s30 offen offset:1024
    s_waitcnt vmcnt(24)
    v_mfma_f32_16x16x32_bf16 v[36:39], a[200:203], v[216:219], v[36:39]
    v_mfma_f32_16x16x32_bf16 v[40:43], a[204:207], v[216:219], v[40:43]
    v_mfma_f32_16x16x32_bf16 v[44:47], a[208:211], v[216:219], v[44:47]
    v_mfma_f32_16x16x32_bf16 v[48:51], a[212:215], v[216:219], v[48:51]
    v_mfma_f32_16x16x32_bf16 v[52:55], a[216:219], v[216:219], v[52:55]
    buffer_load_dwordx4 v[216:219], v11, s[16:19], s30 offen offset:2048
    s_waitcnt vmcnt(24)
    v_mfma_f32_16x16x32_bf16 v[36:39], a[220:223], v[220:223], v[36:39]
    v_mfma_f32_16x16x32_bf16 v[40:43], a[224:227], v[220:223], v[40:43]
    v_mfma_f32_16x16x32_bf16 v[44:47], a[228:231], v[220:223], v[44:47]
    v_mfma_f32_16x16x32_bf16 v[48:51], a[232:235], v[220:223], v[48:51]
    v_mfma_f32_16x16x32_bf16 v[52:55], a[236:239], v[220:223], v[52:55]
    buffer_load_dwordx4 v[220:223], v11, s[16:19], s30 offen offset:3072
    s_branch OU_adv
OU_c0:
    s_waitcnt vmcnt(24)
    v_mfma_f32_16x16x32_bf16 v[16:19], a[0:3], v[128:131], 0
    v_mfma_f32_16x16x32_bf16 v[20:23], a[4:7], v[128:131], 0
    v_mfma_f32_16x16x32_bf16 v[24:27], a[8:11], v[128:131], 0
    v_mfma_f32_16x16x32_bf16 v[28:31], a[12:15], v[128:131], 0
    v_mfma_f32_16x16x32_bf16 v[32:35], a[16:19], v[128:131], 0
    s_waitcnt vmcnt(23)
    v_mfma_f32_16x16x32_bf16 v[16:19], a[20:23], v[132:135], v[16:19]
    v_mfma_f32_16x16x32_bf16 v[20:23], a[24:27], v[132:135], v[20:23]
    v_mfma_f32_16x16x32_bf16 v[24:27], a[28:31], v[132:135], v[24:27]
    v_mfma_f32_16x16x32_bf16 v[28:31], a[32:35], v[132:135], v[28:31]
    v_mfma_f32_16x16x32_bf16 v[32:35], a[36:39], v[132:135], v[32:35]
    s_waitcnt vmcnt(22)
    v_mfma_f32_16x16x32_bf16 v[16:19], a[40:43], v[136:139], v[16:19]
    v_mfma_f32_16x16x32_bf16 v[20:23], a[44:47], v[136:139], v[20:23]
    v_mfma_f32_16x16x32_bf16 v[24:27], a[48:51], v[136:139], v[24:27]
    v_mfma_f32_16x16x32_bf16 v[28:31], a[52:55], v[136:139], v[28:31]
    v_mfma_f32_16x16x32_bf16 v[32:35], a[56:59], v[136:139], v[32:35]
    s_waitcnt vmcnt(21)
    v_mfma_f32_16x16x32_bf16 v[16:19], a[60:63], v[140:143], v[16:19]
    v_mfma_f32_16x16x32_bf16 v[20:23], a[64:67], v[140:143], v[20:23]
    v_mfma_f32_16x16x32_bf16 v[24:27], a[68:71], v[140:143], v[24:27]
    v_mfma_f32_16x16x32_bf16 v[28:31], a[72:75], v[140:143], v[28:31]
    v_mfma_f32_16x16x32_bf16 v[32:35], a[76:79], v[140:143], v[32:35]
    s_waitcnt vmcnt(20)
    v_mfma_f32_16x16x32_bf16 v[16:19], a[80:83], v[144:147], v[16:19]
    v_mfma_f32_16x16x32_bf16 v[20:23], a[84:87], v[144:147], v[20:23]
    v_mfma_f32_16x16x32_bf16 v[24:27], a[88:91], v[144:147], v[24:27]
    v_mfma_f32_16x16x32_bf16 v[28:31], a[92:95], v[144:147], v[28:31]
    v_mfma_f32_16x16x32_bf16 v[32:35], a[96:99], v[144:147], v[32:35]
    s_waitcnt vmcnt(19)
    v_mfma_f32_16x16x32_bf16 v[16:19], a[100:103], v[148:151], v[16:19]
    v_mfma_f32_16x16x32_bf16 v[20:23], a[104:107], v[148:151], v[20:23]
    v_mfma_f32_16x16x32_bf16 v[24:27], a[108:111], v[148:151], v[24:27]
    v_mfma_f32_16x16x32_bf16 v[28:31], a[112:115], v[148:151], v[28:31]
    v_mfma_f32_16x16x32_bf16 v[32:35], a[116:119], v[148:151], v[32:35]
    s_waitcnt vmcnt(18)
    v_mfma_f32_16x16x32_bf16 v[36:39], a[0:3], v[152:155], 0
    v_mfma_f32_16x16x32_bf16 v[40:43], a[4:7], v[152:155], 0
    v_mfma_f32_16x16x32_bf16 v[44:47], a[8:11], v[152:155], 0
    v_mfma_f32_16x16x32_bf16 v[48:51], a[12:15], v[152:155], 0
    v_mfma_f32_16x16x32_bf16 v[52:55], a[16:19], v[152:155], 0
    s_waitcnt vmcnt(17)
    v_mfma_f32_16x16x32_bf16 v[36:39], a[20:23], v[156:159], v[36:39]
    v_mfma_f32_16x16x32_bf16 v[40:43], a[24:27], v[156:159], v[40:43]
    v_mfma_f32_16x16x32_bf16 v[44:47], a[28:31], v[156:159], v[44:47]
    v_mfma_f32_16x16x32_bf16 v[48:51], a[32:35], v[156:159], v[48:51]
    v_mfma_f32_16x16x32_bf16 v[52:55], a[36:39], v[156:159], v[52:55]
    s_waitcnt vmcnt(16)
    v_mfma_f32_16x16x32_bf16 v[36:39], a[40:43], v[160:163], v[36:39]
    v_mfma_f32_16x16x32_bf16 v[40:43], a[44:47], v[160:163], v[40:43]
    v_mfma_f32_16x16x32_bf16 v[44:47], a[48:51], v[160:163], v[44:47]
    v_mfma_f32_16x16x32_bf16 v[48:51], a[52:55], v[160:163], v[48:51]
    v_mfma_f32_16x16x32_bf16 v[52:55], a[56:59], v[160:163], v[52:55]
    s_waitcnt vmcnt(15)
    v_mfma_f32_16x16x32_bf16 v[36:39], a[60:63], v[164:167], v[36:39]
    v_mfma_f32_16x16x32_bf16 v[40:43], a[64:67], v[164:167], v[40:43]
    v_mfma_f32_16x16x32_bf16 v[44:47], a[68:71], v[164:167], v[44:47]
    v_mfma_f32_16x16x32_bf16 v[48:51], a[72:75], v[164:167], v[48:51]
    v_mfma_f32_16x16x32_bf16 v[52:55], a[76:79], v[164:167], v[52:55]
    s_waitcnt vmcnt(14)
    v_mfma_f32_16x16x32_bf16 v[36:39], a[80:83], v[168:171], v[36:39]
    v_mfma_f32_16x16x32_bf16 v[40:43], a[84:87], v[168:171], v[40:43]
    v_mfma_f32_16x16x32_bf16 v[44:47], a[88:91], v[168:171], v[44:47]
    v_mfma_f32_16x16x32_bf16 v[48:51], a[92:95], v[168:171], v[48:51]
    v_mfma_f32_16x16x32_bf16 v[52:55], a[96:99], v[168:171], v[52:55]
    s_waitcnt vmcnt(13)
    v_mfma_f32_16x16x32_bf16 v[36:39], a[100:103], v[172:175], v[36:39]
    v_mfma_f32_16x16x32_bf16 v[40:43], a[104:107], v[172:175], v[40:43]
    v_mfma_f32_16x16x32_bf16 v[44:47], a[108:111], v[172:175], v[44:47]
    v_mfma_f32_16x16x32_bf16 v[48:51], a[112:115], v[172:175], v[48:51]
    v_mfma_f32_16x16x32_bf16 v[52:55], a[116:119], v[172:175], v[52:55]
    s_waitcnt vmcnt(12)
    v_mfma_f32_16x16x32_bf16 v[16:19], a[120:123], v[176:179], v[16:19]
    v_mfma_f32_16x16x32_bf16 v[20:23], a[124:127], v[176:179], v[20:23]
    v_mfma_f32_16x16x32_bf16 v[24:27], a[128:131], v[176:179], v[24:27]
    v_mfma_f32_16x16x32_bf16 v[28:31], a[132:135], v[176:179], v[28:31]
    v_mfma_f32_16x16x32_bf16 v[32:35], a[136:139], v[176:179], v[32:35]
    s_waitcnt vmcnt(11)
    v_mfma_f32_16x16x32_bf16 v[16:19], a[140:143], v[180:183], v[16:19]
    v_mfma_f32_16x16x32_bf16 v[20:23], a[144:147], v[180:183], v[20:23]
    v_mfma_f32_16x16x32_bf16 v[24:27], a[148:151], v[180:183], v[24:27]
    v_mfma_f32_16x16x32_bf16 v[28:31], a[152:155], v[180:183], v[28:31]
    v_mfma_f32_16x16x32_bf16 v[32:35], a[156:159], v[180:183], v[32:35]
    s_waitcnt vmcnt(10)
    v_mfma_f32_16x16x32_bf16 v[16:19], a[160:163], v[184:187], v[16:19]
    v_mfma_f32_16x16x32_bf16 v[20:23], a[164:167], v[184:187], v[20:23]
    v_mfma_f32_16x16x32_bf16 v[24:27], a[168:171], v[184:187], v[24:27]
    v_mfma_f32_16x16x32_bf16 v[28:31], a[172:175], v[184:187], v[28:31]
    v_mfma_f32_16x16x32_bf16 v[32:35], a[176:179], v[184:187], v[32:35]
    s_waitcnt vmcnt(9)
    v_mfma_f32_16x16x32_bf16 v[16:19], a[180:183], v[188:191], v[16:19]
    v_mfma_f32_16x16x32_bf16 v[20:23], a[184:187], v[188:191], v[20:23]
    v_mfma_f32_16x16x32_bf16 v[24:27], a[188:191], v[188:191], v[24:27]
    v_mfma_f32_16x16x32_bf16 v[28:31], a[192:195], v[188:191], v[28:31]
    v_mfma_f32_16x16x32_bf16 v[32:35], a[196:199], v[188:191], v[32:35]
    s_waitcnt vmcnt(8)
    v_mfma_f32_16x16x32_bf16 v[16:19], a[200:203], v[192:195], v[16:19]
    v_mfma_f32_16x16x32_bf16 v[20:23], a[204:207], v[192:195], v[20:23]
    v_mfma_f32_16x16x32_bf16 v[24:27], a[208:211], v[192:195], v[24:27]
    v_mfma_f32_16x16x32_bf16 v[28:31], a[212:215], v[192:195], v[28:31]
    v_mfma_f32_16x16x32_bf16 v[32:35], a[216:219], v[192:195], v[32:35]
    s_waitcnt vmcnt(7)
    v_mfma_f32_16x16x32_bf16 v[16:19], a[220:223], v[196:199], v[16:19]
    v_mfma_f32_16x16x32_bf16 v[20:23], a[224:227], v[196:199], v[20:23]
    v_mfma_f32_16x16x32_bf16 v[24:27], a[228:231], v[196:199], v[24:27]
    v_mfma_f32_16x16x32_bf16 v[28:31], a[232:235], v[196:199], v[28:31]
    v_mfma_f32_16x16x32_bf16 v[32:35], a[236:239], v[196:199], v[32:35]
    s_waitcnt vmcnt(6)
    v_mfma_f32_16x16x32_bf16 v[36:39], a[120:123], v[200:203], v[36:39]
    v_mfma_f32_16x16x32_bf16 v[40:43], a[124:127], v[200:203], v[40:43]
    v_mfma_f32_16x16x32_bf16 v[44:47], a[128:131], v[200:203], v[44:47]
    v_mfma_f32_16x16x32_bf16 v[48:51], a[132:135], v[200:203], v[48:51]
    v_mfma_f32_16x16x32_bf16 v[52:55], a[136:139], v[200:203], v[52:55]
    s_waitcnt vmcnt(5)
    v_mfma_f32_16x16x32_bf16 v[36:39], a[140:143], v[204:207], v[36:39]
    v_mfma_f32_16x16x32_bf16 v[40:43], a[144:147], v[204:207], v[40:43]
    v_mfma_f32_16x16x32_bf16 v[44:47], a[148:151], v[204:207], v[44:47]
    v_mfma_f32_16x16x32_bf16 v[48:51], a[152:155], v[204:207], v[48:51]
    v_mfma_f32_16x16x32_bf16 v[52:55], a[156:159], v[204:207], v[52:55]
    s_waitcnt vmcnt(4)
    v_mfma_f32_16x16x32_bf16 v[36:39], a[160:163], v[208:211], v[36:39]
    v_mfma_f32_16x16x32_bf16 v[40:43], a[164:167], v[208:211], v[40:43]
    v_mfma_f32_16x16x32_bf16 v[44:47], a[168:171], v[208:211], v[44:47]
    v_mfma_f32_16x16x32_bf16 v[48:51], a[172:175], v[208:211], v[48:51]
    v_mfma_f32_16x16x32_bf16 v[52:55], a[176:179], v[208:211], v[52:55]
    s_waitcnt vmcnt(3)
    v_mfma_f32_16x16x32_bf16 v[36:39], a[180:183], v[212:215], v[36:39]
    v_mfma_f32_16x16x32_bf16 v[40:43], a[184:187], v[212:215], v[40:43]
    v_mfma_f32_16x16x32_bf16 v[44:47], a[188:191], v[212:215], v[44:47]
    v_mfma_f32_16x16x32_bf16 v[48:51], a[192:195], v[212:215], v[48:51]
    v_mfma_f32_16x16x32_bf16 v[52:55], a[196:199], v[212:215], v[52:55]
    s_waitcnt vmcnt(2)
    v_mfma_f32_16x16x32_bf16 v[36:39], a[200:203], v[216:219], v[36:39]
    v_mfma_f32_16x16x32_bf16 v[40:43], a[204:207], v[216:219], v[40:43]
    v_mfma_f32_16x16x32_bf16 v[44:47], a[208:211], v[216:219], v[44:47]
    v_mfma_f32_16x16x32_bf16 v[48:51], a[212:215], v[216:219], v[48:51]
    v_mfma_f32_16x16x32_bf16 v[52:55], a[216:219], v[216:219], v[52:55]
    s_waitcnt vmcnt(1)
    v_mfma_f32_16x16x32_bf16 v[36:39], a[220:223], v[220:223], v[36:39]
    v_mfma_f32_16x16x32_bf16 v[40:43], a[224:227], v[220:223], v[40:43]
    v_mfma_f32_16x16x32_bf16 v[44:47], a[228:231], v[220:223], v[44:47]
    v_mfma_f32_16x16x32_bf16 v[48:51], a[232:235], v[220:223], v[48:51]
    v_mfma_f32_16x16x32_bf16 v[52:55], a[236:239], v[220:223], v[52:55]
    s_branch OU_drain
OU_loop:
    s_add_u32 s39, s59, 2
    s_cmp_gt_u32 s39, s24
    s_cbranch_scc1 OU_nopf
    s_cmp_ge_u32 s53, s39
    s_cbranch_scc1 OU_pf
    buffer_load_dword v15, v7, s[16:19], s50 offen sc1
    s_waitcnt vmcnt(0)
    s_nop 1
    v_min_u32_dpp v15, v15, v15 row_shl:1 row_mask:0xf bank_mask:0xf
    s_nop 1
    v_min_u32_dpp v15, v15, v15 row_shl:2 row_mask:0xf bank_mask:0xf
    s_nop 1
    v_min_u32_dpp v15, v15, v15 row_shl:4 row_mask:0xf bank_mask:0xf
    s_nop 1
    v_readfirstlane_b32 s53, v15
    s_cmp_ge_u32 s53, s39
    s_cbranch_scc1 OU_pf
OU_nopf:
    v_add_u32 v12, s29, v2
    v_add_u32 v13, s29, v3
    s_xor_b32 s29, s29, 49152
    ds_write_b128 v12, v[16:19] offset:0
    ds_write_b128 v12, v[20:23] offset:1024
    ds_write_b128 v12, v[24:27] offset:2048
    ds_write_b128 v12, v[28:31] offset:3072
    ds_write_b128 v12, v[32:35] offset:4096
    s_waitcnt vmcnt(27)
    v_mfma_f32_16x16x32_bf16 v[16:19], a[0:3], v[128:131], 0
    ds_write_b128 v12, v[36:39] offset:5120
    v_mfma_f32_16x16x32_bf16 v[20:23], a[4:7], v[128:131], 0
    ds_write_b128 v12, v[40:43] offset:6144
    v_mfma_f32_16x16x32_bf16 v[24:27], a[8:11], v[128:131], 0
    ds_write_b128 v12, v[44:47] offset:7168
    v_mfma_f32_16x16x32_bf16 v[28:31], a[12:15], v[128:131], 0
    ds_write_b128 v12, v[48:51] offset:8192
    v_mfma_f32_16x16x32_bf16 v[32:35], a[16:19], v[128:131], 0
    s_waitcnt vmcnt(26)
    v_mfma_f32_16x16x32_bf16 v[16:19], a[20:23], v[132:135], v[16:19]
    ds_write_b128 v12, v[52:55] offset:9216
    v_mfma_f32_16x16x32_bf16 v[20:23], a[24:27], v[132:135], v[20:23]
    s_waitcnt lgkmcnt(0)
    s_barrier
    v_mfma_f32_16x16x32_bf16 v[24:27], a[28:31], v[132:135], v[24:27]
    ds_read_b128 v[56:59], v13 offset:0
    v_mfma_f32_16x16x32_bf16 v[28:31], a[32:35], v[132:135], v[28:31]
    ds_read_b128 v[60:63], v13 offset:1024
    v_mfma_f32_16x16x32_bf16 v[32:35], a[36:39], v[132:135], v[32:35]
    s_waitcnt vmcnt(25)
    v_mfma_f32_16x16x32_bf16 v[16:19], a[40:43], v[136:139], v[16:19]
    ds_read_b128 v[64:67], v13 offset:2048
    v_mfma_f32_16x16x32_bf16 v[20:23], a[44:47], v[136:139], v[20:23]
    ds_read_b128 v[68:71], v13 offset:10240
    v_mfma_f32_16x16x32_bf16 v[24:27], a[48:51], v[136:139], v[24:27]
    ds_read_b128 v[72:75], v13 offset:11264
    v_mfma_f32_16x16x32_bf16 v[28:31], a[52:55], v[136:139], v[28:31]
    ds_read_b128 v[76:79], v13 offset:12288
    v_mfma_f32_16x16x32_bf16 v[32:35], a[56:59], v[136:139], v[32:35]
    s_waitcnt vmcnt(24)
    v_mfma_f32_16x16x32_bf16 v[16:19], a[60:63], v[140:143], v[16:19]
    s_nop 0
    v_mfma_f32_16x16x32_bf16 v[20:23], a[64:67], v[140:143], v[20:23]
    s_nop 0
    v_mfma_f32_16x16x32_bf16 v[24:27], a[68:71], v[140:143], v[24:27]
    s_nop 0
    v_mfma_f32_16x16x32_bf16 v[28:31], a[72:75], v[140:143], v[28:31]
    s_waitcnt lgkmcnt(0)
    v_mfma_f32_16x16x32_bf16 v[32:35], a[76:79], v[140:143], v[32:35]
    s_waitcnt vmcnt(23)
    v_mfma_f32_16x16x32_bf16 v[16:19], a[80:83], v[144:147], v[16:19]
    v_add_f32 v224, v56, v68
    v_mfma_f32_16x16x32_bf16 v[20:23], a[84:87], v[144:147], v[20:23]
    v_add_f32 v225, v57, v69
    v_mfma_f32_16x16x32_bf16 v[24:27], a[88:91], v[144:147], v[24:27]
    v_add_f32 v226, v58, v70
    v_mfma_f32_16x16x32_bf16 v[28:31], a[92:95], v[144:147], v[28:31]
    v_add_f32 v227, v59, v71
    v_mfma_f32_16x16x32_bf16 v[32:35], a[96:99], v[144:147], v[32:35]
    s_waitcnt vmcnt(22)
    v_mfma_f32_16x16x32_bf16 v[16:19], a[100:103], v[148:151], v[16:19]
    v_add_f32 v228, v60, v72
    v_mfma_f32_16x16x32_bf16 v[20:23], a[104:107], v[148:151], v[20:23]
    v_add_f32 v229, v61, v73
    v_mfma_f32_16x16x32_bf16 v[24:27], a[108:111], v[148:151], v[24:27]
    v_add_f32 v230, v62, v74
    v_mfma_f32_16x16x32_bf16 v[28:31], a[112:115], v[148:151], v[28:31]
    v_add_f32 v231, v63, v75
    v_mfma_f32_16x16x32_bf16 v[32:35], a[116:119], v[148:151], v[32:35]
    s_waitcnt vmcnt(21)
    v_mfma_f32_16x16x32_bf16 v[36:39], a[0:3], v[152:155], 0
    v_add_f32 v232, v64, v76
    v_mfma_f32_16x16x32_bf16 v[40:43], a[4:7], v[152:155], 0
    v_add_f32 v233, v65, v77
    v_mfma_f32_16x16x32_bf16 v[44:47], a[8:11], v[152:155], 0
    v_add_f32 v234, v66, v78
    v_mfma_f32_16x16x32_bf16 v[48:51], a[12:15], v[152:155], 0
    v_add_f32 v235, v67, v79
    v_mfma_f32_16x16x32_bf16 v[52:55], a[16:19], v[152:155], 0
    s_waitcnt vmcnt(20)
    v_mfma_f32_16x16x32_bf16 v[36:39], a[20:23], v[156:159], v[36:39]
    ds_read_b128 v[56:59], v13 offset:20480
    v_mfma_f32_16x16x32_bf16 v[40:43], a[24:27], v[156:159], v[40:43]
    ds_read_b128 v[60:63], v13 offset:21504
    v_mfma_f32_16x16x32_bf16 v[44:47], a[28:31], v[156:159], v[44:47]
    ds_read_b128 v[64:67], v13 offset:22528
    v_mfma_f32_16x16x32_bf16 v[48:51], a[32:35], v[156:159], v[48:51]
    ds_read_b128 v[68:71], v13 offset:30720
    v_mfma_f32_16x16x32_bf16 v[52:55], a[36:39], v[156:159], v[52:55]
    s_waitcnt vmcnt(19)
    v_mfma_f32_16x16x32_bf16 v[36:39], a[40:43], v[160:163], v[36:39]
    ds_read_b128 v[72:75], v13 offset:31744
    v_mfma_f32_16x16x32_bf16 v[40:43], a[44:47], v[160:163], v[40:43]
    ds_read_b128 v[76:79], v13 offset:32768
    v_mfma_f32_16x16x32_bf16 v[44:47], a[48:51], v[160:163], v[44:47]
    s_nop 0
    v_mfma_f32_16x16x32_bf16 v[48:51], a[52:55], v[160:163], v[48:51]
    s_nop 0
    v_mfma_f32_16x16x32_bf16 v[52:55], a[56:59], v[160:163], v[52:55]
    s_waitcnt vmcnt(18)
    v_mfma_f32_16x16x32_bf16 v[36:39], a[60:63], v[164:167], v[36:39]
    s_nop 0
    v_mfma_f32_16x16x32_bf16 v[40:43], a[64:67], v[164:167], v[40:43]
    s_waitcnt lgkmcnt(0)
    v_mfma_f32_16x16x32_bf16 v[44:47], a[68:71], v[164:167], v[44:47]
    v_add_f32 v224, v224, v56
    v_mfma_f32_16x16x32_bf16 v[48:51], a[72:75], v[164:167], v[48:51]
    v_add_f32 v225, v225, v57
    v_mfma_f32_16x16x32_bf16 v[52:55], a[76:79], v[164:167], v[52:55]
    s_waitcnt vmcnt(17)
    v_mfma_f32_16x16x32_bf16 v[36:39], a[80:83], v[168:171], v[36:39]
    v_add_f32 v226, v226, v58
    v_mfma_f32_16x16x32_bf16 v[40:43], a[84:87], v[168:171], v[40:43]
    v_add_f32 v227, v227, v59
    v_mfma_f32_16x16x32_bf16 v[44:47], a[88:91], v[168:171], v[44:47]
    v_add_f32 v228, v228, v60
    v_mfma_f32_16x16x32_bf16 v[48:51], a[92:95], v[168:171], v[48:51]
    v_add_f32 v229, v229, v61
    v_mfma_f32_16x16x32_bf16 v[52:55], a[96:99], v[168:171], v[52:55]
    s_waitcnt vmcnt(16)
    v_mfma_f32_16x16x32_bf16 v[36:39], a[100:103], v[172:175], v[36:39]
    v_add_f32 v230, v230, v62
    v_mfma_f32_16x16x32_bf16 v[40:43], a[104:107], v[172:175], v[40:43]
    v_add_f32 v231, v231, v63
    v_mfma_f32_16x16x32_bf16 v[44:47], a[108:111], v[172:175], v[44:47]
    v_add_f32 v232, v232, v64
    v_mfma_f32_16x16x32_bf16 v[48:51], a[112:115], v[172:175], v[48:51]
    v_add_f32 v233, v233, v65
    v_mfma_f32_16x16x32_bf16 v[52:55], a[116:119], v[172:175], v[52:55]
    s_waitcnt vmcnt(15)
    v_mfma_f32_16x16x32_bf16 v[16:19], a[120:123], v[176:179], v[16:19]
    v_add_f32 v234, v234, v66
    v_mfma_f32_16x16x32_bf16 v[20:23], a[124:127], v[176:179], v[20:23]
    v_add_f32 v235, v235, v67
    v_mfma_f32_16x16x32_bf16 v[24:27], a[128:131], v[176:179], v[24:27]
    v_add_f32 v224, v224, v68
    v_mfma_f32_16x16x32_bf16 v[28:31], a[132:135], v[176:179], v[28:31]
    v_add_f32 v225, v225, v69
    v_mfma_f32_16x16x32_bf16 v[32:35], a[136:139], v[176:179], v[32:35]
    s_waitcnt vmcnt(14)
    v_mfma_f32_16x16x32_bf16 v[16:19], a[140:143], v[180:183], v[16:19]
    v_add_f32 v226, v226, v70
    v_mfma_f32_16x16x32_bf16 v[20:23], a[144:147], v[180:183], v[20:23]
    v_add_f32 v227, v227, v71
    v_mfma_f32_16x16x32_bf16 v[24:27], a[148:151], v[180:183], v[24:27]
    v_add_f32 v228, v228, v72
    v_mfma_f32_16x16x32_bf16 v[28:31], a[152:155], v[180:183], v[28:31]
    v_add_f32 v229, v229, v73
    v_mfma_f32_16x16x32_bf16 v[32:35], a[156:159], v[180:183], v[32:35]
    s_waitcnt vmcnt(13)
    v_mfma_f32_16x16x32_bf16 v[16:19], a[160:163], v[184:187], v[16:19]
    v_add_f32 v230, v230, v74
    v_mfma_f32_16x16x32_bf16 v[20:23], a[164:167], v[184:187], v[20:23]
    v_add_f32 v231, v231, v75
    v_mfma_f32_16x16x32_bf16 v[24:27], a[168:171], v[184:187], v[24:27]
    v_add_f32 v232, v232, v76
    v_mfma_f32_16x16x32_bf16 v[28:31], a[172:175], v[184:187], v[28:31]
    v_add_f32 v233, v233, v77
    v_mfma_f32_16x16x32_bf16 v[32:35], a[176:179], v[184:187], v[32:35]
    s_waitcnt vmcnt(12)
    v_mfma_f32_16x16x32_bf16 v[16:19], a[180:183], v[188:191], v[16:19]
    v_add_f32 v234, v234, v78
    v_mfma_f32_16x16x32_bf16 v[20:23], a[184:187], v[188:191], v[20:23]
    v_add_f32 v235, v235, v79
    v_mfma_f32_16x16x32_bf16 v[24:27], a[188:191], v[188:191], v[24:27]
    v_mfma_f32_16x16x32_bf16 v[28:31], a[192:195], v[188:191], v[28:31]
    v_mfma_f32_16x16x32_bf16 v[32:35], a[196:199], v[188:191], v[32:35]
    s_waitcnt vmcnt(11)
    v_mfma_f32_16x16x32_bf16 v[16:19], a[200:203], v[192:195], v[16:19]
    v_mfma_f32_16x16x32_bf16 v[20:23], a[204:207], v[192:195], v[20:23]
    v_mfma_f32_16x16x32_bf16 v[24:27], a[208:211], v[192:195], v[24:27]
    v_mfma_f32_16x16x32_bf16 v[28:31], a[212:215], v[192:195], v[28:31]
    v_mfma_f32_16x16x32_bf16 v[32:35], a[216:219], v[192:195], v[32:35]
    s_waitcnt vmcnt(10)
    v_mfma_f32_16x16x32_bf16 v[16:19], a[220:223], v[196:199], v[16:19]
    v_mfma_f32_16x16x32_bf16 v[20:23], a[224:227], v[196:199], v[20:23]
    v_mfma_f32_16x16x32_bf16 v[24:27], a[228:231], v[196:199], v[24:27]
    v_mfma_f32_16x16x32_bf16 v[28:31], a[232:235], v[196:199], v[28:31]
    v_mfma_f32_16x16x32_bf16 v[32:35], a[236:239], v[196:199], v[32:35]
    s_waitcnt vmcnt(9)
    v_mfma_f32_16x16x32_bf16 v[36:39], a[120:123], v[200:203], v[36:39]
    v_mfma_f32_16x16x32_bf16 v[40:43], a[124:127], v[200:203], v[40:43]
    v_mfma_f32_16x16x32_bf16 v[44:47], a[128:131], v[200:203], v[44:47]
    v_mfma_f32_16x16x32_bf16 v[48:51], a[132:135], v[200:203], v[48:51]
    v_mfma_f32_16x16x32_bf16 v[52:55], a[136:139], v[200:203], v[52:55]
    s_waitcnt vmcnt(8)
    v_mfma_f32_16x16x32_bf16 v[36:39], a[140:143], v[204:207], v[36:39]
    v_mfma_f32_16x16x32_bf16 v[40:43], a[144:147], v[204:207], v[40:43]
    v_mfma_f32_16x16x32_bf16 v[44:47], a[148:151], v[204:207], v[44:47]
    v_mfma_f32_16x16x32_bf16 v[48:51], a[152:155], v[204:207], v[48:51]
    v_mfma_f32_16x16x32_bf16 v[52:55], a[156:159], v[204:207], v[52:55]
    s_waitcnt vmcnt(7)
    v_mfma_f32_16x16x32_bf16 v[36:39], a[160:163], v[208:211], v[36:39]
    v_mfma_f32_16x16x32_bf16 v[40:43], a[164:167], v[208:211], v[40:43]
    v_mfma_f32_16x16x32_bf16 v[44:47], a[168:171], v[208:211], v[44:47]
    v_mfma_f32_16x16x32_bf16 v[48:51], a[172:175], v[208:211], v[48:51]
    v_mfma_f32_16x16x32_bf16 v[52:55], a[176:179], v[208:211], v[52:55]
    s_waitcnt vmcnt(6)
    v_mfma_f32_16x16x32_bf16 v[36:39], a[180:183], v[212:215], v[36:39]
    v_mfma_f32_16x16x32_bf16 v[40:43], a[184:187], v[212:215], v[40:43]
    v_mfma_f32_16x16x32_bf16 v[44:47], a[188:191], v[212:215], v[44:47]
    v_mfma_f32_16x16x32_bf16 v[48:51], a[192:195], v[212:215], v[48:51]
    v_mfma_f32_16x16x32_bf16 v[52:55], a[196:199], v[212:215], v[52:55]
    s_waitcnt vmcnt(5)
    v_mfma_f32_16x16x32_bf16 v[36:39], a[200:203], v[216:219], v[36:39]
    v_mfma_f32_16x16x32_bf16 v[40:43], a[204:207], v[216:219], v[40:43]
    v_mfma_f32_16x16x32_bf16 v[44:47], a[208:211], v[216:219], v[44:47]
    v_mfma_f32_16x16x32_bf16 v[48:51], a[212:215], v[216:219], v[48:51]
    v_mfma_f32_16x16x32_bf16 v[52:55], a[216:219], v[216:219], v[52:55]
    s_waitcnt vmcnt(4)
    v_mfma_f32_16x16x32_bf16 v[36:39], a[220:223], v[220:223], v[36:39]
    v_mfma_f32_16x16x32_bf16 v[40:43], a[224:227], v[220:223], v[40:43]
    v_mfma_f32_16x16x32_bf16 v[44:47], a[228:231], v[220:223], v[44:47]
    v_mfma_f32_16x16x32_bf16 v[48:51], a[232:235], v[220:223], v[48:51]
    v_mfma_f32_16x16x32_bf16 v[52:55], a[236:239], v[220:223], v[52:55]
    s_cmp_eq_u32 s57, 0
    s_cbranch_scc1 OU_p0_s_84
    s_waitcnt vmcnt(0)
    s_mul_i32 s30, s58, 81920
    s_add_u32 s30, s30, s47
    v_pk_add_f32 v[104:105], v[104:105], v[80:81]
    v_pk_add_f32 v[106:107], v[106:107], v[82:83]
    v_pk_add_f32 v[108:109], v[108:109], v[84:85]
    v_pk_add_f32 v[110:111], v[110:111], v[86:87]
    v_pk_add_f32 v[112:113], v[112:113], v[88:89]
    v_pk_add_f32 v[114:115], v[114:115], v[90:91]
    v_pk_add_f32 v[104:105], v[104:105], v[92:93]
    v_pk_add_f32 v[106:107], v[106:107], v[94:95]
    v_pk_add_f32 v[108:109], v[108:109], v[96:97]
    v_pk_add_f32 v[110:111], v[110:111], v[98:99]
    v_pk_add_f32 v[112:113], v[112:113], v[100:101]
    v_pk_add_f32 v[114:115], v[114:115], v[102:103]
    v_pk_add_f32 v[104:105], v[104:105], v[116:117]
    v_pk_add_f32 v[106:107], v[106:107], v[118:119]
    v_pk_add_f32 v[108:109], v[108:109], v[120:121]
    v_pk_add_f32 v[110:111], v[110:111], v[122:123]
    v_pk_add_f32 v[112:113], v[112:113], v[124:125]
    v_pk_add_f32 v[114:115], v[114:115], v[126:127]
    v_cvt_pk_bf16_f32 v104, v104, v105
    v_cvt_pk_bf16_f32 v105, v106, v107
    buffer_store_dwordx2 v[104:105], v4, s[8:11], s30 offen
    v_cvt_pk_bf16_f32 v108, v108, v109
    v_cvt_pk_bf16_f32 v109, v110, v111
    buffer_store_dwordx2 v[108:109], v5, s[8:11], s30 offen
    v_cvt_pk_bf16_f32 v112, v112, v113
    v_cvt_pk_bf16_f32 v113, v114, v115
    buffer_store_dwordx2 v[112:113], v6, s[8:11], s30 offen
    s_mov_b32 s58, -1
    s_mov_b32 s57, 0
OU_p0_s_84:
    s_and_b32 s30, s56, 3
    s_cmp_eq_u32 s30, s21
    s_cbranch_scc1 OU_p0_k_81
    s_cmp_eq_u32 s58, -1
    s_cbranch_scc1 OU_p0_q_83
    s_add_u32 s30, s58, 2
    s_cmp_gt_u32 s30, s56
    s_cbranch_scc1 OU_p0_q_83
    s_add_u32 s39, s58, 1
    s_cmp_ge_u32 s54, s39
    s_cbranch_scc1 OU_p0_f_wf_86
    v_min_u32 v14, 3, v1
    v_lshlrev_b32 v14, 2, v14
    v_mov_b32 v14, v8
OU_p0_f_wf_85:
    buffer_load_dword v15, v14, s[16:19], s48 offen sc1
    s_sub_u32 s34, s34, 1
    s_cbranch_scc1 G_end
    s_waitcnt vmcnt(0)
    s_nop 1
    v_min_u32_dpp v15, v15, v15 row_shl:1 row_mask:0xf bank_mask:0xf
    s_nop 1
    v_min_u32_dpp v15, v15, v15 row_shl:2 row_mask:0xf bank_mask:0xf
    s_nop 1
    v_readfirstlane_b32 s54, v15
    s_cmp_ge_u32 s54, s39
    s_cbranch_scc1 OU_p0_f_wf_86
    s_sleep 4
    s_branch OU_p0_f_wf_85
OU_p0_f_wf_86:
    s_add_u32 s30, s21, 1
    s_and_b32 s30, s30, 3
    s_mul_i32 s30, s30, 10240
    s_add_u32 s30, s30, s46
    buffer_load_dwordx4 v[80:83], v11, s[16:19], s30 offen sc1
    buffer_load_dwordx4 v[84:87], v11, s[16:19], s30 offen offset:1024 sc1
    buffer_load_dwordx4 v[88:91], v9, s[16:19], s30 offen offset:2048 sc1
    s_add_u32 s30, s21, 2
    s_and_b32 s30, s30, 3
    s_mul_i32 s30, s30, 10240
    s_add_u32 s30, s30, s46
    buffer_load_dwordx4 v[92:95], v11, s[16:19], s30 offen sc1
    buffer_load_dwordx4 v[96:99], v11, s[16:19], s30 offen offset:1024 sc1
    buffer_load_dwordx4 v[100:103], v9, s[16:19], s30 offen offset:2048 sc1
    s_add_u32 s30, s21, 3
    s_and_b32 s30, s30, 3
    s_mul_i32 s30, s30, 10240
    s_add_u32 s30, s30, s46
    buffer_load_dwordx4 v[116:119], v11, s[16:19], s30 offen sc1
    buffer_load_dwordx4 v[120:123], v11, s[16:19], s30 offen offset:1024 sc1
    buffer_load_dwordx4 v[124:127], v9, s[16:19], s30 offen offset:2048 sc1
    s_mov_b32 s57, 1
OU_p0_q_83:
    s_mul_i32 s30, s21, 10240
    s_add_u32 s30, s30, s45
    buffer_store_dwordx4 v[224:227], v11, s[16:19], s30 offen sc1
    buffer_store_dwordx4 v[228:231], v11, s[16:19], s30 offen offset:1024 sc1
    buffer_store_dwordx4 v[232:235], v9, s[16:19], s30 offen offset:2048 sc1
    s_branch OU_p0_n_82
OU_p0_k_81:
    v_mov_b32 v104, v224
    v_mov_b32 v105, v225
    v_mov_b32 v106, v226
    v_mov_b32 v107, v227
    v_mov_b32 v108, v228
    v_mov_b32 v109, v229
    v_mov_b32 v110, v230
    v_mov_b32 v111, v231
    v_mov_b32 v112, v232
    v_mov_b32 v113, v233
    v_mov_b32 v114, v234
    v_mov_b32 v115, v235
    s_mov_b32 s58, s56
    s_mov_b32 s46, s45
    buffer_load_dword v10, v7, s[16:19], s50 offen sc1
    buffer_load_dword v10, v7, s[16:19], s50 offen sc1
    buffer_load_dword v10, v7, s[16:19], s50 offen sc1
OU_p0_n_82:
    s_add_u32 s56, s56, 1
    s_add_u32 s45, s45, 327680
    s_branch OU_drain
OU_pf:
    s_add_u32 s30, s44, 393216
    v_add_u32 v12, s29, v2
    v_add_u32 v13, s29, v3
    s_xor_b32 s29, s29, 49152
    ds_write_b128 v12, v[16:19] offset:0
    ds_write_b128 v12, v[20:23] offset:1024
    ds_write_b128 v12, v[24:27] offset:2048
    ds_write_b128 v12, v[28:31] offset:3072
    ds_write_b128 v12, v[32:35] offset:4096
    s_waitcnt vmcnt(27)
    v_mfma_f32_16x16x32_bf16 v[16:19], a[0:3], v[128:131], 0
    ds_write_b128 v12, v[36:39] offset:5120
    v_mfma_f32_16x16x32_bf16 v[20:23], a[4:7], v[128:131], 0
    ds_write_b128 v12, v[40:43] offset:6144
    v_mfma_f32_16x16x32_bf16 v[24:27], a[8:11], v[128:131], 0
    ds_write_b128 v12, v[44:47] offset:7168
    v_mfma_f32_16x16x32_bf16 v[28:31], a[12:15], v[128:131], 0
    ds_write_b128 v12, v[48:51] offset:8192
    v_mfma_f32_16x16x32_bf16 v[32:35], a[16:19], v[128:131], 0
    buffer_load_dwordx4 v[128:131], v11, s[16:19], s30 offen offset:0
    s_waitcnt vmcnt(27)
    v_mfma_f32_16x16x32_bf16 v[16:19], a[20:23], v[132:135], v[16:19]
    ds_write_b128 v12, v[52:55] offset:9216
    v_mfma_f32_16x16x32_bf16 v[20:23], a[24:27], v[132:135], v[20:23]
    s_waitcnt lgkmcnt(0)
    s_barrier
    v_mfma_f32_16x16x32_bf16 v[24:27], a[28:31], v[132:135], v[24:27]
    ds_read_b128 v[56:59], v13 offset:0
    v_mfma_f32_16x16x32_bf16 v[28:31], a[32:35], v[132:135], v[28:31]
    ds_read_b128 v[60:63], v13 offset:1024
    v_mfma_f32_16x16x32_bf16 v[32:35], a[36:39], v[132:135], v[32:35]
    buffer_load_dwordx4 v[132:135], v11, s[16:19], s30 offen offset:1024
    s_waitcnt vmcnt(27)
    v_mfma_f32_16x16x32_bf16 v[16:19], a[40:43], v[136:139], v[16:19]
    ds_read_b128 v[64:67], v13 offset:2048
    v_mfma_f32_16x16x32_bf16 v[20:23], a[44:47], v[136:139], v[20:23]
    ds_read_b128 v[68:71], v13 offset:10240
    v_mfma_f32_16x16x32_bf16 v[24:27], a[48:51], v[136:139], v[24:27]
    ds_read_b128 v[72:75], v13 offset:11264
    v_mfma_f32_16x16x32_bf16 v[28:31], a[52:55], v[136:139], v[28:31]
    ds_read_b128 v[76:79], v13 offset:12288
    v_mfma_f32_16x16x32_bf16 v[32:35], a[56:59], v[136:139], v[32:35]
    buffer_load_dwordx4 v[136:139], v11, s[16:19], s30 offen offset:2048
    s_waitcnt vmcnt(27)
    v_mfma_f32_16x16x32_bf16 v[16:19], a[60:63], v[140:143], v[16:19]
    s_nop 0
    v_mfma_f32_16x16x32_bf16 v[20:23], a[64:67], v[140:143], v[20:23]
    s_nop 0
    v_mfma_f32_16x16x32_bf16 v[24:27], a[68:71], v[140:143], v[24:27]
    s_nop 0
    v_mfma_f32_16x16x32_bf16 v[28:31], a[72:75], v[140:143], v[28:31]
    s_waitcnt lgkmcnt(0)
    v_mfma_f32_16x16x32_bf16 v[32:35], a[76:79], v[140:143], v[32:35]
    buffer_load_dwordx4 v[140:143], v11, s[16:19], s30 offen offset:3072
    s_waitcnt vmcnt(27)
    v_mfma_f32_16x16x32_bf16 v[16:19], a[80:83], v[144:147], v[16:19]
    v_add_f32 v224, v56, v68
    v_mfma_f32_16x16x32_bf16 v[20:23], a[84:87], v[144:147], v[20:23]
    v_add_f32 v225, v57, v69
    v_mfma_f32_16x16x32_bf16 v[24:27], a[88:91], v[144:147], v[24:27]
    v_add_f32 v226, v58, v70
    v_mfma_f32_16x16x32_bf16 v[28:31], a[92:95], v[144:147], v[28:31]
    v_add_f32 v227, v59, v71
    v_mfma_f32_16x16x32_bf16 v[32:35], a[96:99], v[144:147], v[32:35]
    s_add_u32 s30, s30, 4096
    buffer_load_dwordx4 v[144:147], v11, s[16:19], s30 offen offset:0
    s_waitcnt vmcnt(27)
    v_mfma_f32_16x16x32_bf16 v[16:19], a[100:103], v[148:151], v[16:19]
    v_add_f32 v228, v60, v72
    v_mfma_f32_16x16x32_bf16 v[20:23], a[104:107], v[148:151], v[20:23]
    v_add_f32 v229, v61, v73
    v_mfma_f32_16x16x32_bf16 v[24:27], a[108:111], v[148:151], v[24:27]
    v_add_f32 v230, v62, v74
    v_mfma_f32_16x16x32_bf16 v[28:31], a[112:115], v[148:151], v[28:31]
    v_add_f32 v231, v63, v75
    v_mfma_f32_16x16x32_bf16 v[32:35], a[116:119], v[148:151], v[32:35]
    buffer_load_dwordx4 v[148:151], v11, s[16:19], s30 offen offset:1024
    s_waitcnt vmcnt(27)
    v_mfma_f32_16x16x32_bf16 v[36:39], a[0:3], v[152:155], 0
    v_add_f32 v232, v64, v76
    v_mfma_f32_16x16x32_bf16 v[40:43], a[4:7], v[152:155], 0
    v_add_f32 v233, v65, v77
    v_mfma_f32_16x16x32_bf16 v[44:47], a[8:11], v[152:155], 0
    v_add_f32 v234, v66, v78
    v_mfma_f32_16x16x32_bf16 v[48:51], a[12:15], v[152:155], 0
    v_add_f32 v235, v67, v79
    v_mfma_f32_16x16x32_bf16 v[52:55], a[16:19], v[152:155], 0
    buffer_load_dwordx4 v[152:155], v11, s[16:19], s30 offen offset:2048
    s_waitcnt vmcnt(27)
    v_mfma_f32_16x16x32_bf16 v[36:39], a[20:23], v[156:159], v[36:39]
    ds_read_b128 v[56:59], v13 offset:20480
    v_mfma_f32_16x16x32_bf16 v[40:43], a[24:27], v[156:159], v[40:43]
    ds_read_b128 v[60:63], v13 offset:21504
    v_mfma_f32_16x16x32_bf16 v[44:47], a[28:31], v[156:159], v[44:47]
    ds_read_b128 v[64:67], v13 offset:22528
    v_mfma_f32_16x16x32_bf16 v[48:51], a[32:35], v[156:159], v[48:51]
    ds_read_b128 v[68:71], v13 offset:30720
    v_mfma_f32_16x16x32_bf16 v[52:55], a[36:39], v[156:159], v[52:55]
    buffer_load_dwordx4 v[156:159], v11, s[16:19], s30 offen offset:3072
    s_waitcnt vmcnt(27)
    v_mfma_f32_16x16x32_bf16 v[36:39], a[40:43], v[160:163], v[36:39]
    ds_read_b128 v[72:75], v13 offset:31744
    v_mfma_f32_16x16x32_bf16 v[40:43], a[44:47], v[160:163], v[40:43]
    ds_read_b128 v[76:79], v13 offset:32768
    v_mfma_f32_16x16x32_bf16 v[44:47], a[48:51], v[160:163], v[44:47]
    s_nop 0
    v_mfma_f32_16x16x32_bf16 v[48:51], a[52:55], v[160:163], v[48:51]
    s_nop 0
    v_mfma_f32_16x16x32_bf16 v[52:55], a[56:59], v[160:163], v[52:55]
    s_add_u32 s30, s30, 4096
    buffer_load_dwordx4 v[160:163], v11, s[16:19], s30 offen offset:0
    s_waitcnt vmcnt(27)
    v_mfma_f32_16x16x32_bf16 v[36:39], a[60:63], v[164:167], v[36:39]
    s_nop 0
    v_mfma_f32_16x16x32_bf16 v[40:43], a[64:67], v[164:167], v[40:43]
    s_waitcnt lgkmcnt(0)
    v_mfma_f32_16x16x32_bf16 v[44:47], a[68:71], v[164:167], v[44:47]
    v_add_f32 v224, v224, v56
    v_mfma_f32_16x16x32_bf16 v[48:51], a[72:75], v[164:167], v[48:51]
    v_add_f32 v225, v225, v57
    v_mfma_f32_16x16x32_bf16 v[52:55], a[76:79], v[164:167], v[52:55]
    buffer_load_dwordx4 v[164:167], v11, s[16:19], s30 offen offset:1024
    s_waitcnt vmcnt(27)
    v_mfma_f32_16x16x32_bf16 v[36:39], a[80:83], v[168:171], v[36:39]
    v_add_f32 v226, v226, v58
    v_mfma_f32_16x16x32_bf16 v[40:43], a[84:87], v[168:171], v[40:43]
    v_add_f32 v227, v227, v59
    v_mfma_f32_16x16x32_bf16 v[44:47], a[88:91], v[168:171], v[44:47]
    v_add_f32 v228, v228, v60
    v_mfma_f32_16x16x32_bf16 v[48:51], a[92:95], v[168:171], v[48:51]
    v_add_f32 v229, v229, v61
    v_mfma_f32_16x16x32_bf16 v[52:55], a[96:99], v[168:171], v[52:55]
    buffer_load_dwordx4 v[168:171], v11, s[16:19], s30 offen offset:2048
    s_waitcnt vmcnt(27)
    v_mfma_f32_16x16x32_bf16 v[36:39], a[100:103], v[172:175], v[36:39]
    v_add_f32 v230, v230, v62
    v_mfma_f32_16x16x32_bf16 v[40:43], a[104:107], v[172:175], v[40:43]
    v_add_f32 v231, v231, v63
    v_mfma_f32_16x16x32_bf16 v[44:47], a[108:111], v[172:175], v[44:47]
    v_add_f32 v232, v232, v64
    v_mfma_f32_16x16x32_bf16 v[48:51], a[112:115], v[172:175], v[48:51]
    v_add_f32 v233, v233, v65
    v_mfma_f32_16x16x32_bf16 v[52:55], a[116:119], v[172:175], v[52:55]
    buffer_load_dwordx4 v[172:175], v11, s[16:19], s30 offen offset:3072
    s_waitcnt vmcnt(27)
    v_mfma_f32_16x16x32_bf16 v[16:19], a[120:123], v[176:179], v[16:19]
    v_add_f32 v234, v234, v66
    v_mfma_f32_16x16x32_bf16 v[20:23], a[124:127], v[176:179], v[20:23]
    v_add_f32 v235, v235, v67
    v_mfma_f32_16x16x32_bf16 v[24:27], a[128:131], v[176:179], v[24:27]
    v_add_f32 v224, v224, v68
    v_mfma_f32_16x16x32_bf16 v[28:31], a[132:135], v[176:179], v[28:31]
    v_add_f32 v225, v225, v69
    v_mfma_f32_16x16x32_bf16 v[32:35], a[136:139], v[176:179], v[32:35]
    s_add_u32 s30, s30, 4096
    buffer_load_dwordx4 v[176:179], v11, s[16:19], s30 offen offset:0
    s_waitcnt vmcnt(27)
    v_mfma_f32_16x16x32_bf16 v[16:19], a[140:143], v[180:183], v[16:19]
    v_add_f32 v226, v226, v70
    v_mfma_f32_16x16x32_bf16 v[20:23], a[144:147], v[180:183], v[20:23]
    v_add_f32 v227, v227, v71
    v_mfma_f32_16x16x32_bf16 v[24:27], a[148:151], v[180:183], v[24:27]
    v_add_f32 v228, v228, v72
    v_mfma_f32_16x16x32_bf16 v[28:31], a[152:155], v[180:183], v[28:31]
    v_add_f32 v229, v229, v73
    v_mfma_f32_16x16x32_bf16 v[32:35], a[156:159], v[180:183], v[32:35]
    buffer_load_dwordx4 v[180:183], v11, s[16:19], s30 offen offset:1024
    s_waitcnt vmcnt(27)
    v_mfma_f32_16x16x32_bf16 v[16:19], a[160:163], v[184:187], v[16:19]
    v_add_f32 v230, v230, v74
    v_mfma_f32_16x16x32_bf16 v[20:23], a[164:167], v[184:187], v[20:23]
    v_add_f32 v231, v231, v75
    v_mfma_f32_16x16x32_bf16 v[24:27], a[168:171], v[184:187], v[24:27]
    v_add_f32 v232, v232, v76
    v_mfma_f32_16x16x32_bf16 v[28:31], a[172:175], v[184:187], v[28:31]
    v_add_f32 v233, v233, v77
    v_mfma_f32_16x16x32_bf16 v[32:35], a[176:179], v[184:187], v[32:35]
    buffer_load_dwordx4 v[184:187], v11, s[16:19], s30 offen offset:2048
    s_waitcnt vmcnt(27)
    v_mfma_f32_16x16x32_bf16 v[16:19], a[180:183], v[188:191], v[16:19]
    v_add_f32 v234, v234, v78
    v_mfma_f32_16x16x32_bf16 v[20:23], a[184:187], v[188:191], v[20:23]
    v_add_f32 v235, v235, v79
    v_mfma_f32_16x16x32_bf16 v[24:27], a[188:191], v[188:191], v[24:27]
    v_mfma_f32_16x16x32_bf16 v[28:31], a[192:195], v[188:191], v[28:31]
    v_mfma_f32_16x16x32_bf16 v[32:35], a[196:199], v[188:191], v[32:35]
    buffer_load_dwordx4 v[188:191], v11, s[16:19], s30 offen offset:3072
    s_waitcnt vmcnt(27)
    v_mfma_f32_16x16x32_bf16 v[16:19], a[200:203], v[192:195], v[16:19]
    buffer_load_dword v248, v7, s[16:19], s50 offen sc1
    v_mfma_f32_16x16x32_bf16 v[20:23], a[204:207], v[192:195], v[20:23]
    buffer_load_dword v249, v8, s[16:19], s48 offen sc1
    v_mfma_f32_16x16x32_bf16 v[24:27], a[208:211], v[192:195], v[24:27]
    v_mfma_f32_16x16x32_bf16 v[28:31], a[212:215], v[192:195], v[28:31]
    v_mfma_f32_16x16x32_bf16 v[32:35], a[216:219], v[192:195], v[32:35]
    s_add_u32 s30, s30, 4096
    buffer_load_dwordx4 v[192:195], v11, s[16:19], s30 offen offset:0
    s_waitcnt vmcnt(29)
    v_mfma_f32_16x16x32_bf16 v[16:19], a[220:223], v[196:199], v[16:19]
    v_mfma_f32_16x16x32_bf16 v[20:23], a[224:227], v[196:199], v[20:23]
    v_mfma_f32_16x16x32_bf16 v[24:27], a[228:231], v[196:199], v[24:27]
    v_mfma_f32_16x16x32_bf16 v[28:31], a[232:235], v[196:199], v[28:31]
    v_mfma_f32_16x16x32_bf16 v[32:35], a[236:239], v[196:199], v[32:35]
    buffer_load_dwordx4 v[196:199], v11, s[16:19], s30 offen offset:1024
    s_waitcnt vmcnt(29)
    v_mfma_f32_16x16x32_bf16 v[36:39], a[120:123], v[200:203], v[36:39]
    v_mfma_f32_16x16x32_bf16 v[40:43], a[124:127], v[200:203], v[40:43]
    v_mfma_f32_16x16x32_bf16 v[44:47], a[128:131], v[200:203], v[44:47]
    v_mfma_f32_16x16x32_bf16 v[48:51], a[132:135], v[200:203], v[48:51]
    v_mfma_f32_16x16x32_bf16 v[52:55], a[136:139], v[200:203], v[52:55]
    buffer_load_dwordx4 v[200:203], v11, s[16:19], s30 offen offset:2048
    s_waitcnt vmcnt(29)
    v_mfma_f32_16x16x32_bf16 v[36:39], a[140:143], v[204:207], v[36:39]
    v_mfma_f32_16x16x32_bf16 v[40:43], a[144:147], v[204:207], v[40:43]
    v_mfma_f32_16x16x32_bf16 v[44:47], a[148:151], v[204:207], v[44:47]
    v_mfma_f32_16x16x32_bf16 v[48:51], a[152:155], v[204:207], v[48:51]
    v_mfma_f32_16x16x32_bf16 v[52:55], a[156:159], v[204:207], v[52:55]
    buffer_load_dwordx4 v[204:207], v11, s[16:19], s30 offen offset:3072
    s_waitcnt vmcnt(29)
    v_mfma_f32_16x16x32_bf16 v[36:39], a[160:163], v[208:211], v[36:39]
    v_mfma_f32_16x16x32_bf16 v[40:43], a[164:167], v[208:211], v[40:43]
    v_mfma_f32_16x16x32_bf16 v[44:47], a[168:171], v[208:211], v[44:47]
    v_mfma_f32_16x16x32_bf16 v[48:51], a[172:175], v[208:211], v[48:51]
    v_mfma_f32_16x16x32_bf16 v[52:55], a[176:179], v[208:211], v[52:55]
    s_add_u32 s30, s30, 4096
    buffer_load_dwordx4 v[208:211], v11, s[16:19], s30 offen offset:0
    s_waitcnt vmcnt(29)
    v_mfma_f32_16x16x32_bf16 v[36:39], a[180:183], v[212:215], v[36:39]
    v_mfma_f32_16x16x32_bf16 v[40:43], a[184:187], v[212:215], v[40:43]
    v_mfma_f32_16x16x32_bf16 v[44:47], a[188:191], v[212:215], v[44:47]
    v_mfma_f32_16x16x32_bf16 v[48:51], a[192:195], v[212:215], v[48:51]
    v_mfma_f32_16x16x32_bf16 v[52:55], a[196:199], v[212:215], v[52:55]
    buffer_load_dwordx4 v[212:215], v11, s[16:19], s30 offen offset:1024
    s_waitcnt vmcnt(29)
    v_mfma_f32_16x16x32_bf16 v[36:39], a[200:203], v[216:219], v[36:39]
    v_mfma_f32_16x16x32_bf16 v[40:43], a[204:207], v[216:219], v[40:43]
    v_mfma_f32_16x16x32_bf16 v[44:47], a[208:211], v[216:219], v[44:47]
    v_mfma_f32_16x16x32_bf16 v[48:51], a[212:215], v[216:219], v[48:51]
    v_mfma_f32_16x16x32_bf16 v[52:55], a[216:219], v[216:219], v[52:55]
    buffer_load_dwordx4 v[216:219], v11, s[16:19], s30 offen offset:2048
    s_waitcnt vmcnt(29)
    v_mfma_f32_16x16x32_bf16 v[36:39], a[220:223], v[220:223], v[36:39]
    v_mfma_f32_16x16x32_bf16 v[40:43], a[224:227], v[220:223], v[40:43]
    v_mfma_f32_16x16x32_bf16 v[44:47], a[228:231], v[220:223], v[44:47]
    v_mfma_f32_16x16x32_bf16 v[48:51], a[232:235], v[220:223], v[48:51]
    v_mfma_f32_16x16x32_bf16 v[52:55], a[236:239], v[220:223], v[52:55]
    buffer_load_dwordx4 v[220:223], v11, s[16:19], s30 offen offset:3072
    s_waitcnt vmcnt(8)
    v_mov_b32 v14, s56
    v_mov_b32 v15, 0
    s_mov_b64 exec, 1
    buffer_store_dword v14, v15, s[16:19], s49 offen sc1
    s_mov_b64 exec, -1
    v_min_u32_dpp v248, v248, v248 row_shl:1 row_mask:0xf bank_mask:0xf
    v_min_u32_dpp v249, v249, v249 row_shl:1 row_mask:0xf bank_mask:0xf
    s_nop 0
    v_min_u32_dpp v248, v248, v248 row_shl:2 row_mask:0xf bank_mask:0xf
    v_min_u32_dpp v249, v249, v249 row_shl:2 row_mask:0xf bank_mask:0xf
    s_nop 0
    v_min_u32_dpp v248, v248, v248 row_shl:4 row_mask:0xf bank_mask:0xf
    s_nop 0
    v_readfirstlane_b32 s30, v248
    v_readfirstlane_b32 s31, v249
    s_max_u32 s53, s53, s30
    s_max_u32 s54, s54, s31
    s_cmp_eq_u32 s57, 0
    s_cbranch_scc1 OU_p1_s_90
    s_mul_i32 s30, s58, 81920
    s_add_u32 s30, s30, s47
    v_pk_add_f32 v[104:105], v[104:105], v[80:81]
    v_pk_add_f32 v[106:107], v[106:107], v[82:83]
    v_pk_add_f32 v[108:109], v[108:109], v[84:85]
    v_pk_add_f32 v[110:111], v[110:111], v[86:87]
    v_pk_add_f32 v[112:113], v[112:113], v[88:89]
    v_pk_add_f32 v[114:115], v[114:115], v[90:91]
    v_pk_add_f32 v[104:105], v[104:105], v[92:93]
    v_pk_add_f32 v[106:107], v[106:107], v[94:95]
    v_pk_add_f32 v[108:109], v[108:109], v[96:97]
    v_pk_add_f32 v[110:111], v[110:111], v[98:99]
    v_pk_add_f32 v[112:113], v[112:113], v[100:101]
    v_pk_add_f32 v[114:115], v[114:115], v[102:103]
    v_pk_add_f32 v[104:105], v[104:105], v[116:117]
    v_pk_add_f32 v[106:107], v[106:107], v[118:119]
    v_pk_add_f32 v[108:109], v[108:109], v[120:121]
    v_pk_add_f32 v[110:111], v[110:111], v[122:123]
    v_pk_add_f32 v[112:113], v[112:113], v[124:125]
    v_pk_add_f32 v[114:115], v[114:115], v[126:127]
    v_cvt_pk_bf16_f32 v104, v104, v105
    v_cvt_pk_bf16_f32 v105, v106, v107
    buffer_store_dwordx2 v[104:105], v4, s[8:11], s30 offen
    v_cvt_pk_bf16_f32 v108, v108, v109
    v_cvt_pk_bf16_f32 v109, v110, v111
    buffer_store_dwordx2 v[108:109], v5, s[8:11], s30 offen
    v_cvt_pk_bf16_f32 v112, v112, v113
    v_cvt_pk_bf16_f32 v113, v114, v115
    buffer_store_dwordx2 v[112:113], v6, s[8:11], s30 offen
    s_mov_b32 s58, -1
    s_mov_b32 s57, 0
OU_p1_s_90:
    s_and_b32 s30, s56, 3
    s_cmp_eq_u32 s30, s21
    s_cbranch_scc1 OU_p1_k_87
    s_cmp_eq_u32 s58, -1
    s_cbranch_scc1 OU_p1_q_89
    s_add_u32 s30, s58, 3
    s_cmp_gt_u32 s30, s56
    s_cbranch_scc1 OU_p1_q_89
    s_add_u32 s39, s58, 1
    s_cmp_ge_u32 s54, s39
    s_cbranch_scc1 OU_p1_f_wf_92
    v_min_u32 v14, 3, v1
    v_lshlrev_b32 v14, 2, v14
    v_mov_b32 v14, v8
OU_p1_f_wf_91:
    buffer_load_dword v15, v14, s[16:19], s48 offen sc1
    s_sub_u32 s34, s34, 1
    s_cbranch_scc1 G_end
    s_waitcnt vmcnt(0)
    s_nop 1
    v_min_u32_dpp v15, v15, v15 row_shl:1 row_mask:0xf bank_mask:0xf
    s_nop 1
    v_min_u32_dpp v15, v15, v15 row_shl:2 row_mask:0xf bank_mask:0xf
    s_nop 1
    v_readfirstlane_b32 s54, v15
    s_cmp_ge_u32 s54, s39
    s_cbranch_scc1 OU_p1_f_wf_92
    s_sleep 4
    s_branch OU_p1_f_wf_91
OU_p1_f_wf_92:
    s_add_u32 s30, s21, 1
    s_and_b32 s30, s30, 3
    s_mul_i32 s30, s30, 10240
    s_add_u32 s30, s30, s46
    buffer_load_dwordx4 v[80:83], v11, s[16:19], s30 offen sc1
    buffer_load_dwordx4 v[84:87], v11, s[16:19], s30 offen offset:1024 sc1
    buffer_load_dwordx4 v[88:91], v9, s[16:19], s30 offen offset:2048 sc1
    s_add_u32 s30, s21, 2
    s_and_b32 s30, s30, 3
    s_mul_i32 s30, s30, 10240
    s_add_u32 s30, s30, s46
    buffer_load_dwordx4 v[92:95], v11, s[16:19], s30 offen sc1
    buffer_load_dwordx4 v[96:99], v11, s[16:19], s30 offen offset:1024 sc1
    buffer_load_dwordx4 v[100:103], v9, s[16:19], s30 offen offset:2048 sc1
    s_add_u32 s30, s21, 3
    s_and_b32 s30, s30, 3
    s_mul_i32 s30, s30, 10240
    s_add_u32 s30, s30, s46
    buffer_load_dwordx4 v[116:119], v11, s[16:19], s30 offen sc1
    buffer_load_dwordx4 v[120:123], v11, s[16:19], s30 offen offset:1024 sc1
    buffer_load_dwordx4 v[124:127], v9, s[16:19], s30 offen offset:2048 sc1
    s_mov_b32 s57, 1
OU_p1_q_89:
    s_mul_i32 s30, s21, 10240
    s_add_u32 s30, s30, s45
    buffer_store_dwordx4 v[224:227], v11, s[16:19], s30 offen sc1
    buffer_store_dwordx4 v[228:231], v11, s[16:19], s30 offen offset:1024 sc1
    buffer_store_dwordx4 v[232:235], v9, s[16:19], s30 offen offset:2048 sc1
    s_branch OU_p1_n_88
OU_p1_k_87:
    v_mov_b32 v104, v224
    v_mov_b32 v105, v225
    v_mov_b32 v106, v226
    v_mov_b32 v107, v227
    v_mov_b32 v108, v228
    v_mov_b32 v109, v229
    v_mov_b32 v110, v230
    v_mov_b32 v111, v231
    v_mov_b32 v112, v232
    v_mov_b32 v113, v233
    v_mov_b32 v114, v234
    v_mov_b32 v115, v235
    s_mov_b32 s58, s56
    s_mov_b32 s46, s45
    buffer_load_dword v10, v7, s[16:19], s50 offen sc1
    buffer_load_dword v10, v7, s[16:19], s50 offen sc1
    buffer_load_dword v10, v7, s[16:19], s50 offen sc1
OU_p1_n_88:
    s_add_u32 s56, s56, 1
    s_add_u32 s45, s45, 327680
    s_add_u32 s59, s59, 1
    s_add_u32 s44, s44, 393216
    s_branch OU_loop
OU_adv:
    s_add_u32 s59, s59, 1
    s_add_u32 s44, s44, 393216
    s_waitcnt vmcnt(0)
    s_branch OU_loop
OU_drain:
    s_nop 5
    v_add_u32 v12, s29, v2
    v_add_u32 v13, s29, v3
    s_xor_b32 s29, s29, 49152
    ds_write_b128 v12, v[16:19] offset:0
    ds_write_b128 v12, v[20:23] offset:1024
    ds_write_b128 v12, v[24:27] offset:2048
    ds_write_b128 v12, v[28:31] offset:3072
    ds_write_b128 v12, v[32:35] offset:4096
    ds_write_b128 v12, v[36:39] offset:5120
    ds_write_b128 v12, v[40:43] offset:6144
    ds_write_b128 v12, v[44:47] offset:7168
    ds_write_b128 v12, v[48:51] offset:8192
    ds_write_b128 v12, v[52:55] offset:9216
    s_waitcnt lgkmcnt(0)
    s_barrier
    ds_read_b128 v[56:59], v13 offset:0
    ds_read_b128 v[60:63], v13 offset:1024
    ds_read_b128 v[64:67], v13 offset:2048
    ds_read_b128 v[68:71], v13 offset:10240
    ds_read_b128 v[72:75], v13 offset:11264
    ds_read_b128 v[76:79], v13 offset:12288
    s_nop 0
    s_nop 0
    s_nop 0
    s_waitcnt lgkmcnt(0)
    v_add_f32 v224, v56, v68
    v_add_f32 v225, v57, v69
    v_add_f32 v226, v58, v70
    v_add_f32 v227, v59, v71
    v_add_f32 v228, v60, v72
    v_add_f32 v229, v61, v73
    v_add_f32 v230, v62, v74
    v_add_f32 v231, v63, v75
    v_add_f32 v232, v64, v76
    v_add_f32 v233, v65, v77
    v_add_f32 v234, v66, v78
    v_add_f32 v235, v67, v79
    ds_read_b128 v[56:59], v13 offset:20480
    ds_read_b128 v[60:63], v13 offset:21504
    ds_read_b128 v[64:67], v13 offset:22528
    ds_read_b128 v[68:71], v13 offset:30720
    ds_read_b128 v[72:75], v13 offset:31744
    ds_read_b128 v[76:79], v13 offset:32768
    s_nop 0
    s_nop 0
    s_nop 0
    s_waitcnt lgkmcnt(0)
    v_add_f32 v224, v224, v56
    v_add_f32 v225, v225, v57
    v_add_f32 v226, v226, v58
    v_add_f32 v227, v227, v59
    v_add_f32 v228, v228, v60
    v_add_f32 v229, v229, v61
    v_add_f32 v230, v230, v62
    v_add_f32 v231, v231, v63
    v_add_f32 v232, v232, v64
    v_add_f32 v233, v233, v65
    v_add_f32 v234, v234, v66
    v_add_f32 v235, v235, v67
    v_add_f32 v224, v224, v68
    v_add_f32 v225, v225, v69
    v_add_f32 v226, v226, v70
    v_add_f32 v227, v227, v71
    v_add_f32 v228, v228, v72
    v_add_f32 v229, v229, v73
    v_add_f32 v230, v230, v74
    v_add_f32 v231, v231, v75
    v_add_f32 v232, v232, v76
    v_add_f32 v233, v233, v77
    v_add_f32 v234, v234, v78
    v_add_f32 v235, v235, v79
    s_cmp_eq_u32 s57, 0
    s_cbranch_scc1 OU_p2_s_96
    s_waitcnt vmcnt(0)
    s_mul_i32 s30, s58, 81920
    s_add_u32 s30, s30, s47
    v_pk_add_f32 v[104:105], v[104:105], v[80:81]
    v_pk_add_f32 v[106:107], v[106:107], v[82:83]
    v_pk_add_f32 v[108:109], v[108:109], v[84:85]
    v_pk_add_f32 v[110:111], v[110:111], v[86:87]
    v_pk_add_f32 v[112:113], v[112:113], v[88:89]
    v_pk_add_f32 v[114:115], v[114:115], v[90:91]
    v_pk_add_f32 v[104:105], v[104:105], v[92:93]
    v_pk_add_f32 v[106:107], v[106:107], v[94:95]
    v_pk_add_f32 v[108:109], v[108:109], v[96:97]
    v_pk_add_f32 v[110:111], v[110:111], v[98:99]
    v_pk_add_f32 v[112:113], v[112:113], v[100:101]
    v_pk_add_f32 v[114:115], v[114:115], v[102:103]
    v_pk_add_f32 v[104:105], v[104:105], v[116:117]
    v_pk_add_f32 v[106:107], v[106:107], v[118:119]
    v_pk_add_f32 v[108:109], v[108:109], v[120:121]
    v_pk_add_f32 v[110:111], v[110:111], v[122:123]
    v_pk_add_f32 v[112:113], v[112:113], v[124:125]
    v_pk_add_f32 v[114:115], v[114:115], v[126:127]
    v_cvt_pk_bf16_f32 v104, v104, v105
    v_cvt_pk_bf16_f32 v105, v106, v107
    buffer_store_dwordx2 v[104:105], v4, s[8:11], s30 offen
    v_cvt_pk_bf16_f32 v108, v108, v109
    v_cvt_pk_bf16_f32 v109, v110, v111
    buffer_store_dwordx2 v[108:109], v5, s[8:11], s30 offen
    v_cvt_pk_bf16_f32 v112, v112, v113
    v_cvt_pk_bf16_f32 v113, v114, v115
    buffer_store_dwordx2 v[112:113], v6, s[8:11], s30 offen
    s_mov_b32 s58, -1
    s_mov_b32 s57, 0
OU_p2_s_96:
    s_and_b32 s30, s56, 3
    s_cmp_eq_u32 s30, s21
    s_cbranch_scc1 OU_p2_k_93
    s_cmp_eq_u32 s58, -1
    s_cbranch_scc1 OU_p2_q_95
    s_add_u32 s30, s58, 2
    s_cmp_gt_u32 s30, s56
    s_cbranch_scc1 OU_p2_q_95
    s_add_u32 s39, s58, 1
    s_cmp_ge_u32 s54, s39
    s_cbranch_scc1 OU_p2_f_wf_98
    v_min_u32 v14, 3, v1
    v_lshlrev_b32 v14, 2, v14
    v_mov_b32 v14, v8
OU_p2_f_wf_97:
    buffer_load_dword v15, v14, s[16:19], s48 offen sc1
    s_sub_u32 s34, s34, 1
    s_cbranch_scc1 G_end
    s_waitcnt vmcnt(0)
    s_nop 1
    v_min_u32_dpp v15, v15, v15 row_shl:1 row_mask:0xf bank_mask:0xf
    s_nop 1
    v_min_u32_dpp v15, v15, v15 row_shl:2 row_mask:0xf bank_mask:0xf
    s_nop 1
    v_readfirstlane_b32 s54, v15
    s_cmp_ge_u32 s54, s39
    s_cbranch_scc1 OU_p2_f_wf_98
    s_sleep 4
    s_branch OU_p2_f_wf_97
OU_p2_f_wf_98:
    s_add_u32 s30, s21, 1
    s_and_b32 s30, s30, 3
    s_mul_i32 s30, s30, 10240
    s_add_u32 s30, s30, s46
    buffer_load_dwordx4 v[80:83], v11, s[16:19], s30 offen sc1
    buffer_load_dwordx4 v[84:87], v11, s[16:19], s30 offen offset:1024 sc1
    buffer_load_dwordx4 v[88:91], v9, s[16:19], s30 offen offset:2048 sc1
    s_add_u32 s30, s21, 2
    s_and_b32 s30, s30, 3
    s_mul_i32 s30, s30, 10240
    s_add_u32 s30, s30, s46
    buffer_load_dwordx4 v[92:95], v11, s[16:19], s30 offen sc1
    buffer_load_dwordx4 v[96:99], v11, s[16:19], s30 offen offset:1024 sc1
    buffer_load_dwordx4 v[100:103], v9, s[16:19], s30 offen offset:2048 sc1
    s_add_u32 s30, s21, 3
    s_and_b32 s30, s30, 3
    s_mul_i32 s30, s30, 10240
    s_add_u32 s30, s30, s46
    buffer_load_dwordx4 v[116:119], v11, s[16:19], s30 offen sc1
    buffer_load_dwordx4 v[120:123], v11, s[16:19], s30 offen offset:1024 sc1
    buffer_load_dwordx4 v[124:127], v9, s[16:19], s30 offen offset:2048 sc1
    s_mov_b32 s57, 1
OU_p2_q_95:
    s_mul_i32 s30, s21, 10240
    s_add_u32 s30, s30, s45
    buffer_store_dwordx4 v[224:227], v11, s[16:19], s30 offen sc1
    buffer_store_dwordx4 v[228:231], v11, s[16:19], s30 offen offset:1024 sc1
    buffer_store_dwordx4 v[232:235], v9, s[16:19], s30 offen offset:2048 sc1
    s_branch OU_p2_n_94
OU_p2_k_93:
    v_mov_b32 v104, v224
    v_mov_b32 v105, v225
    v_mov_b32 v106, v226
    v_mov_b32 v107, v227
    v_mov_b32 v108, v228
    v_mov_b32 v109, v229
    v_mov_b32 v110, v230
    v_mov_b32 v111, v231
    v_mov_b32 v112, v232
    v_mov_b32 v113, v233
    v_mov_b32 v114, v234
    v_mov_b32 v115, v235
    s_mov_b32 s58, s56
    s_mov_b32 s46, s45
    buffer_load_dword v10, v7, s[16:19], s50 offen sc1
    buffer_load_dword v10, v7, s[16:19], s50 offen sc1
    buffer_load_dword v10, v7, s[16:19], s50 offen sc1
OU_p2_n_94:
    s_add_u32 s56, s56, 1
    s_add_u32 s45, s45, 327680
    s_add_u32 s59, s59, 1
    s_add_u32 s44, s44, 393216
    s_cmp_lt_u32 s59, s24
    s_cbranch_scc1 OU_cold
    s_waitcnt vmcnt(0)
    v_mov_b32 v14, s56
    v_mov_b32 v15, 0
    s_mov_b64 exec, 1
    buffer_store_dword v14, v15, s[16:19], s49 offen sc1
    s_mov_b64 exec, -1
    s_cmp_eq_u32 s58, -1
    s_cbranch_scc1 OU_z_99
    s_cmp_eq_u32 s57, 1
    s_cbranch_scc1 OU_f3_h_100
    s_add_u32 s39, s58, 1
    s_cmp_ge_u32 s54, s39
    s_cbranch_scc1 OU_f3_wf_102
    v_min_u32 v14, 3, v1
    v_lshlrev_b32 v14, 2, v14
    v_mov_b32 v14, v8
OU_f3_wf_101:
    buffer_load_dword v15, v14, s[16:19], s48 offen sc1
    s_sub_u32 s34, s34, 1
    s_cbranch_scc1 G_end
    s_waitcnt vmcnt(0)
    s_nop 1
    v_min_u32_dpp v15, v15, v15 row_shl:1 row_mask:0xf bank_mask:0xf
    s_nop 1
    v_min_u32_dpp v15, v15, v15 row_shl:2 row_mask:0xf bank_mask:0xf
    s_nop 1
    v_readfirstlane_b32 s54, v15
    s_cmp_ge_u32 s54, s39
    s_cbranch_scc1 OU_f3_wf_102
    s_sleep 4
    s_branch OU_f3_wf_101
OU_f3_wf_102:
    s_add_u32 s30, s21, 1
    s_and_b32 s30, s30, 3
    s_mul_i32 s30, s30, 10240
    s_add_u32 s30, s30, s46
    buffer_load_dwordx4 v[80:83], v11, s[16:19], s30 offen sc1
    buffer_load_dwordx4 v[84:87], v11, s[16:19], s30 offen offset:1024 sc1
    buffer_load_dwordx4 v[88:91], v9, s[16:19], s30 offen offset:2048 sc1
    s_add_u32 s30, s21, 2
    s_and_b32 s30, s30, 3
    s_mul_i32 s30, s30, 10240
    s_add_u32 s30, s30, s46
    buffer_load_dwordx4 v[92:95], v11, s[16:19], s30 offen sc1
    buffer_load_dwordx4 v[96:99], v11, s[16:19], s30 offen offset:1024 sc1
    buffer_load_dwordx4 v[100:103], v9, s[16:19], s30 offen offset:2048 sc1
    s_add_u32 s30, s21, 3
    s_and_b32 s30, s30, 3
    s_mul_i32 s30, s30, 10240
    s_add_u32 s30, s30, s46
    buffer_load_dwordx4 v[116:119], v11, s[16:19], s30 offen sc1
    buffer_load_dwordx4 v[120:123], v11, s[16:19], s30 offen offset:1024 sc1
    buffer_load_dwordx4 v[124:127], v9, s[16:19], s30 offen offset:2048 sc1
    s_mov_b32 s57, 1
OU_f3_h_100:
    s_waitcnt vmcnt(0)
    s_mul_i32 s30, s58, 81920
    s_add_u32 s30, s30, s47
    v_pk_add_f32 v[104:105], v[104:105], v[80:81]
    v_pk_add_f32 v[106:107], v[106:107], v[82:83]
    v_pk_add_f32 v[108:109], v[108:109], v[84:85]
    v_pk_add_f32 v[110:111], v[110:111], v[86:87]
    v_pk_add_f32 v[112:113], v[112:113], v[88:89]
    v_pk_add_f32 v[114:115], v[114:115], v[90:91]
    v_pk_add_f32 v[104:105], v[104:105], v[92:93]
    v_pk_add_f32 v[106:107], v[106:107], v[94:95]
    v_pk_add_f32 v[108:109], v[108:109], v[96:97]
    v_pk_add_f32 v[110:111], v[110:111], v[98:99]
    v_pk_add_f32 v[112:113], v[112:113], v[100:101]
    v_pk_add_f32 v[114:115], v[114:115], v[102:103]
    v_pk_add_f32 v[104:105], v[104:105], v[116:117]
    v_pk_add_f32 v[106:107], v[106:107], v[118:119]
    v_pk_add_f32 v[108:109], v[108:109], v[120:121]
    v_pk_add_f32 v[110:111], v[110:111], v[122:123]
    v_pk_add_f32 v[112:113], v[112:113], v[124:125]
    v_pk_add_f32 v[114:115], v[114:115], v[126:127]
    v_cvt_pk_bf16_f32 v104, v104, v105
    v_cvt_pk_bf16_f32 v105, v106, v107
    buffer_store_dwordx2 v[104:105], v4, s[8:11], s30 offen
    v_cvt_pk_bf16_f32 v108, v108, v109
    v_cvt_pk_bf16_f32 v109, v110, v111
    buffer_store_dwordx2 v[108:109], v5, s[8:11], s30 offen
    v_cvt_pk_bf16_f32 v112, v112, v113
    v_cvt_pk_bf16_f32 v113, v114, v115
    buffer_store_dwordx2 v[112:113], v6, s[8:11], s30 offen
    s_mov_b32 s58, -1
    s_mov_b32 s57, 0
OU_z_99:
    s_waitcnt vmcnt(0)
G_end:
    s_endpgm
.section .rodata,"a"
.p2align 6
.amdhsa_kernel main_kernel
  .amdhsa_next_free_vgpr 512
  .amdhsa_next_free_sgpr 102
  .amdhsa_accum_offset 256
  .amdhsa_group_segment_fixed_size 0
  .amdhsa_kernarg_size 136
  .amdhsa_user_sgpr_count 2
  .amdhsa_user_sgpr_kernarg_segment_ptr 1
  .amdhsa_system_sgpr_workgroup_id_x 1
  .amdhsa_float_denorm_mode_32 3
.end_amdhsa_kernel
```
